```python
import torch

def _softmax(x, axis=-1):
    return torch.softmax(x, dim=axis)
def _gelu(x):
    return torch.nn.functional.gelu(x, approximate="tanh")
def _silu(x):
    return torch.nn.functional.silu(x)
def _sigmoid(x):
    return torch.sigmoid(x)
def _layernorm(x, axis=-1, eps=1e-5):
    m = x.mean(dim=axis, keepdim=True)
    v = x.var(dim=axis, keepdim=True, unbiased=False)
    return (x - m) / torch.sqrt(v + eps)
def _scatter_add(tgt, idx, src, axis=0):
    return tgt.clone().index_add_(axis, idx, src)
def _segment_sum(src, seg, n):
    out = torch.zeros((n,) + src.shape[1:], dtype=src.dtype)
    return out.index_add_(0, seg, src)
def _pad(x, pw):
    flat = tuple(v for pair in reversed(pw) for v in pair)
    return torch.nn.functional.pad(x, flat)

kernel_name = 'parallel_sum__grouped_kv_mqa__glu_gated_bilinear__prompt'

def setup_inputs():

    _w = (lambda a: (lambda t: t.to(torch.bfloat16) if t.is_floating_point() else t)(torch.as_tensor(a)))
    def _A_setup():
        B, S, D, H = 1, 2048, 576, 32
        Dh = D // H
        return {
            "x": _w((lambda *s: torch.randn(*s, dtype=torch.bfloat16) * 0.05)(B, S, D)),
            "wq": _w((lambda *s: torch.randn(*s, dtype=torch.bfloat16) * 0.05)(D, H * Dh)),
            "wk": _w((lambda *s: torch.randn(*s, dtype=torch.bfloat16) * 0.05)(D, Dh)),
            "wv": _w((lambda *s: torch.randn(*s, dtype=torch.bfloat16) * 0.05)(D, Dh)),
            "wo": _w((lambda *s: torch.randn(*s, dtype=torch.bfloat16) * 0.05)(H * Dh, D)),
        }
    _A_in = _A_setup()

    def _B_setup():
        B, S, D, F = 1, 2048, 576, 4608
        return {
            "x": _w((lambda *s: torch.randn(*s, dtype=torch.bfloat16) * 0.05)(B, S, D)),
            "w_gate": _w((lambda *s: torch.randn(*s, dtype=torch.bfloat16) * 0.4)(D, F) * (D ** -0.5)),
            "w_up": _w((lambda *s: torch.randn(*s, dtype=torch.bfloat16) * 0.4)(D, F) * (D ** -0.5)),
            "w_down": _w((lambda *s: torch.randn(*s, dtype=torch.bfloat16) * 0.4)(F, D) * (F ** -0.5)),
        }
    _B_in = _B_setup()

    return {
        "A_x": _A_in["x"],
        "A_wq": _A_in["wq"],
        "A_wk": _A_in["wk"],
        "A_wv": _A_in["wv"],
        "A_wo": _A_in["wo"],
        "B_x": _B_in["x"],
        "B_w_gate": _B_in["w_gate"],
        "B_w_up": _B_in["w_up"],
        "B_w_down": _B_in["w_down"],
    }

def reference(A_x, A_wq, A_wk, A_wv, A_wo, B_x, B_w_gate, B_w_up, B_w_down):
    def _A_ref(x, wq, wk, wv, wo):
        B, S, D = x.shape
        H = 32
        Dh = D // H
        q = (lambda x, *d: x.permute(*d))((x @ wq).reshape(B, S, H, Dh), 0, 2, 1, 3)
        k = x @ wk
        v = x @ wv
        scores = torch.einsum("bhqd,bkd->bhqk", q, k) * (Dh ** -0.5)
        p = _softmax(scores, axis=-1)
        o = torch.einsum("bhqk,bkd->bhqd", p, v)
        return (lambda x, *d: x.permute(*d))(o, 0, 2, 1, 3).reshape(B, S, H * Dh) @ wo

    def _B_ref(x, w_gate, w_up, w_down):
        g = torch.einsum("bsd,df->bsf", x, w_gate)
        u = torch.einsum("bsd,df->bsf", x, w_up)
        h = g * u
        return torch.einsum("bsf,fd->bsd", h, w_down)

    x = A_x
    xn = _layernorm(x, axis=-1)
    return x + _A_ref(xn, A_wq, A_wk, A_wv, A_wo) + _B_ref(xn, B_w_gate, B_w_up, B_w_down)
```

```asm
; @launch grid=(256,1,1) block=(256,1,1) lds=163840
.amdgcn_target "amdgcn-amd-amdhsa--gfx950"
.text
.globl parallel_sum__grouped_kv_mqa__glu_gated_bilinear__prompt_kernel
.p2align 8
.type parallel_sum__grouped_kv_mqa__glu_gated_bilinear__prompt_kernel,@function
parallel_sum__grouped_kv_mqa__glu_gated_bilinear__prompt_kernel:
  s_cmp_ge_u32 s2, 256
  s_cbranch_scc1 L_end
  s_load_dwordx16 s[40:55], s[0:1], 0
  s_load_dwordx8 s[56:63], s[0:1], 64
  v_lshrrev_b32 v16, 6, v0
  v_and_b32 v1, 63, v0
  v_readfirstlane_b32 s66, v16
  s_lshr_b32 s64, s2, 4
  s_and_b32 s65, s2, 7
  s_lshl_b32 s65, s65, 1
  s_bfe_u32 s78, s2, 0x10003
  s_add_u32 s65, s65, s78
  s_lshr_b32 s67, s66, 1
  s_and_b32 s68, s66, 1
  s_getpc_b64 s[4:5]
L_pc:
  s_lshr_b32 s78, s2, 3
  s_lshl_b32 s78, s78, 2
  s_add_u32 s78, s78, s66
  v_min_u32 v40, 9, v1
  v_lshlrev_b32 v40, 7, v40
  v_add_u32 v40, s78, v40
  v_lshlrev_b32 v40, 6, v40
  v_min_u32 v40, L_codeend-L_pc-4, v40
  v_mov_b32 v41, 0
  v_lshl_add_u64 v[40:41], v[40:41], 0, s[4:5]
  global_load_dword v42, v[40:41], off
  v_lshrrev_b32 v17, 5, v1
  v_bfe_u32 v22, v1, 4, 1
  v_bfe_u32 v23, v1, 2, 2
  v_lshl_add_u32 v23, v22, 3, v23
  s_lshl_b32 s79, s68, 4
  v_add_u32 v23, s79, v23
  v_mul_u32_u24 v23, 9216, v23
  v_and_b32 v24, 3, v1
  v_lshlrev_b32 v25, 1, v22
  v_xor_b32 v25, v24, v25
  v_lshl_add_u32 v23, v25, 4, v23
  s_mul_i32 s79, s65, 576
  s_bitcmp1_b32 s65, 0
  s_cselect_b32 s80, 64, 0
  s_cselect_b32 s81, 0, 512
  s_add_u32 s80, s80, s79
  s_add_u32 s81, s81, s79
  v_lshl_add_u32 v2, v17, 6, v23
  v_add_u32 v2, s80, v2
  v_mul_u32_u24 v25, 36864, v17
  v_add3_u32 v110, v23, v25, s81
  v_lshrrev_b32 v26, 3, v1
  s_lshl_b32 s79, s66, 3
  v_add_u32 v26, s79, v26
  v_mul_u32_u24 v26, 1152, v26
  v_lshrrev_b32 v27, 4, v1
  s_lshl_b32 s79, s68, 2
  v_add_u32 v27, s79, v27
  v_and_b32 v25, 7, v1
  v_xor_b32 v27, v25, v27
  v_lshl_add_u32 v4, v27, 4, v26
  s_and_b32 s79, s64, 3
  s_lshl_b32 s79, s79, 2
  s_lshr_b32 s92, 0x7520, s79
  s_and_b32 s92, s92, 15
  s_lshl_b32 s92, s92, 1
  s_lshl_b32 s95, s92, 6
  s_mul_i32 s101, s64, 147456
  s_add_u32 s72, s101, s95
  s_mul_i32 s70, s92, 294912
  s_add_u32 s73, s70, 36864
  s_lshl_b32 s74, s66, 11
  s_lshl_b32 s75, s66, 10
  s_add_u32 s76, s75, 131072
  s_add_u32 s75, s75, 16384
  s_mov_b32 s100, s75
  s_mov_b32 s10, 2359296
  s_mov_b32 s11, 0x20000
  s_mov_b32 s14, 5308416
  s_mov_b32 s15, 0x20000
  s_waitcnt lgkmcnt(0)
  s_mov_b32 s8, s40
  s_mov_b32 s9, s41
  s_mov_b32 m0, s76
  s_cmp_eq_u32 s67, 0
  buffer_load_dwordx4 v4, s[8:11], s72 offen lds
  s_cselect_b32 s12, s52, s54
  s_cselect_b32 s13, s53, s55
  s_add_u32 m0, s76, 4096
  s_add_u32 s72, s72, 36864
  buffer_load_dwordx4 v4, s[8:11], s72 offen lds
  s_add_u32 m0, s76, 8192
  s_add_u32 s72, s72, 36864
  buffer_load_dwordx4 v4, s[8:11], s72 offen lds
  s_add_u32 s72, s72, 36864
  s_add_u32 m0, s76, 12288
  s_nop 0
  buffer_load_dwordx4 v4, s[8:11], s72 offen lds
  s_add_u32 m0, s100, 0
  s_nop 0
  buffer_load_dwordx4 v110, s[12:15], s70 offen lds
  s_add_u32 m0, s74, 0
  s_nop 0
  buffer_load_dwordx4 v2, s[12:15], s70 offen offset:0 lds
  s_add_u32 m0, s74, 1024
  s_nop 0
  buffer_load_dwordx4 v2, s[12:15], s73 offen offset:0 lds
  s_add_u32 m0, s74, 8064
  s_nop 0
  buffer_load_dwordx4 v2, s[12:15], s70 offen offset:128 lds
  s_add_u32 m0, s74, 9088
  s_nop 0
  buffer_load_dwordx4 v2, s[12:15], s73 offen offset:128 lds
  s_lshl_b32 s79, s66, 6
  v_add_u32 v28, s79, v1
  v_mul_u32_u24 v29, 43691, v28
  v_lshrrev_b32 v29, 18, v29
  v_mul_u32_u24 v30, 6, v29
  v_sub_u32 v30, v28, v30
  v_cmp_le_u32 vcc, 3, v30
  v_mul_u32_u24 v29, 1152, v29
  s_mul_i32 s79, s65, 72
  v_cndmask_b32 v31, 0, 1, vcc
  v_mul_u32_u24 v32, 3, v31
  v_sub_u32 v32, v30, v32
  v_lshlrev_b32 v32, 4, v32
  v_min_u32 v32, 20, v32
  v_mul_u32_u24 v31, 36, v31
  v_add3_u32 v29, v29, v31, v32
  v_add_u32 v29, s79, v29
  v_lshrrev_b32 v30, 1, v1
  v_mul_u32_u24 v30, 36, v30
  v_and_b32 v31, 1, v1
  s_bitcmp1_b32 s65, 0
  s_cselect_b32 s79, 20, 0
  s_cselect_b32 s80, 1073741824, 16
  v_mul_lo_u32 v31, v31, s80
  v_add3_u32 v30, v30, v31, s79
  s_movk_i32 s77, 1152
  s_cmp_eq_u32 s66, 3
  s_cselect_b64 s[96:97], -1, 0
  s_cselect_b32 s77, s77, 36864
  v_cndmask_b32 v3, v29, v30, s[96:97]
  s_mul_i32 s71, s92, s77
  s_cmp_lt_u32 s65, 2
  s_cselect_b32 s16, s44, s46
  s_cselect_b32 s17, s45, s47
  s_cselect_b32 s98, s44, s46
  s_cselect_b32 s99, s45, s47
  s_cmp_lt_u32 s65, 4
  s_cselect_b32 s18, 20736, 0
  s_cmp_eq_u32 s66, 3
  s_cselect_b32 s16, s16, s42
  s_cselect_b32 s17, s17, s43
  s_cselect_b32 s18, s18, 663552
  s_mov_b32 s19, 0x20000
  v_lshrrev_b32 v30, 4, v1
  v_bfe_u32 v31, v1, 2, 2
  v_and_b32 v32, 3, v1
  v_and_b32 v33, 1, v30
  v_lshrrev_b32 v34, 1, v30
  v_lshl_add_u32 v35, v33, 2, v31
  v_lshlrev_b32 v35, 6, v35
  v_xor_b32 v33, s68, v33
  v_lshl_add_u32 v35, v33, 5, v35
  v_lshl_add_u32 v35, v32, 3, v35
  v_lshl_add_u32 v5, v34, 11, v35
  v_add_u32 v6, 61440, v5
  v_lshl_add_u32 v44, v34, 10, v35
  v_add_u32 v45, 61440, v44
  v_and_b32 v33, 15, v1
  v_lshrrev_b32 v34, 1, v33
  v_xor_b32 v34, v30, v34
  v_lshlrev_b32 v33, 7, v33
  v_lshl_add_u32 v33, v34, 4, v33
  s_lshl_b32 s79, s67, 13
  s_add_u32 s79, s79, 131072
  v_add_u32 v13, s79, v33
  v_xor_b32 v14, 64, v13
  v_lshl_add_u32 v33, v30, 3, v31
  v_mul_u32_u24 v34, 96, v33
  s_mul_i32 s79, s68, 48
  s_add_u32 s79, s79, 16384
  v_add_u32 v34, s79, v34
  v_lshl_add_u32 v7, v32, 3, v34
  v_add_u32 v34, 40, v34
  v_lshlrev_b32 v35, 5, v33
  s_lshl_b32 s79, s68, 4
  s_add_u32 s79, s79, 19448
  v_add_u32 v35, s79, v35
  v_min_u32 v36, 2, v32
  v_cmp_eq_u32 vcc, 0, v32
  v_lshl_add_u32 v35, v36, 3, v35
  v_add_u32 v8, 61440, v7
  v_cndmask_b32 v9, v35, v34, vcc
  v_add_u32 v34, 384, v34
  v_add_u32 v35, 128, v35
  v_cndmask_b32 v11, v35, v34, vcc
  v_add_u32 v10, 61440, v9
  v_add_u32 v12, 61440, v11
  s_mov_b64 exec, 0
  s_cmp_eq_u32 s66, 0
  s_cbranch_scc1 L_wc0_0
  s_cmp_eq_u32 s66, 1
  s_cbranch_scc1 L_wc0_1
  s_cmp_eq_u32 s66, 2
  s_cbranch_scc1 L_wc0_2
  s_branch L_wc0_3
L_wr0:
  s_mov_b64 exec, -1
  s_add_u32 s95, s95, 128
  s_cmp_eq_u32 s95, 1152
  s_cselect_b32 s95, 0, s95
  s_add_u32 s72, s101, s95
  s_add_u32 m0, s76, 16384
  s_nop 0
  buffer_load_dwordx4 v4, s[8:11], s72 offen lds
  s_add_u32 m0, s75, 20480
  s_nop 0
  buffer_load_dwordx4 v3, s[16:19], s71 offen lds
  s_add_u32 m0, s74, 20224
  s_nop 0
  buffer_load_dwordx4 v2, s[12:15], s70 offen offset:256 lds
  s_add_u32 m0, s74, 21248
  s_nop 0
  buffer_load_dwordx4 v2, s[12:15], s73 offen offset:256 lds
  s_add_u32 m0, s74, 28288
  s_nop 0
  buffer_load_dwordx4 v2, s[12:15], s70 offen offset:384 lds
  s_add_u32 m0, s74, 29312
  s_nop 0
  buffer_load_dwordx4 v2, s[12:15], s73 offen offset:384 lds
  s_lshl_b32 s78, s64, 7
  s_lshl_b32 s79, s65, 3
  s_lshl_b32 s80, s66, 1
  s_add_u32 s79, s79, s80
  s_add_u32 s78, s78, s79
  v_add_u32 v46, s78, v17
  v_mul_u32_u24 v18, 1152, v46
  v_and_b32 v19, 31, v1
  v_lshl_add_u32 v20, v19, 4, v18
  v_lshl_add_u32 v21, v19, 2, v18
  buffer_load_dwordx4 v[60:63], v20, s[8:11], 0 offen
  buffer_load_dwordx4 v[64:67], v20, s[8:11], 0 offen offset:512
  buffer_load_dword v68, v21, s[8:11], 0 offen offset:1024
  s_branch L_main
.p2align 12
L_main:
L_wc0_0:
L_pg0:
  s_cbranch_execz L_pg4
  s_waitcnt vmcnt(9)
  s_barrier
  ds_read_b64_tr_b16 a[176:177], v5 offset:0
  ds_read_b64_tr_b16 a[178:179], v5 offset:1024
  ds_read_b64_tr_b16 a[180:181], v5 offset:4096
  ds_read_b64_tr_b16 a[182:183], v5 offset:5120
  ds_read_b128 a[196:199], v13 offset:0
  ds_read_b128 a[200:203], v13 offset:2048
  ds_read_b128 a[204:207], v13 offset:4096
  ds_read_b128 a[208:211], v13 offset:6144
  ds_read_b64_tr_b16 a[184:185], v5 offset:512
  ds_read_b64_tr_b16 a[186:187], v5 offset:1536
  ds_read_b64_tr_b16 a[188:189], v5 offset:4608
  ds_read_b64_tr_b16 a[190:191], v5 offset:5632
  s_waitcnt lgkmcnt(7)
  v_mfma_f32_16x16x32_bf16 v[112:115], a[176:179], a[196:199], 0
  ds_read_b64_tr_b16 a[192:193], v5 offset:8192
  s_add_u32 s70, s70, 294912
  v_mfma_f32_16x16x32_bf16 a[0:3], a[180:183], a[196:199], 0
  ds_read_b128 a[212:215], v14 offset:0
  s_waitcnt lgkmcnt(8)
  v_mfma_f32_16x16x32_bf16 v[116:119], a[176:179], a[200:203], 0
  ds_read_b64_tr_b16 a[194:195], v5 offset:9216
  s_add_u32 s73, s73, 294912
  v_mfma_f32_16x16x32_bf16 a[4:7], a[180:183], a[200:203], 0
  ds_read_b128 a[216:219], v14 offset:2048
  s_waitcnt lgkmcnt(9)
  v_mfma_f32_16x16x32_bf16 v[120:123], a[176:179], a[204:207], 0
  ds_read_b64_tr_b16 a[244:245], v5 offset:12288
  s_add_u32 s71, s71, s77
  v_mfma_f32_16x16x32_bf16 a[8:11], a[180:183], a[204:207], 0
  ds_read_b128 a[220:223], v14 offset:4096
  s_waitcnt lgkmcnt(10)
  v_mfma_f32_16x16x32_bf16 v[124:127], a[176:179], a[208:211], 0
  ds_read_b64_tr_b16 a[246:247], v5 offset:13312
  s_add_u32 s72, s72, 36864
  v_mfma_f32_16x16x32_bf16 a[12:15], a[180:183], a[208:211], 0
  ds_read_b128 a[224:227], v14 offset:6144
  s_waitcnt lgkmcnt(8)
  v_mfma_f32_16x16x32_bf16 v[128:131], a[184:187], a[196:199], 0
  ds_read_b64_tr_b16 a[176:177], v5 offset:8704
  s_add_u32 m0, s76, 20480
  v_mfma_f32_16x16x32_bf16 a[16:19], a[188:191], a[196:199], 0
  buffer_load_dwordx4 v4, s[8:11], s72 offen lds
  s_add_u32 m0, s100, 40960
  v_mfma_f32_16x16x32_bf16 v[132:135], a[184:187], a[200:203], 0
  ds_read_b64_tr_b16 a[178:179], v5 offset:9728
  s_mov_b32 s20, s56
  v_mfma_f32_16x16x32_bf16 a[20:23], a[188:191], a[200:203], 0
  buffer_load_dwordx4 v110, s[12:15], s70 offen lds
  s_add_u32 m0, s74, 40960
  v_mfma_f32_16x16x32_bf16 v[136:139], a[184:187], a[204:207], 0
  ds_read_b64_tr_b16 a[180:181], v5 offset:12800
  s_mov_b32 s21, s57
  v_mfma_f32_16x16x32_bf16 a[24:27], a[188:191], a[204:207], 0
  s_mov_b32 s22, 5308416
  s_mov_b32 s23, 0x20000
  v_mfma_f32_16x16x32_bf16 v[140:143], a[184:187], a[208:211], 0
  ds_read_b64_tr_b16 a[182:183], v5 offset:13824
  s_mov_b32 s24, s48
  v_mfma_f32_16x16x32_bf16 a[28:31], a[188:191], a[208:211], 0
  s_mov_b32 s25, s49
  s_waitcnt lgkmcnt(5)
  v_mfma_f32_16x16x32_bf16 v[144:147], a[192:195], a[196:199], 0
  ds_read_b64_tr_b16 a[184:185], v44 offset:16384
  s_mov_b32 s26, 663552
  v_mfma_f32_16x16x32_bf16 a[32:35], a[244:247], a[196:199], 0
  buffer_load_dwordx4 v2, s[12:15], s70 offen offset:0 lds
  s_add_u32 m0, s74, 41984
  v_mfma_f32_16x16x32_bf16 v[148:151], a[192:195], a[200:203], 0
  ds_read_b64_tr_b16 a[186:187], v44 offset:16896
  s_mov_b32 s27, 0x20000
  v_mfma_f32_16x16x32_bf16 a[36:39], a[244:247], a[200:203], 0
  s_mov_b32 s28, s62
  s_mov_b32 s29, s63
  v_mfma_f32_16x16x32_bf16 v[152:155], a[192:195], a[204:207], 0
  ds_read_b64_tr_b16 a[188:189], v44 offset:18432
  s_mov_b32 s30, 0x10000000
  v_mfma_f32_16x16x32_bf16 a[40:43], a[244:247], a[204:207], 0
  buffer_load_dwordx4 v2, s[12:15], s73 offen offset:0 lds
  s_add_u32 m0, s74, 49024
  v_mfma_f32_16x16x32_bf16 v[156:159], a[192:195], a[208:211], 0
  ds_read_b64_tr_b16 a[190:191], v44 offset:18944
  s_mov_b32 s31, 0x20000
  v_mfma_f32_16x16x32_bf16 a[44:47], a[244:247], a[208:211], 0
  s_mov_b32 s32, s58
  s_waitcnt lgkmcnt(4)
  s_waitcnt vmcnt(7)
  s_barrier
  v_mfma_f32_16x16x32_bf16 v[160:163], a[176:179], a[196:199], 0
  ds_read_b64_tr_b16 a[192:193], v5 offset:20480
  s_mov_b32 s33, s59
  v_mfma_f32_16x16x32_bf16 a[48:51], a[180:183], a[196:199], 0
  s_mov_b32 s34, 2359296
  s_mov_b32 s35, 0x20000
  v_mfma_f32_16x16x32_bf16 v[164:167], a[176:179], a[200:203], 0
  ds_read_b64_tr_b16 a[194:195], v5 offset:21504
  s_mov_b32 s36, s60
  v_mfma_f32_16x16x32_bf16 a[52:55], a[180:183], a[200:203], 0
  buffer_load_dwordx4 v2, s[12:15], s70 offen offset:128 lds
  s_add_u32 m0, s74, 50048
  v_mfma_f32_16x16x32_bf16 v[168:171], a[176:179], a[204:207], 0
  ds_read_b64_tr_b16 a[244:245], v5 offset:24576
  s_mov_b32 s37, s61
  v_mfma_f32_16x16x32_bf16 a[56:59], a[180:183], a[204:207], 0
  s_mov_b32 s38, 256
  s_mov_b32 s39, 0x20000
  v_mfma_f32_16x16x32_bf16 v[172:175], a[176:179], a[208:211], 0
  ds_read_b64_tr_b16 a[246:247], v5 offset:25600
  s_lshl_b32 s79, s64, 2
  v_mfma_f32_16x16x32_bf16 a[60:63], a[180:183], a[208:211], 0
  buffer_load_dwordx4 v2, s[12:15], s73 offen offset:128 lds
  s_waitcnt lgkmcnt(4)
  v_mfma_f32_16x16x32_bf16 v[176:179], a[184:187], a[196:199], 0
  ds_read_b64_tr_b16 a[176:177], v5 offset:20992
  s_add_u32 s72, s72, 36864
  v_mfma_f32_16x16x32_bf16 a[64:67], a[188:191], a[196:199], 0
  s_add_u32 m0, s76, 24576
  s_add_u32 s79, s79, s66
  v_mfma_f32_16x16x32_bf16 v[180:183], a[184:187], a[200:203], 0
  ds_read_b64_tr_b16 a[178:179], v5 offset:22016
  s_min_u32 s78, s79, 59
  v_mfma_f32_16x16x32_bf16 a[68:71], a[188:191], a[200:203], 0
  s_mul_i32 s80, s78, 86
  s_lshr_b32 s80, s80, 8
  v_mfma_f32_16x16x32_bf16 v[184:187], a[184:187], a[204:207], 0
  ds_read_b64_tr_b16 a[180:181], v5 offset:25088
  s_mul_i32 s81, s80, 3
  v_mfma_f32_16x16x32_bf16 a[72:75], a[188:191], a[204:207], 0
  buffer_load_dwordx4 v4, s[8:11], s72 offen lds
  s_add_u32 m0, s75, 61440
  v_mfma_f32_16x16x32_bf16 v[188:191], a[184:187], a[208:211], 0
  ds_read_b64_tr_b16 a[182:183], v5 offset:26112
  s_sub_u32 s81, s78, s81
  v_mfma_f32_16x16x32_bf16 a[76:79], a[188:191], a[208:211], 0
  s_mul_i32 s78, s81, 2560
  s_waitcnt lgkmcnt(4)
  v_mfma_f32_16x16x32_bf16 v[192:195], a[192:195], a[196:199], 0
  ds_read_b64_tr_b16 a[184:185], v5 offset:28672
  s_cmp_lt_u32 s79, 60
  s_cselect_b32 s69, s78, 1073741824
  v_mfma_f32_16x16x32_bf16 a[80:83], a[244:247], a[196:199], 0
  buffer_load_dwordx4 v3, s[16:19], s71 offen lds
  s_add_u32 m0, s74, 61184
  v_mfma_f32_16x16x32_bf16 v[196:199], a[192:195], a[200:203], 0
  ds_read_b64_tr_b16 a[186:187], v5 offset:29696
  v_lshl_add_u32 v111, s80, 2, v32
  v_mfma_f32_16x16x32_bf16 a[84:87], a[244:247], a[200:203], 0
  s_lshl_b32 s81, s81, 4
  v_lshrrev_b32 v18, 2, v1
  v_mfma_f32_16x16x32_bf16 v[200:203], a[192:195], a[204:207], 0
  ds_read_b64_tr_b16 a[188:189], v5 offset:32768
  v_add_u32 v18, s81, v18
  v_mfma_f32_16x16x32_bf16 a[88:91], a[244:247], a[204:207], 0
  v_cmp_le_u32 vcc, 36, v111
  v_mov_b32 v48, s52
  v_mfma_f32_16x16x32_bf16 v[204:207], a[192:195], a[208:211], 0
  ds_read_b64_tr_b16 a[190:191], v5 offset:33792
  v_mov_b32 v49, s53
  v_mfma_f32_16x16x32_bf16 a[92:95], a[244:247], a[208:211], 0
  buffer_load_dwordx4 v2, s[12:15], s70 offen offset:256 lds
  s_waitcnt lgkmcnt(4)
  v_mfma_f32_16x16x32_bf16 v[208:211], a[176:179], a[196:199], 0
  ds_read_b64_tr_b16 a[192:193], v5 offset:29184
  s_add_u32 m0, s74, 62208
  v_mfma_f32_16x16x32_bf16 a[96:99], a[180:183], a[196:199], 0
  v_mov_b32 v20, s54
  v_mov_b32 v21, s55
  v_mfma_f32_16x16x32_bf16 v[212:215], a[176:179], a[200:203], 0
  ds_read_b64_tr_b16 a[194:195], v5 offset:30208
  v_cndmask_b32 v48, v48, v20, vcc
  v_mfma_f32_16x16x32_bf16 a[100:103], a[180:183], a[200:203], 0
  buffer_load_dwordx4 v2, s[12:15], s73 offen offset:256 lds
  s_add_u32 m0, s74, 69248
  v_mfma_f32_16x16x32_bf16 v[216:219], a[176:179], a[204:207], 0
  ds_read_b64_tr_b16 a[244:245], v5 offset:33280
  v_cndmask_b32 v49, v49, v21, vcc
  v_mfma_f32_16x16x32_bf16 a[104:107], a[180:183], a[204:207], 0
  v_cndmask_b32 v22, 0, 36, vcc
  v_sub_u32 v22, v111, v22
  v_mfma_f32_16x16x32_bf16 v[220:223], a[176:179], a[208:211], 0
  ds_read_b64_tr_b16 a[246:247], v5 offset:34304
  v_lshlrev_b32 v22, 4, v22
  v_mfma_f32_16x16x32_bf16 a[108:111], a[180:183], a[208:211], 0
  s_mul_i32 s79, s65, 576
  s_waitcnt lgkmcnt(4)
  v_mfma_f32_16x16x32_bf16 v[224:227], a[184:187], a[196:199], 0
  ds_read_b64_tr_b16 a[176:177], v7 offset:20480
  v_add_u32 v22, s79, v22
  v_mfma_f32_16x16x32_bf16 a[112:115], a[188:191], a[196:199], 0
  buffer_load_dwordx4 v2, s[12:15], s70 offen offset:384 lds
  s_add_u32 m0, s74, 70272
  v_mfma_f32_16x16x32_bf16 v[228:231], a[184:187], a[200:203], 0
  ds_read_b64_tr_b16 a[178:179], v7 offset:20864
  v_mov_b32 v50, 9216
  v_mfma_f32_16x16x32_bf16 a[116:119], a[188:191], a[200:203], 0
  v_cmp_le_u32 vcc, 0x48, v111
  v_mov_b32 v20, s42
  v_mfma_f32_16x16x32_bf16 v[232:235], a[184:187], a[204:207], 0
  ds_read_b64_tr_b16 a[180:181], v9 offset:20480
  v_mov_b32 v21, s43
  v_mfma_f32_16x16x32_bf16 a[120:123], a[188:191], a[204:207], 0
  buffer_load_dwordx4 v2, s[12:15], s73 offen offset:384 lds
  s_add_u32 s92, s92, 2
  v_mfma_f32_16x16x32_bf16 v[236:239], a[184:187], a[208:211], 0
  ds_read_b64_tr_b16 a[182:183], v11 offset:20480
  s_cmp_eq_u32 s92, 18
  s_cselect_b32 s92, 0, s92
  v_mfma_f32_16x16x32_bf16 a[124:127], a[188:191], a[208:211], 0
  s_mul_i32 s70, s92, 294912
  s_waitcnt lgkmcnt(4)
  s_waitcnt vmcnt(6)
  s_barrier
  v_mfma_f32_16x16x32_bf16 v[240:243], a[192:195], a[196:199], 0
  ds_read_b64_tr_b16 a[184:185], v5 offset:40960
  s_add_u32 s73, s70, 36864
  v_mfma_f32_16x16x32_bf16 a[128:131], a[244:247], a[196:199], 0
  s_mul_i32 s71, s92, s77
  s_add_u32 s72, s72, 36864
  v_mfma_f32_16x16x32_bf16 v[244:247], a[192:195], a[200:203], 0
  ds_read_b64_tr_b16 a[186:187], v5 offset:41984
  s_add_u32 m0, s76, 28672
  v_mfma_f32_16x16x32_bf16 a[132:135], a[244:247], a[200:203], 0
  buffer_load_dwordx4 v4, s[8:11], s72 offen lds
  s_add_u32 m0, s100, 81920
  v_mfma_f32_16x16x32_bf16 v[248:251], a[192:195], a[204:207], 0
  ds_read_b64_tr_b16 a[188:189], v5 offset:45056
  v_subrev_u32 v23, 0x48, v111
  v_mfma_f32_16x16x32_bf16 a[136:139], a[244:247], a[204:207], 0
  v_cndmask_b32 v48, v48, v20, vcc
  v_cndmask_b32 v49, v49, v21, vcc
  v_mfma_f32_16x16x32_bf16 v[252:255], a[192:195], a[208:211], 0
  ds_read_b64_tr_b16 a[190:191], v5 offset:46080
  v_mov_b32 v20, 1152
  v_mfma_f32_16x16x32_bf16 a[140:143], a[244:247], a[208:211], 0
  buffer_load_dwordx4 v110, s[12:15], s70 offen lds
  s_waitcnt lgkmcnt(4)
  v_mfma_f32_16x16x32_bf16 a[144:147], a[176:179], a[196:199], 0
  ds_read_b64_tr_b16 a[192:193], v5 offset:41472
  s_add_u32 m0, s74, 81920
  v_mfma_f32_16x16x32_bf16 a[160:163], a[180:183], a[196:199], 0
  v_cndmask_b32 v50, v50, v20, vcc
  v_cmp_le_u32 s[96:97], 3, v23
  v_mfma_f32_16x16x32_bf16 a[148:151], a[176:179], a[200:203], 0
  ds_read_b64_tr_b16 a[194:195], v5 offset:42496
  v_lshlrev_b32 v24, 4, v23
  v_mfma_f32_16x16x32_bf16 a[164:167], a[180:183], a[200:203], 0
  v_min_u32 v25, 20, v24
  v_subrev_u32 v24, 48, v24
  v_mfma_f32_16x16x32_bf16 a[152:155], a[176:179], a[204:207], 0
  ds_read_b64_tr_b16 a[244:245], v5 offset:45568
  v_min_u32 v24, 20, v24
  v_mfma_f32_16x16x32_bf16 a[168:171], a[180:183], a[204:207], 0
  buffer_load_dwordx4 v2, s[12:15], s70 offen offset:0 lds
  s_add_u32 m0, s74, 82944
  v_mfma_f32_16x16x32_bf16 a[156:159], a[176:179], a[208:211], 0
  ds_read_b64_tr_b16 a[246:247], v5 offset:46592
  v_add_u32 v24, 36, v24
  v_mfma_f32_16x16x32_bf16 a[172:175], a[180:183], a[208:211], 0
  v_cndmask_b32 v24, v25, v24, s[96:97]
  s_waitcnt lgkmcnt(4)
  v_mfma_f32_16x16x32_bf16 v[112:115], a[184:187], a[212:215], v[112:115]
  ds_read_b64_tr_b16 a[176:177], v5 offset:49152
  s_mul_i32 s79, s65, 72
  v_mfma_f32_16x16x32_bf16 a[0:3], a[188:191], a[212:215], a[0:3]
  buffer_load_dwordx4 v2, s[12:15], s73 offen offset:0 lds
  s_add_u32 m0, s74, 89984
  v_mfma_f32_16x16x32_bf16 v[116:119], a[184:187], a[216:219], v[116:119]
  ds_read_b64_tr_b16 a[178:179], v5 offset:50176
  v_add_u32 v24, s79, v24
  v_mfma_f32_16x16x32_bf16 a[4:7], a[188:191], a[216:219], a[4:7]
  v_cndmask_b32 v22, v22, v24, vcc
  v_cmp_le_u32 vcc, 0x4e, v111
  v_mfma_f32_16x16x32_bf16 v[120:123], a[184:187], a[220:223], v[120:123]
  ds_read_b64_tr_b16 a[180:181], v5 offset:53248
  v_mov_b32 v20, s98
  v_mfma_f32_16x16x32_bf16 a[8:11], a[188:191], a[220:223], a[8:11]
  v_mov_b32 v21, s99
  v_subrev_u32 v23, 0x4e, v111
  v_mfma_f32_16x16x32_bf16 v[124:127], a[184:187], a[224:227], v[124:127]
  ds_read_b64_tr_b16 a[182:183], v5 offset:54272
  v_cndmask_b32 v48, v48, v20, vcc
  v_mfma_f32_16x16x32_bf16 a[12:15], a[188:191], a[224:227], a[12:15]
  buffer_load_dwordx4 v2, s[12:15], s70 offen offset:128 lds
  s_waitcnt lgkmcnt(4)
  v_mfma_f32_16x16x32_bf16 v[128:131], a[192:195], a[212:215], v[128:131]
  ds_read_b64_tr_b16 a[184:185], v5 offset:49664
  s_add_u32 m0, s74, 91008
  v_mfma_f32_16x16x32_bf16 a[16:19], a[244:247], a[212:215], a[16:19]
  v_cndmask_b32 v49, v49, v21, vcc
  v_cndmask_b32 v50, v50, 36, vcc
  v_mfma_f32_16x16x32_bf16 v[132:135], a[192:195], a[216:219], v[132:135]
  ds_read_b64_tr_b16 a[186:187], v5 offset:50688
  s_bitcmp1_b32 s65, 0
  s_cselect_b32 s79, 20, 0
  s_cselect_b32 s80, 0, 16
  v_mfma_f32_16x16x32_bf16 a[20:23], a[244:247], a[216:219], a[20:23]
  buffer_load_dwordx4 v2, s[12:15], s73 offen offset:128 lds
  s_add_u32 s95, s95, 128
  v_mfma_f32_16x16x32_bf16 v[136:139], a[192:195], a[220:223], v[136:139]
  ds_read_b64_tr_b16 a[188:189], v5 offset:53760
  s_cmp_eq_u32 s95, 1152
  s_cselect_b32 s95, 0, s95
  v_mfma_f32_16x16x32_bf16 a[24:27], a[244:247], a[220:223], a[24:27]
  s_add_u32 s72, s101, s95
  s_add_u32 m0, s76, 0
  v_mfma_f32_16x16x32_bf16 v[140:143], a[192:195], a[224:227], v[140:143]
  ds_read_b64_tr_b16 a[190:191], v5 offset:54784
  v_mul_u32_u24 v23, s80, v23
  v_mfma_f32_16x16x32_bf16 a[28:31], a[244:247], a[224:227], a[28:31]
  v_add_u32 v23, s79, v23
  s_waitcnt lgkmcnt(4)
  v_mfma_f32_16x16x32_bf16 v[144:147], a[176:179], a[212:215], v[144:147]
  ds_read_b64_tr_b16 a[192:193], v44 offset:57344
  v_cndmask_b32 v22, v22, v23, vcc
  v_mfma_f32_16x16x32_bf16 a[32:35], a[180:183], a[212:215], a[32:35]
  buffer_load_dwordx4 v4, s[8:11], s72 offen lds
  s_add_u32 m0, s75, 102400
  v_mfma_f32_16x16x32_bf16 v[148:151], a[176:179], a[216:219], v[148:151]
  ds_read_b64_tr_b16 a[194:195], v44 offset:57856
  v_mad_u32_u24 v22, v18, v50, v22
  v_mfma_f32_16x16x32_bf16 a[36:39], a[180:183], a[216:219], a[36:39]
  v_add_co_u32 v48, vcc, v48, v22
  s_nop 1
  v_addc_co_u32 v49, vcc, 0, v49, vcc
  v_mfma_f32_16x16x32_bf16 v[152:155], a[176:179], a[220:223], v[152:155]
  ds_read_b64_tr_b16 a[244:245], v44 offset:59392
  v_mul_u32_u24 v50, 48, v50
  v_mfma_f32_16x16x32_bf16 a[40:43], a[180:183], a[220:223], a[40:43]
  buffer_load_dwordx4 v3, s[16:19], s71 offen lds
  s_add_u32 m0, s74, 102144
  v_mfma_f32_16x16x32_bf16 v[156:159], a[176:179], a[224:227], v[156:159]
  ds_read_b64_tr_b16 a[246:247], v44 offset:59904
  v_mov_b32 v51, 0
  v_mfma_f32_16x16x32_bf16 a[44:47], a[180:183], a[224:227], a[44:47]
  v_mov_b32 v52, 0
  s_waitcnt lgkmcnt(4)
  s_waitcnt vmcnt(8)
  s_barrier
  v_mfma_f32_16x16x32_bf16 v[160:163], a[184:187], a[212:215], v[160:163]
  ds_read_b64_tr_b16 a[176:177], v6 offset:0
  v_mov_b32 v53, 0
  v_mfma_f32_16x16x32_bf16 a[48:51], a[188:191], a[212:215], a[48:51]
  v_mov_b32 v54, 0
  v_mov_b32 v55, 0
  v_mfma_f32_16x16x32_bf16 v[164:167], a[184:187], a[216:219], v[164:167]
  ds_read_b64_tr_b16 a[178:179], v6 offset:1024
  v_mov_b32 v56, 0
  v_mfma_f32_16x16x32_bf16 a[52:55], a[188:191], a[216:219], a[52:55]
  buffer_load_dwordx4 v2, s[12:15], s70 offen offset:256 lds
  s_add_u32 m0, s74, 103168
  v_mfma_f32_16x16x32_bf16 v[168:171], a[184:187], a[220:223], v[168:171]
  ds_read_b64_tr_b16 a[180:181], v6 offset:4096
  v_mov_b32 v57, 0
  v_mfma_f32_16x16x32_bf16 a[56:59], a[188:191], a[220:223], a[56:59]
  v_mov_b32 v58, 0
  v_mov_b32 v59, 0
  v_mfma_f32_16x16x32_bf16 v[172:175], a[184:187], a[224:227], v[172:175]
  ds_read_b64_tr_b16 a[182:183], v6 offset:5120
  s_or_b32 s78, s2, s66
  v_mfma_f32_16x16x32_bf16 a[60:63], a[188:191], a[224:227], a[60:63]
  buffer_load_dwordx4 v2, s[12:15], s73 offen offset:256 lds
  s_waitcnt lgkmcnt(4)
  v_mfma_f32_16x16x32_bf16 v[176:179], a[192:195], a[212:215], v[176:179]
  ds_read_b64_tr_b16 a[184:185], v6 offset:512
  s_add_u32 m0, s74, 110208
  v_mfma_f32_16x16x32_bf16 a[64:67], a[244:247], a[212:215], a[64:67]
  s_cmp_eq_u32 s78, 0
  s_cselect_b32 s61, 0, 1073741824
  v_mfma_f32_16x16x32_bf16 v[180:183], a[192:195], a[216:219], v[180:183]
  ds_read_b64_tr_b16 a[186:187], v6 offset:1536
  s_add_u32 s78, s61, 1015808
  v_mfma_f32_16x16x32_bf16 a[68:71], a[244:247], a[216:219], a[68:71]
  buffer_load_dword v108, off, s[28:31], s78 sc1
  s_lshl_b32 s78, s64, 4
  v_mfma_f32_16x16x32_bf16 v[184:187], a[192:195], a[220:223], v[184:187]
  ds_read_b64_tr_b16 a[188:189], v6 offset:4608
  s_add_u32 s78, s78, s65
  v_mfma_f32_16x16x32_bf16 a[72:75], a[244:247], a[220:223], a[72:75]
  buffer_load_dwordx4 v2, s[12:15], s70 offen offset:384 lds
  s_add_u32 m0, s74, 111232
  v_mfma_f32_16x16x32_bf16 v[188:191], a[192:195], a[224:227], v[188:191]
  ds_read_b64_tr_b16 a[190:191], v6 offset:5632
  s_lshl_b32 s78, s78, 7
  v_mfma_f32_16x16x32_bf16 a[76:79], a[244:247], a[224:227], a[76:79]
  s_add_u32 s78, s78, 851968
  s_waitcnt lgkmcnt(4)
  v_mfma_f32_16x16x32_bf16 v[192:195], a[176:179], a[212:215], v[192:195]
  ds_read_b64_tr_b16 a[192:193], v6 offset:8192
  s_cmp_eq_u32 s66, 0
  s_cselect_b32 s60, s78, 1073741824
  v_mfma_f32_16x16x32_bf16 a[80:83], a[180:183], a[212:215], a[80:83]
  buffer_load_dwordx4 v2, s[12:15], s73 offen offset:384 lds
  s_add_u32 s70, s70, 294912
  v_mfma_f32_16x16x32_bf16 v[196:199], a[176:179], a[216:219], v[196:199]
  ds_read_b64_tr_b16 a[194:195], v6 offset:9216
  s_add_u32 s73, s73, 294912
  v_mfma_f32_16x16x32_bf16 a[84:87], a[180:183], a[216:219], a[84:87]
  s_add_u32 s71, s71, s77
  s_add_u32 s72, s72, 36864
  v_mfma_f32_16x16x32_bf16 v[200:203], a[176:179], a[220:223], v[200:203]
  ds_read_b64_tr_b16 a[244:245], v6 offset:12288
  s_add_u32 m0, s76, 4096
  v_mfma_f32_16x16x32_bf16 a[88:91], a[180:183], a[220:223], a[88:91]
  s_lshl_b32 s78, s64, 2
  s_lshl_b32 s79, s67, 1
  v_mfma_f32_16x16x32_bf16 v[204:207], a[176:179], a[224:227], v[204:207]
  ds_read_b64_tr_b16 a[246:247], v6 offset:13312
  s_add_u32 s78, s78, s79
  v_mfma_f32_16x16x32_bf16 a[92:95], a[180:183], a[224:227], a[92:95]
  buffer_load_dwordx4 v4, s[8:11], s72 offen lds
  s_waitcnt lgkmcnt(4)
  v_mfma_f32_16x16x32_bf16 v[208:211], a[184:187], a[212:215], v[208:211]
  ds_read_b64_tr_b16 a[176:177], v6 offset:8704
  s_add_u32 m0, s100, 0
  v_mfma_f32_16x16x32_bf16 a[96:99], a[188:191], a[212:215], a[96:99]
  s_mul_i32 s43, s78, 36864
  s_add_u32 s43, s43, 1310720
  v_mfma_f32_16x16x32_bf16 v[212:215], a[184:187], a[216:219], v[212:215]
  ds_read_b64_tr_b16 a[178:179], v6 offset:9728
  v_mov_b32 v40, -1
  v_mfma_f32_16x16x32_bf16 a[100:103], a[188:191], a[216:219], a[100:103]
  buffer_load_dwordx4 v110, s[12:15], s70 offen lds
  s_add_u32 m0, s74, 0
  v_mfma_f32_16x16x32_bf16 v[216:219], a[184:187], a[220:223], v[216:219]
  ds_read_b64_tr_b16 a[180:181], v6 offset:12800
  v_mov_b32 v41, -1
  v_mfma_f32_16x16x32_bf16 a[104:107], a[188:191], a[220:223], a[104:107]
  v_mov_b32 v42, -1
  v_mov_b32 v43, -1
  v_mfma_f32_16x16x32_bf16 v[220:223], a[184:187], a[224:227], v[220:223]
  ds_read_b64_tr_b16 a[182:183], v6 offset:13824
  s_lshl_b32 s80, s65, 1
  v_mfma_f32_16x16x32_bf16 a[108:111], a[188:191], a[224:227], a[108:111]
  s_add_u32 s80, s80, s68
  s_waitcnt lgkmcnt(4)
  v_mfma_f32_16x16x32_bf16 v[224:227], a[192:195], a[212:215], v[224:227]
  ds_read_b64_tr_b16 a[184:185], v8 offset:0
  s_lshl_b32 s81, s80, 10
  v_mfma_f32_16x16x32_bf16 a[112:115], a[244:247], a[212:215], a[112:115]
  buffer_load_dwordx4 v2, s[12:15], s70 offen offset:0 lds
  s_add_u32 m0, s74, 1024
  v_mfma_f32_16x16x32_bf16 v[228:231], a[192:195], a[216:219], v[228:231]
  ds_read_b64_tr_b16 a[186:187], v8 offset:384
  v_lshlrev_b32 v38, 4, v1
  v_mfma_f32_16x16x32_bf16 a[116:119], a[244:247], a[216:219], a[116:119]
  v_lshrrev_b32 v39, 5, v1
  v_mul_u32_u24 v39, 36736, v39
  v_mfma_f32_16x16x32_bf16 v[232:235], a[192:195], a[220:223], v[232:235]
  ds_read_b64_tr_b16 a[188:189], v10 offset:0
  v_lshl_add_u32 v39, v1, 2, v39
  v_mfma_f32_16x16x32_bf16 a[120:123], a[244:247], a[220:223], a[120:123]
  buffer_load_dwordx4 v2, s[12:15], s73 offen offset:0 lds
  s_add_u32 m0, s74, 8064
  v_mfma_f32_16x16x32_bf16 v[236:239], a[192:195], a[224:227], v[236:239]
  ds_read_b64_tr_b16 a[190:191], v12 offset:0
  v_add_u32 v38, s81, v38
  v_mfma_f32_16x16x32_bf16 a[124:127], a[244:247], a[224:227], a[124:127]
  s_lshl_b32 s81, s80, 7
  s_waitcnt lgkmcnt(4)
  s_waitcnt vmcnt(11)
  s_barrier
  v_mfma_f32_16x16x32_bf16 v[240:243], a[176:179], a[212:215], v[240:243]
  ds_read_b64_tr_b16 a[192:193], v6 offset:20480
  s_add_u32 s81, s81, 32768
  v_mfma_f32_16x16x32_bf16 a[128:131], a[180:183], a[212:215], a[128:131]
  ds_read_b128 a[228:231], v13 offset:16384
  v_add_u32 v39, s81, v39
  v_mfma_f32_16x16x32_bf16 v[244:247], a[176:179], a[216:219], v[244:247]
  ds_read_b64_tr_b16 a[194:195], v6 offset:21504
  s_movk_i32 s49, 128
  v_mfma_f32_16x16x32_bf16 a[132:135], a[180:183], a[216:219], a[132:135]
  ds_read_b128 a[232:235], v13 offset:18432
  s_and_b32 s79, s65, 1
  v_mfma_f32_16x16x32_bf16 v[248:251], a[176:179], a[220:223], v[248:251]
  ds_read_b64_tr_b16 a[244:245], v6 offset:24576
  s_mul_i32 s82, s79, 36864
  v_mfma_f32_16x16x32_bf16 a[136:139], a[180:183], a[220:223], a[136:139]
  ds_read_b128 a[236:239], v13 offset:20480
  s_add_u32 s83, s82, 36864
  v_mfma_f32_16x16x32_bf16 v[252:255], a[176:179], a[224:227], v[252:255]
  ds_read_b64_tr_b16 a[246:247], v6 offset:25600
  s_add_u32 s84, s82, 73728
  v_mfma_f32_16x16x32_bf16 a[140:143], a[180:183], a[224:227], a[140:143]
  ds_read_b128 a[240:243], v13 offset:22528
  s_waitcnt lgkmcnt(8)
  v_mfma_f32_16x16x32_bf16 a[144:147], a[184:187], a[212:215], a[144:147]
  ds_read_b64_tr_b16 a[176:177], v6 offset:20992
  s_add_u32 s85, s82, 110592
  v_mfma_f32_16x16x32_bf16 a[160:163], a[188:191], a[212:215], a[160:163]
  ds_read_b128 v[84:87], v14 offset:16384
  s_add_u32 s87, s82, 147456
  v_mfma_f32_16x16x32_bf16 a[148:151], a[184:187], a[216:219], a[148:151]
  ds_read_b64_tr_b16 a[178:179], v6 offset:22016
  s_add_u32 s88, s82, 184320
  v_mfma_f32_16x16x32_bf16 a[164:167], a[188:191], a[216:219], a[164:167]
  ds_read_b128 v[88:91], v14 offset:18432
  s_add_u32 s89, s82, 221184
  v_mfma_f32_16x16x32_bf16 a[152:155], a[184:187], a[220:223], a[152:155]
  ds_read_b64_tr_b16 a[180:181], v6 offset:25088
  s_add_u32 s90, s82, 258048
  v_mfma_f32_16x16x32_bf16 a[168:171], a[188:191], a[220:223], a[168:171]
  ds_read_b128 v[92:95], v14 offset:20480
  s_bitcmp1_b32 s65, 0
  s_cselect_b32 s86, 0, 294912
  v_mfma_f32_16x16x32_bf16 a[156:159], a[184:187], a[224:227], a[156:159]
  ds_read_b64_tr_b16 a[182:183], v6 offset:26112
  s_and_b32 s91, s64, 3
  v_mfma_f32_16x16x32_bf16 a[172:175], a[188:191], a[224:227], a[172:175]
  ds_read_b128 v[96:99], v14 offset:22528
  s_waitcnt lgkmcnt(9)
  v_mfma_f32_16x16x32_bf16 v[112:115], a[192:195], a[228:231], v[112:115]
  ds_read_b64_tr_b16 a[184:185], v6 offset:28672
  s_mov_b32 s44, s91
  v_mfma_f32_16x16x32_bf16 a[0:3], a[244:247], a[228:231], a[0:3]
  buffer_load_dwordx4 v2, s[12:15], s70 offen offset:128 lds
  s_add_u32 m0, s74, 9088
  v_mfma_f32_16x16x32_bf16 v[116:119], a[192:195], a[232:235], v[116:119]
  ds_read_b64_tr_b16 a[186:187], v6 offset:29696
  s_mul_i32 s93, s64, 2359296
  v_mfma_f32_16x16x32_bf16 a[4:7], a[244:247], a[232:235], a[4:7]
  buffer_load_dwordx4 v2, s[12:15], s73 offen offset:128 lds
  s_add_u32 s72, s72, 36864
  v_mfma_f32_16x16x32_bf16 v[120:123], a[192:195], a[236:239], v[120:123]
  ds_read_b64_tr_b16 a[188:189], v6 offset:32768
  s_add_u32 m0, s76, 8192
  v_mfma_f32_16x16x32_bf16 a[8:11], a[244:247], a[236:239], a[8:11]
  s_lshl_b32 s79, s65, 13
  s_waitcnt lgkmcnt(11)
  v_mfma_f32_16x16x32_bf16 v[124:127], a[192:195], a[240:243], v[124:127]
  ds_read_b64_tr_b16 a[190:191], v6 offset:33792
  s_add_u32 s93, s93, s79
  v_mfma_f32_16x16x32_bf16 a[12:15], a[244:247], a[240:243], a[12:15]
  s_lshl_b32 s79, s67, 12
  s_waitcnt lgkmcnt(5)
  v_mfma_f32_16x16x32_bf16 v[128:131], a[176:179], a[228:231], v[128:131]
  ds_read_b64_tr_b16 a[192:193], v6 offset:29184
  s_add_u32 s93, s93, s79
  v_mfma_f32_16x16x32_bf16 a[16:19], a[180:183], a[228:231], a[16:19]
  buffer_load_dwordx4 v4, s[8:11], s72 offen lds
  s_add_u32 m0, s75, 20480
  v_mfma_f32_16x16x32_bf16 v[132:135], a[176:179], a[232:235], v[132:135]
  ds_read_b64_tr_b16 a[194:195], v6 offset:30208
  s_add_u32 s93, s93, 4194304
  v_mfma_f32_16x16x32_bf16 a[20:23], a[180:183], a[232:235], a[20:23]
  s_lshl_b32 s79, s68, 17
  s_add_u32 s3, s93, s79
  v_mfma_f32_16x16x32_bf16 v[136:139], a[176:179], a[236:239], v[136:139]
  ds_read_b64_tr_b16 a[244:245], v6 offset:33280
  s_add_u32 s3, s3, 1048576
  v_mfma_f32_16x16x32_bf16 a[24:27], a[180:183], a[236:239], a[24:27]
  buffer_load_dwordx4 v3, s[16:19], s71 offen lds
  s_add_u32 m0, s74, 20224
  v_mfma_f32_16x16x32_bf16 v[140:143], a[176:179], a[240:243], v[140:143]
  ds_read_b64_tr_b16 a[246:247], v6 offset:34304
  s_mul_i32 s79, s68, 1310720
  v_mfma_f32_16x16x32_bf16 a[28:31], a[180:183], a[240:243], a[28:31]
  s_add_u32 s93, s93, s79
  s_waitcnt lgkmcnt(4)
  v_mfma_f32_16x16x32_bf16 v[144:147], a[184:187], a[228:231], v[144:147]
  ds_read_b64_tr_b16 a[176:177], v45 offset:36864
  v_bfe_u32 v28, v1, 4, 1
  v_mfma_f32_16x16x32_bf16 a[32:35], a[188:191], a[228:231], a[32:35]
  v_and_b32 v30, 3, v1
  v_lshrrev_b32 v31, 5, v1
  v_mfma_f32_16x16x32_bf16 v[148:151], a[184:187], a[232:235], v[148:151]
  ds_read_b64_tr_b16 a[178:179], v45 offset:37376
  v_bfe_u32 v32, v1, 2, 3
  v_mfma_f32_16x16x32_bf16 a[36:39], a[188:191], a[232:235], a[36:39]
  buffer_load_dwordx4 v2, s[12:15], s70 offen offset:256 lds
  s_add_u32 m0, s74, 21248
  v_mfma_f32_16x16x32_bf16 v[152:155], a[184:187], a[236:239], v[152:155]
  ds_read_b64_tr_b16 a[180:181], v45 offset:38912
  v_lshlrev_b32 v32, 6, v32
  v_mfma_f32_16x16x32_bf16 a[40:43], a[188:191], a[236:239], a[40:43]
  v_lshl_add_u32 v32, v31, 10, v32
  v_lshl_add_u32 v32, v28, 5, v32
  v_mfma_f32_16x16x32_bf16 v[156:159], a[184:187], a[240:243], v[156:159]
  ds_read_b64_tr_b16 a[182:183], v45 offset:39424
  v_lshl_add_u32 v32, v30, 3, v32
  v_mfma_f32_16x16x32_bf16 a[44:47], a[188:191], a[240:243], a[44:47]
  buffer_load_dwordx4 v2, s[12:15], s73 offen offset:256 lds
  s_waitcnt lgkmcnt(4)
  s_waitcnt vmcnt(10)
  s_barrier
  v_mfma_f32_16x16x32_bf16 v[160:163], a[192:195], a[228:231], v[160:163]
  ds_read_b64_tr_b16 a[184:185], v6 offset:40960
  s_add_u32 m0, s74, 28288
  v_mfma_f32_16x16x32_bf16 a[48:51], a[244:247], a[228:231], a[48:51]
L_wc0_1:
L_pg1:
  s_cbranch_execz L_pg5
  s_mul_i32 s79, s68, 6144
  v_add_u32 v16, s79, v32
  v_mfma_f32_16x16x32_bf16 v[164:167], a[192:195], a[232:235], v[164:167]
  ds_read_b64_tr_b16 a[186:187], v6 offset:41984
  v_xor_b32 v17, 2048, v16
  v_mfma_f32_16x16x32_bf16 a[52:55], a[244:247], a[232:235], a[52:55]
  v_xor_b32 v18, 32, v16
  v_xor_b32 v19, 2080, v16
  v_mfma_f32_16x16x32_bf16 v[168:171], a[192:195], a[236:239], v[168:171]
  ds_read_b64_tr_b16 a[188:189], v6 offset:45056
  v_add_u32 v20, 61440, v16
  v_mfma_f32_16x16x32_bf16 a[56:59], a[244:247], a[236:239], a[56:59]
  buffer_load_dwordx4 v2, s[12:15], s70 offen offset:384 lds
  s_add_u32 m0, s74, 29312
  v_mfma_f32_16x16x32_bf16 v[172:175], a[192:195], a[240:243], v[172:175]
  ds_read_b64_tr_b16 a[190:191], v6 offset:46080
  v_add_u32 v21, 61440, v17
  v_mfma_f32_16x16x32_bf16 a[60:63], a[244:247], a[240:243], a[60:63]
  v_add_u32 v22, 61440, v18
  s_waitcnt lgkmcnt(4)
  v_mfma_f32_16x16x32_bf16 v[176:179], a[176:179], a[228:231], v[176:179]
  ds_read_b64_tr_b16 a[192:193], v6 offset:41472
  v_add_u32 v23, 61440, v19
  v_mfma_f32_16x16x32_bf16 a[64:67], a[180:183], a[228:231], a[64:67]
  buffer_load_dwordx4 v2, s[12:15], s73 offen offset:384 lds
  s_add_u32 s92, s92, 2
  v_mfma_f32_16x16x32_bf16 v[180:183], a[176:179], a[232:235], v[180:183]
  ds_read_b64_tr_b16 a[194:195], v6 offset:42496
  s_cmp_eq_u32 s92, 18
  s_cselect_b32 s92, 0, s92
  v_mfma_f32_16x16x32_bf16 a[68:71], a[180:183], a[232:235], a[68:71]
  s_mul_i32 s70, s92, 294912
  s_add_u32 s73, s70, 36864
  v_mfma_f32_16x16x32_bf16 v[184:187], a[176:179], a[236:239], v[184:187]
  ds_read_b64_tr_b16 a[244:245], v6 offset:45568
  s_mul_i32 s71, s92, s77
  v_mfma_f32_16x16x32_bf16 a[72:75], a[180:183], a[236:239], a[72:75]
  s_add_u32 s72, s72, 36864
  s_add_u32 m0, s76, 12288
  v_mfma_f32_16x16x32_bf16 v[188:191], a[176:179], a[240:243], v[188:191]
  ds_read_b64_tr_b16 a[246:247], v6 offset:46592
  v_mfma_f32_16x16x32_bf16 a[76:79], a[180:183], a[240:243], a[76:79]
  buffer_load_dwordx4 v4, s[8:11], s72 offen lds
  s_waitcnt lgkmcnt(4)
  v_mfma_f32_16x16x32_bf16 v[192:195], a[184:187], a[228:231], v[192:195]
  ds_read_b64_tr_b16 a[176:177], v6 offset:49152
  s_add_u32 s95, s95, 128
  v_mfma_f32_16x16x32_bf16 a[80:83], a[188:191], a[228:231], a[80:83]
  s_cmp_eq_u32 s95, 1152
  s_cselect_b32 s95, 0, s95
  v_mfma_f32_16x16x32_bf16 v[196:199], a[184:187], a[232:235], v[196:199]
  ds_read_b64_tr_b16 a[178:179], v6 offset:50176
  s_add_u32 s72, s101, s95
  v_mfma_f32_16x16x32_bf16 a[84:87], a[188:191], a[232:235], a[84:87]
  s_add_u32 m0, s76, 16384
  v_add_u32 v108, 1, v108
  v_mfma_f32_16x16x32_bf16 v[200:203], a[184:187], a[236:239], v[200:203]
  ds_read_b64_tr_b16 a[180:181], v6 offset:53248
  v_max_u32 v108, 1, v108
  v_mfma_f32_16x16x32_bf16 a[88:91], a[188:191], a[236:239], a[88:91]
  buffer_load_dwordx4 v4, s[8:11], s72 offen lds
  s_add_u32 m0, s100, 40960
  v_mfma_f32_16x16x32_bf16 v[204:207], a[184:187], a[240:243], v[204:207]
  ds_read_b64_tr_b16 a[182:183], v6 offset:54272
  s_add_u32 s78, s61, 1015808
  s_mov_b64 exec, 1
  buffer_store_dword v108, off, s[36:39], s61 sc1
  buffer_store_dword v108, off, s[28:31], s78 sc1
  s_mov_b64 exec, -1
  v_mfma_f32_16x16x32_bf16 a[92:95], a[188:191], a[240:243], a[92:95]
  v_lshlrev_b32 v69, 16, v60
  s_waitcnt lgkmcnt(4)
  v_mfma_f32_16x16x32_bf16 v[208:211], a[192:195], a[228:231], v[208:211]
  ds_read_b64_tr_b16 a[184:185], v6 offset:49664
  v_and_b32 v60, 0xffff0000, v60
  v_mfma_f32_16x16x32_bf16 a[96:99], a[244:247], a[228:231], a[96:99]
  buffer_load_dwordx4 v110, s[12:15], s70 offen lds
  s_add_u32 m0, s74, 40960
  v_mfma_f32_16x16x32_bf16 v[212:215], a[192:195], a[232:235], v[212:215]
  ds_read_b64_tr_b16 a[186:187], v6 offset:50688
  v_lshlrev_b32 v70, 16, v61
  v_mfma_f32_16x16x32_bf16 a[100:103], a[244:247], a[232:235], a[100:103]
  v_and_b32 v61, 0xffff0000, v61
  v_lshlrev_b32 v71, 16, v62
  v_mfma_f32_16x16x32_bf16 v[216:219], a[192:195], a[236:239], v[216:219]
  ds_read_b64_tr_b16 a[188:189], v6 offset:53760
  v_and_b32 v62, 0xffff0000, v62
  v_mfma_f32_16x16x32_bf16 a[104:107], a[244:247], a[236:239], a[104:107]
  buffer_load_dwordx4 v2, s[12:15], s70 offen offset:0 lds
  s_add_u32 m0, s74, 41984
  v_mfma_f32_16x16x32_bf16 v[220:223], a[192:195], a[240:243], v[220:223]
  ds_read_b64_tr_b16 a[190:191], v6 offset:54784
  v_lshlrev_b32 v72, 16, v63
  v_mfma_f32_16x16x32_bf16 a[108:111], a[244:247], a[240:243], a[108:111]
  v_and_b32 v63, 0xffff0000, v63
  s_waitcnt lgkmcnt(4)
  v_mfma_f32_16x16x32_bf16 v[224:227], a[176:179], a[228:231], v[224:227]
  ds_read_b64_tr_b16 a[192:193], v8 offset:40960
  v_lshlrev_b32 v73, 16, v64
  v_mfma_f32_16x16x32_bf16 a[112:115], a[180:183], a[228:231], a[112:115]
  v_and_b32 v64, 0xffff0000, v64
  v_lshlrev_b32 v74, 16, v65
  v_mfma_f32_16x16x32_bf16 v[228:231], a[176:179], a[232:235], v[228:231]
  ds_read_b64_tr_b16 a[194:195], v8 offset:41344
  v_and_b32 v65, 0xffff0000, v65
  v_mfma_f32_16x16x32_bf16 a[116:119], a[180:183], a[232:235], a[116:119]
  buffer_load_dwordx4 v2, s[12:15], s73 offen offset:0 lds
  s_add_u32 m0, s74, 49024
  v_mfma_f32_16x16x32_bf16 v[232:235], a[176:179], a[236:239], v[232:235]
  ds_read_b64_tr_b16 a[244:245], v10 offset:40960
  v_lshlrev_b32 v75, 16, v66
  v_mfma_f32_16x16x32_bf16 a[120:123], a[180:183], a[236:239], a[120:123]
  v_and_b32 v66, 0xffff0000, v66
  v_lshlrev_b32 v76, 16, v67
  v_mfma_f32_16x16x32_bf16 v[236:239], a[176:179], a[240:243], v[236:239]
  ds_read_b64_tr_b16 a[246:247], v12 offset:40960
  v_and_b32 v67, 0xffff0000, v67
  v_mfma_f32_16x16x32_bf16 a[124:127], a[180:183], a[240:243], a[124:127]
  buffer_load_dwordx4 v2, s[12:15], s70 offen offset:128 lds
  s_waitcnt lgkmcnt(4)
  s_waitcnt vmcnt(14)
  s_barrier
  v_mfma_f32_16x16x32_bf16 v[240:243], a[184:187], a[228:231], v[240:243]
  ds_read_b64_tr_b16 a[176:177], v5 offset:0
  s_add_u32 m0, s74, 50048
  v_mfma_f32_16x16x32_bf16 a[128:131], a[188:191], a[228:231], a[128:131]
  v_lshlrev_b32 v77, 16, v68
  v_and_b32 v68, 0xffff0000, v68
  v_mfma_f32_16x16x32_bf16 v[244:247], a[184:187], a[232:235], v[244:247]
  ds_read_b64_tr_b16 a[178:179], v5 offset:1024
  v_add_f32 v36, v60, v61
  v_mfma_f32_16x16x32_bf16 a[132:135], a[188:191], a[232:235], a[132:135]
  v_add_f32 v37, v62, v63
  v_add_f32 v36, v36, v64
  v_mfma_f32_16x16x32_bf16 v[248:251], a[184:187], a[236:239], v[248:251]
  ds_read_b64_tr_b16 a[180:181], v5 offset:4096
  v_add_f32 v37, v37, v65
  v_mfma_f32_16x16x32_bf16 a[136:139], a[188:191], a[236:239], a[136:139]
  buffer_load_dwordx4 v2, s[12:15], s73 offen offset:128 lds
  s_add_u32 s72, s72, 36864
  v_mfma_f32_16x16x32_bf16 v[252:255], a[184:187], a[240:243], v[252:255]
  ds_read_b64_tr_b16 a[182:183], v5 offset:5120
  s_add_u32 m0, s76, 20480
  v_mfma_f32_16x16x32_bf16 a[140:143], a[188:191], a[240:243], a[140:143]
  v_add_f32 v36, v36, v66
  s_waitcnt lgkmcnt(4)
  v_mfma_f32_16x16x32_bf16 a[144:147], a[192:195], a[228:231], a[144:147]
  ds_read_b64_tr_b16 a[184:185], v5 offset:512
  v_add_f32 v37, v37, v67
  v_mfma_f32_16x16x32_bf16 a[160:163], a[244:247], a[228:231], a[160:163]
  buffer_load_dwordx4 v4, s[8:11], s72 offen lds
  s_add_u32 m0, s75, 61440
  v_mfma_f32_16x16x32_bf16 a[148:151], a[192:195], a[232:235], a[148:151]
  ds_read_b64_tr_b16 a[186:187], v5 offset:1536
  v_add_f32 v36, v36, v68
  v_mfma_f32_16x16x32_bf16 a[164:167], a[244:247], a[232:235], a[164:167]
  v_add_f32 v37, v37, v69
  v_add_f32 v36, v36, v70
  v_mfma_f32_16x16x32_bf16 a[152:155], a[192:195], a[236:239], a[152:155]
  ds_read_b64_tr_b16 a[188:189], v5 offset:4608
  v_add_f32 v37, v37, v71
  v_mfma_f32_16x16x32_bf16 a[168:171], a[244:247], a[236:239], a[168:171]
  v_add_f32 v36, v36, v72
  v_add_f32 v37, v37, v73
  v_mfma_f32_16x16x32_bf16 a[156:159], a[192:195], a[240:243], a[156:159]
  ds_read_b64_tr_b16 a[190:191], v5 offset:5632
  v_add_f32 v36, v36, v74
  v_mfma_f32_16x16x32_bf16 a[172:175], a[244:247], a[240:243], a[172:175]
  buffer_load_dwordx4 v3, s[16:19], s71 offen lds
  s_waitcnt lgkmcnt(4)
  v_mfma_f32_16x16x32_bf16 v[112:115], a[176:179], v[84:87], v[112:115]
  ds_read_b64_tr_b16 a[192:193], v5 offset:8192
  s_add_u32 m0, s74, 61184
  v_mfma_f32_16x16x32_bf16 a[0:3], a[180:183], v[84:87], a[0:3]
  v_add_f32 v37, v37, v75
  v_add_f32 v36, v36, v76
  v_mfma_f32_16x16x32_bf16 v[116:119], a[176:179], v[88:91], v[116:119]
  ds_read_b64_tr_b16 a[194:195], v5 offset:9216
  v_add_f32 v37, v37, v77
  v_mfma_f32_16x16x32_bf16 a[4:7], a[180:183], v[88:91], a[4:7]
  buffer_load_dwordx4 v2, s[12:15], s70 offen offset:256 lds
  s_add_u32 m0, s74, 62208
  v_mfma_f32_16x16x32_bf16 v[120:123], a[176:179], v[92:95], v[120:123]
  ds_read_b64_tr_b16 a[244:245], v5 offset:12288
  v_add_f32 v36, v36, v37
  v_mfma_f32_16x16x32_bf16 a[8:11], a[180:183], v[92:95], a[8:11]
  s_nop 0
  v_add_f32_dpp v36, v36, v36 row_ror:8 row_mask:0xf bank_mask:0xf
  v_mfma_f32_16x16x32_bf16 v[124:127], a[176:179], v[96:99], v[124:127]
  ds_read_b64_tr_b16 a[246:247], v5 offset:13312
  s_nop 0
  v_mfma_f32_16x16x32_bf16 a[12:15], a[180:183], v[96:99], a[12:15]
  v_add_f32_dpp v36, v36, v36 row_ror:4 row_mask:0xf bank_mask:0xf
  s_waitcnt lgkmcnt(4)
  v_mfma_f32_16x16x32_bf16 v[128:131], a[184:187], v[84:87], v[128:131]
  ds_read_b64_tr_b16 a[176:177], v5 offset:8704
  s_nop 0
  v_mfma_f32_16x16x32_bf16 a[16:19], a[188:191], v[84:87], a[16:19]
  buffer_load_dwordx4 v2, s[12:15], s73 offen offset:256 lds
  s_add_u32 m0, s74, 69248
  v_mfma_f32_16x16x32_bf16 v[132:135], a[184:187], v[88:91], v[132:135]
  ds_read_b64_tr_b16 a[178:179], v5 offset:9728
  v_add_f32_dpp v36, v36, v36 row_ror:2 row_mask:0xf bank_mask:0xf
  v_mfma_f32_16x16x32_bf16 a[20:23], a[188:191], v[88:91], a[20:23]
  s_nop 0
  v_add_f32_dpp v36, v36, v36 row_ror:1 row_mask:0xf bank_mask:0xf
  v_mfma_f32_16x16x32_bf16 v[136:139], a[184:187], v[92:95], v[136:139]
  ds_read_b64_tr_b16 a[180:181], v5 offset:12800
  v_mov_b32 v37, v36
  v_mfma_f32_16x16x32_bf16 a[24:27], a[188:191], v[92:95], a[24:27]
  buffer_load_dwordx4 v2, s[12:15], s70 offen offset:384 lds
  s_add_u32 m0, s74, 70272
  v_mfma_f32_16x16x32_bf16 v[140:143], a[184:187], v[96:99], v[140:143]
  ds_read_b64_tr_b16 a[182:183], v5 offset:13824
  s_nop 0
  v_mfma_f32_16x16x32_bf16 a[28:31], a[188:191], v[96:99], a[28:31]
  v_permlane16_swap_b32 v36, v37
  s_waitcnt lgkmcnt(4)
  v_mfma_f32_16x16x32_bf16 v[144:147], a[192:195], v[84:87], v[144:147]
  ds_read_b64_tr_b16 a[184:185], v44 offset:16384
  v_add_f32 v36, v36, v37
  v_mfma_f32_16x16x32_bf16 a[32:35], a[244:247], v[84:87], a[32:35]
  v_mul_f32 v36, 0x3ae38e39, v36
  v_sub_f32 v60, v60, v36
  v_mfma_f32_16x16x32_bf16 v[148:151], a[192:195], v[88:91], v[148:151]
  ds_read_b64_tr_b16 a[186:187], v44 offset:16896
  v_sub_f32 v61, v61, v36
  v_mfma_f32_16x16x32_bf16 a[36:39], a[244:247], v[88:91], a[36:39]
  buffer_load_dwordx4 v2, s[12:15], s73 offen offset:384 lds
  s_add_u32 s70, s70, 294912
  v_mfma_f32_16x16x32_bf16 v[152:155], a[192:195], v[92:95], v[152:155]
  ds_read_b64_tr_b16 a[188:189], v44 offset:18432
  s_add_u32 s73, s73, 294912
  v_mfma_f32_16x16x32_bf16 a[40:43], a[244:247], v[92:95], a[40:43]
  s_add_u32 s71, s71, s77
  s_add_u32 s72, s72, 36864
  v_mfma_f32_16x16x32_bf16 v[156:159], a[192:195], v[96:99], v[156:159]
  ds_read_b64_tr_b16 a[190:191], v44 offset:18944
  s_add_u32 m0, s76, 24576
  v_mfma_f32_16x16x32_bf16 a[44:47], a[244:247], v[96:99], a[44:47]
  buffer_load_dwordx4 v4, s[8:11], s72 offen lds
  s_waitcnt lgkmcnt(4)
  s_waitcnt vmcnt(16)
  s_barrier
  v_mfma_f32_16x16x32_bf16 v[160:163], a[176:179], v[84:87], v[160:163]
  ds_read_b64_tr_b16 a[192:193], v5 offset:20480
  s_add_u32 m0, s100, 81920
  v_mfma_f32_16x16x32_bf16 a[48:51], a[180:183], v[84:87], a[48:51]
  v_sub_f32 v62, v62, v36
  v_sub_f32 v63, v63, v36
  v_mfma_f32_16x16x32_bf16 v[164:167], a[176:179], v[88:91], v[164:167]
  ds_read_b64_tr_b16 a[194:195], v5 offset:21504
  v_sub_f32 v64, v64, v36
  v_mfma_f32_16x16x32_bf16 a[52:55], a[180:183], v[88:91], a[52:55]
  v_sub_f32 v65, v65, v36
  v_sub_f32 v66, v66, v36
  v_mfma_f32_16x16x32_bf16 v[168:171], a[176:179], v[92:95], v[168:171]
  ds_read_b64_tr_b16 a[244:245], v5 offset:24576
  v_sub_f32 v67, v67, v36
  v_mfma_f32_16x16x32_bf16 a[56:59], a[180:183], v[92:95], a[56:59]
  buffer_load_dwordx4 v110, s[12:15], s70 offen lds
  s_add_u32 m0, s74, 81920
  v_mfma_f32_16x16x32_bf16 v[172:175], a[176:179], v[96:99], v[172:175]
  ds_read_b64_tr_b16 a[246:247], v5 offset:25600
  v_sub_f32 v68, v68, v36
  v_mfma_f32_16x16x32_bf16 a[60:63], a[180:183], v[96:99], a[60:63]
  v_sub_f32 v69, v69, v36
  s_waitcnt lgkmcnt(4)
  v_mfma_f32_16x16x32_bf16 v[176:179], a[184:187], v[84:87], v[176:179]
  ds_read_b64_tr_b16 a[176:177], v5 offset:20992
  v_sub_f32 v70, v70, v36
  v_mfma_f32_16x16x32_bf16 a[64:67], a[188:191], v[84:87], a[64:67]
  buffer_load_dwordx4 v2, s[12:15], s70 offen offset:0 lds
  s_add_u32 m0, s74, 82944
  v_mfma_f32_16x16x32_bf16 v[180:183], a[184:187], v[88:91], v[180:183]
  ds_read_b64_tr_b16 a[178:179], v5 offset:22016
  v_sub_f32 v71, v71, v36
  v_mfma_f32_16x16x32_bf16 a[68:71], a[188:191], v[88:91], a[68:71]
  v_sub_f32 v72, v72, v36
  v_sub_f32 v73, v73, v36
  v_mfma_f32_16x16x32_bf16 v[184:187], a[184:187], v[92:95], v[184:187]
  ds_read_b64_tr_b16 a[180:181], v5 offset:25088
  v_sub_f32 v74, v74, v36
  v_mfma_f32_16x16x32_bf16 a[72:75], a[188:191], v[92:95], a[72:75]
  v_sub_f32 v75, v75, v36
  v_sub_f32 v76, v76, v36
  v_mfma_f32_16x16x32_bf16 v[188:191], a[184:187], v[96:99], v[188:191]
  ds_read_b64_tr_b16 a[182:183], v5 offset:26112
  v_sub_f32 v77, v77, v36
  v_mfma_f32_16x16x32_bf16 a[76:79], a[188:191], v[96:99], a[76:79]
  buffer_load_dwordx4 v2, s[12:15], s73 offen offset:0 lds
  s_waitcnt lgkmcnt(4)
  v_mfma_f32_16x16x32_bf16 v[192:195], a[192:195], v[84:87], v[192:195]
  ds_read_b64_tr_b16 a[184:185], v5 offset:28672
  s_add_u32 m0, s74, 89984
  v_mfma_f32_16x16x32_bf16 a[80:83], a[244:247], v[84:87], a[80:83]
  v_mul_f32 v78, v60, v60
  v_mul_f32 v79, v61, v61
  v_mfma_f32_16x16x32_bf16 v[196:199], a[192:195], v[88:91], v[196:199]
  ds_read_b64_tr_b16 a[186:187], v5 offset:29696
  v_fmac_f32 v78, v62, v62
  v_mfma_f32_16x16x32_bf16 a[84:87], a[244:247], v[88:91], a[84:87]
  buffer_load_dwordx4 v2, s[12:15], s70 offen offset:128 lds
  s_add_u32 m0, s74, 91008
  v_mfma_f32_16x16x32_bf16 v[200:203], a[192:195], v[92:95], v[200:203]
  ds_read_b64_tr_b16 a[188:189], v5 offset:32768
  v_fmac_f32 v79, v63, v63
  v_mfma_f32_16x16x32_bf16 a[88:91], a[244:247], v[92:95], a[88:91]
  v_fmac_f32 v78, v64, v64
  v_fmac_f32 v79, v65, v65
  v_mfma_f32_16x16x32_bf16 v[204:207], a[192:195], v[96:99], v[204:207]
  ds_read_b64_tr_b16 a[190:191], v5 offset:33792
  v_fmac_f32 v78, v66, v66
  v_mfma_f32_16x16x32_bf16 a[92:95], a[244:247], v[96:99], a[92:95]
  v_fmac_f32 v79, v67, v67
  s_waitcnt lgkmcnt(4)
  v_mfma_f32_16x16x32_bf16 v[208:211], a[176:179], v[84:87], v[208:211]
  ds_read_b64_tr_b16 a[192:193], v5 offset:29184
  v_fmac_f32 v78, v68, v68
  v_mfma_f32_16x16x32_bf16 a[96:99], a[180:183], v[84:87], a[96:99]
  buffer_load_dwordx4 v2, s[12:15], s73 offen offset:128 lds
  s_add_u32 s72, s72, 36864
  v_mfma_f32_16x16x32_bf16 v[212:215], a[176:179], v[88:91], v[212:215]
  ds_read_b64_tr_b16 a[194:195], v5 offset:30208
  s_add_u32 m0, s76, 28672
  v_mfma_f32_16x16x32_bf16 a[100:103], a[180:183], v[88:91], a[100:103]
  v_fmac_f32 v79, v69, v69
  v_fmac_f32 v78, v70, v70
  v_mfma_f32_16x16x32_bf16 v[216:219], a[176:179], v[92:95], v[216:219]
  ds_read_b64_tr_b16 a[244:245], v5 offset:33280
  v_fmac_f32 v79, v71, v71
  v_mfma_f32_16x16x32_bf16 a[104:107], a[180:183], v[92:95], a[104:107]
  buffer_load_dwordx4 v4, s[8:11], s72 offen lds
  s_add_u32 m0, s75, 102400
  v_mfma_f32_16x16x32_bf16 v[220:223], a[176:179], v[96:99], v[220:223]
  ds_read_b64_tr_b16 a[246:247], v5 offset:34304
  v_fmac_f32 v78, v72, v72
  v_mfma_f32_16x16x32_bf16 a[108:111], a[180:183], v[96:99], a[108:111]
  v_fmac_f32 v79, v73, v73
  s_waitcnt lgkmcnt(4)
  v_mfma_f32_16x16x32_bf16 v[224:227], a[184:187], v[84:87], v[224:227]
  ds_read_b64_tr_b16 a[176:177], v7 offset:20480
  v_fmac_f32 v78, v74, v74
  v_mfma_f32_16x16x32_bf16 a[112:115], a[188:191], v[84:87], a[112:115]
  v_fmac_f32 v79, v75, v75
  v_fmac_f32 v78, v76, v76
  v_mfma_f32_16x16x32_bf16 v[228:231], a[184:187], v[88:91], v[228:231]
  ds_read_b64_tr_b16 a[178:179], v7 offset:20864
  v_fmac_f32 v79, v77, v77
  v_mfma_f32_16x16x32_bf16 a[116:119], a[188:191], v[88:91], a[116:119]
  buffer_load_dwordx4 v3, s[16:19], s71 offen lds
  s_add_u32 m0, s74, 102144
  v_mfma_f32_16x16x32_bf16 v[232:235], a[184:187], v[92:95], v[232:235]
  ds_read_b64_tr_b16 a[180:181], v9 offset:20480
  v_add_f32 v78, v78, v79
  v_mfma_f32_16x16x32_bf16 a[120:123], a[188:191], v[92:95], a[120:123]
  s_nop 0
  v_add_f32_dpp v78, v78, v78 row_ror:8 row_mask:0xf bank_mask:0xf
  v_mfma_f32_16x16x32_bf16 v[236:239], a[184:187], v[96:99], v[236:239]
  ds_read_b64_tr_b16 a[182:183], v11 offset:20480
  s_nop 0
  v_mfma_f32_16x16x32_bf16 a[124:127], a[188:191], v[96:99], a[124:127]
  buffer_load_dwordx4 v2, s[12:15], s70 offen offset:256 lds
  s_waitcnt lgkmcnt(4)
  s_waitcnt vmcnt(15)
  s_barrier
  v_mfma_f32_16x16x32_bf16 v[240:243], a[192:195], v[84:87], v[240:243]
  ds_read_b64_tr_b16 a[184:185], v5 offset:40960
  s_add_u32 m0, s74, 103168
  v_mfma_f32_16x16x32_bf16 a[128:131], a[244:247], v[84:87], a[128:131]
  ds_read_b128 a[196:199], v13 offset:0
  v_add_f32_dpp v78, v78, v78 row_ror:4 row_mask:0xf bank_mask:0xf
  v_mfma_f32_16x16x32_bf16 v[244:247], a[192:195], v[88:91], v[244:247]
  ds_read_b64_tr_b16 a[186:187], v5 offset:41984
  s_nop 0
  v_mfma_f32_16x16x32_bf16 a[132:135], a[244:247], v[88:91], a[132:135]
  ds_read_b128 a[200:203], v13 offset:2048
  v_add_f32_dpp v78, v78, v78 row_ror:2 row_mask:0xf bank_mask:0xf
  v_mfma_f32_16x16x32_bf16 v[248:251], a[192:195], v[92:95], v[248:251]
  ds_read_b64_tr_b16 a[188:189], v5 offset:45056
  s_nop 0
  v_mfma_f32_16x16x32_bf16 a[136:139], a[244:247], v[92:95], a[136:139]
  ds_read_b128 a[204:207], v13 offset:4096
  v_add_f32_dpp v78, v78, v78 row_ror:1 row_mask:0xf bank_mask:0xf
  v_mfma_f32_16x16x32_bf16 v[252:255], a[192:195], v[96:99], v[252:255]
  ds_read_b64_tr_b16 a[190:191], v5 offset:46080
  v_mov_b32 v79, v78
  v_mfma_f32_16x16x32_bf16 a[140:143], a[244:247], v[96:99], a[140:143]
  ds_read_b128 a[208:211], v13 offset:6144
  s_waitcnt lgkmcnt(8)
  v_mfma_f32_16x16x32_bf16 a[144:147], a[176:179], v[84:87], a[144:147]
  ds_read_b64_tr_b16 a[192:193], v5 offset:41472
  s_nop 0
  v_mfma_f32_16x16x32_bf16 a[160:163], a[180:183], v[84:87], a[160:163]
  ds_read_b128 a[212:215], v14 offset:0
  v_permlane16_swap_b32 v78, v79
  v_mfma_f32_16x16x32_bf16 a[148:151], a[176:179], v[88:91], a[148:151]
  ds_read_b64_tr_b16 a[194:195], v5 offset:42496
  v_add_f32 v78, v78, v79
  v_mfma_f32_16x16x32_bf16 a[164:167], a[180:183], v[88:91], a[164:167]
  ds_read_b128 a[216:219], v14 offset:2048
  v_mul_f32 v78, 0x3ae38e39, v78
  v_mfma_f32_16x16x32_bf16 a[152:155], a[176:179], v[92:95], a[152:155]
  ds_read_b64_tr_b16 a[244:245], v5 offset:45568
  v_cvt_pk_bf16_f32 v79, v36, v78
  v_mfma_f32_16x16x32_bf16 a[168:171], a[180:183], v[92:95], a[168:171]
  ds_read_b128 a[220:223], v14 offset:4096
  v_lshlrev_b32 v36, 16, v79
  v_mfma_f32_16x16x32_bf16 a[156:159], a[176:179], v[96:99], a[156:159]
  ds_read_b64_tr_b16 a[246:247], v5 offset:46592
  v_and_b32 v78, 0xffff0000, v79
  v_mfma_f32_16x16x32_bf16 a[172:175], a[180:183], v[96:99], a[172:175]
  ds_read_b128 a[224:227], v14 offset:6144
  s_waitcnt lgkmcnt(9)
  v_mfma_f32_16x16x32_bf16 v[112:115], a[184:187], a[196:199], v[112:115]
  ds_read_b64_tr_b16 a[176:177], v5 offset:49152
  v_add_f32 v78, 0x3727c5ac, v78
  v_mfma_f32_16x16x32_bf16 a[0:3], a[188:191], a[196:199], a[0:3]
  buffer_load_dwordx4 v2, s[12:15], s73 offen offset:256 lds
  s_add_u32 m0, s74, 110208
  v_mfma_f32_16x16x32_bf16 v[116:119], a[184:187], a[200:203], v[116:119]
  ds_read_b64_tr_b16 a[178:179], v5 offset:50176
  v_cvt_pk_bf16_f32 v78, v78, v78
  v_mfma_f32_16x16x32_bf16 a[4:7], a[188:191], a[200:203], a[4:7]
  buffer_load_dwordx4 v2, s[12:15], s70 offen offset:384 lds
  s_add_u32 m0, s74, 111232
  v_mfma_f32_16x16x32_bf16 v[120:123], a[184:187], a[204:207], v[120:123]
  ds_read_b64_tr_b16 a[180:181], v5 offset:53248
  v_lshlrev_b32 v78, 16, v78
  v_mfma_f32_16x16x32_bf16 a[8:11], a[188:191], a[204:207], a[8:11]
  v_sqrt_f32 v78, v78
  s_waitcnt lgkmcnt(11)
  v_mfma_f32_16x16x32_bf16 v[124:127], a[184:187], a[208:211], v[124:127]
  ds_read_b64_tr_b16 a[182:183], v5 offset:54272
  v_lshlrev_b32 v46, 3, v46
  v_mfma_f32_16x16x32_bf16 a[12:15], a[188:191], a[208:211], a[12:15]
  v_cvt_pk_bf16_f32 v78, v78, v78
  s_waitcnt lgkmcnt(5)
  v_mfma_f32_16x16x32_bf16 v[128:131], a[192:195], a[196:199], v[128:131]
  ds_read_b64_tr_b16 a[184:185], v5 offset:49664
  v_lshlrev_b32 v78, 16, v78
  v_mfma_f32_16x16x32_bf16 a[16:19], a[244:247], a[196:199], a[16:19]
  buffer_load_dwordx4 v2, s[12:15], s73 offen offset:384 lds
  s_add_u32 s92, s92, 2
  v_mfma_f32_16x16x32_bf16 v[132:135], a[192:195], a[200:203], v[132:135]
  ds_read_b64_tr_b16 a[186:187], v5 offset:50688
  s_cmp_eq_u32 s92, 18
  s_cselect_b32 s92, 0, s92
  v_mfma_f32_16x16x32_bf16 a[20:23], a[244:247], a[200:203], a[20:23]
  s_mul_i32 s70, s92, 294912
  s_add_u32 s73, s70, 36864
  v_mfma_f32_16x16x32_bf16 v[136:139], a[192:195], a[204:207], v[136:139]
  ds_read_b64_tr_b16 a[188:189], v5 offset:53760
  s_mul_i32 s71, s92, s77
  v_mfma_f32_16x16x32_bf16 a[24:27], a[244:247], a[204:207], a[24:27]
  v_rcp_f32 v37, v78
  v_and_b32 v79, 31, v1
  v_mfma_f32_16x16x32_bf16 v[140:143], a[192:195], a[208:211], v[140:143]
  ds_read_b64_tr_b16 a[190:191], v5 offset:54784
  v_cmp_eq_u32 vcc, 0, v79
  v_mfma_f32_16x16x32_bf16 a[28:31], a[244:247], a[208:211], a[28:31]
  v_mov_b32 v79, 1073741824
  s_waitcnt lgkmcnt(4)
  v_mfma_f32_16x16x32_bf16 v[144:147], a[176:179], a[196:199], v[144:147]
  ds_read_b64_tr_b16 a[192:193], v44 offset:57344
  s_nop 0
  v_mfma_f32_16x16x32_bf16 a[32:35], a[180:183], a[196:199], a[32:35]
  v_cndmask_b32 v46, v79, v46, vcc
  v_mfma_f32_16x16x32_bf16 v[148:151], a[176:179], a[200:203], v[148:151]
  ds_read_b64_tr_b16 a[194:195], v44 offset:57856
  v_mfma_f32_16x16x32_bf16 a[36:39], a[180:183], a[200:203], a[36:39]
  v_mfma_f32_16x16x32_bf16 v[152:155], a[176:179], a[204:207], v[152:155]
  ds_read_b64_tr_b16 a[244:245], v44 offset:59392
  v_mfma_f32_16x16x32_bf16 a[40:43], a[180:183], a[204:207], a[40:43]
  v_mfma_f32_16x16x32_bf16 v[156:159], a[176:179], a[208:211], v[156:159]
  ds_read_b64_tr_b16 a[246:247], v44 offset:59904
  v_mfma_f32_16x16x32_bf16 a[44:47], a[180:183], a[208:211], a[44:47]
  s_waitcnt lgkmcnt(4)
  s_waitcnt vmcnt(12)
  s_barrier
  v_mfma_f32_16x16x32_bf16 v[160:163], a[184:187], a[196:199], v[160:163]
  ds_read_b64_tr_b16 a[176:177], v6 offset:0
  s_add_u32 s95, s95, 128
  v_mfma_f32_16x16x32_bf16 a[48:51], a[188:191], a[196:199], a[48:51]
  s_cmp_eq_u32 s95, 1152
  s_cselect_b32 s95, 0, s95
  v_mfma_f32_16x16x32_bf16 v[164:167], a[184:187], a[200:203], v[164:167]
  ds_read_b64_tr_b16 a[178:179], v6 offset:1024
  s_add_u32 s72, s101, s95
  v_mfma_f32_16x16x32_bf16 a[52:55], a[188:191], a[200:203], a[52:55]
  s_add_u32 m0, s76, 0
  v_mfma_f32_16x16x32_bf16 v[168:171], a[184:187], a[204:207], v[168:171]
  ds_read_b64_tr_b16 a[180:181], v6 offset:4096
  v_mfma_f32_16x16x32_bf16 a[56:59], a[188:191], a[204:207], a[56:59]
  buffer_load_dwordx4 v4, s[8:11], s72 offen lds
  s_add_u32 m0, s100, 0
  v_mfma_f32_16x16x32_bf16 v[172:175], a[184:187], a[208:211], v[172:175]
  ds_read_b64_tr_b16 a[182:183], v6 offset:5120
  v_mfma_f32_16x16x32_bf16 a[60:63], a[188:191], a[208:211], a[60:63]
  buffer_load_dwordx4 v110, s[12:15], s70 offen lds
  s_waitcnt lgkmcnt(4)
  v_mfma_f32_16x16x32_bf16 v[176:179], a[192:195], a[196:199], v[176:179]
  ds_read_b64_tr_b16 a[184:185], v6 offset:512
  s_add_u32 m0, s74, 0
  v_mfma_f32_16x16x32_bf16 a[64:67], a[244:247], a[196:199], a[64:67]
  v_mfma_f32_16x16x32_bf16 v[180:183], a[192:195], a[200:203], v[180:183]
  ds_read_b64_tr_b16 a[186:187], v6 offset:1536
  v_mfma_f32_16x16x32_bf16 a[68:71], a[244:247], a[200:203], a[68:71]
  v_mfma_f32_16x16x32_bf16 v[184:187], a[192:195], a[204:207], v[184:187]
  ds_read_b64_tr_b16 a[188:189], v6 offset:4608
  v_mfma_f32_16x16x32_bf16 a[72:75], a[244:247], a[204:207], a[72:75]
  buffer_load_dwordx4 v2, s[12:15], s70 offen offset:0 lds
  s_add_u32 m0, s74, 1024
  v_mfma_f32_16x16x32_bf16 v[188:191], a[192:195], a[208:211], v[188:191]
  ds_read_b64_tr_b16 a[190:191], v6 offset:5632
  v_mfma_f32_16x16x32_bf16 a[76:79], a[244:247], a[208:211], a[76:79]
  s_waitcnt lgkmcnt(4)
  v_mfma_f32_16x16x32_bf16 v[192:195], a[176:179], a[196:199], v[192:195]
  ds_read_b64_tr_b16 a[192:193], v6 offset:8192
  v_mfma_f32_16x16x32_bf16 a[80:83], a[180:183], a[196:199], a[80:83]
  buffer_load_dwordx4 v2, s[12:15], s73 offen offset:0 lds
  s_add_u32 m0, s74, 8064
  v_mfma_f32_16x16x32_bf16 v[196:199], a[176:179], a[200:203], v[196:199]
  ds_read_b64_tr_b16 a[194:195], v6 offset:9216
  v_mfma_f32_16x16x32_bf16 a[84:87], a[180:183], a[200:203], a[84:87]
  v_mfma_f32_16x16x32_bf16 v[200:203], a[176:179], a[204:207], v[200:203]
  ds_read_b64_tr_b16 a[244:245], v6 offset:12288
  v_mfma_f32_16x16x32_bf16 a[88:91], a[180:183], a[204:207], a[88:91]
  v_mfma_f32_16x16x32_bf16 v[204:207], a[176:179], a[208:211], v[204:207]
  ds_read_b64_tr_b16 a[246:247], v6 offset:13312
  v_mfma_f32_16x16x32_bf16 a[92:95], a[180:183], a[208:211], a[92:95]
  buffer_load_dwordx4 v2, s[12:15], s70 offen offset:128 lds
  s_waitcnt lgkmcnt(4)
  v_mfma_f32_16x16x32_bf16 v[208:211], a[184:187], a[196:199], v[208:211]
  ds_read_b64_tr_b16 a[176:177], v6 offset:8704
  s_add_u32 m0, s74, 9088
  v_mfma_f32_16x16x32_bf16 a[96:99], a[188:191], a[196:199], a[96:99]
  v_mfma_f32_16x16x32_bf16 v[212:215], a[184:187], a[200:203], v[212:215]
  ds_read_b64_tr_b16 a[178:179], v6 offset:9728
  v_mfma_f32_16x16x32_bf16 a[100:103], a[188:191], a[200:203], a[100:103]
  buffer_load_dwordx4 v2, s[12:15], s73 offen offset:128 lds
  s_add_u32 s70, s70, 294912
  v_mfma_f32_16x16x32_bf16 v[216:219], a[184:187], a[204:207], v[216:219]
  ds_read_b64_tr_b16 a[180:181], v6 offset:12800
  s_add_u32 s73, s73, 294912
  v_mfma_f32_16x16x32_bf16 a[104:107], a[188:191], a[204:207], a[104:107]
  s_add_u32 s71, s71, s77
  s_add_u32 s72, s72, 36864
  v_mfma_f32_16x16x32_bf16 v[220:223], a[184:187], a[208:211], v[220:223]
  ds_read_b64_tr_b16 a[182:183], v6 offset:13824
  s_add_u32 m0, s76, 4096
  v_mfma_f32_16x16x32_bf16 a[108:111], a[188:191], a[208:211], a[108:111]
  s_waitcnt lgkmcnt(4)
  v_mfma_f32_16x16x32_bf16 v[224:227], a[192:195], a[196:199], v[224:227]
  ds_read_b64_tr_b16 a[184:185], v8 offset:0
  v_mfma_f32_16x16x32_bf16 a[112:115], a[244:247], a[196:199], a[112:115]
  buffer_load_dwordx4 v4, s[8:11], s72 offen lds
  s_add_u32 m0, s100, 20480
  v_mfma_f32_16x16x32_bf16 v[228:231], a[192:195], a[200:203], v[228:231]
  ds_read_b64_tr_b16 a[186:187], v8 offset:384
  v_mfma_f32_16x16x32_bf16 a[116:119], a[244:247], a[200:203], a[116:119]
  v_mfma_f32_16x16x32_bf16 v[232:235], a[192:195], a[204:207], v[232:235]
  ds_read_b64_tr_b16 a[188:189], v10 offset:0
  v_mfma_f32_16x16x32_bf16 a[120:123], a[244:247], a[204:207], a[120:123]
  buffer_load_dwordx4 v110, s[12:15], s70 offen lds
  s_add_u32 m0, s74, 20480
  v_mfma_f32_16x16x32_bf16 v[236:239], a[192:195], a[208:211], v[236:239]
  ds_read_b64_tr_b16 a[190:191], v12 offset:0
  v_mfma_f32_16x16x32_bf16 a[124:127], a[244:247], a[208:211], a[124:127]
  s_waitcnt lgkmcnt(4)
  s_waitcnt vmcnt(14)
  s_barrier
  v_mfma_f32_16x16x32_bf16 v[240:243], a[176:179], a[196:199], v[240:243]
  ds_read_b64_tr_b16 a[192:193], v6 offset:20480
  v_mfma_f32_16x16x32_bf16 a[128:131], a[180:183], a[196:199], a[128:131]
  v_mfma_f32_16x16x32_bf16 v[244:247], a[176:179], a[200:203], v[244:247]
  ds_read_b64_tr_b16 a[194:195], v6 offset:21504
  v_mfma_f32_16x16x32_bf16 a[132:135], a[180:183], a[200:203], a[132:135]
  buffer_load_dwordx4 v2, s[12:15], s70 offen offset:0 lds
  s_add_u32 m0, s74, 21504
  v_mfma_f32_16x16x32_bf16 v[248:251], a[176:179], a[204:207], v[248:251]
  ds_read_b64_tr_b16 a[244:245], v6 offset:24576
  v_mfma_f32_16x16x32_bf16 a[136:139], a[180:183], a[204:207], a[136:139]
  v_mfma_f32_16x16x32_bf16 v[252:255], a[176:179], a[208:211], v[252:255]
  ds_read_b64_tr_b16 a[246:247], v6 offset:25600
  v_mfma_f32_16x16x32_bf16 a[140:143], a[180:183], a[208:211], a[140:143]
L_wc0_2:
L_pg2:
  s_cbranch_execz L_pg6
  buffer_load_dwordx4 v2, s[12:15], s73 offen offset:0 lds
  s_waitcnt lgkmcnt(4)
  v_mfma_f32_16x16x32_bf16 a[144:147], a[184:187], a[196:199], a[144:147]
  ds_read_b64_tr_b16 a[176:177], v6 offset:20992
  s_add_u32 m0, s74, 28544
  v_mfma_f32_16x16x32_bf16 a[160:163], a[188:191], a[196:199], a[160:163]
  v_mfma_f32_16x16x32_bf16 a[148:151], a[184:187], a[200:203], a[148:151]
  ds_read_b64_tr_b16 a[178:179], v6 offset:22016
  v_mfma_f32_16x16x32_bf16 a[164:167], a[188:191], a[200:203], a[164:167]
  v_mfma_f32_16x16x32_bf16 a[152:155], a[184:187], a[204:207], a[152:155]
  ds_read_b64_tr_b16 a[180:181], v6 offset:25088
  v_mfma_f32_16x16x32_bf16 a[168:171], a[188:191], a[204:207], a[168:171]
  buffer_load_dwordx4 v2, s[12:15], s70 offen offset:128 lds
  s_add_u32 m0, s74, 29568
  v_mfma_f32_16x16x32_bf16 a[156:159], a[184:187], a[208:211], a[156:159]
  ds_read_b64_tr_b16 a[182:183], v6 offset:26112
  v_mfma_f32_16x16x32_bf16 a[172:175], a[188:191], a[208:211], a[172:175]
  s_waitcnt lgkmcnt(4)
  v_mfma_f32_16x16x32_bf16 v[112:115], a[192:195], a[212:215], v[112:115]
  ds_read_b64_tr_b16 a[184:185], v6 offset:28672
  global_load_dwordx4 v[60:63], v[48:49], off
  v_mfma_f32_16x16x32_bf16 a[0:3], a[244:247], a[212:215], a[0:3]
  buffer_load_dwordx4 v2, s[12:15], s73 offen offset:128 lds
  s_sub_u32 s70, s70, 294912
  v_mfma_f32_16x16x32_bf16 v[116:119], a[192:195], a[216:219], v[116:119]
  ds_read_b64_tr_b16 a[186:187], v6 offset:29696
  s_sub_u32 s73, s73, 294912
  v_mfma_f32_16x16x32_bf16 a[4:7], a[244:247], a[216:219], a[4:7]
  s_sub_u32 s71, s71, s77
  s_add_u32 s72, s72, 36864
  v_mfma_f32_16x16x32_bf16 v[120:123], a[192:195], a[220:223], v[120:123]
  ds_read_b64_tr_b16 a[188:189], v6 offset:32768
  s_add_u32 m0, s76, 8192
  v_mfma_f32_16x16x32_bf16 a[8:11], a[244:247], a[220:223], a[8:11]
  v_lshl_add_u64 v[48:49], v[50:51], 0, v[48:49]
  v_mfma_f32_16x16x32_bf16 v[124:127], a[192:195], a[224:227], v[124:127]
  ds_read_b64_tr_b16 a[190:191], v6 offset:33792
  global_load_dwordx4 v[64:67], v[48:49], off
  v_mfma_f32_16x16x32_bf16 a[12:15], a[244:247], a[224:227], a[12:15]
  buffer_load_dwordx4 v4, s[8:11], s72 offen lds
  s_waitcnt lgkmcnt(4)
  v_mfma_f32_16x16x32_bf16 v[128:131], a[176:179], a[212:215], v[128:131]
  ds_read_b64_tr_b16 a[192:193], v6 offset:29184
  s_add_u32 m0, s75, 40960
  v_mfma_f32_16x16x32_bf16 a[16:19], a[180:183], a[212:215], a[16:19]
  v_lshl_add_u64 v[48:49], v[50:51], 0, v[48:49]
  v_mfma_f32_16x16x32_bf16 v[132:135], a[176:179], a[216:219], v[132:135]
  ds_read_b64_tr_b16 a[194:195], v6 offset:30208
  v_mfma_f32_16x16x32_bf16 a[20:23], a[180:183], a[216:219], a[20:23]
  buffer_load_dwordx4 v3, s[16:19], s71 offen lds
  s_add_u32 m0, s74, 40704
  v_mfma_f32_16x16x32_bf16 v[136:139], a[176:179], a[220:223], v[136:139]
  ds_read_b64_tr_b16 a[244:245], v6 offset:33280
  v_mfma_f32_16x16x32_bf16 a[24:27], a[180:183], a[220:223], a[24:27]
  v_mfma_f32_16x16x32_bf16 v[140:143], a[176:179], a[224:227], v[140:143]
  ds_read_b64_tr_b16 a[246:247], v6 offset:34304
  v_mfma_f32_16x16x32_bf16 a[28:31], a[180:183], a[224:227], a[28:31]
  s_waitcnt lgkmcnt(4)
  v_mfma_f32_16x16x32_bf16 v[144:147], a[184:187], a[212:215], v[144:147]
  ds_read_b64_tr_b16 a[176:177], v45 offset:36864
  v_mfma_f32_16x16x32_bf16 a[32:35], a[188:191], a[212:215], a[32:35]
  buffer_load_dwordx4 v2, s[12:15], s70 offen offset:256 lds
  s_add_u32 m0, s74, 41728
  v_mfma_f32_16x16x32_bf16 v[148:151], a[184:187], a[216:219], v[148:151]
  ds_read_b64_tr_b16 a[178:179], v45 offset:37376
  v_mfma_f32_16x16x32_bf16 a[36:39], a[188:191], a[216:219], a[36:39]
  v_mfma_f32_16x16x32_bf16 v[152:155], a[184:187], a[220:223], v[152:155]
  ds_read_b64_tr_b16 a[180:181], v45 offset:38912
  v_mfma_f32_16x16x32_bf16 a[40:43], a[188:191], a[220:223], a[40:43]
  buffer_load_dwordx4 v2, s[12:15], s73 offen offset:256 lds
  s_add_u32 m0, s74, 48768
  v_mfma_f32_16x16x32_bf16 v[156:159], a[184:187], a[224:227], v[156:159]
  ds_read_b64_tr_b16 a[182:183], v45 offset:39424
  v_mfma_f32_16x16x32_bf16 a[44:47], a[188:191], a[224:227], a[44:47]
  s_waitcnt lgkmcnt(4)
  s_waitcnt vmcnt(18)
  s_barrier
  v_mfma_f32_16x16x32_bf16 v[160:163], a[192:195], a[212:215], v[160:163]
  ds_read_b64_tr_b16 a[184:185], v6 offset:40960
  v_mfma_f32_16x16x32_bf16 a[48:51], a[244:247], a[212:215], a[48:51]
  v_mfma_f32_16x16x32_bf16 v[164:167], a[192:195], a[216:219], v[164:167]
  ds_read_b64_tr_b16 a[186:187], v6 offset:41984
  v_mfma_f32_16x16x32_bf16 a[52:55], a[244:247], a[216:219], a[52:55]
  ds_read_b128 a[228:231], v13 offset:16384
  v_mfma_f32_16x16x32_bf16 v[168:171], a[192:195], a[220:223], v[168:171]
  ds_read_b64_tr_b16 a[188:189], v6 offset:45056
  v_mfma_f32_16x16x32_bf16 a[56:59], a[244:247], a[220:223], a[56:59]
  buffer_load_dwordx4 v2, s[12:15], s70 offen offset:384 lds
  s_add_u32 m0, s74, 49792
  v_mfma_f32_16x16x32_bf16 v[172:175], a[192:195], a[224:227], v[172:175]
  ds_read_b64_tr_b16 a[190:191], v6 offset:46080
  v_mfma_f32_16x16x32_bf16 a[60:63], a[244:247], a[224:227], a[60:63]
  ds_read_b128 v[84:87], v14 offset:16384
  s_waitcnt lgkmcnt(6)
  v_mfma_f32_16x16x32_bf16 v[176:179], a[176:179], a[212:215], v[176:179]
  ds_read_b64_tr_b16 a[192:193], v6 offset:41472
  v_mfma_f32_16x16x32_bf16 a[64:67], a[180:183], a[212:215], a[64:67]
  buffer_load_dwordx4 v2, s[12:15], s73 offen offset:384 lds
  s_add_u32 s70, s70, 294912
  v_mfma_f32_16x16x32_bf16 v[180:183], a[176:179], a[216:219], v[180:183]
  ds_read_b64_tr_b16 a[194:195], v6 offset:42496
  s_add_u32 s73, s73, 294912
  v_mfma_f32_16x16x32_bf16 a[68:71], a[180:183], a[216:219], a[68:71]
  ds_read_b128 a[232:235], v13 offset:18432
  s_add_u32 s71, s71, s77
  v_mfma_f32_16x16x32_bf16 v[184:187], a[176:179], a[220:223], v[184:187]
  ds_read_b64_tr_b16 a[244:245], v6 offset:45568
  s_add_u32 s72, s72, 36864
  v_mfma_f32_16x16x32_bf16 a[72:75], a[180:183], a[220:223], a[72:75]
  s_add_u32 m0, s76, 12288
  v_mfma_f32_16x16x32_bf16 v[188:191], a[176:179], a[224:227], v[188:191]
  ds_read_b64_tr_b16 a[246:247], v6 offset:46592
  v_mfma_f32_16x16x32_bf16 a[76:79], a[180:183], a[224:227], a[76:79]
  ds_read_b128 v[88:91], v14 offset:18432
  s_waitcnt lgkmcnt(7)
  v_mfma_f32_16x16x32_bf16 v[192:195], a[184:187], a[212:215], v[192:195]
  ds_read_b64_tr_b16 a[176:177], v6 offset:49152
  global_load_dwordx4 v[68:71], v[48:49], off
  v_mfma_f32_16x16x32_bf16 a[80:83], a[188:191], a[212:215], a[80:83]
  buffer_load_dwordx4 v4, s[8:11], s72 offen lds
  s_add_u32 m0, s75, 61440
  v_mfma_f32_16x16x32_bf16 v[196:199], a[184:187], a[216:219], v[196:199]
  ds_read_b64_tr_b16 a[178:179], v6 offset:50176
  v_lshl_add_u64 v[48:49], v[50:51], 0, v[48:49]
  v_mfma_f32_16x16x32_bf16 a[84:87], a[188:191], a[216:219], a[84:87]
  ds_read_b128 a[236:239], v13 offset:20480
  global_load_dwordx4 v[72:75], v[48:49], off
  v_mfma_f32_16x16x32_bf16 v[200:203], a[184:187], a[220:223], v[200:203]
  ds_read_b64_tr_b16 a[180:181], v6 offset:53248
  v_lshl_add_u64 v[48:49], v[50:51], 0, v[48:49]
  v_mfma_f32_16x16x32_bf16 a[88:91], a[188:191], a[220:223], a[88:91]
  buffer_load_dwordx4 v3, s[16:19], s71 offen lds
  s_add_u32 m0, s74, 61184
  v_mfma_f32_16x16x32_bf16 v[204:207], a[184:187], a[224:227], v[204:207]
  ds_read_b64_tr_b16 a[182:183], v6 offset:54272
  v_mfma_f32_16x16x32_bf16 a[92:95], a[188:191], a[224:227], a[92:95]
  ds_read_b128 v[92:95], v14 offset:20480
  s_waitcnt lgkmcnt(7)
  v_mfma_f32_16x16x32_bf16 v[208:211], a[192:195], a[212:215], v[208:211]
  ds_read_b64_tr_b16 a[184:185], v6 offset:49664
  v_mfma_f32_16x16x32_bf16 a[96:99], a[244:247], a[212:215], a[96:99]
  buffer_load_dwordx4 v2, s[12:15], s70 offen offset:256 lds
  s_add_u32 m0, s74, 62208
  v_mfma_f32_16x16x32_bf16 v[212:215], a[192:195], a[216:219], v[212:215]
  ds_read_b64_tr_b16 a[186:187], v6 offset:50688
  v_mfma_f32_16x16x32_bf16 a[100:103], a[244:247], a[216:219], a[100:103]
  ds_read_b128 a[240:243], v13 offset:22528
  v_mfma_f32_16x16x32_bf16 v[216:219], a[192:195], a[220:223], v[216:219]
  ds_read_b64_tr_b16 a[188:189], v6 offset:53760
  v_mfma_f32_16x16x32_bf16 a[104:107], a[244:247], a[220:223], a[104:107]
  buffer_load_dwordx4 v2, s[12:15], s73 offen offset:256 lds
  s_add_u32 m0, s74, 69248
  v_mfma_f32_16x16x32_bf16 v[220:223], a[192:195], a[224:227], v[220:223]
  ds_read_b64_tr_b16 a[190:191], v6 offset:54784
  v_mfma_f32_16x16x32_bf16 a[108:111], a[244:247], a[224:227], a[108:111]
  ds_read_b128 v[96:99], v14 offset:22528
  s_waitcnt lgkmcnt(7)
  v_mfma_f32_16x16x32_bf16 v[224:227], a[176:179], a[212:215], v[224:227]
  ds_read_b64_tr_b16 a[192:193], v8 offset:40960
  v_mfma_f32_16x16x32_bf16 a[112:115], a[180:183], a[212:215], a[112:115]
  v_mfma_f32_16x16x32_bf16 v[228:231], a[176:179], a[216:219], v[228:231]
  ds_read_b64_tr_b16 a[194:195], v8 offset:41344
  v_mfma_f32_16x16x32_bf16 a[116:119], a[180:183], a[216:219], a[116:119]
  buffer_load_dwordx4 v2, s[12:15], s70 offen offset:384 lds
  s_add_u32 m0, s74, 70272
  v_mfma_f32_16x16x32_bf16 v[232:235], a[176:179], a[220:223], v[232:235]
  ds_read_b64_tr_b16 a[244:245], v10 offset:40960
  v_mfma_f32_16x16x32_bf16 a[120:123], a[180:183], a[220:223], a[120:123]
  v_mfma_f32_16x16x32_bf16 v[236:239], a[176:179], a[224:227], v[236:239]
  ds_read_b64_tr_b16 a[246:247], v12 offset:40960
  v_mfma_f32_16x16x32_bf16 a[124:127], a[180:183], a[224:227], a[124:127]
  buffer_load_dwordx4 v2, s[12:15], s73 offen offset:384 lds
  s_waitcnt lgkmcnt(5)
  s_waitcnt vmcnt(15)
  s_barrier
  v_mfma_f32_16x16x32_bf16 v[240:243], a[184:187], a[212:215], v[240:243]
  ds_read_b64_tr_b16 a[176:177], v5 offset:0
  s_add_u32 s92, s92, 2
  v_mfma_f32_16x16x32_bf16 a[128:131], a[188:191], a[212:215], a[128:131]
  s_cmp_eq_u32 s92, 18
  s_cselect_b32 s92, 0, s92
  v_mfma_f32_16x16x32_bf16 v[244:247], a[184:187], a[216:219], v[244:247]
  ds_read_b64_tr_b16 a[178:179], v5 offset:1024
  s_mul_i32 s70, s92, 294912
  v_mfma_f32_16x16x32_bf16 a[132:135], a[188:191], a[216:219], a[132:135]
  s_add_u32 s73, s70, 36864
  s_mul_i32 s71, s92, s77
  v_mfma_f32_16x16x32_bf16 v[248:251], a[184:187], a[220:223], v[248:251]
  ds_read_b64_tr_b16 a[180:181], v5 offset:20480
  v_mfma_f32_16x16x32_bf16 a[136:139], a[188:191], a[220:223], a[136:139]
  v_mfma_f32_16x16x32_bf16 v[252:255], a[184:187], a[224:227], v[252:255]
  ds_read_b64_tr_b16 a[182:183], v5 offset:21504
  v_mfma_f32_16x16x32_bf16 a[140:143], a[188:191], a[224:227], a[140:143]
  s_waitcnt lgkmcnt(4)
  v_mfma_f32_16x16x32_bf16 a[144:147], a[192:195], a[212:215], a[144:147]
  ds_read_b64_tr_b16 a[184:185], v5 offset:4096
  v_mfma_f32_16x16x32_bf16 a[160:163], a[244:247], a[212:215], a[160:163]
  v_mfma_f32_16x16x32_bf16 a[148:151], a[192:195], a[216:219], a[148:151]
  ds_read_b64_tr_b16 a[186:187], v5 offset:5120
  v_mfma_f32_16x16x32_bf16 a[164:167], a[244:247], a[216:219], a[164:167]
  v_mfma_f32_16x16x32_bf16 a[152:155], a[192:195], a[220:223], a[152:155]
  ds_read_b64_tr_b16 a[188:189], v5 offset:24576
  v_mfma_f32_16x16x32_bf16 a[168:171], a[244:247], a[220:223], a[168:171]
  v_mfma_f32_16x16x32_bf16 a[156:159], a[192:195], a[224:227], a[156:159]
  ds_read_b64_tr_b16 a[190:191], v5 offset:25600
  v_mfma_f32_16x16x32_bf16 a[172:175], a[244:247], a[224:227], a[172:175]
  s_waitcnt lgkmcnt(4)
  v_mfma_f32_16x16x32_bf16 v[112:115], a[176:179], a[228:231], v[112:115]
  ds_read_b64_tr_b16 a[192:193], v5 offset:512
  global_load_dwordx4 v[76:79], v[48:49], off
  v_mfma_f32_16x16x32_bf16 v[112:115], a[180:183], v[84:87], v[112:115]
  v_lshl_add_u64 v[48:49], v[50:51], 0, v[48:49]
  v_mfma_f32_16x16x32_bf16 v[116:119], a[180:183], v[88:91], v[116:119]
  ds_read_b64_tr_b16 a[194:195], v5 offset:1536
  global_load_dwordx4 v[80:83], v[48:49], off
  v_mfma_f32_16x16x32_bf16 v[116:119], a[176:179], a[232:235], v[116:119]
  v_lshl_add_u64 v[48:49], v[50:51], 0, v[48:49]
  v_lshlrev_b32 v28, 16, v60
  v_mfma_f32_16x16x32_bf16 v[120:123], a[176:179], a[236:239], v[120:123]
  ds_read_b64_tr_b16 a[244:245], v5 offset:20992
  v_and_b32 v60, 0xffff0000, v60
  v_mfma_f32_16x16x32_bf16 v[120:123], a[180:183], v[92:95], v[120:123]
  v_lshlrev_b32 v29, 16, v61
  v_and_b32 v61, 0xffff0000, v61
  v_mfma_f32_16x16x32_bf16 v[124:127], a[180:183], v[96:99], v[124:127]
  ds_read_b64_tr_b16 a[246:247], v5 offset:22016
  v_add_f32 v52, v52, v28
  v_mfma_f32_16x16x32_bf16 v[124:127], a[176:179], a[240:243], v[124:127]
  v_add_f32 v53, v53, v60
  s_waitcnt lgkmcnt(4)
  v_mfma_f32_16x16x32_bf16 a[0:3], a[184:187], a[228:231], a[0:3]
  ds_read_b64_tr_b16 a[176:177], v5 offset:4608
  v_add_f32 v54, v54, v29
  v_mfma_f32_16x16x32_bf16 a[0:3], a[188:191], v[84:87], a[0:3]
  v_add_f32 v55, v55, v61
  v_lshlrev_b32 v28, 16, v62
  v_mfma_f32_16x16x32_bf16 a[4:7], a[188:191], v[88:91], a[4:7]
  ds_read_b64_tr_b16 a[178:179], v5 offset:5632
  v_and_b32 v62, 0xffff0000, v62
  v_mfma_f32_16x16x32_bf16 a[4:7], a[184:187], a[232:235], a[4:7]
  v_lshlrev_b32 v29, 16, v63
  v_and_b32 v63, 0xffff0000, v63
  v_mfma_f32_16x16x32_bf16 a[8:11], a[184:187], a[236:239], a[8:11]
  ds_read_b64_tr_b16 a[180:181], v5 offset:25088
  v_add_f32 v56, v56, v28
  v_mfma_f32_16x16x32_bf16 a[8:11], a[188:191], v[92:95], a[8:11]
  v_add_f32 v57, v57, v62
  v_add_f32 v58, v58, v29
  v_mfma_f32_16x16x32_bf16 a[12:15], a[188:191], v[96:99], a[12:15]
  ds_read_b64_tr_b16 a[182:183], v5 offset:26112
  v_add_f32 v59, v59, v63
  v_mfma_f32_16x16x32_bf16 a[12:15], a[184:187], a[240:243], a[12:15]
  s_waitcnt vmcnt(16)
  v_lshlrev_b32 v28, 16, v64
  s_waitcnt lgkmcnt(4)
  s_barrier
  v_mfma_f32_16x16x32_bf16 v[128:131], a[192:195], a[228:231], v[128:131]
  ds_read_b64_tr_b16 a[184:185], v5 offset:8192
  s_add_u32 s95, s95, 128
  v_mfma_f32_16x16x32_bf16 v[128:131], a[244:247], v[84:87], v[128:131]
  s_cmp_eq_u32 s95, 1152
  s_cselect_b32 s95, 0, s95
  v_mfma_f32_16x16x32_bf16 v[132:135], a[244:247], v[88:91], v[132:135]
  ds_read_b64_tr_b16 a[186:187], v5 offset:9216
  s_add_u32 s72, s101, s95
  v_mfma_f32_16x16x32_bf16 v[132:135], a[192:195], a[232:235], v[132:135]
  s_add_u32 m0, s76, 16384
  v_and_b32 v64, 0xffff0000, v64
  v_mfma_f32_16x16x32_bf16 v[136:139], a[192:195], a[236:239], v[136:139]
  ds_read_b64_tr_b16 a[188:189], v5 offset:28672
  v_lshlrev_b32 v29, 16, v65
  v_mfma_f32_16x16x32_bf16 v[136:139], a[244:247], v[92:95], v[136:139]
  buffer_load_dwordx4 v4, s[8:11], s72 offen lds
  s_add_u32 m0, s100, 81920
  v_mfma_f32_16x16x32_bf16 v[140:143], a[244:247], v[96:99], v[140:143]
  ds_read_b64_tr_b16 a[190:191], v5 offset:29696
  v_and_b32 v65, 0xffff0000, v65
  v_mfma_f32_16x16x32_bf16 v[140:143], a[192:195], a[240:243], v[140:143]
  v_add_f32 v52, v52, v28
  s_waitcnt lgkmcnt(4)
  v_mfma_f32_16x16x32_bf16 a[16:19], a[176:179], a[228:231], a[16:19]
  ds_read_b64_tr_b16 a[192:193], v5 offset:12288
  v_add_f32 v53, v53, v64
  v_mfma_f32_16x16x32_bf16 a[16:19], a[180:183], v[84:87], a[16:19]
  buffer_load_dwordx4 v110, s[12:15], s70 offen lds
  s_add_u32 m0, s74, 81920
  v_mfma_f32_16x16x32_bf16 a[20:23], a[180:183], v[88:91], a[20:23]
  ds_read_b64_tr_b16 a[194:195], v5 offset:13312
  v_add_f32 v54, v54, v29
  v_mfma_f32_16x16x32_bf16 a[20:23], a[176:179], a[232:235], a[20:23]
  v_add_f32 v55, v55, v65
  v_lshlrev_b32 v28, 16, v66
  v_mfma_f32_16x16x32_bf16 a[24:27], a[176:179], a[236:239], a[24:27]
  ds_read_b64_tr_b16 a[244:245], v5 offset:32768
  v_and_b32 v66, 0xffff0000, v66
  v_mfma_f32_16x16x32_bf16 a[24:27], a[180:183], v[92:95], a[24:27]
  buffer_load_dwordx4 v2, s[12:15], s70 offen offset:0 lds
  s_add_u32 m0, s74, 82944
  v_mfma_f32_16x16x32_bf16 a[28:31], a[180:183], v[96:99], a[28:31]
  ds_read_b64_tr_b16 a[246:247], v5 offset:33792
  v_lshlrev_b32 v29, 16, v67
  v_mfma_f32_16x16x32_bf16 a[28:31], a[176:179], a[240:243], a[28:31]
  v_and_b32 v67, 0xffff0000, v67
  s_waitcnt lgkmcnt(4)
  v_mfma_f32_16x16x32_bf16 v[144:147], a[184:187], a[228:231], v[144:147]
  ds_read_b64_tr_b16 a[176:177], v5 offset:8704
  v_add_f32 v56, v56, v28
  v_mfma_f32_16x16x32_bf16 v[144:147], a[188:191], v[84:87], v[144:147]
  v_add_f32 v57, v57, v66
  v_add_f32 v58, v58, v29
  v_mfma_f32_16x16x32_bf16 v[148:151], a[188:191], v[88:91], v[148:151]
  ds_read_b64_tr_b16 a[178:179], v5 offset:9728
  v_add_f32 v59, v59, v67
  v_mfma_f32_16x16x32_bf16 v[148:151], a[184:187], a[232:235], v[148:151]
  buffer_load_dwordx4 v2, s[12:15], s73 offen offset:0 lds
  s_add_u32 m0, s74, 89984
  v_mfma_f32_16x16x32_bf16 v[152:155], a[184:187], a[236:239], v[152:155]
  ds_read_b64_tr_b16 a[180:181], v5 offset:29184
  v_mfma_f32_16x16x32_bf16 v[152:155], a[188:191], v[92:95], v[152:155]
  v_mfma_f32_16x16x32_bf16 v[156:159], a[188:191], v[96:99], v[156:159]
  ds_read_b64_tr_b16 a[182:183], v5 offset:30208
  v_mfma_f32_16x16x32_bf16 v[156:159], a[184:187], a[240:243], v[156:159]
  s_waitcnt lgkmcnt(4)
  v_mfma_f32_16x16x32_bf16 a[32:35], a[192:195], a[228:231], a[32:35]
  ds_read_b64_tr_b16 a[184:185], v5 offset:12800
  global_load_dwordx4 v[60:63], v[48:49], off
  v_mfma_f32_16x16x32_bf16 a[32:35], a[244:247], v[84:87], a[32:35]
  buffer_load_dwordx4 v2, s[12:15], s70 offen offset:128 lds
  s_add_u32 m0, s74, 91008
  v_mfma_f32_16x16x32_bf16 a[36:39], a[244:247], v[88:91], a[36:39]
  ds_read_b64_tr_b16 a[186:187], v5 offset:13824
  v_lshl_add_u64 v[48:49], v[50:51], 0, v[48:49]
  v_mfma_f32_16x16x32_bf16 a[36:39], a[192:195], a[232:235], a[36:39]
  global_load_dwordx4 v[64:67], v[48:49], off
  v_lshl_add_u64 v[48:49], v[50:51], 0, v[48:49]
  v_mfma_f32_16x16x32_bf16 a[40:43], a[192:195], a[236:239], a[40:43]
  ds_read_b64_tr_b16 a[188:189], v5 offset:33280
  s_waitcnt vmcnt(16)
  v_lshlrev_b32 v28, 16, v68
  v_mfma_f32_16x16x32_bf16 a[40:43], a[244:247], v[92:95], a[40:43]
  v_and_b32 v68, 0xffff0000, v68
  v_lshlrev_b32 v29, 16, v69
  v_mfma_f32_16x16x32_bf16 a[44:47], a[244:247], v[96:99], a[44:47]
  ds_read_b64_tr_b16 a[190:191], v5 offset:34304
  v_and_b32 v69, 0xffff0000, v69
  v_mfma_f32_16x16x32_bf16 a[44:47], a[192:195], a[240:243], a[44:47]
  buffer_load_dwordx4 v2, s[12:15], s73 offen offset:128 lds
  s_waitcnt lgkmcnt(4)
  v_mfma_f32_16x16x32_bf16 v[160:163], a[176:179], a[228:231], v[160:163]
  ds_read_b64_tr_b16 a[192:193], v44 offset:16384
  s_add_u32 s70, s70, 294912
  v_mfma_f32_16x16x32_bf16 v[160:163], a[180:183], v[84:87], v[160:163]
  s_add_u32 s73, s73, 294912
  s_add_u32 s71, s71, s77
  v_mfma_f32_16x16x32_bf16 v[164:167], a[180:183], v[88:91], v[164:167]
  ds_read_b64_tr_b16 a[194:195], v44 offset:16896
  s_add_u32 s72, s72, 36864
  v_mfma_f32_16x16x32_bf16 v[164:167], a[176:179], a[232:235], v[164:167]
  s_add_u32 m0, s76, 20480
  v_add_f32 v52, v52, v28
  v_mfma_f32_16x16x32_bf16 v[168:171], a[176:179], a[236:239], v[168:171]
  ds_read_b64_tr_b16 a[244:245], v44 offset:36864
  v_add_f32 v53, v53, v68
  v_mfma_f32_16x16x32_bf16 v[168:171], a[180:183], v[92:95], v[168:171]
  buffer_load_dwordx4 v4, s[8:11], s72 offen lds
  s_add_u32 m0, s100, 102400
  v_mfma_f32_16x16x32_bf16 v[172:175], a[180:183], v[96:99], v[172:175]
  ds_read_b64_tr_b16 a[246:247], v44 offset:37376
  v_add_f32 v54, v54, v29
  v_mfma_f32_16x16x32_bf16 v[172:175], a[176:179], a[240:243], v[172:175]
  v_add_f32 v55, v55, v69
  s_waitcnt lgkmcnt(4)
  v_mfma_f32_16x16x32_bf16 a[48:51], a[184:187], a[228:231], a[48:51]
  ds_read_b64_tr_b16 a[176:177], v44 offset:18432
  v_lshlrev_b32 v28, 16, v70
  v_mfma_f32_16x16x32_bf16 a[48:51], a[188:191], v[84:87], a[48:51]
  buffer_load_dwordx4 v110, s[12:15], s70 offen lds
  s_add_u32 m0, s74, 102400
  v_mfma_f32_16x16x32_bf16 a[52:55], a[188:191], v[88:91], a[52:55]
  ds_read_b64_tr_b16 a[178:179], v44 offset:18944
  v_and_b32 v70, 0xffff0000, v70
  v_mfma_f32_16x16x32_bf16 a[52:55], a[184:187], a[232:235], a[52:55]
  v_lshlrev_b32 v29, 16, v71
  v_and_b32 v71, 0xffff0000, v71
  v_mfma_f32_16x16x32_bf16 a[56:59], a[184:187], a[236:239], a[56:59]
  ds_read_b64_tr_b16 a[180:181], v44 offset:38912
  v_add_f32 v56, v56, v28
  v_mfma_f32_16x16x32_bf16 a[56:59], a[188:191], v[92:95], a[56:59]
  v_add_f32 v57, v57, v70
  v_add_f32 v58, v58, v29
  v_mfma_f32_16x16x32_bf16 a[60:63], a[188:191], v[96:99], a[60:63]
  ds_read_b64_tr_b16 a[182:183], v44 offset:39424
  v_add_f32 v59, v59, v71
  v_mfma_f32_16x16x32_bf16 a[60:63], a[184:187], a[240:243], a[60:63]
  buffer_load_dwordx4 v2, s[12:15], s70 offen offset:0 lds
  s_waitcnt lgkmcnt(4)
  s_waitcnt vmcnt(13)
  s_barrier
  v_mfma_f32_16x16x32_bf16 v[176:179], a[192:195], a[228:231], v[176:179]
  ds_read_b64_tr_b16 a[184:185], v5 offset:40960
  s_add_u32 m0, s74, 103424
  v_mfma_f32_16x16x32_bf16 v[176:179], a[244:247], v[84:87], v[176:179]
  v_lshlrev_b32 v28, 16, v72
  v_and_b32 v72, 0xffff0000, v72
  v_mfma_f32_16x16x32_bf16 v[180:183], a[244:247], v[88:91], v[180:183]
  ds_read_b64_tr_b16 a[186:187], v5 offset:41984
  v_lshlrev_b32 v29, 16, v73
  v_mfma_f32_16x16x32_bf16 v[180:183], a[192:195], a[232:235], v[180:183]
  ds_read_b128 a[196:199], v13 offset:0
  v_and_b32 v73, 0xffff0000, v73
  v_mfma_f32_16x16x32_bf16 v[184:187], a[192:195], a[236:239], v[184:187]
  ds_read_b64_tr_b16 a[188:189], v6 offset:0
  v_add_f32 v52, v52, v28
  v_mfma_f32_16x16x32_bf16 v[184:187], a[244:247], v[92:95], v[184:187]
  buffer_load_dwordx4 v2, s[12:15], s73 offen offset:0 lds
  s_add_u32 m0, s74, 110464
  v_mfma_f32_16x16x32_bf16 v[188:191], a[244:247], v[96:99], v[188:191]
  ds_read_b64_tr_b16 a[190:191], v6 offset:1024
  v_add_f32 v53, v53, v72
  v_mfma_f32_16x16x32_bf16 v[188:191], a[192:195], a[240:243], v[188:191]
  ds_read_b128 a[212:215], v14 offset:0
  s_waitcnt lgkmcnt(6)
  v_mfma_f32_16x16x32_bf16 a[64:67], a[176:179], a[228:231], a[64:67]
  ds_read_b64_tr_b16 a[192:193], v5 offset:45056
  v_add_f32 v54, v54, v29
  v_mfma_f32_16x16x32_bf16 a[64:67], a[180:183], v[84:87], a[64:67]
  buffer_load_dwordx4 v2, s[12:15], s70 offen offset:128 lds
  s_add_u32 m0, s74, 111488
  v_mfma_f32_16x16x32_bf16 a[68:71], a[180:183], v[88:91], a[68:71]
  ds_read_b64_tr_b16 a[194:195], v5 offset:46080
  v_add_f32 v55, v55, v73
  v_mfma_f32_16x16x32_bf16 a[68:71], a[176:179], a[232:235], a[68:71]
  ds_read_b128 a[200:203], v13 offset:2048
  v_lshlrev_b32 v28, 16, v74
  v_mfma_f32_16x16x32_bf16 a[72:75], a[176:179], a[236:239], a[72:75]
  ds_read_b64_tr_b16 a[244:245], v6 offset:4096
  v_and_b32 v74, 0xffff0000, v74
  v_mfma_f32_16x16x32_bf16 a[72:75], a[180:183], v[92:95], a[72:75]
  v_lshlrev_b32 v29, 16, v75
  v_and_b32 v75, 0xffff0000, v75
  v_mfma_f32_16x16x32_bf16 a[76:79], a[180:183], v[96:99], a[76:79]
  ds_read_b64_tr_b16 a[246:247], v6 offset:5120
  v_add_f32 v56, v56, v28
  v_mfma_f32_16x16x32_bf16 a[76:79], a[176:179], a[240:243], a[76:79]
  ds_read_b128 a[216:219], v14 offset:2048
  s_waitcnt lgkmcnt(7)
  v_mfma_f32_16x16x32_bf16 v[192:195], a[184:187], a[228:231], v[192:195]
  ds_read_b64_tr_b16 a[176:177], v5 offset:41472
  v_add_f32 v57, v57, v74
  v_mfma_f32_16x16x32_bf16 v[192:195], a[188:191], v[84:87], v[192:195]
  buffer_load_dwordx4 v2, s[12:15], s73 offen offset:128 lds
  s_sub_u32 s70, s70, 294912
  v_mfma_f32_16x16x32_bf16 v[196:199], a[188:191], v[88:91], v[196:199]
  ds_read_b64_tr_b16 a[178:179], v5 offset:42496
  s_sub_u32 s73, s73, 294912
  v_mfma_f32_16x16x32_bf16 v[196:199], a[184:187], a[232:235], v[196:199]
  ds_read_b128 a[204:207], v13 offset:4096
  s_sub_u32 s71, s71, s77
  v_mfma_f32_16x16x32_bf16 v[200:203], a[184:187], a[236:239], v[200:203]
  ds_read_b64_tr_b16 a[180:181], v6 offset:512
  v_add_f32 v58, v58, v29
  v_mfma_f32_16x16x32_bf16 v[200:203], a[188:191], v[92:95], v[200:203]
  v_add_f32 v59, v59, v75
  v_mfma_f32_16x16x32_bf16 v[204:207], a[188:191], v[96:99], v[204:207]
  ds_read_b64_tr_b16 a[182:183], v6 offset:1536
  global_load_dwordx4 v[68:71], v[48:49], off
  v_mfma_f32_16x16x32_bf16 v[204:207], a[184:187], a[240:243], v[204:207]
  ds_read_b128 a[220:223], v14 offset:4096
  s_waitcnt lgkmcnt(7)
  v_mfma_f32_16x16x32_bf16 a[80:83], a[192:195], a[228:231], a[80:83]
  ds_read_b64_tr_b16 a[184:185], v5 offset:45568
  v_lshl_add_u64 v[48:49], v[50:51], 0, v[48:49]
  v_mfma_f32_16x16x32_bf16 a[80:83], a[244:247], v[84:87], a[80:83]
  global_load_dwordx4 v[72:75], v[48:49], off
  v_lshl_add_u64 v[48:49], v[50:51], 0, v[48:49]
  v_mfma_f32_16x16x32_bf16 a[84:87], a[244:247], v[88:91], a[84:87]
  ds_read_b64_tr_b16 a[186:187], v5 offset:46592
  s_waitcnt vmcnt(17)
  v_lshlrev_b32 v28, 16, v76
  v_mfma_f32_16x16x32_bf16 a[84:87], a[192:195], a[232:235], a[84:87]
  ds_read_b128 a[208:211], v13 offset:6144
  v_and_b32 v76, 0xffff0000, v76
  v_mfma_f32_16x16x32_bf16 a[88:91], a[192:195], a[236:239], a[88:91]
  ds_read_b64_tr_b16 a[188:189], v6 offset:4608
  v_lshlrev_b32 v29, 16, v77
  v_mfma_f32_16x16x32_bf16 a[88:91], a[244:247], v[92:95], a[88:91]
  v_and_b32 v77, 0xffff0000, v77
  v_add_f32 v52, v52, v28
  v_mfma_f32_16x16x32_bf16 a[92:95], a[244:247], v[96:99], a[92:95]
  ds_read_b64_tr_b16 a[190:191], v6 offset:5632
  v_add_f32 v53, v53, v76
  v_mfma_f32_16x16x32_bf16 a[92:95], a[192:195], a[240:243], a[92:95]
  ds_read_b128 a[224:227], v14 offset:6144
  s_waitcnt lgkmcnt(7)
  s_barrier
  v_mfma_f32_16x16x32_bf16 v[208:211], a[176:179], a[228:231], v[208:211]
  ds_read_b64_tr_b16 a[192:193], v5 offset:49152
  s_add_u32 s72, s72, 36864
  v_mfma_f32_16x16x32_bf16 v[208:211], a[180:183], v[84:87], v[208:211]
  s_add_u32 m0, s76, 24576
  v_add_f32 v54, v54, v29
  v_mfma_f32_16x16x32_bf16 v[212:215], a[180:183], v[88:91], v[212:215]
  ds_read_b64_tr_b16 a[194:195], v5 offset:50176
  v_add_f32 v55, v55, v77
  v_mfma_f32_16x16x32_bf16 v[212:215], a[176:179], a[232:235], v[212:215]
  buffer_load_dwordx4 v4, s[8:11], s72 offen lds
  s_add_u32 m0, s75, 0
  v_mfma_f32_16x16x32_bf16 v[216:219], a[176:179], a[236:239], v[216:219]
  ds_read_b64_tr_b16 a[244:245], v6 offset:8192
  v_lshlrev_b32 v28, 16, v78
  v_mfma_f32_16x16x32_bf16 v[216:219], a[180:183], v[92:95], v[216:219]
  v_and_b32 v78, 0xffff0000, v78
  v_lshlrev_b32 v29, 16, v79
  v_mfma_f32_16x16x32_bf16 v[220:223], a[180:183], v[96:99], v[220:223]
  ds_read_b64_tr_b16 a[246:247], v6 offset:9216
  v_and_b32 v79, 0xffff0000, v79
  v_mfma_f32_16x16x32_bf16 v[220:223], a[176:179], a[240:243], v[220:223]
  buffer_load_dwordx4 v3, s[16:19], s71 offen lds
  s_waitcnt lgkmcnt(5)
  v_mfma_f32_16x16x32_bf16 a[96:99], a[184:187], a[228:231], a[96:99]
  ds_read_b64_tr_b16 a[176:177], v5 offset:53248
  s_add_u32 s70, s70, 256
  v_mfma_f32_16x16x32_bf16 a[96:99], a[188:191], v[84:87], a[96:99]
  s_add_u32 s73, s73, 256
  s_add_u32 m0, s74, 0
  v_mfma_f32_16x16x32_bf16 a[100:103], a[188:191], v[88:91], a[100:103]
  ds_read_b64_tr_b16 a[178:179], v5 offset:54272
  v_add_f32 v56, v56, v28
  v_mfma_f32_16x16x32_bf16 a[100:103], a[184:187], a[232:235], a[100:103]
  buffer_load_dwordx4 v2, s[12:15], s70 offen offset:0 lds
  s_add_u32 m0, s74, 1024
  v_mfma_f32_16x16x32_bf16 a[104:107], a[184:187], a[236:239], a[104:107]
  ds_read_b64_tr_b16 a[180:181], v6 offset:12288
  v_add_f32 v57, v57, v78
  v_mfma_f32_16x16x32_bf16 a[104:107], a[188:191], v[92:95], a[104:107]
  v_add_f32 v58, v58, v29
  v_add_f32 v59, v59, v79
  v_mfma_f32_16x16x32_bf16 a[108:111], a[188:191], v[96:99], a[108:111]
  ds_read_b64_tr_b16 a[182:183], v6 offset:13312
  s_waitcnt vmcnt(19)
  v_lshlrev_b32 v28, 16, v80
  v_mfma_f32_16x16x32_bf16 a[108:111], a[184:187], a[240:243], a[108:111]
  v_and_b32 v80, 0xffff0000, v80
  s_waitcnt lgkmcnt(4)
  v_mfma_f32_16x16x32_bf16 v[224:227], a[192:195], a[228:231], v[224:227]
  ds_read_b64_tr_b16 a[184:185], v5 offset:49664
  v_lshlrev_b32 v29, 16, v81
  v_mfma_f32_16x16x32_bf16 v[224:227], a[244:247], v[84:87], v[224:227]
  buffer_load_dwordx4 v2, s[12:15], s73 offen offset:0 lds
  s_add_u32 m0, s74, 8064
  v_mfma_f32_16x16x32_bf16 v[228:231], a[244:247], v[88:91], v[228:231]
  ds_read_b64_tr_b16 a[186:187], v5 offset:50688
  v_and_b32 v81, 0xffff0000, v81
  v_mfma_f32_16x16x32_bf16 v[228:231], a[192:195], a[232:235], v[228:231]
  v_add_f32 v52, v52, v28
  v_add_f32 v53, v53, v80
  v_mfma_f32_16x16x32_bf16 v[232:235], a[192:195], a[236:239], v[232:235]
  ds_read_b64_tr_b16 a[188:189], v6 offset:8704
  v_add_f32 v54, v54, v29
  v_mfma_f32_16x16x32_bf16 v[232:235], a[244:247], v[92:95], v[232:235]
  v_add_f32 v55, v55, v81
  v_lshlrev_b32 v28, 16, v82
  v_mfma_f32_16x16x32_bf16 v[236:239], a[244:247], v[96:99], v[236:239]
  ds_read_b64_tr_b16 a[190:191], v6 offset:9728
  v_and_b32 v82, 0xffff0000, v82
  v_mfma_f32_16x16x32_bf16 v[236:239], a[192:195], a[240:243], v[236:239]
  buffer_load_dwordx4 v2, s[12:15], s70 offen offset:128 lds
  s_waitcnt lgkmcnt(4)
  v_mfma_f32_16x16x32_bf16 a[112:115], a[176:179], a[228:231], a[112:115]
  ds_read_b64_tr_b16 a[192:193], v5 offset:53760
  s_add_u32 m0, s74, 9088
L_wc0_3:
L_pg3:
  s_cbranch_execz L_pg7
  v_mfma_f32_16x16x32_bf16 a[112:115], a[180:183], v[84:87], a[112:115]
  v_lshlrev_b32 v29, 16, v83
  v_and_b32 v83, 0xffff0000, v83
  v_mfma_f32_16x16x32_bf16 a[116:119], a[180:183], v[88:91], a[116:119]
  ds_read_b64_tr_b16 a[194:195], v5 offset:54784
  v_add_f32 v56, v56, v28
  v_mfma_f32_16x16x32_bf16 a[116:119], a[176:179], a[232:235], a[116:119]
  v_add_f32 v57, v57, v82
  v_add_f32 v58, v58, v29
  v_mfma_f32_16x16x32_bf16 a[120:123], a[176:179], a[236:239], a[120:123]
  ds_read_b64_tr_b16 a[244:245], v6 offset:12800
  v_add_f32 v59, v59, v83
  v_mfma_f32_16x16x32_bf16 a[120:123], a[180:183], v[92:95], a[120:123]
  buffer_load_dwordx4 v2, s[12:15], s73 offen offset:128 lds
  s_sub_u32 s70, s70, 256
  v_mfma_f32_16x16x32_bf16 a[124:127], a[180:183], v[96:99], a[124:127]
  ds_read_b64_tr_b16 a[246:247], v6 offset:13824
  s_sub_u32 s73, s73, 256
  v_mfma_f32_16x16x32_bf16 a[124:127], a[176:179], a[240:243], a[124:127]
  s_add_u32 s70, s70, 294912
  s_waitcnt lgkmcnt(4)
  v_mfma_f32_16x16x32_bf16 v[240:243], a[184:187], a[228:231], v[240:243]
  ds_read_b64_tr_b16 a[176:177], v7 offset:40960
  s_add_u32 s73, s73, 294912
  v_mfma_f32_16x16x32_bf16 v[240:243], a[188:191], v[84:87], v[240:243]
  s_add_u32 s71, s71, s77
  s_add_u32 s72, s72, 36864
  v_mfma_f32_16x16x32_bf16 v[244:247], a[188:191], v[88:91], v[244:247]
  ds_read_b64_tr_b16 a[178:179], v7 offset:41344
  s_add_u32 m0, s76, 28672
  v_mfma_f32_16x16x32_bf16 v[244:247], a[184:187], a[232:235], v[244:247]
  buffer_load_dwordx4 v4, s[8:11], s72 offen lds
  s_add_u32 m0, s75, 20480
  v_mfma_f32_16x16x32_bf16 v[248:251], a[184:187], a[236:239], v[248:251]
  ds_read_b64_tr_b16 a[180:181], v8 offset:0
  global_load_dwordx4 v[76:79], v[48:49], off
  v_mfma_f32_16x16x32_bf16 v[248:251], a[188:191], v[92:95], v[248:251]
  v_lshl_add_u64 v[48:49], v[50:51], 0, v[48:49]
  v_mfma_f32_16x16x32_bf16 v[252:255], a[188:191], v[96:99], v[252:255]
  ds_read_b64_tr_b16 a[182:183], v8 offset:384
  global_load_dwordx4 v[80:83], v[48:49], off
  v_mfma_f32_16x16x32_bf16 v[252:255], a[184:187], a[240:243], v[252:255]
  buffer_load_dwordx4 v3, s[16:19], s71 offen lds
  s_waitcnt lgkmcnt(4)
  v_mfma_f32_16x16x32_bf16 a[128:131], a[192:195], a[228:231], a[128:131]
  ds_read_b64_tr_b16 a[184:185], v9 offset:40960
  s_add_u32 m0, s74, 20224
  v_mfma_f32_16x16x32_bf16 a[128:131], a[244:247], v[84:87], a[128:131]
  s_waitcnt vmcnt(21)
  v_lshlrev_b32 v28, 16, v60
  v_and_b32 v60, 0xffff0000, v60
  v_mfma_f32_16x16x32_bf16 a[132:135], a[244:247], v[88:91], a[132:135]
  ds_read_b64_tr_b16 a[186:187], v11 offset:40960
  v_lshlrev_b32 v29, 16, v61
  v_mfma_f32_16x16x32_bf16 a[132:135], a[192:195], a[232:235], a[132:135]
  v_and_b32 v61, 0xffff0000, v61
  v_add_f32 v52, v52, v28
  v_mfma_f32_16x16x32_bf16 a[136:139], a[192:195], a[236:239], a[136:139]
  ds_read_b64_tr_b16 a[188:189], v10 offset:0
  v_add_f32 v53, v53, v60
  v_mfma_f32_16x16x32_bf16 a[136:139], a[244:247], v[92:95], a[136:139]
  buffer_load_dwordx4 v2, s[12:15], s70 offen offset:256 lds
  s_add_u32 m0, s74, 21248
  v_mfma_f32_16x16x32_bf16 a[140:143], a[244:247], v[96:99], a[140:143]
  ds_read_b64_tr_b16 a[190:191], v12 offset:0
  v_add_f32 v54, v54, v29
  v_mfma_f32_16x16x32_bf16 a[140:143], a[192:195], a[240:243], a[140:143]
  v_add_f32 v55, v55, v61
  s_waitcnt lgkmcnt(4)
  s_waitcnt vmcnt(13)
  s_barrier
  v_mfma_f32_16x16x32_bf16 a[144:147], a[176:179], a[228:231], a[144:147]
  ds_read_b64_tr_b16 a[192:193], v6 offset:20480
  v_lshlrev_b32 v28, 16, v62
  v_mfma_f32_16x16x32_bf16 a[144:147], a[180:183], v[84:87], a[144:147]
  v_and_b32 v62, 0xffff0000, v62
  v_lshlrev_b32 v29, 16, v63
  v_mfma_f32_16x16x32_bf16 a[148:151], a[180:183], v[88:91], a[148:151]
  ds_read_b64_tr_b16 a[194:195], v6 offset:21504
  v_and_b32 v63, 0xffff0000, v63
  v_mfma_f32_16x16x32_bf16 a[148:151], a[176:179], a[232:235], a[148:151]
  buffer_load_dwordx4 v2, s[12:15], s73 offen offset:256 lds
  s_add_u32 m0, s74, 28288
  v_mfma_f32_16x16x32_bf16 a[152:155], a[176:179], a[236:239], a[152:155]
  ds_read_b64_tr_b16 a[244:245], v6 offset:40960
  v_add_f32 v56, v56, v28
  v_mfma_f32_16x16x32_bf16 a[152:155], a[180:183], v[92:95], a[152:155]
  v_add_f32 v57, v57, v62
  v_add_f32 v58, v58, v29
  v_mfma_f32_16x16x32_bf16 a[156:159], a[180:183], v[96:99], a[156:159]
  ds_read_b64_tr_b16 a[246:247], v6 offset:41984
  v_add_f32 v59, v59, v63
  v_mfma_f32_16x16x32_bf16 a[156:159], a[176:179], a[240:243], a[156:159]
  buffer_load_dwordx4 v2, s[12:15], s70 offen offset:384 lds
  s_waitcnt lgkmcnt(4)
  v_mfma_f32_16x16x32_bf16 a[160:163], a[184:187], a[228:231], a[160:163]
  ds_read_b64_tr_b16 a[176:177], v6 offset:24576
  s_add_u32 m0, s74, 29312
  v_mfma_f32_16x16x32_bf16 a[160:163], a[188:191], v[84:87], a[160:163]
  v_lshlrev_b32 v28, 16, v64
  v_and_b32 v64, 0xffff0000, v64
  v_mfma_f32_16x16x32_bf16 a[164:167], a[188:191], v[88:91], a[164:167]
  ds_read_b64_tr_b16 a[178:179], v6 offset:25600
  v_lshlrev_b32 v29, 16, v65
  v_mfma_f32_16x16x32_bf16 a[164:167], a[184:187], a[232:235], a[164:167]
  v_and_b32 v65, 0xffff0000, v65
  v_add_f32 v52, v52, v28
  v_mfma_f32_16x16x32_bf16 a[168:171], a[184:187], a[236:239], a[168:171]
  ds_read_b64_tr_b16 a[180:181], v6 offset:45056
  v_add_f32 v53, v53, v64
  v_mfma_f32_16x16x32_bf16 a[168:171], a[188:191], v[92:95], a[168:171]
  buffer_load_dwordx4 v2, s[12:15], s73 offen offset:384 lds
  s_add_u32 s92, s92, 2
  v_mfma_f32_16x16x32_bf16 a[172:175], a[188:191], v[96:99], a[172:175]
  ds_read_b64_tr_b16 a[182:183], v6 offset:46080
  s_cmp_eq_u32 s92, 18
  s_cselect_b32 s92, 0, s92
  v_mfma_f32_16x16x32_bf16 a[172:175], a[184:187], a[240:243], a[172:175]
  s_mul_i32 s70, s92, 294912
  s_waitcnt lgkmcnt(4)
  v_mfma_f32_16x16x32_bf16 v[112:115], a[192:195], a[196:199], v[112:115]
  ds_read_b64_tr_b16 a[184:185], v6 offset:20992
  s_add_u32 s73, s70, 36864
  v_mfma_f32_16x16x32_bf16 v[112:115], a[244:247], a[212:215], v[112:115]
  s_mul_i32 s71, s92, s77
  v_add_f32 v54, v54, v29
  v_mfma_f32_16x16x32_bf16 v[116:119], a[244:247], a[216:219], v[116:119]
  ds_read_b64_tr_b16 a[186:187], v6 offset:22016
  v_add_f32 v55, v55, v65
  v_mfma_f32_16x16x32_bf16 v[116:119], a[192:195], a[200:203], v[116:119]
  v_lshlrev_b32 v28, 16, v66
  v_and_b32 v66, 0xffff0000, v66
  v_mfma_f32_16x16x32_bf16 v[120:123], a[192:195], a[204:207], v[120:123]
  ds_read_b64_tr_b16 a[188:189], v6 offset:41472
  v_lshlrev_b32 v29, 16, v67
  v_mfma_f32_16x16x32_bf16 v[120:123], a[244:247], a[220:223], v[120:123]
  v_and_b32 v67, 0xffff0000, v67
  v_add_f32 v56, v56, v28
  v_mfma_f32_16x16x32_bf16 v[124:127], a[244:247], a[224:227], v[124:127]
  ds_read_b64_tr_b16 a[190:191], v6 offset:42496
  v_add_f32 v57, v57, v66
  v_mfma_f32_16x16x32_bf16 v[124:127], a[192:195], a[208:211], v[124:127]
  v_add_f32 v58, v58, v29
  s_waitcnt lgkmcnt(4)
  v_mfma_f32_16x16x32_bf16 a[0:3], a[176:179], a[196:199], a[0:3]
  ds_read_b64_tr_b16 a[192:193], v6 offset:25088
  v_add_f32 v59, v59, v67
  v_mfma_f32_16x16x32_bf16 a[0:3], a[180:183], a[212:215], a[0:3]
  s_waitcnt vmcnt(15)
  v_lshlrev_b32 v28, 16, v68
  v_and_b32 v68, 0xffff0000, v68
  v_mfma_f32_16x16x32_bf16 a[4:7], a[180:183], a[216:219], a[4:7]
  ds_read_b64_tr_b16 a[194:195], v6 offset:26112
  v_lshlrev_b32 v29, 16, v69
  v_mfma_f32_16x16x32_bf16 a[4:7], a[176:179], a[200:203], a[4:7]
  v_and_b32 v69, 0xffff0000, v69
  v_add_f32 v52, v52, v28
  v_mfma_f32_16x16x32_bf16 a[8:11], a[176:179], a[204:207], a[8:11]
  ds_read_b64_tr_b16 a[244:245], v6 offset:45568
  v_add_f32 v53, v53, v68
  v_mfma_f32_16x16x32_bf16 a[8:11], a[180:183], a[220:223], a[8:11]
  v_add_f32 v54, v54, v29
  v_add_f32 v55, v55, v69
  v_mfma_f32_16x16x32_bf16 a[12:15], a[180:183], a[224:227], a[12:15]
  ds_read_b64_tr_b16 a[246:247], v6 offset:46592
  v_lshlrev_b32 v28, 16, v70
  v_mfma_f32_16x16x32_bf16 a[12:15], a[176:179], a[208:211], a[12:15]
  v_and_b32 v70, 0xffff0000, v70
  s_waitcnt lgkmcnt(4)
  s_barrier
  v_mfma_f32_16x16x32_bf16 v[128:131], a[184:187], a[196:199], v[128:131]
  ds_read_b64_tr_b16 a[176:177], v6 offset:28672
  s_add_u32 s95, s95, 128
  v_mfma_f32_16x16x32_bf16 v[128:131], a[188:191], a[212:215], v[128:131]
  s_cmp_eq_u32 s95, 1152
  s_cselect_b32 s95, 0, s95
  v_mfma_f32_16x16x32_bf16 v[132:135], a[188:191], a[216:219], v[132:135]
  ds_read_b64_tr_b16 a[178:179], v6 offset:29696
  s_add_u32 s72, s101, s95
  v_mfma_f32_16x16x32_bf16 v[132:135], a[184:187], a[200:203], v[132:135]
  s_add_u32 m0, s76, 0
  v_lshlrev_b32 v29, 16, v71
  v_mfma_f32_16x16x32_bf16 v[136:139], a[184:187], a[204:207], v[136:139]
  ds_read_b64_tr_b16 a[180:181], v6 offset:49152
  v_and_b32 v71, 0xffff0000, v71
  v_mfma_f32_16x16x32_bf16 v[136:139], a[188:191], a[220:223], v[136:139]
  buffer_load_dwordx4 v4, s[8:11], s72 offen lds
  s_add_u32 m0, s100, 40960
  v_mfma_f32_16x16x32_bf16 v[140:143], a[188:191], a[224:227], v[140:143]
  ds_read_b64_tr_b16 a[182:183], v6 offset:50176
  v_add_f32 v56, v56, v28
  v_mfma_f32_16x16x32_bf16 v[140:143], a[184:187], a[208:211], v[140:143]
  v_add_f32 v57, v57, v70
  s_waitcnt lgkmcnt(4)
  v_mfma_f32_16x16x32_bf16 a[16:19], a[192:195], a[196:199], a[16:19]
  ds_read_b64_tr_b16 a[184:185], v6 offset:32768
  v_add_f32 v58, v58, v29
  v_mfma_f32_16x16x32_bf16 a[16:19], a[244:247], a[212:215], a[16:19]
  buffer_load_dwordx4 v110, s[12:15], s70 offen lds
  s_add_u32 m0, s74, 40960
  v_mfma_f32_16x16x32_bf16 a[20:23], a[244:247], a[216:219], a[20:23]
  ds_read_b64_tr_b16 a[186:187], v6 offset:33792
  v_add_f32 v59, v59, v71
  v_mfma_f32_16x16x32_bf16 a[20:23], a[192:195], a[200:203], a[20:23]
  s_waitcnt vmcnt(16)
  v_lshlrev_b32 v28, 16, v72
  v_and_b32 v72, 0xffff0000, v72
  v_mfma_f32_16x16x32_bf16 a[24:27], a[192:195], a[204:207], a[24:27]
  ds_read_b64_tr_b16 a[188:189], v6 offset:53248
  v_lshlrev_b32 v29, 16, v73
  v_mfma_f32_16x16x32_bf16 a[24:27], a[244:247], a[220:223], a[24:27]
  buffer_load_dwordx4 v2, s[12:15], s70 offen offset:0 lds
  s_add_u32 m0, s74, 41984
  v_mfma_f32_16x16x32_bf16 a[28:31], a[244:247], a[224:227], a[28:31]
  ds_read_b64_tr_b16 a[190:191], v6 offset:54272
  v_and_b32 v73, 0xffff0000, v73
  v_mfma_f32_16x16x32_bf16 a[28:31], a[192:195], a[208:211], a[28:31]
  v_add_f32 v52, v52, v28
  s_waitcnt lgkmcnt(4)
  v_mfma_f32_16x16x32_bf16 v[144:147], a[176:179], a[196:199], v[144:147]
  ds_read_b64_tr_b16 a[192:193], v6 offset:29184
  v_add_f32 v53, v53, v72
  v_mfma_f32_16x16x32_bf16 v[144:147], a[180:183], a[212:215], v[144:147]
  v_add_f32 v54, v54, v29
  v_add_f32 v55, v55, v73
  v_mfma_f32_16x16x32_bf16 v[148:151], a[180:183], a[216:219], v[148:151]
  ds_read_b64_tr_b16 a[194:195], v6 offset:30208
  v_lshlrev_b32 v28, 16, v74
  v_mfma_f32_16x16x32_bf16 v[148:151], a[176:179], a[200:203], v[148:151]
  buffer_load_dwordx4 v2, s[12:15], s73 offen offset:0 lds
  s_add_u32 m0, s74, 49024
  v_mfma_f32_16x16x32_bf16 v[152:155], a[176:179], a[204:207], v[152:155]
  ds_read_b64_tr_b16 a[244:245], v6 offset:49664
  v_and_b32 v74, 0xffff0000, v74
  v_mfma_f32_16x16x32_bf16 v[152:155], a[180:183], a[220:223], v[152:155]
  v_lshlrev_b32 v29, 16, v75
  v_and_b32 v75, 0xffff0000, v75
  v_mfma_f32_16x16x32_bf16 v[156:159], a[180:183], a[224:227], v[156:159]
  ds_read_b64_tr_b16 a[246:247], v6 offset:50688
  v_add_f32 v56, v56, v28
  v_mfma_f32_16x16x32_bf16 v[156:159], a[176:179], a[208:211], v[156:159]
  v_add_f32 v57, v57, v74
  s_waitcnt lgkmcnt(4)
  v_mfma_f32_16x16x32_bf16 a[32:35], a[184:187], a[196:199], a[32:35]
  ds_read_b64_tr_b16 a[176:177], v6 offset:33280
  v_add_f32 v58, v58, v29
  v_mfma_f32_16x16x32_bf16 a[32:35], a[188:191], a[212:215], a[32:35]
  buffer_load_dwordx4 v2, s[12:15], s70 offen offset:128 lds
  s_add_u32 m0, s74, 50048
  v_mfma_f32_16x16x32_bf16 a[36:39], a[188:191], a[216:219], a[36:39]
  ds_read_b64_tr_b16 a[178:179], v6 offset:34304
  v_add_f32 v59, v59, v75
  v_mfma_f32_16x16x32_bf16 a[36:39], a[184:187], a[200:203], a[36:39]
  s_waitcnt vmcnt(11)
  v_lshlrev_b32 v28, 16, v76
  v_and_b32 v76, 0xffff0000, v76
  v_mfma_f32_16x16x32_bf16 a[40:43], a[184:187], a[204:207], a[40:43]
  ds_read_b64_tr_b16 a[180:181], v6 offset:53760
  v_lshlrev_b32 v29, 16, v77
  v_mfma_f32_16x16x32_bf16 a[40:43], a[188:191], a[220:223], a[40:43]
  v_and_b32 v77, 0xffff0000, v77
  v_add_f32 v52, v52, v28
  v_mfma_f32_16x16x32_bf16 a[44:47], a[188:191], a[224:227], a[44:47]
  ds_read_b64_tr_b16 a[182:183], v6 offset:54784
  v_add_f32 v53, v53, v76
  v_mfma_f32_16x16x32_bf16 a[44:47], a[184:187], a[208:211], a[44:47]
  buffer_load_dwordx4 v2, s[12:15], s73 offen offset:128 lds
  s_waitcnt lgkmcnt(4)
  v_mfma_f32_16x16x32_bf16 v[160:163], a[192:195], a[196:199], v[160:163]
  ds_read_b64_tr_b16 a[184:185], v45 offset:36864
  s_add_u32 s70, s70, 294912
  v_mfma_f32_16x16x32_bf16 v[160:163], a[244:247], a[212:215], v[160:163]
  s_add_u32 s73, s73, 294912
  s_add_u32 s71, s71, s77
  v_mfma_f32_16x16x32_bf16 v[164:167], a[244:247], a[216:219], v[164:167]
  ds_read_b64_tr_b16 a[186:187], v45 offset:37376
  s_add_u32 s72, s72, 36864
  v_mfma_f32_16x16x32_bf16 v[164:167], a[192:195], a[200:203], v[164:167]
  s_add_u32 m0, s76, 4096
  v_add_f32 v54, v54, v29
  v_mfma_f32_16x16x32_bf16 v[168:171], a[192:195], a[204:207], v[168:171]
  ds_read_b64_tr_b16 a[188:189], v45 offset:57344
  v_add_f32 v55, v55, v77
  v_mfma_f32_16x16x32_bf16 v[168:171], a[244:247], a[220:223], v[168:171]
  buffer_load_dwordx4 v4, s[8:11], s72 offen lds
  s_add_u32 m0, s100, 61440
  v_mfma_f32_16x16x32_bf16 v[172:175], a[244:247], a[224:227], v[172:175]
  ds_read_b64_tr_b16 a[190:191], v45 offset:57856
  v_lshlrev_b32 v28, 16, v78
  v_mfma_f32_16x16x32_bf16 v[172:175], a[192:195], a[208:211], v[172:175]
  v_and_b32 v78, 0xffff0000, v78
  s_waitcnt lgkmcnt(4)
  v_mfma_f32_16x16x32_bf16 a[48:51], a[176:179], a[196:199], a[48:51]
  ds_read_b64_tr_b16 a[192:193], v45 offset:38912
  v_lshlrev_b32 v29, 16, v79
  v_mfma_f32_16x16x32_bf16 a[48:51], a[180:183], a[212:215], a[48:51]
  buffer_load_dwordx4 v110, s[12:15], s70 offen lds
  s_add_u32 m0, s74, 61440
  v_mfma_f32_16x16x32_bf16 a[52:55], a[180:183], a[216:219], a[52:55]
  ds_read_b64_tr_b16 a[194:195], v45 offset:39424
  v_and_b32 v79, 0xffff0000, v79
  v_mfma_f32_16x16x32_bf16 a[52:55], a[176:179], a[200:203], a[52:55]
  v_add_f32 v56, v56, v28
  v_add_f32 v57, v57, v78
  v_mfma_f32_16x16x32_bf16 a[56:59], a[176:179], a[204:207], a[56:59]
  ds_read_b64_tr_b16 a[244:245], v45 offset:59392
  v_add_f32 v58, v58, v29
  v_mfma_f32_16x16x32_bf16 a[56:59], a[180:183], a[220:223], a[56:59]
  v_add_f32 v59, v59, v79
  s_waitcnt vmcnt(13)
  v_lshlrev_b32 v28, 16, v80
  v_mfma_f32_16x16x32_bf16 a[60:63], a[180:183], a[224:227], a[60:63]
  ds_read_b64_tr_b16 a[246:247], v45 offset:59904
  v_and_b32 v80, 0xffff0000, v80
  v_mfma_f32_16x16x32_bf16 a[60:63], a[176:179], a[208:211], a[60:63]
  buffer_load_dwordx4 v2, s[12:15], s70 offen offset:0 lds
  s_waitcnt lgkmcnt(4)
  s_waitcnt vmcnt(9)
  s_barrier
  v_mfma_f32_16x16x32_bf16 v[176:179], a[184:187], a[196:199], v[176:179]
  ds_read_b64_tr_b16 a[176:177], v5 offset:0
  s_add_u32 m0, s74, 62464
  v_mfma_f32_16x16x32_bf16 v[176:179], a[188:191], a[212:215], v[176:179]
  v_lshlrev_b32 v29, 16, v81
  v_and_b32 v81, 0xffff0000, v81
  v_mfma_f32_16x16x32_bf16 v[180:183], a[188:191], a[216:219], v[180:183]
  ds_read_b64_tr_b16 a[178:179], v5 offset:1024
  v_add_f32 v52, v52, v28
  v_mfma_f32_16x16x32_bf16 v[180:183], a[184:187], a[200:203], v[180:183]
  ds_read_b128 a[228:231], v13 offset:16384
  v_add_f32 v53, v53, v80
  v_mfma_f32_16x16x32_bf16 v[184:187], a[184:187], a[204:207], v[184:187]
  ds_read_b64_tr_b16 a[180:181], v5 offset:20480
  v_add_f32 v54, v54, v29
  v_mfma_f32_16x16x32_bf16 v[184:187], a[188:191], a[220:223], v[184:187]
  buffer_load_dwordx4 v2, s[12:15], s73 offen offset:0 lds
  s_add_u32 m0, s74, 69504
  v_mfma_f32_16x16x32_bf16 v[188:191], a[188:191], a[224:227], v[188:191]
  ds_read_b64_tr_b16 a[182:183], v5 offset:21504
  v_add_f32 v55, v55, v81
  v_mfma_f32_16x16x32_bf16 v[188:191], a[184:187], a[208:211], v[188:191]
  ds_read_b128 v[84:87], v14 offset:16384
  s_waitcnt lgkmcnt(6)
  v_mfma_f32_16x16x32_bf16 a[64:67], a[192:195], a[196:199], a[64:67]
  ds_read_b64_tr_b16 a[184:185], v5 offset:4096
  v_lshlrev_b32 v28, 16, v82
  v_mfma_f32_16x16x32_bf16 a[64:67], a[244:247], a[212:215], a[64:67]
  buffer_load_dwordx4 v2, s[12:15], s70 offen offset:128 lds
  s_add_u32 m0, s74, 70528
  v_mfma_f32_16x16x32_bf16 a[68:71], a[244:247], a[216:219], a[68:71]
  ds_read_b64_tr_b16 a[186:187], v5 offset:5120
  v_and_b32 v82, 0xffff0000, v82
  v_mfma_f32_16x16x32_bf16 a[68:71], a[192:195], a[200:203], a[68:71]
  ds_read_b128 a[232:235], v13 offset:18432
  v_lshlrev_b32 v29, 16, v83
  v_mfma_f32_16x16x32_bf16 a[72:75], a[192:195], a[204:207], a[72:75]
  ds_read_b64_tr_b16 a[188:189], v5 offset:24576
  v_and_b32 v83, 0xffff0000, v83
  v_mfma_f32_16x16x32_bf16 a[72:75], a[244:247], a[220:223], a[72:75]
  v_add_f32 v56, v56, v28
  v_add_f32 v57, v57, v82
  v_mfma_f32_16x16x32_bf16 a[76:79], a[244:247], a[224:227], a[76:79]
  ds_read_b64_tr_b16 a[190:191], v5 offset:25600
  v_add_f32 v58, v58, v29
  v_mfma_f32_16x16x32_bf16 a[76:79], a[192:195], a[208:211], a[76:79]
  ds_read_b128 v[88:91], v14 offset:18432
  s_waitcnt lgkmcnt(7)
  v_mfma_f32_16x16x32_bf16 v[192:195], a[176:179], a[196:199], v[192:195]
  ds_read_b64_tr_b16 a[192:193], v5 offset:512
  v_add_f32 v59, v59, v83
  v_mfma_f32_16x16x32_bf16 v[192:195], a[180:183], a[212:215], v[192:195]
  buffer_load_dwordx4 v2, s[12:15], s73 offen offset:128 lds
  s_sub_u32 s70, s70, 294912
  v_mfma_f32_16x16x32_bf16 v[196:199], a[180:183], a[216:219], v[196:199]
  ds_read_b64_tr_b16 a[194:195], v5 offset:1536
  s_sub_u32 s73, s73, 294912
  v_mfma_f32_16x16x32_bf16 v[196:199], a[176:179], a[200:203], v[196:199]
  ds_read_b128 a[236:239], v13 offset:20480
  s_sub_u32 s71, s71, s77
  v_mfma_f32_16x16x32_bf16 v[200:203], a[176:179], a[204:207], v[200:203]
  ds_read_b64_tr_b16 a[244:245], v5 offset:20992
  buffer_load_dword v109, off, s[36:39], 0
  v_mfma_f32_16x16x32_bf16 v[200:203], a[180:183], a[220:223], v[200:203]
  v_permlane32_swap_b32 v52, v56
  v_permlane32_swap_b32 v53, v57
  v_mfma_f32_16x16x32_bf16 v[204:207], a[180:183], a[224:227], v[204:207]
  ds_read_b64_tr_b16 a[246:247], v5 offset:22016
  v_permlane32_swap_b32 v54, v58
  v_mfma_f32_16x16x32_bf16 v[204:207], a[176:179], a[208:211], v[204:207]
  ds_read_b128 v[92:95], v14 offset:20480
  s_waitcnt lgkmcnt(7)
  v_mfma_f32_16x16x32_bf16 a[80:83], a[184:187], a[196:199], a[80:83]
  ds_read_b64_tr_b16 a[176:177], v5 offset:4608
  v_permlane32_swap_b32 v55, v59
  v_mfma_f32_16x16x32_bf16 a[80:83], a[188:191], a[212:215], a[80:83]
  v_add_f32 v52, v52, v56
  v_add_f32 v53, v53, v57
  v_mfma_f32_16x16x32_bf16 a[84:87], a[188:191], a[216:219], a[84:87]
  ds_read_b64_tr_b16 a[178:179], v5 offset:5632
  v_add_f32 v54, v54, v58
  v_mfma_f32_16x16x32_bf16 a[84:87], a[184:187], a[200:203], a[84:87]
  ds_read_b128 a[240:243], v13 offset:22528
  v_add_f32 v55, v55, v59
  v_mfma_f32_16x16x32_bf16 a[88:91], a[184:187], a[204:207], a[88:91]
  ds_read_b64_tr_b16 a[180:181], v5 offset:25088
  s_mul_i32 s79, s65, 10240
  v_mfma_f32_16x16x32_bf16 a[88:91], a[188:191], a[220:223], a[88:91]
  s_add_u32 s79, s79, 65536
  v_permlane16_swap_b32 v52, v54
  v_mfma_f32_16x16x32_bf16 a[92:95], a[188:191], a[224:227], a[92:95]
  ds_read_b64_tr_b16 a[182:183], v5 offset:26112
  v_permlane16_swap_b32 v53, v55
  v_mfma_f32_16x16x32_bf16 a[92:95], a[184:187], a[208:211], a[92:95]
  ds_read_b128 v[96:99], v14 offset:22528
  s_waitcnt lgkmcnt(7)
  s_barrier
  v_mfma_f32_16x16x32_bf16 v[208:211], a[192:195], a[196:199], v[208:211]
  ds_read_b64_tr_b16 a[184:185], v5 offset:8192
  s_add_u32 s72, s72, 36864
  v_mfma_f32_16x16x32_bf16 v[208:211], a[244:247], a[212:215], v[208:211]
  s_add_u32 m0, s76, 8192
  v_add_f32 v52, v52, v54
  v_mfma_f32_16x16x32_bf16 v[212:215], a[244:247], a[216:219], v[212:215]
  ds_read_b64_tr_b16 a[186:187], v5 offset:9216
  v_add_f32 v53, v53, v55
  v_mfma_f32_16x16x32_bf16 v[212:215], a[192:195], a[200:203], v[212:215]
  buffer_load_dwordx4 v4, s[8:11], s72 offen lds
  s_add_u32 m0, s75, 81920
  v_mfma_f32_16x16x32_bf16 v[216:219], a[192:195], a[204:207], v[216:219]
  ds_read_b64_tr_b16 a[188:189], v5 offset:28672
  v_lshlrev_b32 v51, 5, v111
  v_mfma_f32_16x16x32_bf16 v[216:219], a[244:247], a[220:223], v[216:219]
  v_lshrrev_b32 v61, 4, v1
  v_add_f32_dpp v52, v52, v52 row_ror:4 row_mask:0xf bank_mask:0xf
  v_mfma_f32_16x16x32_bf16 v[220:223], a[244:247], a[224:227], v[220:223]
  ds_read_b64_tr_b16 a[190:191], v5 offset:29696
  v_add_f32_dpp v53, v53, v53 row_ror:4 row_mask:0xf bank_mask:0xf
  v_mfma_f32_16x16x32_bf16 v[220:223], a[192:195], a[208:211], v[220:223]
  buffer_load_dwordx4 v3, s[16:19], s71 offen lds
  s_waitcnt lgkmcnt(5)
  v_mfma_f32_16x16x32_bf16 a[96:99], a[176:179], a[196:199], a[96:99]
  ds_read_b64_tr_b16 a[192:193], v5 offset:12288
  s_add_u32 m0, s74, 81664
  v_mfma_f32_16x16x32_bf16 a[96:99], a[180:183], a[212:215], a[96:99]
  v_lshl_add_u32 v51, v61, 3, v51
  v_and_b32 v60, 12, v1
  v_mfma_f32_16x16x32_bf16 a[100:103], a[180:183], a[216:219], a[100:103]
  ds_read_b64_tr_b16 a[194:195], v5 offset:13312
  v_add_f32_dpp v52, v52, v52 row_ror:8 row_mask:0xf bank_mask:0xf
  v_mfma_f32_16x16x32_bf16 a[100:103], a[176:179], a[200:203], a[100:103]
  buffer_load_dwordx4 v2, s[12:15], s70 offen offset:256 lds
  s_add_u32 m0, s74, 82688
  v_mfma_f32_16x16x32_bf16 a[104:107], a[176:179], a[204:207], a[104:107]
  ds_read_b64_tr_b16 a[244:245], v5 offset:32768
  v_add_f32_dpp v53, v53, v53 row_ror:8 row_mask:0xf bank_mask:0xf
  v_mfma_f32_16x16x32_bf16 a[104:107], a[180:183], a[220:223], a[104:107]
  v_cmp_eq_u32 vcc, 0, v60
  v_mov_b32 v61, 1073741824
  v_mfma_f32_16x16x32_bf16 a[108:111], a[180:183], a[224:227], a[108:111]
  ds_read_b64_tr_b16 a[246:247], v5 offset:33792
  s_add_u32 s79, s79, s69
  v_mfma_f32_16x16x32_bf16 a[108:111], a[176:179], a[208:211], a[108:111]
  v_cndmask_b32 v51, v61, v51, vcc
  s_waitcnt lgkmcnt(4)
  v_mfma_f32_16x16x32_bf16 v[224:227], a[184:187], a[196:199], v[224:227]
  ds_read_b64_tr_b16 a[176:177], v5 offset:8704
  buffer_store_dwordx2 v[52:53], v51, s[28:31], s79 offen sc1
  v_mfma_f32_16x16x32_bf16 v[224:227], a[188:191], a[212:215], v[224:227]
  buffer_load_dwordx4 v2, s[12:15], s73 offen offset:256 lds
  s_add_u32 m0, s74, 89728
  v_mfma_f32_16x16x32_bf16 v[228:231], a[188:191], a[216:219], v[228:231]
  ds_read_b64_tr_b16 a[178:179], v5 offset:9728
  buffer_store_dwordx2 v[36:37], v46, s[28:31], 0 offen sc1
  v_mfma_f32_16x16x32_bf16 v[228:231], a[184:187], a[200:203], v[228:231]
  s_add_u32 s78, s43, 0
  buffer_store_dwordx4 v[40:43], v38, s[28:31], s78 offen sc1
  v_mfma_f32_16x16x32_bf16 v[232:235], a[184:187], a[204:207], v[232:235]
  ds_read_b64_tr_b16 a[180:181], v5 offset:29184
  s_add_u32 s78, s43, 36864
  v_mfma_f32_16x16x32_bf16 v[232:235], a[188:191], a[220:223], v[232:235]
  buffer_store_dwordx4 v[40:43], v38, s[28:31], s78 offen sc1
  buffer_store_dword v40, v39, s[28:31], s43 offen sc1
  v_mfma_f32_16x16x32_bf16 v[236:239], a[188:191], a[224:227], v[236:239]
  ds_read_b64_tr_b16 a[182:183], v5 offset:30208
  v_accvgpr_write_b32 a252, v38
  v_mfma_f32_16x16x32_bf16 v[236:239], a[184:187], a[208:211], v[236:239]
  buffer_load_dwordx4 v2, s[12:15], s70 offen offset:384 lds
  s_waitcnt lgkmcnt(4)
  v_mfma_f32_16x16x32_bf16 a[112:115], a[192:195], a[196:199], a[112:115]
  ds_read_b64_tr_b16 a[184:185], v5 offset:12800
  s_add_u32 m0, s74, 90752
  v_mfma_f32_16x16x32_bf16 a[112:115], a[244:247], a[212:215], a[112:115]
  v_accvgpr_write_b32 a253, v39
  v_mfma_f32_16x16x32_bf16 a[116:119], a[244:247], a[216:219], a[116:119]
  ds_read_b64_tr_b16 a[186:187], v5 offset:13824
  v_mfma_f32_16x16x32_bf16 a[116:119], a[192:195], a[200:203], a[116:119]
  v_mfma_f32_16x16x32_bf16 a[120:123], a[192:195], a[204:207], a[120:123]
  ds_read_b64_tr_b16 a[188:189], v5 offset:33280
  v_mfma_f32_16x16x32_bf16 a[120:123], a[244:247], a[220:223], a[120:123]
  buffer_load_dwordx4 v2, s[12:15], s73 offen offset:384 lds
  s_add_u32 s70, s70, 294912
  v_mfma_f32_16x16x32_bf16 a[124:127], a[244:247], a[224:227], a[124:127]
  ds_read_b64_tr_b16 a[190:191], v5 offset:34304
  s_add_u32 s73, s73, 294912
  v_mfma_f32_16x16x32_bf16 a[124:127], a[192:195], a[208:211], a[124:127]
  s_add_u32 s71, s71, s77
  s_waitcnt lgkmcnt(4)
  v_mfma_f32_16x16x32_bf16 v[240:243], a[176:179], a[196:199], v[240:243]
  ds_read_b64_tr_b16 a[192:193], v7 offset:0
  s_add_u32 s72, s72, 36864
  v_mfma_f32_16x16x32_bf16 v[240:243], a[180:183], a[212:215], v[240:243]
  s_add_u32 m0, s76, 12288
  v_mfma_f32_16x16x32_bf16 v[244:247], a[180:183], a[216:219], v[244:247]
  ds_read_b64_tr_b16 a[194:195], v7 offset:384
  v_mfma_f32_16x16x32_bf16 v[244:247], a[176:179], a[200:203], v[244:247]
  buffer_load_dwordx4 v4, s[8:11], s72 offen lds
  s_add_u32 m0, s75, 102400
  v_mfma_f32_16x16x32_bf16 v[248:251], a[176:179], a[204:207], v[248:251]
  ds_read_b64_tr_b16 a[244:245], v7 offset:20480
  v_mfma_f32_16x16x32_bf16 v[248:251], a[180:183], a[220:223], v[248:251]
  v_mfma_f32_16x16x32_bf16 v[252:255], a[180:183], a[224:227], v[252:255]
  ds_read_b64_tr_b16 a[246:247], v7 offset:20864
  v_mfma_f32_16x16x32_bf16 v[252:255], a[176:179], a[208:211], v[252:255]
  buffer_load_dwordx4 v3, s[16:19], s71 offen lds
  s_waitcnt lgkmcnt(4)
  v_mfma_f32_16x16x32_bf16 a[128:131], a[184:187], a[196:199], a[128:131]
  ds_read_b64_tr_b16 a[176:177], v9 offset:0
  s_add_u32 m0, s74, 102144
  v_mfma_f32_16x16x32_bf16 a[128:131], a[188:191], a[212:215], a[128:131]
  v_mfma_f32_16x16x32_bf16 a[132:135], a[188:191], a[216:219], a[132:135]
  ds_read_b64_tr_b16 a[178:179], v11 offset:0
  v_mfma_f32_16x16x32_bf16 a[132:135], a[184:187], a[200:203], a[132:135]
  v_mfma_f32_16x16x32_bf16 a[136:139], a[184:187], a[204:207], a[136:139]
  ds_read_b64_tr_b16 a[180:181], v9 offset:20480
  v_mfma_f32_16x16x32_bf16 a[136:139], a[188:191], a[220:223], a[136:139]
  buffer_load_dwordx4 v2, s[12:15], s70 offen offset:256 lds
  s_add_u32 m0, s74, 103168
  v_mfma_f32_16x16x32_bf16 a[140:143], a[188:191], a[224:227], a[140:143]
  ds_read_b64_tr_b16 a[182:183], v11 offset:20480
  v_mfma_f32_16x16x32_bf16 a[140:143], a[184:187], a[208:211], a[140:143]
  s_waitcnt lgkmcnt(4)
  s_waitcnt vmcnt(15)
  s_barrier
  v_mfma_f32_16x16x32_bf16 a[144:147], a[192:195], a[196:199], a[144:147]
  ds_read_b64_tr_b16 a[184:185], v5 offset:40960
  v_mfma_f32_16x16x32_bf16 a[144:147], a[244:247], a[212:215], a[144:147]
  v_mfma_f32_16x16x32_bf16 a[148:151], a[244:247], a[216:219], a[148:151]
  ds_read_b64_tr_b16 a[186:187], v5 offset:41984
  v_mfma_f32_16x16x32_bf16 a[148:151], a[192:195], a[200:203], a[148:151]
  buffer_load_dwordx4 v2, s[12:15], s73 offen offset:256 lds
  s_add_u32 m0, s74, 110208
  v_mfma_f32_16x16x32_bf16 a[152:155], a[192:195], a[204:207], a[152:155]
  ds_read_b64_tr_b16 a[188:189], v6 offset:0
  v_mfma_f32_16x16x32_bf16 a[152:155], a[244:247], a[220:223], a[152:155]
  v_mfma_f32_16x16x32_bf16 a[156:159], a[244:247], a[224:227], a[156:159]
  ds_read_b64_tr_b16 a[190:191], v6 offset:1024
  v_mfma_f32_16x16x32_bf16 a[156:159], a[192:195], a[208:211], a[156:159]
  buffer_load_dwordx4 v2, s[12:15], s70 offen offset:384 lds
  s_waitcnt lgkmcnt(4)
  v_mfma_f32_16x16x32_bf16 a[160:163], a[176:179], a[196:199], a[160:163]
  ds_read_b64_tr_b16 a[192:193], v5 offset:45056
  s_add_u32 m0, s74, 111232
  v_mfma_f32_16x16x32_bf16 a[160:163], a[180:183], a[212:215], a[160:163]
  v_mfma_f32_16x16x32_bf16 a[164:167], a[180:183], a[216:219], a[164:167]
  ds_read_b64_tr_b16 a[194:195], v5 offset:46080
  v_mfma_f32_16x16x32_bf16 a[164:167], a[176:179], a[200:203], a[164:167]
  v_mfma_f32_16x16x32_bf16 a[168:171], a[176:179], a[204:207], a[168:171]
  ds_read_b64_tr_b16 a[244:245], v6 offset:4096
  v_mfma_f32_16x16x32_bf16 a[168:171], a[180:183], a[220:223], a[168:171]
  buffer_load_dwordx4 v2, s[12:15], s73 offen offset:384 lds
  s_add_u32 s92, s92, 2
  v_mfma_f32_16x16x32_bf16 a[172:175], a[180:183], a[224:227], a[172:175]
  ds_read_b64_tr_b16 a[246:247], v6 offset:5120
  s_cmp_eq_u32 s92, 18
  s_cselect_b32 s92, 0, s92
  v_mfma_f32_16x16x32_bf16 a[172:175], a[176:179], a[208:211], a[172:175]
  s_mul_i32 s70, s92, 294912
  s_waitcnt lgkmcnt(4)
  v_mfma_f32_16x16x32_bf16 v[112:115], a[184:187], a[228:231], v[112:115]
  ds_read_b64_tr_b16 a[176:177], v5 offset:41472
  s_add_u32 s73, s70, 36864
  v_mfma_f32_16x16x32_bf16 v[112:115], a[188:191], v[84:87], v[112:115]
  s_mul_i32 s71, s92, s77
  v_mfma_f32_16x16x32_bf16 v[116:119], a[188:191], v[88:91], v[116:119]
  ds_read_b64_tr_b16 a[178:179], v5 offset:42496
  v_mfma_f32_16x16x32_bf16 v[116:119], a[184:187], a[232:235], v[116:119]
L_pg4:
  s_cbranch_execz L_pg8
  v_mfma_f32_16x16x32_bf16 v[120:123], a[184:187], a[236:239], v[120:123]
  ds_read_b64_tr_b16 a[180:181], v6 offset:512
  v_mfma_f32_16x16x32_bf16 v[120:123], a[188:191], v[92:95], v[120:123]
  v_mfma_f32_16x16x32_bf16 v[124:127], a[188:191], v[96:99], v[124:127]
  ds_read_b64_tr_b16 a[182:183], v6 offset:1536
  v_mfma_f32_16x16x32_bf16 v[124:127], a[184:187], a[240:243], v[124:127]
  s_waitcnt lgkmcnt(4)
  v_mfma_f32_16x16x32_bf16 a[0:3], a[192:195], a[228:231], a[0:3]
  ds_read_b64_tr_b16 a[184:185], v5 offset:45568
  v_mfma_f32_16x16x32_bf16 a[0:3], a[244:247], v[84:87], a[0:3]
  v_mfma_f32_16x16x32_bf16 a[4:7], a[244:247], v[88:91], a[4:7]
  ds_read_b64_tr_b16 a[186:187], v5 offset:46592
  v_mfma_f32_16x16x32_bf16 a[4:7], a[192:195], a[232:235], a[4:7]
  v_mfma_f32_16x16x32_bf16 a[8:11], a[192:195], a[236:239], a[8:11]
  ds_read_b64_tr_b16 a[188:189], v6 offset:4608
  v_mfma_f32_16x16x32_bf16 a[8:11], a[244:247], v[92:95], a[8:11]
  v_mfma_f32_16x16x32_bf16 a[12:15], a[244:247], v[96:99], a[12:15]
  ds_read_b64_tr_b16 a[190:191], v6 offset:5632
  v_mfma_f32_16x16x32_bf16 a[12:15], a[192:195], a[240:243], a[12:15]
  s_waitcnt lgkmcnt(4)
  s_waitcnt vmcnt(8)
  s_barrier
  v_readfirstlane_b32 s59, v109
  s_nop 0
  s_cmp_lg_u32 s59, 0
  s_cbranch_scc0 L_N_spin
L_N_ok:
  v_mfma_f32_16x16x32_bf16 v[128:131], a[176:179], a[228:231], v[128:131]
  ds_read_b64_tr_b16 a[192:193], v5 offset:49152
  s_add_u32 s95, s95, 128
  v_mfma_f32_16x16x32_bf16 v[128:131], a[180:183], v[84:87], v[128:131]
  s_cmp_eq_u32 s95, 1152
  s_cselect_b32 s95, 0, s95
  v_mfma_f32_16x16x32_bf16 v[132:135], a[180:183], v[88:91], v[132:135]
  ds_read_b64_tr_b16 a[194:195], v5 offset:50176
  s_add_u32 s72, s101, s95
  v_mfma_f32_16x16x32_bf16 v[132:135], a[176:179], a[232:235], v[132:135]
  s_add_u32 m0, s76, 16384
  s_add_u32 s99, s60, 0
  v_mov_b32 v76, s59
  s_mov_b64 exec, 1
  buffer_store_dword v76, off, s[28:31], s99 sc1
  s_mov_b64 exec, -1
  v_mfma_f32_16x16x32_bf16 v[136:139], a[176:179], a[236:239], v[136:139]
  ds_read_b64_tr_b16 a[244:245], v6 offset:8192
  v_lshrrev_b32 v76, 4, v1
  v_mfma_f32_16x16x32_bf16 v[136:139], a[180:183], v[92:95], v[136:139]
  buffer_load_dwordx4 v4, s[8:11], s72 offen lds
  s_add_u32 m0, s100, 0
  v_mfma_f32_16x16x32_bf16 v[140:143], a[180:183], v[96:99], v[140:143]
  ds_read_b64_tr_b16 a[246:247], v6 offset:9216
  v_and_b32 v77, 15, v1
  v_mfma_f32_16x16x32_bf16 v[140:143], a[176:179], a[240:243], v[140:143]
  v_and_b32 v78, 1, v76
  s_waitcnt lgkmcnt(4)
  v_mfma_f32_16x16x32_bf16 a[16:19], a[184:187], a[228:231], a[16:19]
  ds_read_b64_tr_b16 a[176:177], v5 offset:53248
  v_mul_u32_u24 v78, 288, v78
  v_mfma_f32_16x16x32_bf16 a[16:19], a[188:191], v[84:87], a[16:19]
  buffer_load_dwordx4 v110, s[12:15], s70 offen lds
  s_add_u32 m0, s74, 0
  v_mfma_f32_16x16x32_bf16 a[20:23], a[188:191], v[88:91], a[20:23]
  ds_read_b64_tr_b16 a[178:179], v5 offset:54272
  v_lshrrev_b32 v79, 1, v76
  v_mfma_f32_16x16x32_bf16 a[20:23], a[184:187], a[232:235], a[20:23]
  v_lshl_add_u32 v78, v79, 5, v78
  s_and_b32 s80, s65, 1
  v_mfma_f32_16x16x32_bf16 a[24:27], a[184:187], a[236:239], a[24:27]
  ds_read_b64_tr_b16 a[180:181], v6 offset:12288
  s_lshl_b32 s80, s80, 1
  v_mfma_f32_16x16x32_bf16 a[24:27], a[188:191], v[92:95], a[24:27]
  buffer_load_dwordx4 v2, s[12:15], s70 offen offset:0 lds
  s_add_u32 m0, s74, 1024
  v_mfma_f32_16x16x32_bf16 a[28:31], a[188:191], v[96:99], a[28:31]
  ds_read_b64_tr_b16 a[182:183], v6 offset:13312
  s_add_u32 s79, s68, s80
  v_mfma_f32_16x16x32_bf16 a[28:31], a[184:187], a[240:243], a[28:31]
  s_lshl_b32 s79, s79, 4
  s_waitcnt lgkmcnt(4)
  v_mfma_f32_16x16x32_bf16 v[144:147], a[192:195], a[228:231], v[144:147]
  ds_read_b64_tr_b16 a[184:185], v5 offset:49664
  v_add3_u32 v78, v78, v77, s79
  v_mfma_f32_16x16x32_bf16 v[144:147], a[244:247], v[84:87], v[144:147]
  v_lshlrev_b32 v108, 2, v78
  v_subrev_u32 v82, 128, v108
  v_mfma_f32_16x16x32_bf16 v[148:151], a[244:247], v[88:91], v[148:151]
  ds_read_b64_tr_b16 a[186:187], v5 offset:50688
  s_bitcmp1_b32 s65, 0
  s_cselect_b32 s79, 4294966656, s49
  s_cselect_b32 s80, 0, 384
  v_mfma_f32_16x16x32_bf16 v[148:151], a[192:195], a[232:235], v[148:151]
  buffer_load_dwordx4 v2, s[12:15], s73 offen offset:0 lds
  s_add_u32 m0, s74, 8064
  v_mfma_f32_16x16x32_bf16 v[152:155], a[192:195], a[236:239], v[152:155]
  ds_read_b64_tr_b16 a[188:189], v6 offset:8704
  s_add_u32 s79, s79, s80
  v_mfma_f32_16x16x32_bf16 v[152:155], a[244:247], v[92:95], v[152:155]
  v_cmp_eq_u32 vcc, 0, v79
  v_add_u32 v83, s79, v108
  v_mfma_f32_16x16x32_bf16 v[156:159], a[244:247], v[96:99], v[156:159]
  ds_read_b64_tr_b16 a[190:191], v6 offset:9728
  v_add_u32 v78, 224, v78
  v_mfma_f32_16x16x32_bf16 v[156:159], a[192:195], a[240:243], v[156:159]
  v_cndmask_b32 v83, v82, v83, vcc
  s_waitcnt lgkmcnt(4)
  v_mfma_f32_16x16x32_bf16 a[32:35], a[176:179], a[228:231], a[32:35]
  ds_read_b64_tr_b16 a[192:193], v5 offset:53760
  s_mul_i32 s79, s68, 24
  v_mfma_f32_16x16x32_bf16 a[32:35], a[180:183], v[84:87], a[32:35]
  buffer_load_dwordx4 v2, s[12:15], s70 offen offset:128 lds
  s_add_u32 m0, s74, 9088
  v_mfma_f32_16x16x32_bf16 a[36:39], a[180:183], v[88:91], a[36:39]
  ds_read_b64_tr_b16 a[194:195], v5 offset:54784
  s_add_u32 s79, s79, 576
  v_mfma_f32_16x16x32_bf16 a[36:39], a[176:179], a[232:235], a[36:39]
  v_add_u32 v79, s79, v77
  v_cmp_eq_u32 vcc, 2, v76
  v_mfma_f32_16x16x32_bf16 a[40:43], a[176:179], a[236:239], a[40:43]
  ds_read_b64_tr_b16 a[244:245], v6 offset:12800
  s_lshl_b32 s80, s68, 3
  v_mfma_f32_16x16x32_bf16 a[40:43], a[180:183], v[92:95], a[40:43]
  s_add_u32 s80, s80, 620
  v_cndmask_b32 v78, v78, v79, vcc
  v_mfma_f32_16x16x32_bf16 a[44:47], a[180:183], v[96:99], a[44:47]
  ds_read_b64_tr_b16 a[246:247], v6 offset:13824
  v_add_u32 v79, 20, v79
  v_mfma_f32_16x16x32_bf16 a[44:47], a[176:179], a[240:243], a[44:47]
  buffer_load_dwordx4 v2, s[12:15], s73 offen offset:128 lds
  s_waitcnt lgkmcnt(4)
  v_mfma_f32_16x16x32_bf16 v[160:163], a[184:187], a[228:231], v[160:163]
  ds_read_b64_tr_b16 a[176:177], v44 offset:57344
  s_add_u32 s70, s70, 294912
  v_mfma_f32_16x16x32_bf16 v[160:163], a[188:191], v[84:87], v[160:163]
  s_add_u32 s73, s73, 294912
  s_add_u32 s71, s71, s77
  v_mfma_f32_16x16x32_bf16 v[164:167], a[188:191], v[88:91], v[164:167]
  ds_read_b64_tr_b16 a[178:179], v44 offset:57856
  s_add_u32 s72, s72, 36864
  v_mfma_f32_16x16x32_bf16 v[164:167], a[184:187], a[232:235], v[164:167]
  s_add_u32 m0, s76, 20480
  v_min_u32 v80, 11, v77
  v_mfma_f32_16x16x32_bf16 v[168:171], a[184:187], a[236:239], v[168:171]
  ds_read_b64_tr_b16 a[180:181], v45 offset:16384
  v_add_u32 v80, s80, v80
  v_mfma_f32_16x16x32_bf16 v[168:171], a[188:191], v[92:95], v[168:171]
  buffer_load_dwordx4 v4, s[8:11], s72 offen lds
  s_add_u32 m0, s100, 20480
  v_mfma_f32_16x16x32_bf16 v[172:175], a[188:191], v[96:99], v[172:175]
  ds_read_b64_tr_b16 a[182:183], v45 offset:16896
  v_cmp_gt_u32 vcc, 4, v77
  v_mfma_f32_16x16x32_bf16 v[172:175], a[184:187], a[240:243], v[172:175]
  s_mul_i32 s50, s65, 10240
  s_waitcnt lgkmcnt(4)
  v_mfma_f32_16x16x32_bf16 a[48:51], a[192:195], a[228:231], a[48:51]
  ds_read_b64_tr_b16 a[184:185], v44 offset:59392
  s_add_u32 s50, s50, 65536
  v_mfma_f32_16x16x32_bf16 a[48:51], a[244:247], v[84:87], a[48:51]
  buffer_load_dwordx4 v110, s[12:15], s70 offen lds
  s_add_u32 m0, s74, 20480
  v_mfma_f32_16x16x32_bf16 a[52:55], a[244:247], v[88:91], a[52:55]
  ds_read_b64_tr_b16 a[186:187], v44 offset:59904
  v_cndmask_b32 v79, v80, v79, vcc
  v_mfma_f32_16x16x32_bf16 a[52:55], a[192:195], a[232:235], a[52:55]
  v_cmp_eq_u32 vcc, 3, v76
  s_mul_i32 s79, s67, 36864
  v_mfma_f32_16x16x32_bf16 a[56:59], a[192:195], a[236:239], a[56:59]
  ds_read_b64_tr_b16 a[188:189], v45 offset:18432
  s_lshl_b32 s80, s68, 9
  v_mfma_f32_16x16x32_bf16 a[56:59], a[244:247], v[92:95], a[56:59]
  v_cndmask_b32 v78, v78, v79, vcc
  v_lshlrev_b32 v109, 2, v78
  v_mfma_f32_16x16x32_bf16 a[60:63], a[244:247], v[96:99], a[60:63]
  ds_read_b64_tr_b16 a[190:191], v45 offset:18944
  s_add_u32 s79, s79, 81920
  v_mfma_f32_16x16x32_bf16 a[60:63], a[192:195], a[240:243], a[60:63]
  buffer_load_dwordx4 v2, s[12:15], s70 offen offset:0 lds
  s_waitcnt lgkmcnt(4)
  s_waitcnt vmcnt(10)
  s_barrier
  v_mfma_f32_16x16x32_bf16 v[176:179], a[176:179], a[228:231], v[176:179]
  ds_read_b64_tr_b16 a[192:193], v6 offset:20480
  s_add_u32 m0, s74, 21504
  v_mfma_f32_16x16x32_bf16 v[176:179], a[180:183], v[84:87], v[176:179]
  s_add_u32 s79, s79, s80
  v_lshlrev_b32 v15, 3, v1
  v_mfma_f32_16x16x32_bf16 v[180:183], a[180:183], v[88:91], v[180:183]
  ds_read_b64_tr_b16 a[194:195], v6 offset:21504
  v_add_u32 v15, s79, v15
  v_mfma_f32_16x16x32_bf16 v[180:183], a[176:179], a[232:235], v[180:183]
  ds_read_b128 a[196:199], v13 offset:0
  v_xor_b32 v46, 512, v15
  v_mfma_f32_16x16x32_bf16 v[184:187], a[176:179], a[236:239], v[184:187]
  ds_read_b64_tr_b16 a[244:245], v6 offset:40960
  s_lshl_b32 s79, s64, 11
  v_mfma_f32_16x16x32_bf16 v[184:187], a[180:183], v[92:95], v[184:187]
  buffer_load_dwordx4 v2, s[12:15], s73 offen offset:0 lds
  s_add_u32 m0, s74, 28544
  v_mfma_f32_16x16x32_bf16 v[188:191], a[180:183], v[96:99], v[188:191]
  ds_read_b64_tr_b16 a[246:247], v6 offset:41984
  s_lshl_b32 s80, s65, 7
  v_mfma_f32_16x16x32_bf16 v[188:191], a[176:179], a[240:243], v[188:191]
  ds_read_b128 a[212:215], v14 offset:0
  s_waitcnt lgkmcnt(6)
  v_mfma_f32_16x16x32_bf16 a[64:67], a[184:187], a[228:231], a[64:67]
  ds_read_b64_tr_b16 a[176:177], v6 offset:24576
  v_lshlrev_b32 v79, 7, v77
  v_mfma_f32_16x16x32_bf16 a[64:67], a[188:191], v[84:87], a[64:67]
  buffer_load_dwordx4 v2, s[12:15], s70 offen offset:128 lds
  s_add_u32 m0, s74, 29568
  v_mfma_f32_16x16x32_bf16 a[68:71], a[188:191], v[88:91], a[68:71]
  ds_read_b64_tr_b16 a[178:179], v6 offset:25600
  v_add_u32 v79, s79, v79
  v_mfma_f32_16x16x32_bf16 a[68:71], a[184:187], a[232:235], a[68:71]
  ds_read_b128 a[200:203], v13 offset:2048
  v_lshlrev_b32 v80, 11, v77
  v_mfma_f32_16x16x32_bf16 a[72:75], a[184:187], a[236:239], a[72:75]
  ds_read_b64_tr_b16 a[180:181], v6 offset:45056
  v_and_b32 v76, 1, v76
  v_mfma_f32_16x16x32_bf16 a[72:75], a[188:191], v[92:95], a[72:75]
  v_cmp_eq_u32 vcc, 0, v76
  v_add_u32 v80, s80, v80
  v_mfma_f32_16x16x32_bf16 a[76:79], a[188:191], v[96:99], a[76:79]
  ds_read_b64_tr_b16 a[182:183], v6 offset:46080
  s_nop 0
  v_mfma_f32_16x16x32_bf16 a[76:79], a[184:187], a[240:243], a[76:79]
  ds_read_b128 a[216:219], v14 offset:2048
  s_waitcnt lgkmcnt(7)
  v_mfma_f32_16x16x32_bf16 v[192:195], a[192:195], a[228:231], v[192:195]
  ds_read_b64_tr_b16 a[184:185], v6 offset:20992
  v_cndmask_b32 v81, v80, v79, vcc
  v_mfma_f32_16x16x32_bf16 v[192:195], a[244:247], v[84:87], v[192:195]
  buffer_load_dwordx4 v2, s[12:15], s73 offen offset:128 lds
  s_sub_u32 s70, s70, 294912
  v_mfma_f32_16x16x32_bf16 v[196:199], a[244:247], v[88:91], v[196:199]
  ds_read_b64_tr_b16 a[186:187], v6 offset:22016
  s_sub_u32 s73, s73, 294912
  v_mfma_f32_16x16x32_bf16 v[196:199], a[192:195], a[232:235], v[196:199]
  ds_read_b128 a[204:207], v13 offset:4096
  s_sub_u32 s71, s71, s77
  v_mfma_f32_16x16x32_bf16 v[200:203], a[192:195], a[236:239], v[200:203]
  ds_read_b64_tr_b16 a[188:189], v6 offset:41472
  v_lshrrev_b32 v34, 4, v1
  v_mfma_f32_16x16x32_bf16 v[200:203], a[244:247], v[92:95], v[200:203]
  v_and_b32 v35, 15, v1
  s_lshl_b32 s58, s66, 12
  v_mfma_f32_16x16x32_bf16 v[204:207], a[244:247], v[96:99], v[204:207]
  ds_read_b64_tr_b16 a[190:191], v6 offset:42496
  s_add_u32 s58, s58, 81920
  v_mfma_f32_16x16x32_bf16 v[204:207], a[192:195], a[240:243], v[204:207]
  ds_read_b128 a[220:223], v14 offset:4096
  s_waitcnt lgkmcnt(7)
  v_mfma_f32_16x16x32_bf16 a[80:83], a[176:179], a[228:231], a[80:83]
  ds_read_b64_tr_b16 a[192:193], v6 offset:25088
  v_lshlrev_b32 v36, 5, v35
  v_mfma_f32_16x16x32_bf16 a[80:83], a[180:183], v[84:87], a[80:83]
  v_lshl_add_u32 v36, v34, 3, v36
  v_add_u32 v36, s58, v36
  v_mfma_f32_16x16x32_bf16 a[84:87], a[180:183], v[88:91], a[84:87]
  ds_read_b64_tr_b16 a[194:195], v6 offset:26112
  v_cmp_eq_u32 vcc, 0, v34
  v_mfma_f32_16x16x32_bf16 a[84:87], a[176:179], a[232:235], a[84:87]
  ds_read_b128 a[208:211], v13 offset:6144
  v_mov_b32 v28, 98304
  v_mfma_f32_16x16x32_bf16 a[88:91], a[176:179], a[236:239], a[88:91]
  ds_read_b64_tr_b16 a[244:245], v6 offset:45568
  s_add_u32 s79, s58, 2048
  v_mfma_f32_16x16x32_bf16 a[88:91], a[180:183], v[92:95], a[88:91]
  v_mov_b32 v29, s79
  v_cndmask_b32 v37, v28, v29, vcc
  v_mfma_f32_16x16x32_bf16 a[92:95], a[180:183], v[96:99], a[92:95]
  ds_read_b64_tr_b16 a[246:247], v6 offset:46592
  v_lshl_add_u32 v37, v35, 2, v37
  v_mfma_f32_16x16x32_bf16 a[92:95], a[176:179], a[240:243], a[92:95]
  ds_read_b128 a[224:227], v14 offset:6144
  s_waitcnt lgkmcnt(7)
  s_barrier
  v_mfma_f32_16x16x32_bf16 v[208:211], a[184:187], a[228:231], v[208:211]
  ds_read_b64_tr_b16 a[176:177], v6 offset:28672
  s_add_u32 s72, s72, 36864
  v_mfma_f32_16x16x32_bf16 v[208:211], a[188:191], v[84:87], v[208:211]
  s_add_u32 m0, s76, 24576
  v_mov_b32 v30, 0x3eae1a93
  v_mfma_f32_16x16x32_bf16 v[212:215], a[188:191], v[88:91], v[212:215]
  ds_read_b64_tr_b16 a[178:179], v6 offset:29696
  v_cndmask_b32 v42, 1.0, v30, vcc
  v_mfma_f32_16x16x32_bf16 v[212:215], a[184:187], a[232:235], v[212:215]
  buffer_load_dwordx4 v4, s[8:11], s72 offen lds
  s_add_u32 m0, s75, 40960
  v_mfma_f32_16x16x32_bf16 v[216:219], a[184:187], a[236:239], v[216:219]
  ds_read_b64_tr_b16 a[180:181], v6 offset:49152
  s_mov_b32 s54, 0xffff0000
  v_mfma_f32_16x16x32_bf16 v[216:219], a[188:191], v[92:95], v[216:219]
  s_mov_b32 s55, 0xffff
  s_add_u32 s79, s58, 2552
  v_mfma_f32_16x16x32_bf16 v[220:223], a[188:191], v[96:99], v[220:223]
  ds_read_b64_tr_b16 a[182:183], v6 offset:50176
  v_mov_b32 v29, s79
  v_mfma_f32_16x16x32_bf16 v[220:223], a[184:187], a[240:243], v[220:223]
  buffer_load_dwordx4 v3, s[16:19], s71 offen lds
  s_waitcnt lgkmcnt(5)
  v_mfma_f32_16x16x32_bf16 a[96:99], a[192:195], a[228:231], a[96:99]
  ds_read_b64_tr_b16 a[184:185], v6 offset:32768
  s_add_u32 m0, s74, 40704
  v_mfma_f32_16x16x32_bf16 a[96:99], a[244:247], v[84:87], a[96:99]
  v_cndmask_b32 v38, v28, v29, s[54:55]
  v_lshl_add_u32 v38, v35, 4, v38
  v_mfma_f32_16x16x32_bf16 a[100:103], a[244:247], v[88:91], a[100:103]
  ds_read_b64_tr_b16 a[186:187], v6 offset:33792
  v_lshl_add_u32 v38, v34, 3, v38
  v_mfma_f32_16x16x32_bf16 a[100:103], a[192:195], a[232:235], a[100:103]
  buffer_load_dwordx4 v2, s[12:15], s70 offen offset:256 lds
  s_add_u32 m0, s74, 41728
  v_mfma_f32_16x16x32_bf16 a[104:107], a[192:195], a[236:239], a[104:107]
  ds_read_b64_tr_b16 a[188:189], v6 offset:53248
  s_lshr_b32 s79, s64, 1
  v_mfma_f32_16x16x32_bf16 a[104:107], a[244:247], v[92:95], a[104:107]
  s_mul_i32 s51, s79, 20480
  s_add_u32 s51, s51, 1048576
  v_mfma_f32_16x16x32_bf16 a[108:111], a[244:247], v[96:99], a[108:111]
  ds_read_b64_tr_b16 a[190:191], v6 offset:54272
  s_and_b32 s79, s64, 1
  v_mfma_f32_16x16x32_bf16 a[108:111], a[192:195], a[240:243], a[108:111]
  s_lshl_b32 s79, s79, 1
  s_waitcnt lgkmcnt(4)
  v_mfma_f32_16x16x32_bf16 v[224:227], a[176:179], a[228:231], v[224:227]
  ds_read_b64_tr_b16 a[192:193], v6 offset:29184
  s_add_u32 s52, s79, s67
  v_mfma_f32_16x16x32_bf16 v[224:227], a[180:183], v[84:87], v[224:227]
  buffer_load_dwordx4 v2, s[12:15], s73 offen offset:256 lds
  s_add_u32 m0, s74, 48768
  v_mfma_f32_16x16x32_bf16 v[228:231], a[180:183], v[88:91], v[228:231]
  ds_read_b64_tr_b16 a[194:195], v6 offset:30208
  s_lshl_b32 s79, s52, 11
  v_mfma_f32_16x16x32_bf16 v[228:231], a[176:179], a[232:235], v[228:231]
  s_lshl_b32 s80, s68, 9
  s_add_u32 s79, s79, s80
  v_mfma_f32_16x16x32_bf16 v[232:235], a[176:179], a[236:239], v[232:235]
  ds_read_b64_tr_b16 a[244:245], v6 offset:49664
  s_sub_u32 s79, s79, 8
  v_mfma_f32_16x16x32_bf16 v[232:235], a[180:183], v[92:95], v[232:235]
  s_lshl_b32 s80, s52, 9
  s_add_u32 s80, s80, 8176
  v_mfma_f32_16x16x32_bf16 v[236:239], a[180:183], v[96:99], v[236:239]
  ds_read_b64_tr_b16 a[246:247], v6 offset:50688
  s_cmp_eq_u32 s65, 0
  s_cselect_b32 s79, s79, s80
  s_cselect_b32 s80, 1024, 8
  s_cselect_b32 s54, 0xffff0000, 0
  v_mfma_f32_16x16x32_bf16 v[236:239], a[176:179], a[240:243], v[236:239]
  buffer_load_dwordx4 v2, s[12:15], s70 offen offset:384 lds
  s_waitcnt lgkmcnt(4)
  v_mfma_f32_16x16x32_bf16 a[112:115], a[184:187], a[228:231], a[112:115]
  ds_read_b64_tr_b16 a[176:177], v6 offset:33280
  s_add_u32 m0, s74, 49792
  v_mfma_f32_16x16x32_bf16 a[112:115], a[188:191], v[84:87], a[112:115]
  s_add_u32 s79, s79, s51
  s_lshl_b32 s81, s65, 1
  v_mfma_f32_16x16x32_bf16 a[116:119], a[188:191], v[88:91], a[116:119]
  ds_read_b64_tr_b16 a[178:179], v6 offset:34304
  s_add_u32 s81, s81, s68
  v_mfma_f32_16x16x32_bf16 a[116:119], a[184:187], a[232:235], a[116:119]
  s_cmp_lt_u32 s81, 3
  s_cselect_b32 s55, 0xffff, 0
  v_mfma_f32_16x16x32_bf16 a[120:123], a[184:187], a[236:239], a[120:123]
  ds_read_b64_tr_b16 a[180:181], v6 offset:53760
  v_lshlrev_b32 v28, 4, v35
  v_mfma_f32_16x16x32_bf16 a[120:123], a[188:191], v[92:95], a[120:123]
  buffer_load_dwordx4 v2, s[12:15], s73 offen offset:384 lds
  s_add_u32 s70, s70, 294912
  v_mfma_f32_16x16x32_bf16 a[124:127], a[188:191], v[96:99], a[124:127]
  ds_read_b64_tr_b16 a[182:183], v6 offset:54784
  s_add_u32 s73, s73, 294912
  v_mfma_f32_16x16x32_bf16 a[124:127], a[184:187], a[240:243], a[124:127]
  s_add_u32 s71, s71, s77
  s_waitcnt lgkmcnt(4)
  v_mfma_f32_16x16x32_bf16 v[240:243], a[192:195], a[228:231], v[240:243]
  ds_read_b64_tr_b16 a[184:185], v8 offset:20480
  s_add_u32 s72, s72, 36864
  v_mfma_f32_16x16x32_bf16 v[240:243], a[244:247], v[84:87], v[240:243]
  s_add_u32 m0, s76, 28672
  v_lshl_add_u32 v28, v34, 3, v28
  v_mfma_f32_16x16x32_bf16 v[244:247], a[244:247], v[88:91], v[244:247]
  ds_read_b64_tr_b16 a[186:187], v8 offset:20864
  v_add_u32 v28, s79, v28
  v_mfma_f32_16x16x32_bf16 v[244:247], a[192:195], a[232:235], v[244:247]
  buffer_load_dwordx4 v4, s[8:11], s72 offen lds
  s_add_u32 m0, s75, 61440
  v_mfma_f32_16x16x32_bf16 v[248:251], a[192:195], a[236:239], v[248:251]
  ds_read_b64_tr_b16 a[188:189], v8 offset:40960
  v_mov_b32 v29, 1073741824
  v_mfma_f32_16x16x32_bf16 v[248:251], a[244:247], v[92:95], v[248:251]
  v_cndmask_b32 v39, v29, v28, s[54:55]
  v_add_u32 v40, s80, v39
  v_mfma_f32_16x16x32_bf16 v[252:255], a[244:247], v[96:99], v[252:255]
  ds_read_b64_tr_b16 a[190:191], v8 offset:41344
  s_andn2_b32 s79, s81, 4
  v_mfma_f32_16x16x32_bf16 v[252:255], a[192:195], a[240:243], v[252:255]
  buffer_load_dwordx4 v3, s[16:19], s71 offen lds
  s_waitcnt lgkmcnt(4)
  v_mfma_f32_16x16x32_bf16 a[128:131], a[176:179], a[228:231], a[128:131]
  ds_read_b64_tr_b16 a[192:193], v10 offset:20480
  s_add_u32 m0, s74, 61184
  v_mfma_f32_16x16x32_bf16 a[128:131], a[180:183], v[84:87], a[128:131]
  s_cmp_eq_u32 s79, 2
  s_cselect_b32 s57, 0xffff, 0
  v_mfma_f32_16x16x32_bf16 a[132:135], a[180:183], v[88:91], a[132:135]
  ds_read_b64_tr_b16 a[194:195], v12 offset:20480
  s_mov_b32 s56, 0
  v_mfma_f32_16x16x32_bf16 a[132:135], a[176:179], a[232:235], a[132:135]
  s_cmp_eq_u32 s81, 6
  s_cselect_b32 s53, 0x3f80, 0
  s_cselect_b32 s79, 2, 0
  v_and_b32 v28, 3, v1
  v_xor_b32 v28, s79, v28
  s_mov_b32 s79, 1073741824
  s_cselect_b32 s80, 192, s79
  v_mfma_f32_16x16x32_bf16 a[136:139], a[176:179], a[236:239], a[136:139]
  ds_read_b64_tr_b16 a[244:245], v10 offset:40960
  s_cmp_eq_u32 s81, 4
  s_cselect_b32 s79, 0, s79
  s_cselect_b32 s80, 128, s80
  v_mfma_f32_16x16x32_bf16 a[136:139], a[180:183], v[92:95], a[136:139]
  buffer_load_dwordx4 v2, s[12:15], s70 offen offset:256 lds
  s_add_u32 m0, s74, 62208
  v_mfma_f32_16x16x32_bf16 a[140:143], a[180:183], v[96:99], a[140:143]
  ds_read_b64_tr_b16 a[246:247], v12 offset:40960
  s_cmp_eq_u32 s81, 5
  s_cselect_b32 s79, 256, s79
  s_cselect_b32 s80, 64, s80
  v_mfma_f32_16x16x32_bf16 a[140:143], a[176:179], a[240:243], a[140:143]
  v_mov_b32 v29, s79
  s_waitcnt lgkmcnt(4)
  s_waitcnt vmcnt(9)
  s_barrier
  v_mfma_f32_16x16x32_bf16 a[144:147], a[184:187], a[228:231], a[144:147]
  ds_read_b64_tr_b16 a[176:177], v5 offset:0
  v_mov_b32 v30, s80
  v_mfma_f32_16x16x32_bf16 a[144:147], a[188:191], v[84:87], a[144:147]
  v_and_b32 v31, 4, v1
  v_cmp_eq_u32 vcc, 0, v31
  v_mfma_f32_16x16x32_bf16 a[148:151], a[188:191], v[88:91], a[148:151]
  ds_read_b64_tr_b16 a[178:179], v5 offset:1024
  v_cndmask_b32 v29, v30, v29, vcc
  v_mfma_f32_16x16x32_bf16 a[148:151], a[184:187], a[232:235], a[148:151]
  buffer_load_dwordx4 v2, s[12:15], s73 offen offset:256 lds
  s_add_u32 m0, s74, 69248
  v_mfma_f32_16x16x32_bf16 a[152:155], a[184:187], a[236:239], a[152:155]
  ds_read_b64_tr_b16 a[180:181], v5 offset:20480
  v_lshl_add_u32 v28, v28, 4, v29
  v_mfma_f32_16x16x32_bf16 a[152:155], a[188:191], v[92:95], a[152:155]
  v_and_b32 v29, 8, v1
  v_add_u32 v28, v28, v29
  v_mfma_f32_16x16x32_bf16 a[156:159], a[188:191], v[96:99], a[156:159]
  ds_read_b64_tr_b16 a[182:183], v5 offset:21504
  v_mul_u32_u24 v29, 320, v34
  v_mfma_f32_16x16x32_bf16 a[156:159], a[184:187], a[240:243], a[156:159]
  buffer_load_dwordx4 v2, s[12:15], s70 offen offset:384 lds
  s_waitcnt lgkmcnt(4)
  v_mfma_f32_16x16x32_bf16 a[160:163], a[192:195], a[228:231], a[160:163]
  ds_read_b64_tr_b16 a[184:185], v5 offset:4096
  s_add_u32 m0, s74, 70272
  v_mfma_f32_16x16x32_bf16 a[160:163], a[244:247], v[84:87], a[160:163]
  s_mul_i32 s79, s52, 2560
  s_add_u32 s79, s79, s51
  v_mfma_f32_16x16x32_bf16 a[164:167], a[244:247], v[88:91], a[164:167]
  ds_read_b64_tr_b16 a[186:187], v5 offset:5120
  s_add_u32 s79, s79, 10240
  v_mfma_f32_16x16x32_bf16 a[164:167], a[192:195], a[232:235], a[164:167]
  v_add3_u32 v41, v28, v29, s79
  v_mfma_f32_16x16x32_bf16 a[168:171], a[192:195], a[236:239], a[168:171]
  ds_read_b64_tr_b16 a[188:189], v5 offset:24576
  v_mfma_f32_16x16x32_bf16 a[168:171], a[244:247], v[92:95], a[168:171]
  buffer_load_dwordx4 v2, s[12:15], s73 offen offset:384 lds
  s_add_u32 s92, s92, 2
  v_mfma_f32_16x16x32_bf16 a[172:175], a[244:247], v[96:99], a[172:175]
  ds_read_b64_tr_b16 a[190:191], v5 offset:25600
  s_cmp_eq_u32 s92, 18
  s_cselect_b32 s92, 0, s92
  v_mfma_f32_16x16x32_bf16 a[172:175], a[192:195], a[240:243], a[172:175]
  s_mul_i32 s70, s92, 294912
  s_waitcnt lgkmcnt(4)
  v_mfma_f32_16x16x32_bf16 v[112:115], a[176:179], a[196:199], v[112:115]
  ds_read_b64_tr_b16 a[192:193], v5 offset:512
  s_add_u32 s73, s70, 36864
  v_mfma_f32_16x16x32_bf16 v[112:115], a[180:183], a[212:215], v[112:115]
  s_mul_i32 s71, s92, s77
  v_mfma_f32_16x16x32_bf16 v[116:119], a[180:183], a[216:219], v[116:119]
  ds_read_b64_tr_b16 a[194:195], v5 offset:1536
  v_mfma_f32_16x16x32_bf16 v[116:119], a[176:179], a[200:203], v[116:119]
  v_mfma_f32_16x16x32_bf16 v[120:123], a[176:179], a[204:207], v[120:123]
  ds_read_b64_tr_b16 a[244:245], v5 offset:20992
  v_mfma_f32_16x16x32_bf16 v[120:123], a[180:183], a[220:223], v[120:123]
  v_mfma_f32_16x16x32_bf16 v[124:127], a[180:183], a[224:227], v[124:127]
  ds_read_b64_tr_b16 a[246:247], v5 offset:22016
  v_mfma_f32_16x16x32_bf16 v[124:127], a[176:179], a[208:211], v[124:127]
  s_waitcnt lgkmcnt(4)
  v_mfma_f32_16x16x32_bf16 a[0:3], a[184:187], a[196:199], a[0:3]
  ds_read_b64_tr_b16 a[176:177], v5 offset:4608
  v_mfma_f32_16x16x32_bf16 a[0:3], a[188:191], a[212:215], a[0:3]
  v_mfma_f32_16x16x32_bf16 a[4:7], a[188:191], a[216:219], a[4:7]
  ds_read_b64_tr_b16 a[178:179], v5 offset:5632
  v_mfma_f32_16x16x32_bf16 a[4:7], a[184:187], a[200:203], a[4:7]
  v_mfma_f32_16x16x32_bf16 a[8:11], a[184:187], a[204:207], a[8:11]
  ds_read_b64_tr_b16 a[180:181], v5 offset:25088
  v_mfma_f32_16x16x32_bf16 a[8:11], a[188:191], a[220:223], a[8:11]
  v_mfma_f32_16x16x32_bf16 a[12:15], a[188:191], a[224:227], a[12:15]
  ds_read_b64_tr_b16 a[182:183], v5 offset:26112
  v_mfma_f32_16x16x32_bf16 a[12:15], a[184:187], a[208:211], a[12:15]
  s_waitcnt lgkmcnt(4)
  s_barrier
  v_mfma_f32_16x16x32_bf16 v[128:131], a[192:195], a[196:199], v[128:131]
  ds_read_b64_tr_b16 a[184:185], v5 offset:8192
  s_add_u32 s95, s95, 128
  v_mfma_f32_16x16x32_bf16 v[128:131], a[244:247], a[212:215], v[128:131]
  s_cmp_eq_u32 s95, 1152
  s_cselect_b32 s95, 0, s95
  v_mfma_f32_16x16x32_bf16 v[132:135], a[244:247], a[216:219], v[132:135]
  ds_read_b64_tr_b16 a[186:187], v5 offset:9216
  s_add_u32 s72, s101, s95
  v_mfma_f32_16x16x32_bf16 v[132:135], a[192:195], a[200:203], v[132:135]
  s_add_u32 m0, s76, 0
  v_mfma_f32_16x16x32_bf16 v[136:139], a[192:195], a[204:207], v[136:139]
  ds_read_b64_tr_b16 a[188:189], v5 offset:28672
  v_mfma_f32_16x16x32_bf16 v[136:139], a[244:247], a[220:223], v[136:139]
  buffer_load_dwordx4 v4, s[8:11], s72 offen lds
  s_add_u32 m0, s100, 81920
  v_mfma_f32_16x16x32_bf16 v[140:143], a[244:247], a[224:227], v[140:143]
  ds_read_b64_tr_b16 a[190:191], v5 offset:29696
  v_mfma_f32_16x16x32_bf16 v[140:143], a[192:195], a[208:211], v[140:143]
  s_waitcnt lgkmcnt(4)
  v_mfma_f32_16x16x32_bf16 a[16:19], a[176:179], a[196:199], a[16:19]
  ds_read_b64_tr_b16 a[192:193], v5 offset:12288
  v_mfma_f32_16x16x32_bf16 a[16:19], a[180:183], a[212:215], a[16:19]
  buffer_load_dwordx4 v110, s[12:15], s70 offen lds
  s_add_u32 m0, s74, 81920
  v_mfma_f32_16x16x32_bf16 a[20:23], a[180:183], a[216:219], a[20:23]
  ds_read_b64_tr_b16 a[194:195], v5 offset:13312
  v_mfma_f32_16x16x32_bf16 a[20:23], a[176:179], a[200:203], a[20:23]
  v_mfma_f32_16x16x32_bf16 a[24:27], a[176:179], a[204:207], a[24:27]
  ds_read_b64_tr_b16 a[244:245], v5 offset:32768
  v_mfma_f32_16x16x32_bf16 a[24:27], a[180:183], a[220:223], a[24:27]
  buffer_load_dwordx4 v2, s[12:15], s70 offen offset:0 lds
  s_add_u32 m0, s74, 82944
  v_mfma_f32_16x16x32_bf16 a[28:31], a[180:183], a[224:227], a[28:31]
  ds_read_b64_tr_b16 a[246:247], v5 offset:33792
  v_mfma_f32_16x16x32_bf16 a[28:31], a[176:179], a[208:211], a[28:31]
  s_waitcnt lgkmcnt(4)
  v_mfma_f32_16x16x32_bf16 v[144:147], a[184:187], a[196:199], v[144:147]
  ds_read_b64_tr_b16 a[176:177], v5 offset:8704
  v_mfma_f32_16x16x32_bf16 v[144:147], a[188:191], a[212:215], v[144:147]
  v_mfma_f32_16x16x32_bf16 v[148:151], a[188:191], a[216:219], v[148:151]
  ds_read_b64_tr_b16 a[178:179], v5 offset:9728
  v_mfma_f32_16x16x32_bf16 v[148:151], a[184:187], a[200:203], v[148:151]
  buffer_load_dwordx4 v2, s[12:15], s73 offen offset:0 lds
  s_add_u32 m0, s74, 89984
  v_mfma_f32_16x16x32_bf16 v[152:155], a[184:187], a[204:207], v[152:155]
  ds_read_b64_tr_b16 a[180:181], v5 offset:29184
  v_mfma_f32_16x16x32_bf16 v[152:155], a[188:191], a[220:223], v[152:155]
  v_mfma_f32_16x16x32_bf16 v[156:159], a[188:191], a[224:227], v[156:159]
  ds_read_b64_tr_b16 a[182:183], v5 offset:30208
  v_mfma_f32_16x16x32_bf16 v[156:159], a[184:187], a[208:211], v[156:159]
  s_waitcnt lgkmcnt(4)
  v_mfma_f32_16x16x32_bf16 a[32:35], a[192:195], a[196:199], a[32:35]
  ds_read_b64_tr_b16 a[184:185], v5 offset:12800
  s_mov_b32 s99, 851968
  buffer_load_dword v76, v81, s[28:31], s99 offen
  v_mfma_f32_16x16x32_bf16 a[32:35], a[244:247], a[212:215], a[32:35]
  buffer_load_dwordx4 v2, s[12:15], s70 offen offset:128 lds
  s_add_u32 m0, s74, 91008
  v_mfma_f32_16x16x32_bf16 a[36:39], a[244:247], a[216:219], a[36:39]
  ds_read_b64_tr_b16 a[186:187], v5 offset:13824
  v_mfma_f32_16x16x32_bf16 a[36:39], a[192:195], a[200:203], a[36:39]
  v_mfma_f32_16x16x32_bf16 a[40:43], a[192:195], a[204:207], a[40:43]
  ds_read_b64_tr_b16 a[188:189], v5 offset:33280
  v_mfma_f32_16x16x32_bf16 a[40:43], a[244:247], a[220:223], a[40:43]
  v_mfma_f32_16x16x32_bf16 a[44:47], a[244:247], a[224:227], a[44:47]
  ds_read_b64_tr_b16 a[190:191], v5 offset:34304
  v_mfma_f32_16x16x32_bf16 a[44:47], a[192:195], a[208:211], a[44:47]
  buffer_load_dwordx4 v2, s[12:15], s73 offen offset:128 lds
  s_waitcnt lgkmcnt(4)
  v_mfma_f32_16x16x32_bf16 v[160:163], a[176:179], a[196:199], v[160:163]
  ds_read_b64_tr_b16 a[192:193], v44 offset:16384
  s_add_u32 s70, s70, 294912
  v_mfma_f32_16x16x32_bf16 v[160:163], a[180:183], a[212:215], v[160:163]
  s_add_u32 s73, s73, 294912
  s_add_u32 s71, s71, s77
L_pg5:
  s_cbranch_execz L_pg9
  v_mfma_f32_16x16x32_bf16 v[164:167], a[180:183], a[216:219], v[164:167]
  ds_read_b64_tr_b16 a[194:195], v44 offset:16896
  s_add_u32 s72, s72, 36864
  v_mfma_f32_16x16x32_bf16 v[164:167], a[176:179], a[200:203], v[164:167]
  s_add_u32 m0, s76, 4096
  v_mfma_f32_16x16x32_bf16 v[168:171], a[176:179], a[204:207], v[168:171]
  ds_read_b64_tr_b16 a[244:245], v44 offset:36864
  v_mfma_f32_16x16x32_bf16 v[168:171], a[180:183], a[220:223], v[168:171]
  buffer_load_dwordx4 v4, s[8:11], s72 offen lds
  s_add_u32 m0, s100, 102400
  v_mfma_f32_16x16x32_bf16 v[172:175], a[180:183], a[224:227], v[172:175]
  ds_read_b64_tr_b16 a[246:247], v44 offset:37376
  v_mfma_f32_16x16x32_bf16 v[172:175], a[176:179], a[208:211], v[172:175]
  s_waitcnt lgkmcnt(4)
  v_mfma_f32_16x16x32_bf16 a[48:51], a[184:187], a[196:199], a[48:51]
  ds_read_b64_tr_b16 a[176:177], v44 offset:18432
  v_mfma_f32_16x16x32_bf16 a[48:51], a[188:191], a[212:215], a[48:51]
  buffer_load_dwordx4 v110, s[12:15], s70 offen lds
  s_add_u32 m0, s74, 102400
  v_mfma_f32_16x16x32_bf16 a[52:55], a[188:191], a[216:219], a[52:55]
  ds_read_b64_tr_b16 a[178:179], v44 offset:18944
  v_mfma_f32_16x16x32_bf16 a[52:55], a[184:187], a[200:203], a[52:55]
  v_mfma_f32_16x16x32_bf16 a[56:59], a[184:187], a[204:207], a[56:59]
  ds_read_b64_tr_b16 a[180:181], v44 offset:38912
  v_mfma_f32_16x16x32_bf16 a[56:59], a[188:191], a[220:223], a[56:59]
  v_mfma_f32_16x16x32_bf16 a[60:63], a[188:191], a[224:227], a[60:63]
  ds_read_b64_tr_b16 a[182:183], v44 offset:39424
  v_mfma_f32_16x16x32_bf16 a[60:63], a[184:187], a[208:211], a[60:63]
  buffer_load_dwordx4 v2, s[12:15], s70 offen offset:0 lds
  s_waitcnt lgkmcnt(4)
  s_waitcnt vmcnt(10)
  s_barrier
  v_mfma_f32_16x16x32_bf16 v[176:179], a[192:195], a[196:199], v[176:179]
  ds_read_b64_tr_b16 a[184:185], v5 offset:40960
  s_add_u32 m0, s74, 103424
  v_mfma_f32_16x16x32_bf16 v[176:179], a[244:247], a[212:215], v[176:179]
  v_mfma_f32_16x16x32_bf16 v[180:183], a[244:247], a[216:219], v[180:183]
  ds_read_b64_tr_b16 a[186:187], v5 offset:41984
  v_mfma_f32_16x16x32_bf16 v[180:183], a[192:195], a[200:203], v[180:183]
  ds_read_b128 a[228:231], v13 offset:16384
  v_mfma_f32_16x16x32_bf16 v[184:187], a[192:195], a[204:207], v[184:187]
  ds_read_b64_tr_b16 a[188:189], v6 offset:0
  v_mfma_f32_16x16x32_bf16 v[184:187], a[244:247], a[220:223], v[184:187]
  buffer_load_dwordx4 v2, s[12:15], s73 offen offset:0 lds
  s_add_u32 m0, s74, 110464
  v_mfma_f32_16x16x32_bf16 v[188:191], a[244:247], a[224:227], v[188:191]
  ds_read_b64_tr_b16 a[190:191], v6 offset:1024
  v_mfma_f32_16x16x32_bf16 v[188:191], a[192:195], a[208:211], v[188:191]
  ds_read_b128 v[84:87], v14 offset:16384
  s_waitcnt lgkmcnt(6)
  v_mfma_f32_16x16x32_bf16 a[64:67], a[176:179], a[196:199], a[64:67]
  ds_read_b64_tr_b16 a[192:193], v5 offset:45056
  v_mfma_f32_16x16x32_bf16 a[64:67], a[180:183], a[212:215], a[64:67]
  buffer_load_dwordx4 v2, s[12:15], s70 offen offset:128 lds
  s_add_u32 m0, s74, 111488
  v_mfma_f32_16x16x32_bf16 a[68:71], a[180:183], a[216:219], a[68:71]
  ds_read_b64_tr_b16 a[194:195], v5 offset:46080
  v_mfma_f32_16x16x32_bf16 a[68:71], a[176:179], a[200:203], a[68:71]
  ds_read_b128 a[232:235], v13 offset:18432
  v_mfma_f32_16x16x32_bf16 a[72:75], a[176:179], a[204:207], a[72:75]
  ds_read_b64_tr_b16 a[244:245], v6 offset:4096
  v_mfma_f32_16x16x32_bf16 a[72:75], a[180:183], a[220:223], a[72:75]
  v_mfma_f32_16x16x32_bf16 a[76:79], a[180:183], a[224:227], a[76:79]
  ds_read_b64_tr_b16 a[246:247], v6 offset:5120
  v_mfma_f32_16x16x32_bf16 a[76:79], a[176:179], a[208:211], a[76:79]
  ds_read_b128 v[88:91], v14 offset:18432
  s_waitcnt lgkmcnt(7)
  v_mfma_f32_16x16x32_bf16 v[192:195], a[184:187], a[196:199], v[192:195]
  ds_read_b64_tr_b16 a[176:177], v5 offset:41472
  v_mfma_f32_16x16x32_bf16 v[192:195], a[188:191], a[212:215], v[192:195]
  buffer_load_dwordx4 v2, s[12:15], s73 offen offset:128 lds
  s_sub_u32 s70, s70, 294912
  v_mfma_f32_16x16x32_bf16 v[196:199], a[188:191], a[216:219], v[196:199]
  ds_read_b64_tr_b16 a[178:179], v5 offset:42496
  s_sub_u32 s73, s73, 294912
  v_mfma_f32_16x16x32_bf16 v[196:199], a[184:187], a[200:203], v[196:199]
  ds_read_b128 a[236:239], v13 offset:20480
  s_sub_u32 s71, s71, s77
  v_mfma_f32_16x16x32_bf16 v[200:203], a[184:187], a[204:207], v[200:203]
  ds_read_b64_tr_b16 a[180:181], v6 offset:512
  v_mfma_f32_16x16x32_bf16 v[200:203], a[188:191], a[220:223], v[200:203]
  v_mfma_f32_16x16x32_bf16 v[204:207], a[188:191], a[224:227], v[204:207]
  ds_read_b64_tr_b16 a[182:183], v6 offset:1536
  v_mfma_f32_16x16x32_bf16 v[204:207], a[184:187], a[208:211], v[204:207]
  ds_read_b128 v[92:95], v14 offset:20480
  s_waitcnt lgkmcnt(7)
  v_mfma_f32_16x16x32_bf16 a[80:83], a[192:195], a[196:199], a[80:83]
  ds_read_b64_tr_b16 a[184:185], v5 offset:45568
  v_mfma_f32_16x16x32_bf16 a[80:83], a[244:247], a[212:215], a[80:83]
  v_mfma_f32_16x16x32_bf16 a[84:87], a[244:247], a[216:219], a[84:87]
  ds_read_b64_tr_b16 a[186:187], v5 offset:46592
  v_mfma_f32_16x16x32_bf16 a[84:87], a[192:195], a[200:203], a[84:87]
  ds_read_b128 a[240:243], v13 offset:22528
  v_mfma_f32_16x16x32_bf16 a[88:91], a[192:195], a[204:207], a[88:91]
  ds_read_b64_tr_b16 a[188:189], v6 offset:4608
  v_mfma_f32_16x16x32_bf16 a[88:91], a[244:247], a[220:223], a[88:91]
  v_mfma_f32_16x16x32_bf16 a[92:95], a[244:247], a[224:227], a[92:95]
  ds_read_b64_tr_b16 a[190:191], v6 offset:5632
  v_mfma_f32_16x16x32_bf16 a[92:95], a[192:195], a[208:211], a[92:95]
  ds_read_b128 v[96:99], v14 offset:22528
  s_waitcnt lgkmcnt(7)
  s_barrier
  v_mfma_f32_16x16x32_bf16 v[208:211], a[176:179], a[196:199], v[208:211]
  ds_read_b64_tr_b16 a[192:193], v5 offset:49152
  s_add_u32 s72, s72, 36864
  v_mfma_f32_16x16x32_bf16 v[208:211], a[180:183], a[212:215], v[208:211]
  s_add_u32 m0, s76, 8192
  v_mfma_f32_16x16x32_bf16 v[212:215], a[180:183], a[216:219], v[212:215]
  ds_read_b64_tr_b16 a[194:195], v5 offset:50176
  v_mfma_f32_16x16x32_bf16 v[212:215], a[176:179], a[200:203], v[212:215]
  buffer_load_dwordx4 v4, s[8:11], s72 offen lds
  s_add_u32 m0, s75, 0
  v_mfma_f32_16x16x32_bf16 v[216:219], a[176:179], a[204:207], v[216:219]
  ds_read_b64_tr_b16 a[244:245], v6 offset:8192
  v_mfma_f32_16x16x32_bf16 v[216:219], a[180:183], a[220:223], v[216:219]
  v_mfma_f32_16x16x32_bf16 v[220:223], a[180:183], a[224:227], v[220:223]
  ds_read_b64_tr_b16 a[246:247], v6 offset:9216
  v_mfma_f32_16x16x32_bf16 v[220:223], a[176:179], a[208:211], v[220:223]
  buffer_load_dwordx4 v3, s[16:19], s71 offen lds
  s_waitcnt lgkmcnt(5)
  v_mfma_f32_16x16x32_bf16 a[96:99], a[184:187], a[196:199], a[96:99]
  ds_read_b64_tr_b16 a[176:177], v5 offset:53248
  s_add_u32 s70, s70, 256
  v_mfma_f32_16x16x32_bf16 a[96:99], a[188:191], a[212:215], a[96:99]
  s_add_u32 s73, s73, 256
  s_add_u32 m0, s74, 0
  v_mfma_f32_16x16x32_bf16 a[100:103], a[188:191], a[216:219], a[100:103]
  ds_read_b64_tr_b16 a[178:179], v5 offset:54272
  v_mfma_f32_16x16x32_bf16 a[100:103], a[184:187], a[200:203], a[100:103]
  buffer_load_dwordx4 v2, s[12:15], s70 offen offset:0 lds
  s_add_u32 m0, s74, 1024
  v_mfma_f32_16x16x32_bf16 a[104:107], a[184:187], a[204:207], a[104:107]
  ds_read_b64_tr_b16 a[180:181], v6 offset:12288
  v_mfma_f32_16x16x32_bf16 a[104:107], a[188:191], a[220:223], a[104:107]
  v_mfma_f32_16x16x32_bf16 a[108:111], a[188:191], a[224:227], a[108:111]
  ds_read_b64_tr_b16 a[182:183], v6 offset:13312
  v_mfma_f32_16x16x32_bf16 a[108:111], a[184:187], a[208:211], a[108:111]
  s_waitcnt lgkmcnt(4)
  v_mfma_f32_16x16x32_bf16 v[224:227], a[192:195], a[196:199], v[224:227]
  ds_read_b64_tr_b16 a[184:185], v5 offset:49664
  v_mfma_f32_16x16x32_bf16 v[224:227], a[244:247], a[212:215], v[224:227]
  buffer_load_dwordx4 v2, s[12:15], s73 offen offset:0 lds
  s_add_u32 m0, s74, 8064
  v_mfma_f32_16x16x32_bf16 v[228:231], a[244:247], a[216:219], v[228:231]
  ds_read_b64_tr_b16 a[186:187], v5 offset:50688
  v_mfma_f32_16x16x32_bf16 v[228:231], a[192:195], a[200:203], v[228:231]
  v_mfma_f32_16x16x32_bf16 v[232:235], a[192:195], a[204:207], v[232:235]
  ds_read_b64_tr_b16 a[188:189], v6 offset:8704
  v_mfma_f32_16x16x32_bf16 v[232:235], a[244:247], a[220:223], v[232:235]
  v_mfma_f32_16x16x32_bf16 v[236:239], a[244:247], a[224:227], v[236:239]
  ds_read_b64_tr_b16 a[190:191], v6 offset:9728
  v_mfma_f32_16x16x32_bf16 v[236:239], a[192:195], a[208:211], v[236:239]
  buffer_load_dwordx4 v2, s[12:15], s70 offen offset:128 lds
  s_waitcnt lgkmcnt(4)
  s_waitcnt vmcnt(13)
  v_cmp_ne_u32 vcc, s59, v76
  s_nop 0
  s_cmp_eq_u64 vcc, 0
  s_cbranch_scc0 L_A_spin
L_A_ok:
  v_mfma_f32_16x16x32_bf16 a[112:115], a[176:179], a[196:199], a[112:115]
  ds_read_b64_tr_b16 a[192:193], v5 offset:53760
  s_add_u32 m0, s74, 9088
  v_mfma_f32_16x16x32_bf16 a[112:115], a[180:183], a[212:215], a[112:115]
  s_lshl_b32 s79, s64, 10
  s_lshl_b32 s80, s67, 9
  v_mfma_f32_16x16x32_bf16 a[116:119], a[180:183], a[216:219], a[116:119]
  ds_read_b64_tr_b16 a[194:195], v5 offset:54784
  s_add_u32 s79, s79, s80
  v_mfma_f32_16x16x32_bf16 a[116:119], a[176:179], a[200:203], a[116:119]
  v_lshlrev_b32 v28, 3, v1
  v_mfma_f32_16x16x32_bf16 a[120:123], a[176:179], a[204:207], a[120:123]
  ds_read_b64_tr_b16 a[244:245], v6 offset:12800
  buffer_load_dwordx2 v[58:59], v28, s[28:31], s79 offen sc1
  v_mfma_f32_16x16x32_bf16 a[120:123], a[180:183], a[220:223], a[120:123]
  buffer_load_dwordx4 v2, s[12:15], s73 offen offset:128 lds
  s_sub_u32 s70, s70, 256
  v_mfma_f32_16x16x32_bf16 a[124:127], a[180:183], a[224:227], a[124:127]
  ds_read_b64_tr_b16 a[246:247], v6 offset:13824
  s_sub_u32 s73, s73, 256
  v_mfma_f32_16x16x32_bf16 a[124:127], a[176:179], a[208:211], a[124:127]
  s_add_u32 s70, s70, 294912
  s_waitcnt lgkmcnt(4)
  v_mfma_f32_16x16x32_bf16 v[240:243], a[184:187], a[196:199], v[240:243]
  ds_read_b64_tr_b16 a[176:177], v7 offset:40960
  s_add_u32 s73, s73, 294912
  v_mfma_f32_16x16x32_bf16 v[240:243], a[188:191], a[212:215], v[240:243]
  s_add_u32 s71, s71, s77
  s_add_u32 s72, s72, 36864
  v_mfma_f32_16x16x32_bf16 v[244:247], a[188:191], a[216:219], v[244:247]
  ds_read_b64_tr_b16 a[178:179], v7 offset:41344
  s_add_u32 m0, s76, 12288
  v_mfma_f32_16x16x32_bf16 v[244:247], a[184:187], a[200:203], v[244:247]
  buffer_load_dwordx4 v4, s[8:11], s72 offen lds
  s_add_u32 m0, s75, 20480
  v_mfma_f32_16x16x32_bf16 v[248:251], a[184:187], a[204:207], v[248:251]
  ds_read_b64_tr_b16 a[180:181], v8 offset:0
  s_add_u32 s80, s50, 0
  v_mfma_f32_16x16x32_bf16 v[248:251], a[188:191], a[220:223], v[248:251]
  buffer_load_dword v60, v108, s[28:31], s80 offen offset:0 sc1
  buffer_load_dword v64, v108, s[28:31], s80 offen offset:256 sc1
  v_mfma_f32_16x16x32_bf16 v[252:255], a[188:191], a[224:227], v[252:255]
  ds_read_b64_tr_b16 a[182:183], v8 offset:384
  buffer_load_dword v68, v83, s[28:31], s80 offen offset:512 sc1
  v_mfma_f32_16x16x32_bf16 v[252:255], a[184:187], a[208:211], v[252:255]
  buffer_load_dwordx4 v3, s[16:19], s71 offen lds
  s_waitcnt lgkmcnt(4)
  v_mfma_f32_16x16x32_bf16 a[128:131], a[192:195], a[196:199], a[128:131]
  ds_read_b64_tr_b16 a[184:185], v9 offset:40960
  s_add_u32 m0, s74, 20224
  v_mfma_f32_16x16x32_bf16 a[128:131], a[244:247], a[212:215], a[128:131]
  buffer_load_dword v72, v82, s[28:31], s80 offen offset:768 sc1
  buffer_load_dword v76, v109, s[28:31], s80 offen offset:0 sc1
  v_mfma_f32_16x16x32_bf16 a[132:135], a[244:247], a[216:219], a[132:135]
  ds_read_b64_tr_b16 a[186:187], v11 offset:40960
  s_add_u32 s80, s50, 2560
  v_mfma_f32_16x16x32_bf16 a[132:135], a[192:195], a[200:203], a[132:135]
  buffer_load_dword v61, v108, s[28:31], s80 offen offset:0 sc1
  buffer_load_dword v65, v108, s[28:31], s80 offen offset:256 sc1
  v_mfma_f32_16x16x32_bf16 a[136:139], a[192:195], a[204:207], a[136:139]
  ds_read_b64_tr_b16 a[188:189], v10 offset:0
  buffer_load_dword v69, v83, s[28:31], s80 offen offset:512 sc1
  v_mfma_f32_16x16x32_bf16 a[136:139], a[244:247], a[220:223], a[136:139]
  buffer_load_dwordx4 v2, s[12:15], s70 offen offset:256 lds
  s_add_u32 m0, s74, 21248
  v_mfma_f32_16x16x32_bf16 a[140:143], a[244:247], a[224:227], a[140:143]
  ds_read_b64_tr_b16 a[190:191], v12 offset:0
  buffer_load_dword v73, v82, s[28:31], s80 offen offset:768 sc1
  v_mfma_f32_16x16x32_bf16 a[140:143], a[192:195], a[208:211], a[140:143]
  buffer_load_dword v77, v109, s[28:31], s80 offen offset:0 sc1
  s_waitcnt lgkmcnt(4)
  s_waitcnt vmcnt(20)
  s_barrier
  v_mfma_f32_16x16x32_bf16 a[144:147], a[176:179], a[196:199], a[144:147]
  ds_read_b64_tr_b16 a[192:193], v6 offset:20480
  s_add_u32 s80, s50, 5120
  v_mfma_f32_16x16x32_bf16 a[144:147], a[180:183], a[212:215], a[144:147]
  buffer_load_dword v62, v108, s[28:31], s80 offen offset:0 sc1
  buffer_load_dword v66, v108, s[28:31], s80 offen offset:256 sc1
  v_mfma_f32_16x16x32_bf16 a[148:151], a[180:183], a[216:219], a[148:151]
  ds_read_b64_tr_b16 a[194:195], v6 offset:21504
  buffer_load_dword v70, v83, s[28:31], s80 offen offset:512 sc1
  v_mfma_f32_16x16x32_bf16 a[148:151], a[176:179], a[200:203], a[148:151]
  buffer_load_dwordx4 v2, s[12:15], s73 offen offset:256 lds
  s_add_u32 m0, s74, 28288
  v_mfma_f32_16x16x32_bf16 a[152:155], a[176:179], a[204:207], a[152:155]
  ds_read_b64_tr_b16 a[244:245], v6 offset:40960
  buffer_load_dword v74, v82, s[28:31], s80 offen offset:768 sc1
  v_mfma_f32_16x16x32_bf16 a[152:155], a[180:183], a[220:223], a[152:155]
  buffer_load_dword v78, v109, s[28:31], s80 offen offset:0 sc1
  v_mfma_f32_16x16x32_bf16 a[156:159], a[180:183], a[224:227], a[156:159]
  ds_read_b64_tr_b16 a[246:247], v6 offset:41984
  v_mfma_f32_16x16x32_bf16 a[156:159], a[176:179], a[208:211], a[156:159]
  buffer_load_dwordx4 v2, s[12:15], s70 offen offset:384 lds
  s_waitcnt lgkmcnt(4)
  v_mfma_f32_16x16x32_bf16 a[160:163], a[184:187], a[196:199], a[160:163]
  ds_read_b64_tr_b16 a[176:177], v6 offset:24576
  s_add_u32 m0, s74, 29312
  v_mfma_f32_16x16x32_bf16 a[160:163], a[188:191], a[212:215], a[160:163]
  v_mfma_f32_16x16x32_bf16 a[164:167], a[188:191], a[216:219], a[164:167]
  ds_read_b64_tr_b16 a[178:179], v6 offset:25600
  v_mfma_f32_16x16x32_bf16 a[164:167], a[184:187], a[200:203], a[164:167]
  v_mfma_f32_16x16x32_bf16 a[168:171], a[184:187], a[204:207], a[168:171]
  ds_read_b64_tr_b16 a[180:181], v6 offset:45056
  v_mfma_f32_16x16x32_bf16 a[168:171], a[188:191], a[220:223], a[168:171]
  buffer_load_dwordx4 v2, s[12:15], s73 offen offset:384 lds
  s_add_u32 s92, s92, 2
  v_mfma_f32_16x16x32_bf16 a[172:175], a[188:191], a[224:227], a[172:175]
  ds_read_b64_tr_b16 a[182:183], v6 offset:46080
  s_cmp_eq_u32 s92, 18
  s_cselect_b32 s92, 0, s92
  v_mfma_f32_16x16x32_bf16 a[172:175], a[184:187], a[208:211], a[172:175]
  s_mul_i32 s70, s92, 294912
  s_waitcnt lgkmcnt(4)
  v_mfma_f32_16x16x32_bf16 v[112:115], a[192:195], a[228:231], v[112:115]
  ds_read_b64_tr_b16 a[184:185], v6 offset:20992
  s_add_u32 s73, s70, 36864
  v_mfma_f32_16x16x32_bf16 v[112:115], a[244:247], v[84:87], v[112:115]
  s_mul_i32 s71, s92, s77
  v_mfma_f32_16x16x32_bf16 v[116:119], a[244:247], v[88:91], v[116:119]
  ds_read_b64_tr_b16 a[186:187], v6 offset:22016
  v_mfma_f32_16x16x32_bf16 v[116:119], a[192:195], a[232:235], v[116:119]
  v_mfma_f32_16x16x32_bf16 v[120:123], a[192:195], a[236:239], v[120:123]
  ds_read_b64_tr_b16 a[188:189], v6 offset:41472
  v_mfma_f32_16x16x32_bf16 v[120:123], a[244:247], v[92:95], v[120:123]
  v_mfma_f32_16x16x32_bf16 v[124:127], a[244:247], v[96:99], v[124:127]
  ds_read_b64_tr_b16 a[190:191], v6 offset:42496
  v_mfma_f32_16x16x32_bf16 v[124:127], a[192:195], a[240:243], v[124:127]
  s_waitcnt lgkmcnt(4)
  v_mfma_f32_16x16x32_bf16 a[0:3], a[176:179], a[228:231], a[0:3]
  ds_read_b64_tr_b16 a[192:193], v6 offset:25088
  v_mfma_f32_16x16x32_bf16 a[0:3], a[180:183], v[84:87], a[0:3]
  v_mfma_f32_16x16x32_bf16 a[4:7], a[180:183], v[88:91], a[4:7]
  ds_read_b64_tr_b16 a[194:195], v6 offset:26112
  v_mfma_f32_16x16x32_bf16 a[4:7], a[176:179], a[232:235], a[4:7]
  v_mfma_f32_16x16x32_bf16 a[8:11], a[176:179], a[236:239], a[8:11]
  ds_read_b64_tr_b16 a[244:245], v6 offset:45568
  v_mfma_f32_16x16x32_bf16 a[8:11], a[180:183], v[92:95], a[8:11]
  v_mfma_f32_16x16x32_bf16 a[12:15], a[180:183], v[96:99], a[12:15]
  ds_read_b64_tr_b16 a[246:247], v6 offset:46592
  v_mfma_f32_16x16x32_bf16 a[12:15], a[176:179], a[240:243], a[12:15]
  s_waitcnt lgkmcnt(4)
  s_barrier
  v_mfma_f32_16x16x32_bf16 v[128:131], a[184:187], a[228:231], v[128:131]
  ds_read_b64_tr_b16 a[176:177], v6 offset:28672
  s_add_u32 m0, s100, 40960
  v_mfma_f32_16x16x32_bf16 v[128:131], a[188:191], v[84:87], v[128:131]
  buffer_load_dwordx4 v110, s[12:15], s70 offen lds
  s_add_u32 m0, s74, 40960
  v_mfma_f32_16x16x32_bf16 v[132:135], a[188:191], v[88:91], v[132:135]
  ds_read_b64_tr_b16 a[178:179], v6 offset:29696
  v_mfma_f32_16x16x32_bf16 v[132:135], a[184:187], a[232:235], v[132:135]
  v_mfma_f32_16x16x32_bf16 v[136:139], a[184:187], a[236:239], v[136:139]
  ds_read_b64_tr_b16 a[180:181], v6 offset:49152
  v_mfma_f32_16x16x32_bf16 v[136:139], a[188:191], v[92:95], v[136:139]
  buffer_load_dwordx4 v2, s[12:15], s70 offen offset:0 lds
  s_add_u32 m0, s74, 41984
  v_mfma_f32_16x16x32_bf16 v[140:143], a[188:191], v[96:99], v[140:143]
  ds_read_b64_tr_b16 a[182:183], v6 offset:50176
  v_mfma_f32_16x16x32_bf16 v[140:143], a[184:187], a[240:243], v[140:143]
  s_waitcnt lgkmcnt(4)
  v_mfma_f32_16x16x32_bf16 a[16:19], a[192:195], a[228:231], a[16:19]
  ds_read_b64_tr_b16 a[184:185], v6 offset:32768
  v_mfma_f32_16x16x32_bf16 a[16:19], a[244:247], v[84:87], a[16:19]
  buffer_load_dwordx4 v2, s[12:15], s73 offen offset:0 lds
  s_add_u32 m0, s74, 49024
  v_mfma_f32_16x16x32_bf16 a[20:23], a[244:247], v[88:91], a[20:23]
  ds_read_b64_tr_b16 a[186:187], v6 offset:33792
  v_mfma_f32_16x16x32_bf16 a[20:23], a[192:195], a[232:235], a[20:23]
  v_mfma_f32_16x16x32_bf16 a[24:27], a[192:195], a[236:239], a[24:27]
  ds_read_b64_tr_b16 a[188:189], v6 offset:53248
  v_mfma_f32_16x16x32_bf16 a[24:27], a[244:247], v[92:95], a[24:27]
  v_mfma_f32_16x16x32_bf16 a[28:31], a[244:247], v[96:99], a[28:31]
  ds_read_b64_tr_b16 a[190:191], v6 offset:54272
  v_mfma_f32_16x16x32_bf16 a[28:31], a[192:195], a[240:243], a[28:31]
  buffer_load_dwordx4 v2, s[12:15], s70 offen offset:128 lds
  s_waitcnt lgkmcnt(4)
  v_mfma_f32_16x16x32_bf16 v[144:147], a[176:179], a[228:231], v[144:147]
  ds_read_b64_tr_b16 a[192:193], v6 offset:29184
  s_add_u32 m0, s74, 50048
  v_mfma_f32_16x16x32_bf16 v[144:147], a[180:183], v[84:87], v[144:147]
  v_mfma_f32_16x16x32_bf16 v[148:151], a[180:183], v[88:91], v[148:151]
  ds_read_b64_tr_b16 a[194:195], v6 offset:30208
  v_mfma_f32_16x16x32_bf16 v[148:151], a[176:179], a[232:235], v[148:151]
  v_mfma_f32_16x16x32_bf16 v[152:155], a[176:179], a[236:239], v[152:155]
  ds_read_b64_tr_b16 a[244:245], v6 offset:49664
  v_mfma_f32_16x16x32_bf16 v[152:155], a[180:183], v[92:95], v[152:155]
  buffer_load_dwordx4 v2, s[12:15], s73 offen offset:128 lds
  s_add_u32 s70, s70, 294912
  v_mfma_f32_16x16x32_bf16 v[156:159], a[180:183], v[96:99], v[156:159]
  ds_read_b64_tr_b16 a[246:247], v6 offset:50688
  s_add_u32 s73, s73, 294912
  v_mfma_f32_16x16x32_bf16 v[156:159], a[176:179], a[240:243], v[156:159]
  s_add_u32 s71, s71, s77
  s_waitcnt lgkmcnt(4)
  v_mfma_f32_16x16x32_bf16 a[32:35], a[184:187], a[228:231], a[32:35]
  ds_read_b64_tr_b16 a[176:177], v6 offset:33280
  s_add_u32 m0, s100, 61440
  v_mfma_f32_16x16x32_bf16 a[32:35], a[188:191], v[84:87], a[32:35]
  v_and_b32 v28, 15, v1
  v_lshlrev_b32 v28, 2, v28
  v_mfma_f32_16x16x32_bf16 a[36:39], a[188:191], v[88:91], a[36:39]
  ds_read_b64_tr_b16 a[178:179], v6 offset:34304
  v_and_b32 v29, 31, v1
  v_mfma_f32_16x16x32_bf16 a[36:39], a[184:187], a[232:235], a[36:39]
  buffer_load_dwordx4 v110, s[12:15], s70 offen lds
  s_add_u32 m0, s74, 61440
  v_mfma_f32_16x16x32_bf16 a[40:43], a[184:187], a[236:239], a[40:43]
  ds_read_b64_tr_b16 a[180:181], v6 offset:53760
  v_lshlrev_b32 v29, 2, v29
  v_mfma_f32_16x16x32_bf16 a[40:43], a[188:191], v[92:95], a[40:43]
  s_waitcnt vmcnt(28)
  ds_bpermute_b32 v24, v28, v59
  ds_bpermute_b32 v25, v28, v59 offset:64
  v_mfma_f32_16x16x32_bf16 a[44:47], a[188:191], v[96:99], a[44:47]
  ds_read_b64_tr_b16 a[182:183], v6 offset:54784
  ds_bpermute_b32 v26, v28, v59 offset:128
  v_mfma_f32_16x16x32_bf16 a[44:47], a[184:187], a[240:243], a[44:47]
  buffer_load_dwordx4 v2, s[12:15], s70 offen offset:0 lds
  s_waitcnt lgkmcnt(7)
  v_mfma_f32_16x16x32_bf16 v[160:163], a[192:195], a[228:231], v[160:163]
  ds_read_b64_tr_b16 a[184:185], v45 offset:36864
  s_add_u32 m0, s74, 62464
  v_mfma_f32_16x16x32_bf16 v[160:163], a[244:247], v[84:87], v[160:163]
  ds_bpermute_b32 v27, v28, v59 offset:192
  ds_bpermute_b32 v30, v29, v59
  v_mfma_f32_16x16x32_bf16 v[164:167], a[244:247], v[88:91], v[164:167]
  ds_read_b64_tr_b16 a[186:187], v45 offset:37376
  ds_bpermute_b32 v31, v29, v59 offset:128
  v_mfma_f32_16x16x32_bf16 v[164:167], a[192:195], a[232:235], v[164:167]
  s_waitcnt vmcnt(20)
  v_add_f32 v60, v60, v61
  s_waitcnt vmcnt(14)
  v_add_f32 v60, v60, v62
  v_mfma_f32_16x16x32_bf16 v[168:171], a[192:195], a[236:239], v[168:171]
  ds_read_b64_tr_b16 a[188:189], v45 offset:57344
  v_and_b32 v61, 0xffff0000, v60
  v_mfma_f32_16x16x32_bf16 v[168:171], a[244:247], v[92:95], v[168:171]
  buffer_load_dwordx4 v2, s[12:15], s73 offen offset:0 lds
  s_add_u32 m0, s74, 69504
  v_mfma_f32_16x16x32_bf16 v[172:175], a[244:247], v[96:99], v[172:175]
  ds_read_b64_tr_b16 a[190:191], v45 offset:57856
  v_sub_f32 v61, v60, v61
  v_mfma_f32_16x16x32_bf16 v[172:175], a[192:195], a[240:243], v[172:175]
  v_lshrrev_b32 v60, 16, v60
  s_waitcnt lgkmcnt(8)
  v_mfma_f32_16x16x32_bf16 a[48:51], a[176:179], a[228:231], a[48:51]
  ds_read_b64_tr_b16 a[192:193], v45 offset:38912
  v_and_b32 v62, 0xffff0000, v61
  v_mfma_f32_16x16x32_bf16 a[48:51], a[180:183], v[84:87], a[48:51]
  v_sub_f32 v63, v61, v62
  v_or_b32 v48, v60, v62
  v_mfma_f32_16x16x32_bf16 a[52:55], a[180:183], v[88:91], a[52:55]
  ds_read_b64_tr_b16 a[194:195], v45 offset:39424
  v_lshrrev_b32 v49, 16, v63
  v_mfma_f32_16x16x32_bf16 a[52:55], a[176:179], a[232:235], a[52:55]
  buffer_load_dwordx4 v2, s[12:15], s70 offen offset:128 lds
  s_add_u32 m0, s74, 70528
  v_mfma_f32_16x16x32_bf16 a[56:59], a[176:179], a[236:239], a[56:59]
  ds_read_b64_tr_b16 a[244:245], v45 offset:59392
  v_add_f32 v64, v64, v65
  v_mfma_f32_16x16x32_bf16 a[56:59], a[180:183], v[92:95], a[56:59]
  s_waitcnt vmcnt(15)
  v_add_f32 v64, v64, v66
  v_and_b32 v65, 0xffff0000, v64
  v_mfma_f32_16x16x32_bf16 a[60:63], a[180:183], v[96:99], a[60:63]
  ds_read_b64_tr_b16 a[246:247], v45 offset:59904
  v_sub_f32 v65, v64, v65
  v_mfma_f32_16x16x32_bf16 a[60:63], a[176:179], a[240:243], a[60:63]
  v_lshrrev_b32 v64, 16, v64
  s_waitcnt lgkmcnt(4)
  s_waitcnt vmcnt(9)
  s_barrier
  v_mfma_f32_16x16x32_bf16 v[176:179], a[184:187], a[228:231], v[176:179]
  ds_read_b64_tr_b16 a[176:177], v5 offset:0
  v_and_b32 v66, 0xffff0000, v65
  v_mfma_f32_16x16x32_bf16 v[176:179], a[188:191], v[84:87], v[176:179]
  buffer_load_dwordx4 v2, s[12:15], s73 offen offset:128 lds
  s_sub_u32 s70, s70, 294912
  v_mfma_f32_16x16x32_bf16 v[180:183], a[188:191], v[88:91], v[180:183]
  ds_read_b64_tr_b16 a[178:179], v5 offset:1024
  s_sub_u32 s73, s73, 294912
  v_mfma_f32_16x16x32_bf16 v[180:183], a[184:187], a[232:235], v[180:183]
  ds_read_b128 a[196:199], v13 offset:0
  s_sub_u32 s71, s71, s77
  v_mfma_f32_16x16x32_bf16 v[184:187], a[184:187], a[236:239], v[184:187]
  ds_read_b64_tr_b16 a[180:181], v5 offset:20480
  v_sub_f32 v67, v65, v66
  v_mfma_f32_16x16x32_bf16 v[184:187], a[188:191], v[92:95], v[184:187]
  v_or_b32 v50, v64, v66
  v_lshrrev_b32 v51, 16, v67
  v_mfma_f32_16x16x32_bf16 v[188:191], a[188:191], v[96:99], v[188:191]
  ds_read_b64_tr_b16 a[182:183], v5 offset:21504
  v_add_f32 v68, v68, v69
  v_mfma_f32_16x16x32_bf16 v[188:191], a[184:187], a[240:243], v[188:191]
  ds_read_b128 a[212:215], v14 offset:0
  s_waitcnt lgkmcnt(6)
  v_mfma_f32_16x16x32_bf16 a[64:67], a[192:195], a[228:231], a[64:67]
  ds_read_b64_tr_b16 a[184:185], v5 offset:4096
  v_add_f32 v68, v68, v70
  v_mfma_f32_16x16x32_bf16 a[64:67], a[244:247], v[84:87], a[64:67]
  v_and_b32 v69, 0xffff0000, v68
  v_sub_f32 v69, v68, v69
  v_mfma_f32_16x16x32_bf16 a[68:71], a[244:247], v[88:91], a[68:71]
  ds_read_b64_tr_b16 a[186:187], v5 offset:5120
  v_lshrrev_b32 v68, 16, v68
  v_mfma_f32_16x16x32_bf16 a[68:71], a[192:195], a[232:235], a[68:71]
  ds_read_b128 a[200:203], v13 offset:2048
  v_and_b32 v70, 0xffff0000, v69
  v_mfma_f32_16x16x32_bf16 a[72:75], a[192:195], a[236:239], a[72:75]
  ds_read_b64_tr_b16 a[188:189], v5 offset:24576
  v_sub_f32 v71, v69, v70
  v_mfma_f32_16x16x32_bf16 a[72:75], a[244:247], v[92:95], a[72:75]
  v_or_b32 v52, v68, v70
  v_lshrrev_b32 v53, 16, v71
  v_mfma_f32_16x16x32_bf16 a[76:79], a[244:247], v[96:99], a[76:79]
  ds_read_b64_tr_b16 a[190:191], v5 offset:25600
  v_add_f32 v72, v72, v73
  v_mfma_f32_16x16x32_bf16 a[76:79], a[192:195], a[240:243], a[76:79]
  ds_read_b128 a[216:219], v14 offset:2048
  s_waitcnt lgkmcnt(7)
  v_mfma_f32_16x16x32_bf16 v[192:195], a[176:179], a[228:231], v[192:195]
  ds_read_b64_tr_b16 a[192:193], v5 offset:512
  v_add_f32 v72, v72, v74
  v_mfma_f32_16x16x32_bf16 v[192:195], a[180:183], v[84:87], v[192:195]
  v_and_b32 v73, 0xffff0000, v72
  v_sub_f32 v73, v72, v73
  v_mfma_f32_16x16x32_bf16 v[196:199], a[180:183], v[88:91], v[196:199]
  ds_read_b64_tr_b16 a[194:195], v5 offset:1536
  v_lshrrev_b32 v72, 16, v72
  v_mfma_f32_16x16x32_bf16 v[196:199], a[176:179], a[232:235], v[196:199]
  ds_read_b128 a[204:207], v13 offset:4096
  v_and_b32 v74, 0xffff0000, v73
  v_mfma_f32_16x16x32_bf16 v[200:203], a[176:179], a[236:239], v[200:203]
  ds_read_b64_tr_b16 a[244:245], v5 offset:20992
  v_sub_f32 v75, v73, v74
  v_mfma_f32_16x16x32_bf16 v[200:203], a[180:183], v[92:95], v[200:203]
  v_or_b32 v54, v72, v74
  v_lshrrev_b32 v55, 16, v75
  v_mfma_f32_16x16x32_bf16 v[204:207], a[180:183], v[96:99], v[204:207]
  ds_read_b64_tr_b16 a[246:247], v5 offset:22016
  v_add_f32 v76, v76, v77
  v_mfma_f32_16x16x32_bf16 v[204:207], a[176:179], a[240:243], v[204:207]
  ds_read_b128 a[220:223], v14 offset:4096
  s_waitcnt lgkmcnt(7)
  v_mfma_f32_16x16x32_bf16 a[80:83], a[184:187], a[228:231], a[80:83]
  ds_read_b64_tr_b16 a[176:177], v5 offset:4608
  v_add_f32 v76, v76, v78
  v_mfma_f32_16x16x32_bf16 a[80:83], a[188:191], v[84:87], a[80:83]
  v_and_b32 v77, 0xffff0000, v76
  v_sub_f32 v77, v76, v77
  v_mfma_f32_16x16x32_bf16 a[84:87], a[188:191], v[88:91], a[84:87]
  ds_read_b64_tr_b16 a[178:179], v5 offset:5632
  v_lshrrev_b32 v76, 16, v76
  v_mfma_f32_16x16x32_bf16 a[84:87], a[184:187], a[232:235], a[84:87]
  ds_read_b128 a[208:211], v13 offset:6144
  v_and_b32 v78, 0xffff0000, v77
  v_mfma_f32_16x16x32_bf16 a[88:91], a[184:187], a[236:239], a[88:91]
  ds_read_b64_tr_b16 a[180:181], v5 offset:25088
  v_sub_f32 v79, v77, v78
  v_mfma_f32_16x16x32_bf16 a[88:91], a[188:191], v[92:95], a[88:91]
  v_or_b32 v56, v76, v78
  v_lshrrev_b32 v57, 16, v79
  v_mfma_f32_16x16x32_bf16 a[92:95], a[188:191], v[96:99], a[92:95]
  ds_read_b64_tr_b16 a[182:183], v5 offset:26112
  v_accvgpr_write_b32 a254, v30
  v_mfma_f32_16x16x32_bf16 a[92:95], a[184:187], a[240:243], a[92:95]
  ds_read_b128 a[224:227], v14 offset:6144
  s_waitcnt lgkmcnt(7)
  s_barrier
  v_mfma_f32_16x16x32_bf16 v[208:211], a[192:195], a[228:231], v[208:211]
  ds_read_b64_tr_b16 a[184:185], v5 offset:8192
  v_accvgpr_write_b32 a255, v31
  v_mfma_f32_16x16x32_bf16 v[208:211], a[244:247], v[84:87], v[208:211]
  v_xor_b32 v58, 0x80000000, v58
  v_lshrrev_b32 v59, 16, v58
  v_mfma_f32_16x16x32_bf16 v[212:215], a[244:247], v[88:91], v[212:215]
  ds_read_b64_tr_b16 a[186:187], v5 offset:9216
  v_or_b32 v58, v58, v59
  v_mfma_f32_16x16x32_bf16 v[212:215], a[192:195], a[232:235], v[212:215]
  s_mul_i32 s79, s68, 3584
  s_sub_u32 s79, 40960, s79
  v_mfma_f32_16x16x32_bf16 v[216:219], a[192:195], a[236:239], v[216:219]
  ds_read_b64_tr_b16 a[188:189], v5 offset:28672
  v_add_u32 v60, s79, v16
  v_mfma_f32_16x16x32_bf16 v[216:219], a[244:247], v[92:95], v[216:219]
  v_add_u32 v61, s79, v17
  v_add_u32 v62, s79, v18
  v_mfma_f32_16x16x32_bf16 v[220:223], a[244:247], v[96:99], v[220:223]
  ds_read_b64_tr_b16 a[190:191], v5 offset:29696
  v_add_u32 v63, s79, v19
  v_mfma_f32_16x16x32_bf16 v[220:223], a[192:195], a[240:243], v[220:223]
  v_bfe_u32 v28, v1, 2, 3
  s_waitcnt lgkmcnt(5)
  v_mfma_f32_16x16x32_bf16 a[96:99], a[176:179], a[228:231], a[96:99]
  ds_read_b64_tr_b16 a[192:193], v5 offset:12288
  s_mul_i32 s79, s65, 288
  v_mfma_f32_16x16x32_bf16 a[96:99], a[180:183], v[84:87], a[96:99]
  v_add_u32 v28, s79, v28
  v_mul_u32_u24 v28, 1152, v28
  v_mfma_f32_16x16x32_bf16 a[100:103], a[180:183], v[88:91], a[100:103]
  ds_read_b64_tr_b16 a[194:195], v5 offset:13312
  v_bfe_u32 v29, v1, 4, 1
  v_mfma_f32_16x16x32_bf16 a[100:103], a[176:179], a[232:235], a[100:103]
  v_lshlrev_b32 v29, 1, v29
  v_and_b32 v30, 3, v1
  v_mfma_f32_16x16x32_bf16 a[104:107], a[176:179], a[236:239], a[104:107]
L_pg6:
  s_cbranch_execz L_pg10
  ds_read_b64_tr_b16 a[244:245], v5 offset:32768
  v_xor_b32 v29, v29, v30
  v_mfma_f32_16x16x32_bf16 a[104:107], a[180:183], v[92:95], a[104:107]
  v_lshl_add_u32 v28, v29, 4, v28
  v_lshrrev_b32 v29, 5, v1
  v_mfma_f32_16x16x32_bf16 a[108:111], a[180:183], v[96:99], a[108:111]
  ds_read_b64_tr_b16 a[246:247], v5 offset:33792
  v_lshl_add_u32 v28, v29, 6, v28
  v_mfma_f32_16x16x32_bf16 a[108:111], a[176:179], a[240:243], a[108:111]
  s_mul_i32 s79, s66, 9216
  s_waitcnt lgkmcnt(4)
  v_mfma_f32_16x16x32_bf16 v[224:227], a[184:187], a[228:231], v[224:227]
  ds_read_b64_tr_b16 a[176:177], v5 offset:8704
  s_add_u32 s79, s79, 512
  v_mfma_f32_16x16x32_bf16 v[224:227], a[188:191], v[84:87], v[224:227]
  v_add_u32 v64, s79, v28
  s_mul_i32 s79, s68, 18432
  v_mfma_f32_16x16x32_bf16 v[228:231], a[188:191], v[88:91], v[228:231]
  ds_read_b64_tr_b16 a[178:179], v5 offset:9728
  s_mul_i32 s80, s67, 640
  v_mfma_f32_16x16x32_bf16 v[228:231], a[184:187], a[232:235], v[228:231]
  s_add_u32 s79, s79, s80
  s_lshl_b32 s80, s91, 7
  v_mfma_f32_16x16x32_bf16 v[232:235], a[184:187], a[236:239], v[232:235]
  ds_read_b64_tr_b16 a[180:181], v5 offset:29184
  s_add_u32 s79, s79, s80
  v_mfma_f32_16x16x32_bf16 v[232:235], a[188:191], v[92:95], v[232:235]
  v_add_u32 v65, s79, v28
  s_mul_i32 s51, s65, 288
  v_mfma_f32_16x16x32_bf16 v[236:239], a[188:191], v[96:99], v[236:239]
  ds_read_b64_tr_b16 a[182:183], v5 offset:30208
  s_mul_i32 s80, s64, 18
  v_mfma_f32_16x16x32_bf16 v[236:239], a[184:187], a[240:243], v[236:239]
  s_add_u32 s51, s51, s80
  s_waitcnt lgkmcnt(4)
  v_mfma_f32_16x16x32_bf16 a[112:115], a[192:195], a[228:231], a[112:115]
  ds_read_b64_tr_b16 a[184:185], v5 offset:12800
  s_mul_i32 s51, s51, 1152
  v_mfma_f32_16x16x32_bf16 a[112:115], a[244:247], v[84:87], a[112:115]
  s_mul_i32 s80, s66, 5248
  s_add_u32 s51, s51, s80
  v_mfma_f32_16x16x32_bf16 a[116:119], a[244:247], v[88:91], a[116:119]
  ds_read_b64_tr_b16 a[186:187], v5 offset:13824
  v_min_u32 v108, 40, v1
  v_mfma_f32_16x16x32_bf16 a[116:119], a[192:195], a[232:235], a[116:119]
  v_lshlrev_b32 v108, 7, v108
  s_and_b32 s80, s65, 1
  v_mfma_f32_16x16x32_bf16 a[120:123], a[192:195], a[236:239], a[120:123]
  ds_read_b64_tr_b16 a[188:189], v5 offset:33280
  s_lshl_b32 s80, s80, 4
  v_mfma_f32_16x16x32_bf16 a[120:123], a[244:247], v[92:95], a[120:123]
  s_add_u32 s80, s80, s64
  s_lshl_b32 s80, s80, 2
  v_mfma_f32_16x16x32_bf16 a[124:127], a[244:247], v[96:99], a[124:127]
  ds_read_b64_tr_b16 a[190:191], v5 offset:34304
  s_add_u32 s80, s80, s66
  v_mfma_f32_16x16x32_bf16 a[124:127], a[192:195], a[240:243], a[124:127]
  s_mul_i32 s80, s80, 23
  s_waitcnt lgkmcnt(4)
  v_mfma_f32_16x16x32_bf16 v[240:243], a[176:179], a[228:231], v[240:243]
  ds_read_b64_tr_b16 a[192:193], v7 offset:0
  v_min_u32 v106, 22, v1
  v_mfma_f32_16x16x32_bf16 v[240:243], a[180:183], v[84:87], v[240:243]
  v_add_u32 v106, s80, v106
  v_mul_u32_u24 v107, 13108, v106
  v_mfma_f32_16x16x32_bf16 v[244:247], a[180:183], v[88:91], v[244:247]
  ds_read_b64_tr_b16 a[194:195], v7 offset:384
  v_lshrrev_b32 v107, 16, v107
  v_mfma_f32_16x16x32_bf16 v[244:247], a[176:179], a[232:235], v[244:247]
  v_lshl_add_u32 v106, v107, 2, v106
  v_lshlrev_b32 v106, 7, v106
  v_mfma_f32_16x16x32_bf16 v[248:251], a[176:179], a[236:239], v[248:251]
  ds_read_b64_tr_b16 a[244:245], v7 offset:20480
  s_bfe_u32 s52, s65, 0x10001
  v_mfma_f32_16x16x32_bf16 v[248:251], a[180:183], v[92:95], v[248:251]
  s_lshl_b32 s52, s52, 9
  v_mfma_f32_16x16x32_bf16 v[252:255], a[180:183], v[96:99], v[252:255]
  ds_read_b64_tr_b16 a[246:247], v7 offset:20864
  v_mfma_f32_16x16x32_bf16 v[252:255], a[176:179], a[240:243], v[252:255]
  s_waitcnt lgkmcnt(4)
  v_mfma_f32_16x16x32_bf16 a[128:131], a[184:187], a[228:231], a[128:131]
  ds_read_b64_tr_b16 a[176:177], v9 offset:0
  v_mfma_f32_16x16x32_bf16 a[128:131], a[188:191], v[84:87], a[128:131]
  v_mfma_f32_16x16x32_bf16 a[132:135], a[188:191], v[88:91], a[132:135]
  ds_read_b64_tr_b16 a[178:179], v11 offset:0
  v_mfma_f32_16x16x32_bf16 a[132:135], a[184:187], a[232:235], a[132:135]
  v_mfma_f32_16x16x32_bf16 a[136:139], a[184:187], a[236:239], a[136:139]
  ds_read_b64_tr_b16 a[180:181], v9 offset:20480
  v_mfma_f32_16x16x32_bf16 a[136:139], a[188:191], v[92:95], a[136:139]
  v_mfma_f32_16x16x32_bf16 a[140:143], a[188:191], v[96:99], a[140:143]
  ds_read_b64_tr_b16 a[182:183], v11 offset:20480
  v_mfma_f32_16x16x32_bf16 a[140:143], a[184:187], a[240:243], a[140:143]
  s_waitcnt lgkmcnt(4)
  s_waitcnt vmcnt(0)
  s_barrier
  v_mfma_f32_16x16x32_bf16 a[144:147], a[192:195], a[228:231], a[144:147]
  ds_read_b64_tr_b16 a[184:185], v5 offset:40960
  v_mfma_f32_16x16x32_bf16 a[144:147], a[244:247], v[84:87], a[144:147]
  v_mfma_f32_16x16x32_bf16 a[148:151], a[244:247], v[88:91], a[148:151]
  ds_read_b64_tr_b16 a[186:187], v5 offset:41984
  v_mfma_f32_16x16x32_bf16 a[148:151], a[192:195], a[232:235], a[148:151]
  v_mfma_f32_16x16x32_bf16 a[152:155], a[192:195], a[236:239], a[152:155]
  ds_read_b64_tr_b16 a[188:189], v6 offset:0
  v_mfma_f32_16x16x32_bf16 a[152:155], a[244:247], v[92:95], a[152:155]
  v_mfma_f32_16x16x32_bf16 a[156:159], a[244:247], v[96:99], a[156:159]
  ds_read_b64_tr_b16 a[190:191], v6 offset:1024
  v_mfma_f32_16x16x32_bf16 a[156:159], a[192:195], a[240:243], a[156:159]
  s_waitcnt lgkmcnt(4)
  v_mfma_f32_16x16x32_bf16 a[160:163], a[176:179], a[228:231], a[160:163]
  ds_read_b64_tr_b16 a[192:193], v5 offset:45056
  v_mfma_f32_16x16x32_bf16 a[160:163], a[180:183], v[84:87], a[160:163]
  v_mfma_f32_16x16x32_bf16 a[164:167], a[180:183], v[88:91], a[164:167]
  ds_read_b64_tr_b16 a[194:195], v5 offset:46080
  v_mfma_f32_16x16x32_bf16 a[164:167], a[176:179], a[232:235], a[164:167]
  v_mfma_f32_16x16x32_bf16 a[168:171], a[176:179], a[236:239], a[168:171]
  ds_read_b64_tr_b16 a[244:245], v6 offset:4096
  v_mfma_f32_16x16x32_bf16 a[168:171], a[180:183], v[92:95], a[168:171]
  v_mfma_f32_16x16x32_bf16 a[172:175], a[180:183], v[96:99], a[172:175]
  ds_read_b64_tr_b16 a[246:247], v6 offset:5120
  v_mfma_f32_16x16x32_bf16 a[172:175], a[176:179], a[240:243], a[172:175]
  s_waitcnt lgkmcnt(4)
  v_mfma_f32_16x16x32_bf16 v[112:115], a[184:187], a[196:199], v[112:115]
  ds_read_b64_tr_b16 a[176:177], v5 offset:41472
  v_mfma_f32_16x16x32_bf16 v[112:115], a[188:191], a[212:215], v[112:115]
  v_mfma_f32_16x16x32_bf16 v[116:119], a[188:191], a[216:219], v[116:119]
  ds_read_b64_tr_b16 a[178:179], v5 offset:42496
  v_mfma_f32_16x16x32_bf16 v[116:119], a[184:187], a[200:203], v[116:119]
  v_mfma_f32_16x16x32_bf16 v[120:123], a[184:187], a[204:207], v[120:123]
  ds_read_b64_tr_b16 a[180:181], v6 offset:512
  v_mfma_f32_16x16x32_bf16 v[120:123], a[188:191], a[220:223], v[120:123]
  v_mfma_f32_16x16x32_bf16 v[124:127], a[188:191], a[224:227], v[124:127]
  ds_read_b64_tr_b16 a[182:183], v6 offset:1536
  v_mfma_f32_16x16x32_bf16 v[124:127], a[184:187], a[208:211], v[124:127]
  s_waitcnt lgkmcnt(4)
  v_mfma_f32_16x16x32_bf16 a[0:3], a[192:195], a[196:199], a[0:3]
  ds_read_b64_tr_b16 a[184:185], v5 offset:45568
  v_mfma_f32_16x16x32_bf16 a[0:3], a[244:247], a[212:215], a[0:3]
  s_nop 1
  v_mfma_f32_16x16x4_4b_bf16 v[112:127], v[48:49], v[58:59], v[112:127] cbsz:2 abid:0
  v_mfma_f32_16x16x32_bf16 a[4:7], a[244:247], a[216:219], a[4:7]
  ds_read_b64_tr_b16 a[186:187], v5 offset:46592
  v_mfma_f32_16x16x32_bf16 a[4:7], a[192:195], a[200:203], a[4:7]
  v_mfma_f32_16x16x32_bf16 a[8:11], a[192:195], a[204:207], a[8:11]
  ds_read_b64_tr_b16 a[188:189], v6 offset:4608
  v_mfma_f32_16x16x32_bf16 a[8:11], a[244:247], a[220:223], a[8:11]
  v_mfma_f32_16x16x32_bf16 a[12:15], a[244:247], a[224:227], a[12:15]
  ds_read_b64_tr_b16 a[190:191], v6 offset:5632
  v_mfma_f32_16x16x32_bf16 a[12:15], a[192:195], a[208:211], a[12:15]
  s_waitcnt lgkmcnt(4)
  s_barrier
  v_mfma_f32_16x16x32_bf16 v[128:131], a[176:179], a[196:199], v[128:131]
  ds_read_b64_tr_b16 a[192:193], v5 offset:49152
  s_add_u32 m0, s75, 0
  v_mfma_f32_16x16x32_bf16 v[128:131], a[180:183], a[212:215], v[128:131]
  v_mfma_f32_16x16x4_4b_bf16 a[0:15], v[48:49], v[58:59], a[0:15] cbsz:2 abid:1
  buffer_load_dwordx4 v3, s[16:19], s71 offen lds
  s_add_u32 s70, s70, 256
  s_add_u32 s73, s73, 256
  s_add_u32 m0, s74, 0
  v_mfma_f32_16x16x32_bf16 v[132:135], a[180:183], a[216:219], v[132:135]
  ds_read_b64_tr_b16 a[194:195], v5 offset:50176
  v_mfma_f32_16x16x32_bf16 v[132:135], a[176:179], a[200:203], v[132:135]
  buffer_load_dwordx4 v2, s[12:15], s70 offen offset:0 lds
  s_add_u32 m0, s74, 1024
  v_mfma_f32_16x16x32_bf16 v[136:139], a[176:179], a[204:207], v[136:139]
  ds_read_b64_tr_b16 a[244:245], v6 offset:8192
  s_nop 0
  v_accvgpr_read_b32 v28, a0
  v_mfma_f32_16x16x32_bf16 v[136:139], a[180:183], a[220:223], v[136:139]
  v_accvgpr_read_b32 v29, a1
  v_accvgpr_read_b32 v30, a2
  v_accvgpr_read_b32 v31, a3
  v_mfma_f32_16x16x32_bf16 v[140:143], a[180:183], a[224:227], v[140:143]
  ds_read_b64_tr_b16 a[246:247], v6 offset:9216
  v_mul_f32 v112, v112, v28
  v_mul_f32 v113, v113, v29
  v_mfma_f32_16x16x32_bf16 v[140:143], a[176:179], a[208:211], v[140:143]
  buffer_load_dwordx4 v2, s[12:15], s73 offen offset:0 lds
  s_add_u32 m0, s74, 8064
  s_waitcnt lgkmcnt(4)
  v_mfma_f32_16x16x32_bf16 a[16:19], a[184:187], a[196:199], a[16:19]
  ds_read_b64_tr_b16 a[176:177], v5 offset:53248
  v_mul_f32 v114, v114, v30
  v_mul_f32 v115, v115, v31
  v_mfma_f32_16x16x32_bf16 a[16:19], a[188:191], a[212:215], a[16:19]
  v_cvt_pk_bf16_f32 v112, v112, v113
  v_cvt_pk_bf16_f32 v113, v114, v115
  v_mfma_f32_16x16x4_4b_bf16 v[128:143], v[48:49], v[58:59], v[128:143] cbsz:2 abid:2
  ds_write_b64 v15, v[112:113] offset:0
  v_accvgpr_read_b32 v32, a4
  v_accvgpr_read_b32 v33, a5
  v_accvgpr_read_b32 v34, a6
  v_accvgpr_read_b32 v35, a7
  v_mul_f32 v116, v116, v32
  v_mfma_f32_16x16x32_bf16 a[20:23], a[188:191], a[216:219], a[20:23]
  ds_read_b64_tr_b16 a[178:179], v5 offset:54272
  v_mul_f32 v117, v117, v33
  v_mul_f32 v118, v118, v34
  v_mfma_f32_16x16x32_bf16 a[20:23], a[184:187], a[200:203], a[20:23]
  buffer_load_dwordx4 v2, s[12:15], s70 offen offset:128 lds
  s_add_u32 m0, s74, 9088
  v_mul_f32 v119, v119, v35
  v_mfma_f32_16x16x32_bf16 a[24:27], a[184:187], a[204:207], a[24:27]
  ds_read_b64_tr_b16 a[180:181], v6 offset:12288
  v_cvt_pk_bf16_f32 v116, v116, v117
  v_cvt_pk_bf16_f32 v117, v118, v119
  v_mfma_f32_16x16x32_bf16 a[24:27], a[188:191], a[220:223], a[24:27]
  ds_write_b64 v15, v[116:117] offset:1024
  v_accvgpr_read_b32 v28, a8
  v_accvgpr_read_b32 v29, a9
  v_mfma_f32_16x16x32_bf16 a[28:31], a[188:191], a[224:227], a[28:31]
  ds_read_b64_tr_b16 a[182:183], v6 offset:13312
  v_accvgpr_read_b32 v30, a10
  v_accvgpr_read_b32 v31, a11
  v_mfma_f32_16x16x32_bf16 a[28:31], a[184:187], a[208:211], a[28:31]
  buffer_load_dwordx4 v2, s[12:15], s73 offen offset:128 lds
  s_sub_u32 s70, s70, 256
  s_waitcnt lgkmcnt(6)
  v_mfma_f32_16x16x32_bf16 v[144:147], a[192:195], a[196:199], v[144:147]
  ds_read_b64_tr_b16 a[184:185], v5 offset:49664
  s_sub_u32 s73, s73, 256
  s_add_u32 s70, s70, 294912
  v_mfma_f32_16x16x32_bf16 v[144:147], a[244:247], a[212:215], v[144:147]
  s_add_u32 s73, s73, 294912
  s_add_u32 s71, s71, s77
  v_mfma_f32_16x16x4_4b_bf16 a[16:31], v[48:49], v[58:59], a[16:31] cbsz:2 abid:3
  s_add_u32 m0, s75, 20480
  v_mul_f32 v120, v120, v28
  v_mul_f32 v121, v121, v29
  v_mul_f32 v122, v122, v30
  v_mul_f32 v123, v123, v31
  v_cvt_pk_bf16_f32 v120, v120, v121
  v_mfma_f32_16x16x32_bf16 v[148:151], a[244:247], a[216:219], v[148:151]
  ds_read_b64_tr_b16 a[186:187], v5 offset:50688
  v_cvt_pk_bf16_f32 v121, v122, v123
  ds_write_b64 v15, v[120:121] offset:2048
  v_mfma_f32_16x16x32_bf16 v[148:151], a[192:195], a[200:203], v[148:151]
  buffer_load_dwordx4 v3, s[16:19], s71 offen lds
  s_add_u32 m0, s74, 20224
  v_accvgpr_read_b32 v32, a12
  v_mfma_f32_16x16x32_bf16 v[152:155], a[192:195], a[204:207], v[152:155]
  ds_read_b64_tr_b16 a[188:189], v6 offset:8704
  v_accvgpr_read_b32 v33, a13
  v_accvgpr_read_b32 v34, a14
  v_mfma_f32_16x16x32_bf16 v[152:155], a[244:247], a[220:223], v[152:155]
  v_accvgpr_read_b32 v35, a15
  v_mul_f32 v124, v124, v32
  v_mul_f32 v125, v125, v33
  v_mfma_f32_16x16x32_bf16 v[156:159], a[244:247], a[224:227], v[156:159]
  ds_read_b64_tr_b16 a[190:191], v6 offset:9728
  v_mul_f32 v126, v126, v34
  v_mul_f32 v127, v127, v35
  v_mfma_f32_16x16x32_bf16 v[156:159], a[192:195], a[208:211], v[156:159]
  buffer_load_dwordx4 v2, s[12:15], s70 offen offset:256 lds
  s_add_u32 m0, s74, 21248
  s_waitcnt lgkmcnt(5)
  v_mfma_f32_16x16x32_bf16 a[32:35], a[176:179], a[196:199], a[32:35]
  ds_read_b64_tr_b16 a[192:193], v5 offset:53760
  v_cvt_pk_bf16_f32 v124, v124, v125
  v_cvt_pk_bf16_f32 v125, v126, v127
  v_mfma_f32_16x16x32_bf16 a[32:35], a[180:183], a[212:215], a[32:35]
  ds_write_b64 v15, v[124:125] offset:3072
  v_accvgpr_read_b32 v28, a16
  v_mfma_f32_16x16x4_4b_bf16 v[144:159], v[50:51], v[58:59], v[144:159] cbsz:2 abid:0
  v_accvgpr_read_b32 v29, a17
  v_accvgpr_read_b32 v30, a18
  v_accvgpr_read_b32 v31, a19
  v_mul_f32 v128, v128, v28
  v_mul_f32 v129, v129, v29
  v_mul_f32 v130, v130, v30
  v_mfma_f32_16x16x32_bf16 a[36:39], a[180:183], a[216:219], a[36:39]
  ds_read_b64_tr_b16 a[194:195], v5 offset:54784
  v_mul_f32 v131, v131, v31
  v_cvt_pk_bf16_f32 v128, v128, v129
  v_mfma_f32_16x16x32_bf16 a[36:39], a[176:179], a[200:203], a[36:39]
  buffer_load_dwordx4 v2, s[12:15], s73 offen offset:256 lds
  s_add_u32 m0, s74, 28288
  v_cvt_pk_bf16_f32 v129, v130, v131
  v_mfma_f32_16x16x32_bf16 a[40:43], a[176:179], a[204:207], a[40:43]
  ds_read_b64_tr_b16 a[244:245], v6 offset:12800
  ds_write_b64 v15, v[128:129] offset:4096
  v_accvgpr_read_b32 v32, a20
  v_mfma_f32_16x16x32_bf16 a[40:43], a[180:183], a[220:223], a[40:43]
  v_accvgpr_read_b32 v33, a21
  v_accvgpr_read_b32 v34, a22
  v_accvgpr_read_b32 v35, a23
  v_mfma_f32_16x16x32_bf16 a[44:47], a[180:183], a[224:227], a[44:47]
  ds_read_b64_tr_b16 a[246:247], v6 offset:13824
  v_mul_f32 v132, v132, v32
  v_mul_f32 v133, v133, v33
  v_mfma_f32_16x16x32_bf16 a[44:47], a[176:179], a[208:211], a[44:47]
  buffer_load_dwordx4 v2, s[12:15], s70 offen offset:384 lds
  s_add_u32 m0, s74, 29312
  s_waitcnt lgkmcnt(6)
  v_mfma_f32_16x16x32_bf16 v[160:163], a[184:187], a[196:199], v[160:163]
  ds_read_b64_tr_b16 a[176:177], v44 offset:57344
  v_mul_f32 v134, v134, v34
  v_mul_f32 v135, v135, v35
  v_mfma_f32_16x16x32_bf16 v[160:163], a[188:191], a[212:215], v[160:163]
  v_cvt_pk_bf16_f32 v132, v132, v133
  v_cvt_pk_bf16_f32 v133, v134, v135
  v_mfma_f32_16x16x4_4b_bf16 a[32:47], v[50:51], v[58:59], a[32:47] cbsz:2 abid:1
  ds_write_b64 v15, v[132:133] offset:5120
  v_accvgpr_read_b32 v28, a24
  v_accvgpr_read_b32 v29, a25
  v_accvgpr_read_b32 v30, a26
  v_accvgpr_read_b32 v31, a27
  v_mul_f32 v136, v136, v28
  v_mfma_f32_16x16x32_bf16 v[164:167], a[188:191], a[216:219], v[164:167]
  ds_read_b64_tr_b16 a[178:179], v44 offset:57856
  v_mul_f32 v137, v137, v29
  v_mul_f32 v138, v138, v30
  v_mfma_f32_16x16x32_bf16 v[164:167], a[184:187], a[200:203], v[164:167]
  buffer_load_dwordx4 v2, s[12:15], s73 offen offset:384 lds
  v_mul_f32 v139, v139, v31
  v_cvt_pk_bf16_f32 v136, v136, v137
  v_mfma_f32_16x16x32_bf16 v[168:171], a[184:187], a[204:207], v[168:171]
  ds_read_b64_tr_b16 a[180:181], v45 offset:16384
  v_cvt_pk_bf16_f32 v137, v138, v139
  ds_write_b64 v15, v[136:137] offset:6144
  v_mfma_f32_16x16x32_bf16 v[168:171], a[188:191], a[220:223], v[168:171]
  v_accvgpr_read_b32 v32, a28
  v_accvgpr_read_b32 v33, a29
  v_accvgpr_read_b32 v34, a30
  v_mfma_f32_16x16x32_bf16 v[172:175], a[188:191], a[224:227], v[172:175]
  ds_read_b64_tr_b16 a[182:183], v45 offset:16896
  v_accvgpr_read_b32 v35, a31
  v_mul_f32 v140, v140, v32
  v_mfma_f32_16x16x32_bf16 v[172:175], a[184:187], a[208:211], v[172:175]
  v_mul_f32 v141, v141, v33
  v_mul_f32 v142, v142, v34
  s_waitcnt lgkmcnt(6)
  v_mfma_f32_16x16x32_bf16 a[48:51], a[192:195], a[196:199], a[48:51]
  ds_read_b64_tr_b16 a[184:185], v44 offset:59392
  v_mul_f32 v143, v143, v35
  v_cvt_pk_bf16_f32 v140, v140, v141
  v_mfma_f32_16x16x32_bf16 a[48:51], a[244:247], a[212:215], a[48:51]
  v_cvt_pk_bf16_f32 v141, v142, v143
  ds_write_b64 v15, v[140:141] offset:7168
  v_mfma_f32_16x16x4_4b_bf16 v[160:175], v[50:51], v[58:59], v[160:175] cbsz:2 abid:2
  v_lshlrev_b32 v4, 4, v1
  v_accvgpr_read_b32 v28, a32
  v_accvgpr_read_b32 v29, a33
  v_accvgpr_read_b32 v30, a34
  v_accvgpr_read_b32 v31, a35
  v_mul_f32 v144, v144, v28
  v_mfma_f32_16x16x32_bf16 a[52:55], a[244:247], a[216:219], a[52:55]
  ds_read_b64_tr_b16 a[186:187], v44 offset:59904
  v_mul_f32 v145, v145, v29
  v_mul_f32 v146, v146, v30
  v_mfma_f32_16x16x32_bf16 a[52:55], a[192:195], a[200:203], a[52:55]
  buffer_load_dword v109, v108, s[20:23], s51 offen
  v_mul_f32 v147, v147, v31
  v_cvt_pk_bf16_f32 v144, v144, v145
  v_mfma_f32_16x16x32_bf16 a[56:59], a[192:195], a[204:207], a[56:59]
  ds_read_b64_tr_b16 a[188:189], v45 offset:18432
  v_cvt_pk_bf16_f32 v145, v146, v147
  ds_write_b64 v15, v[144:145] offset:8192
  v_mfma_f32_16x16x32_bf16 a[56:59], a[244:247], a[220:223], a[56:59]
  v_accvgpr_read_b32 v32, a36
  v_accvgpr_read_b32 v33, a37
  v_accvgpr_read_b32 v34, a38
  v_mfma_f32_16x16x32_bf16 a[60:63], a[244:247], a[224:227], a[60:63]
  ds_read_b64_tr_b16 a[190:191], v45 offset:18944
  v_accvgpr_read_b32 v35, a39
  v_mul_f32 v148, v148, v32
  v_mfma_f32_16x16x32_bf16 a[60:63], a[192:195], a[208:211], a[60:63]
  buffer_load_dword v107, v106, s[24:27], s52 offen
  v_mul_f32 v149, v149, v33
  s_waitcnt lgkmcnt(6)
  s_waitcnt vmcnt(2)
  s_barrier
  v_mfma_f32_16x16x32_bf16 v[176:179], a[176:179], a[196:199], v[176:179]
  ds_read_b64_tr_b16 a[192:193], v5 offset:0
  v_mul_f32 v150, v150, v34
  v_mul_f32 v151, v151, v35
  v_mfma_f32_16x16x32_bf16 v[176:179], a[180:183], a[212:215], v[176:179]
  v_cvt_pk_bf16_f32 v148, v148, v149
  v_cvt_pk_bf16_f32 v149, v150, v151
  v_mfma_f32_16x16x4_4b_bf16 a[48:63], v[50:51], v[58:59], a[48:63] cbsz:2 abid:3
  ds_write_b64 v15, v[148:149] offset:9216
  v_accvgpr_read_b32 v28, a40
  v_accvgpr_read_b32 v29, a41
  v_accvgpr_read_b32 v30, a42
  v_accvgpr_read_b32 v31, a43
  v_mul_f32 v152, v152, v28
  v_mfma_f32_16x16x32_bf16 v[180:183], a[180:183], a[216:219], v[180:183]
  ds_read_b64_tr_b16 a[194:195], v5 offset:1024
  v_mul_f32 v153, v153, v29
  v_mul_f32 v154, v154, v30
  v_mfma_f32_16x16x32_bf16 v[180:183], a[176:179], a[200:203], v[180:183]
  v_mul_f32 v155, v155, v31
  v_cvt_pk_bf16_f32 v152, v152, v153
  v_cvt_pk_bf16_f32 v153, v154, v155
  v_mfma_f32_16x16x32_bf16 v[184:187], a[176:179], a[204:207], v[184:187]
  ds_read_b64_tr_b16 a[244:245], v5 offset:20480
  ds_write_b64 v15, v[152:153] offset:10240
  v_accvgpr_read_b32 v32, a44
  v_mfma_f32_16x16x32_bf16 v[184:187], a[180:183], a[220:223], v[184:187]
  v_accvgpr_read_b32 v33, a45
  v_accvgpr_read_b32 v34, a46
  v_accvgpr_read_b32 v35, a47
  v_mfma_f32_16x16x32_bf16 v[188:191], a[180:183], a[224:227], v[188:191]
  ds_read_b64_tr_b16 a[246:247], v5 offset:21504
  v_mul_f32 v156, v156, v32
  v_mul_f32 v157, v157, v33
  v_mfma_f32_16x16x32_bf16 v[188:191], a[176:179], a[208:211], v[188:191]
  v_mul_f32 v158, v158, v34
  v_mul_f32 v159, v159, v35
  s_waitcnt lgkmcnt(6)
  v_mfma_f32_16x16x32_bf16 a[64:67], a[184:187], a[196:199], a[64:67]
  ds_read_b64_tr_b16 a[176:177], v5 offset:4096
  v_cvt_pk_bf16_f32 v156, v156, v157
  v_cvt_pk_bf16_f32 v157, v158, v159
  v_mfma_f32_16x16x32_bf16 a[64:67], a[188:191], a[212:215], a[64:67]
  ds_write_b64 v15, v[156:157] offset:11264
  v_accvgpr_read_b32 v28, a48
  v_mfma_f32_16x16x4_4b_bf16 v[176:191], v[52:53], v[58:59], v[176:191] cbsz:2 abid:0
  v_accvgpr_read_b32 v29, a49
  v_accvgpr_read_b32 v30, a50
  v_accvgpr_read_b32 v31, a51
  v_mul_f32 v160, v160, v28
  v_mul_f32 v161, v161, v29
  v_mul_f32 v162, v162, v30
  v_mfma_f32_16x16x32_bf16 a[68:71], a[188:191], a[216:219], a[68:71]
  ds_read_b64_tr_b16 a[178:179], v5 offset:5120
  v_mul_f32 v163, v163, v31
  v_cvt_pk_bf16_f32 v160, v160, v161
  v_mfma_f32_16x16x32_bf16 a[68:71], a[184:187], a[200:203], a[68:71]
  v_cvt_pk_bf16_f32 v161, v162, v163
  ds_write_b64 v15, v[160:161] offset:12288
  v_accvgpr_read_b32 v32, a52
  v_mfma_f32_16x16x32_bf16 a[72:75], a[184:187], a[204:207], a[72:75]
  ds_read_b64_tr_b16 a[180:181], v5 offset:24576
  v_accvgpr_read_b32 v33, a53
  v_accvgpr_read_b32 v34, a54
  v_mfma_f32_16x16x32_bf16 a[72:75], a[188:191], a[220:223], a[72:75]
  v_accvgpr_read_b32 v35, a55
  v_mul_f32 v164, v164, v32
  v_mul_f32 v165, v165, v33
  v_mfma_f32_16x16x32_bf16 a[76:79], a[188:191], a[224:227], a[76:79]
  ds_read_b64_tr_b16 a[182:183], v5 offset:25600
  v_mul_f32 v166, v166, v34
  v_mul_f32 v167, v167, v35
  v_mfma_f32_16x16x32_bf16 a[76:79], a[184:187], a[208:211], a[76:79]
  v_cvt_pk_bf16_f32 v164, v164, v165
  v_cvt_pk_bf16_f32 v165, v166, v167
  s_waitcnt lgkmcnt(6)
  v_mfma_f32_16x16x32_bf16 v[192:195], a[192:195], a[196:199], v[192:195]
  ds_read_b64_tr_b16 a[184:185], v5 offset:512
  ds_write_b64 v15, v[164:165] offset:13312
  v_accvgpr_read_b32 v28, a56
  v_mfma_f32_16x16x32_bf16 v[192:195], a[244:247], a[212:215], v[192:195]
  v_accvgpr_read_b32 v29, a57
  v_accvgpr_read_b32 v30, a58
  v_mfma_f32_16x16x4_4b_bf16 a[64:79], v[52:53], v[58:59], a[64:79] cbsz:2 abid:1
  v_accvgpr_read_b32 v31, a59
  v_mul_f32 v168, v168, v28
  v_mul_f32 v169, v169, v29
  v_mul_f32 v170, v170, v30
  v_mul_f32 v171, v171, v31
  v_cvt_pk_bf16_f32 v168, v168, v169
  v_mfma_f32_16x16x32_bf16 v[196:199], a[244:247], a[216:219], v[196:199]
  ds_read_b64_tr_b16 a[186:187], v5 offset:1536
  v_cvt_pk_bf16_f32 v169, v170, v171
  ds_write_b64 v15, v[168:169] offset:14336
  v_mfma_f32_16x16x32_bf16 v[196:199], a[192:195], a[200:203], v[196:199]
  v_accvgpr_read_b32 v32, a60
  v_accvgpr_read_b32 v33, a61
  v_accvgpr_read_b32 v34, a62
  v_mfma_f32_16x16x32_bf16 v[200:203], a[192:195], a[204:207], v[200:203]
  ds_read_b64_tr_b16 a[188:189], v5 offset:20992
  v_accvgpr_read_b32 v35, a63
  v_mul_f32 v172, v172, v32
  v_mfma_f32_16x16x32_bf16 v[200:203], a[244:247], a[220:223], v[200:203]
  v_mul_f32 v173, v173, v33
  v_mul_f32 v174, v174, v34
  v_mul_f32 v175, v175, v35
  v_mfma_f32_16x16x32_bf16 v[204:207], a[244:247], a[224:227], v[204:207]
  ds_read_b64_tr_b16 a[190:191], v5 offset:22016
  v_cvt_pk_bf16_f32 v172, v172, v173
  v_cvt_pk_bf16_f32 v173, v174, v175
  v_mfma_f32_16x16x32_bf16 v[204:207], a[192:195], a[208:211], v[204:207]
  ds_write_b64 v15, v[172:173] offset:15360
  v_accvgpr_read_b32 v28, a64
  s_waitcnt lgkmcnt(7)
  v_mfma_f32_16x16x32_bf16 a[80:83], a[176:179], a[196:199], a[80:83]
  ds_read_b64_tr_b16 a[192:193], v5 offset:4608
  v_accvgpr_read_b32 v29, a65
  v_accvgpr_read_b32 v30, a66
  v_mfma_f32_16x16x32_bf16 a[80:83], a[180:183], a[212:215], a[80:83]
  v_accvgpr_read_b32 v31, a67
  v_mul_f32 v176, v176, v28
  v_mfma_f32_16x16x4_4b_bf16 v[192:207], v[52:53], v[58:59], v[192:207] cbsz:2 abid:2
  v_mul_f32 v177, v177, v29
  v_mul_f32 v178, v178, v30
  v_mul_f32 v179, v179, v31
  v_cvt_pk_bf16_f32 v176, v176, v177
  v_cvt_pk_bf16_f32 v177, v178, v179
  ds_write_b64 v15, v[176:177] offset:16384
  v_mfma_f32_16x16x32_bf16 a[84:87], a[180:183], a[216:219], a[84:87]
  ds_read_b64_tr_b16 a[194:195], v5 offset:5632
  v_accvgpr_read_b32 v32, a68
  v_accvgpr_read_b32 v33, a69
  v_mfma_f32_16x16x32_bf16 a[84:87], a[176:179], a[200:203], a[84:87]
  v_accvgpr_read_b32 v34, a70
  v_accvgpr_read_b32 v35, a71
  v_mul_f32 v180, v180, v32
  v_mfma_f32_16x16x32_bf16 a[88:91], a[176:179], a[204:207], a[88:91]
  ds_read_b64_tr_b16 a[244:245], v5 offset:25088
  v_mul_f32 v181, v181, v33
  v_mul_f32 v182, v182, v34
  v_mfma_f32_16x16x32_bf16 a[88:91], a[180:183], a[220:223], a[88:91]
  v_mul_f32 v183, v183, v35
  v_cvt_pk_bf16_f32 v180, v180, v181
  v_cvt_pk_bf16_f32 v181, v182, v183
  v_mfma_f32_16x16x32_bf16 a[92:95], a[180:183], a[224:227], a[92:95]
  ds_read_b64_tr_b16 a[246:247], v5 offset:26112
  ds_write_b64 v15, v[180:181] offset:17408
  v_accvgpr_read_b32 v28, a72
  v_mfma_f32_16x16x32_bf16 a[92:95], a[176:179], a[208:211], a[92:95]
  v_accvgpr_read_b32 v29, a73
  v_accvgpr_read_b32 v30, a74
  s_waitcnt lgkmcnt(7)
  s_barrier
  v_mfma_f32_16x16x32_bf16 v[208:211], a[184:187], a[196:199], v[208:211]
  ds_read_b64_tr_b16 a[176:177], v5 offset:8192
  s_add_u32 m0, s75, 24576
  v_accvgpr_read_b32 v31, a75
  v_mfma_f32_16x16x32_bf16 v[208:211], a[188:191], a[212:215], v[208:211]
  v_mul_f32 v184, v184, v28
  v_mul_f32 v185, v185, v29
  v_mfma_f32_16x16x4_4b_bf16 a[80:95], v[52:53], v[58:59], a[80:95] cbsz:2 abid:3
  buffer_load_dwordx4 v64, s[20:23], s82 offen lds
  s_add_u32 m0, s75, 28672
  v_mul_f32 v186, v186, v30
  v_mul_f32 v187, v187, v31
  v_cvt_pk_bf16_f32 v184, v184, v185
  v_cvt_pk_bf16_f32 v185, v186, v187
  v_mfma_f32_16x16x32_bf16 v[212:215], a[188:191], a[216:219], v[212:215]
  ds_read_b64_tr_b16 a[178:179], v5 offset:9216
  ds_write_b64 v15, v[184:185] offset:18432
  v_accvgpr_read_b32 v32, a76
  v_mfma_f32_16x16x32_bf16 v[212:215], a[184:187], a[200:203], v[212:215]
  v_accvgpr_read_b32 v33, a77
  v_accvgpr_read_b32 v34, a78
  v_accvgpr_read_b32 v35, a79
  v_mfma_f32_16x16x32_bf16 v[216:219], a[184:187], a[204:207], v[216:219]
  ds_read_b64_tr_b16 a[180:181], v5 offset:28672
  v_mul_f32 v188, v188, v32
  v_mul_f32 v189, v189, v33
  v_mfma_f32_16x16x32_bf16 v[216:219], a[188:191], a[220:223], v[216:219]
  buffer_load_dwordx4 v64, s[20:23], s83 offen lds
  s_add_u32 m0, s75, 32768
  v_mul_f32 v190, v190, v34
  v_mfma_f32_16x16x32_bf16 v[220:223], a[188:191], a[224:227], v[220:223]
  ds_read_b64_tr_b16 a[182:183], v5 offset:29696
  v_mul_f32 v191, v191, v35
  v_cvt_pk_bf16_f32 v188, v188, v189
  v_mfma_f32_16x16x32_bf16 v[220:223], a[184:187], a[208:211], v[220:223]
  v_cvt_pk_bf16_f32 v189, v190, v191
  ds_write_b64 v15, v[188:189] offset:19456
  s_waitcnt lgkmcnt(7)
  v_mfma_f32_16x16x32_bf16 a[96:99], a[192:195], a[196:199], a[96:99]
  ds_read_b64_tr_b16 a[184:185], v5 offset:12288
  v_accvgpr_read_b32 v28, a80
  v_accvgpr_read_b32 v29, a81
  v_mfma_f32_16x16x32_bf16 a[96:99], a[244:247], a[212:215], a[96:99]
  v_accvgpr_read_b32 v30, a82
  v_accvgpr_read_b32 v31, a83
  v_mfma_f32_16x16x4_4b_bf16 v[208:223], v[54:55], v[58:59], v[208:223] cbsz:2 abid:0
  buffer_load_dwordx4 v64, s[20:23], s84 offen lds
  s_add_u32 m0, s75, 36864
  v_mul_f32 v192, v192, v28
  v_mul_f32 v193, v193, v29
  v_mul_f32 v194, v194, v30
  v_mul_f32 v195, v195, v31
  v_mfma_f32_16x16x32_bf16 a[100:103], a[244:247], a[216:219], a[100:103]
  ds_read_b64_tr_b16 a[186:187], v5 offset:13312
  v_cvt_pk_bf16_f32 v192, v192, v193
  v_cvt_pk_bf16_f32 v193, v194, v195
L_pg7:
  s_cbranch_execz L_pg11
  v_mfma_f32_16x16x32_bf16 a[100:103], a[192:195], a[200:203], a[100:103]
  ds_write_b64 v15, v[192:193] offset:20480
  v_accvgpr_read_b32 v32, a84
  v_accvgpr_read_b32 v33, a85
  v_mfma_f32_16x16x32_bf16 a[104:107], a[192:195], a[204:207], a[104:107]
  ds_read_b64_tr_b16 a[188:189], v5 offset:32768
  v_accvgpr_read_b32 v34, a86
  v_accvgpr_read_b32 v35, a87
  v_mfma_f32_16x16x32_bf16 a[104:107], a[244:247], a[220:223], a[104:107]
  v_mul_f32 v196, v196, v32
  v_mul_f32 v197, v197, v33
  v_mul_f32 v198, v198, v34
  v_mfma_f32_16x16x32_bf16 a[108:111], a[244:247], a[224:227], a[108:111]
  ds_read_b64_tr_b16 a[190:191], v5 offset:33792
  v_mul_f32 v199, v199, v35
  v_cvt_pk_bf16_f32 v196, v196, v197
  v_mfma_f32_16x16x32_bf16 a[108:111], a[192:195], a[208:211], a[108:111]
  buffer_load_dwordx4 v64, s[20:23], s85 offen lds
  s_add_u32 m0, s75, 40960
  s_waitcnt lgkmcnt(6)
  v_mfma_f32_16x16x32_bf16 v[224:227], a[176:179], a[196:199], v[224:227]
  ds_read_b64_tr_b16 a[192:193], v5 offset:8704
  v_cvt_pk_bf16_f32 v197, v198, v199
  ds_write_b64 v15, v[196:197] offset:21504
  v_mfma_f32_16x16x32_bf16 v[224:227], a[180:183], a[212:215], v[224:227]
  v_accvgpr_read_b32 v28, a88
  v_accvgpr_read_b32 v29, a89
  v_mfma_f32_16x16x4_4b_bf16 a[96:111], v[54:55], v[58:59], a[96:111] cbsz:2 abid:1
  v_accvgpr_read_b32 v30, a90
  v_accvgpr_read_b32 v31, a91
  v_mul_f32 v200, v200, v28
  v_mul_f32 v201, v201, v29
  v_mul_f32 v202, v202, v30
  v_mul_f32 v203, v203, v31
  v_mfma_f32_16x16x32_bf16 v[228:231], a[180:183], a[216:219], v[228:231]
  ds_read_b64_tr_b16 a[194:195], v5 offset:9728
  v_cvt_pk_bf16_f32 v200, v200, v201
  v_cvt_pk_bf16_f32 v201, v202, v203
  v_mfma_f32_16x16x32_bf16 v[228:231], a[176:179], a[200:203], v[228:231]
  buffer_load_dwordx4 v64, s[20:23], s86 offen lds
  s_add_u32 m0, s75, 45056
  ds_write_b64 v15, v[200:201] offset:22528
  v_mfma_f32_16x16x32_bf16 v[232:235], a[176:179], a[204:207], v[232:235]
  ds_read_b64_tr_b16 a[244:245], v5 offset:29184
  v_accvgpr_read_b32 v32, a92
  v_accvgpr_read_b32 v33, a93
  v_mfma_f32_16x16x32_bf16 v[232:235], a[180:183], a[220:223], v[232:235]
  v_accvgpr_read_b32 v34, a94
  v_accvgpr_read_b32 v35, a95
  v_mul_f32 v204, v204, v32
  v_mfma_f32_16x16x32_bf16 v[236:239], a[180:183], a[224:227], v[236:239]
  ds_read_b64_tr_b16 a[246:247], v5 offset:30208
  v_mul_f32 v205, v205, v33
  v_mul_f32 v206, v206, v34
  v_mfma_f32_16x16x32_bf16 v[236:239], a[176:179], a[208:211], v[236:239]
  v_mul_f32 v207, v207, v35
  v_cvt_pk_bf16_f32 v204, v204, v205
  s_waitcnt lgkmcnt(6)
  v_mfma_f32_16x16x32_bf16 a[112:115], a[184:187], a[196:199], a[112:115]
  ds_read_b64_tr_b16 a[176:177], v5 offset:12800
  v_cvt_pk_bf16_f32 v205, v206, v207
  ds_write_b64 v15, v[204:205] offset:23552
  v_mfma_f32_16x16x32_bf16 a[112:115], a[188:191], a[212:215], a[112:115]
  v_accvgpr_read_b32 v28, a96
  v_accvgpr_read_b32 v29, a97
  v_mfma_f32_16x16x4_4b_bf16 v[224:239], v[54:55], v[58:59], v[224:239] cbsz:2 abid:2
  buffer_load_dwordx4 v64, s[20:23], s87 offen lds
  s_add_u32 m0, s75, 49152
  v_accvgpr_read_b32 v30, a98
  v_accvgpr_read_b32 v31, a99
  v_mul_f32 v208, v208, v28
  v_mul_f32 v209, v209, v29
  v_mfma_f32_16x16x32_bf16 a[116:119], a[188:191], a[216:219], a[116:119]
  ds_read_b64_tr_b16 a[178:179], v5 offset:13824
  v_mul_f32 v210, v210, v30
  v_mul_f32 v211, v211, v31
  v_mfma_f32_16x16x32_bf16 a[116:119], a[184:187], a[200:203], a[116:119]
  v_cvt_pk_bf16_f32 v208, v208, v209
  v_cvt_pk_bf16_f32 v209, v210, v211
  ds_write_b64 v15, v[208:209] offset:24576
  v_mfma_f32_16x16x32_bf16 a[120:123], a[184:187], a[204:207], a[120:123]
  ds_read_b64_tr_b16 a[180:181], v5 offset:33280
  v_accvgpr_read_b32 v32, a100
  v_accvgpr_read_b32 v33, a101
  v_mfma_f32_16x16x32_bf16 a[120:123], a[188:191], a[220:223], a[120:123]
  buffer_load_dwordx4 v64, s[20:23], s88 offen lds
  s_add_u32 m0, s75, 53248
  v_accvgpr_read_b32 v34, a102
  v_mfma_f32_16x16x32_bf16 a[124:127], a[188:191], a[224:227], a[124:127]
  ds_read_b64_tr_b16 a[182:183], v5 offset:34304
  v_accvgpr_read_b32 v35, a103
  v_mul_f32 v212, v212, v32
  v_mfma_f32_16x16x32_bf16 a[124:127], a[184:187], a[208:211], a[124:127]
  v_mul_f32 v213, v213, v33
  v_mul_f32 v214, v214, v34
  s_waitcnt lgkmcnt(6)
  v_mfma_f32_16x16x32_bf16 v[240:243], a[192:195], a[196:199], v[240:243]
  ds_read_b64_tr_b16 a[184:185], v7 offset:0
  v_mul_f32 v215, v215, v35
  v_cvt_pk_bf16_f32 v212, v212, v213
  v_mfma_f32_16x16x32_bf16 v[240:243], a[244:247], a[212:215], v[240:243]
  v_cvt_pk_bf16_f32 v213, v214, v215
  ds_write_b64 v15, v[212:213] offset:25600
  v_mfma_f32_16x16x4_4b_bf16 a[112:127], v[54:55], v[58:59], a[112:127] cbsz:2 abid:3
  buffer_load_dwordx4 v64, s[20:23], s89 offen lds
  s_add_u32 m0, s75, 57344
  v_accvgpr_read_b32 v28, a104
  v_accvgpr_read_b32 v29, a105
  v_accvgpr_read_b32 v30, a106
  v_accvgpr_read_b32 v31, a107
  v_mfma_f32_16x16x32_bf16 v[244:247], a[244:247], a[216:219], v[244:247]
  ds_read_b64_tr_b16 a[186:187], v7 offset:384
  v_mul_f32 v216, v216, v28
  v_mul_f32 v217, v217, v29
  v_mfma_f32_16x16x32_bf16 v[244:247], a[192:195], a[200:203], v[244:247]
  v_mul_f32 v218, v218, v30
  v_mul_f32 v219, v219, v31
  v_cvt_pk_bf16_f32 v216, v216, v217
  v_mfma_f32_16x16x32_bf16 v[248:251], a[192:195], a[204:207], v[248:251]
  ds_read_b64_tr_b16 a[188:189], v7 offset:20480
  v_cvt_pk_bf16_f32 v217, v218, v219
  ds_write_b64 v15, v[216:217] offset:26624
  v_mfma_f32_16x16x32_bf16 v[248:251], a[244:247], a[220:223], v[248:251]
  v_accvgpr_read_b32 v32, a108
  v_accvgpr_read_b32 v33, a109
  v_accvgpr_read_b32 v34, a110
  v_mfma_f32_16x16x32_bf16 v[252:255], a[244:247], a[224:227], v[252:255]
  ds_read_b64_tr_b16 a[190:191], v7 offset:20864
  v_accvgpr_read_b32 v35, a111
  v_mul_f32 v220, v220, v32
  v_mfma_f32_16x16x32_bf16 v[252:255], a[192:195], a[208:211], v[252:255]
  buffer_load_dwordx4 v64, s[20:23], s90 offen lds
  v_mul_f32 v221, v221, v33
  s_waitcnt lgkmcnt(6)
  v_mfma_f32_16x16x32_bf16 a[128:131], a[176:179], a[196:199], a[128:131]
  ds_read_b64_tr_b16 a[192:193], v9 offset:0
  v_mul_f32 v222, v222, v34
  v_mul_f32 v223, v223, v35
  v_mfma_f32_16x16x32_bf16 a[128:131], a[180:183], a[212:215], a[128:131]
  v_cvt_pk_bf16_f32 v220, v220, v221
  v_cvt_pk_bf16_f32 v221, v222, v223
  v_mfma_f32_16x16x4_4b_bf16 v[240:255], v[56:57], v[58:59], v[240:255] cbsz:2 abid:0
  ds_write_b64 v15, v[220:221] offset:27648
  v_accvgpr_read_b32 v28, a112
  v_accvgpr_read_b32 v29, a113
  v_accvgpr_read_b32 v30, a114
  v_accvgpr_read_b32 v31, a115
  v_mul_f32 v224, v224, v28
  v_mfma_f32_16x16x32_bf16 a[132:135], a[180:183], a[216:219], a[132:135]
  ds_read_b64_tr_b16 a[194:195], v11 offset:0
  v_mul_f32 v225, v225, v29
  v_mul_f32 v226, v226, v30
  v_mfma_f32_16x16x32_bf16 a[132:135], a[176:179], a[200:203], a[132:135]
  v_mul_f32 v227, v227, v31
  v_cvt_pk_bf16_f32 v224, v224, v225
  v_cvt_pk_bf16_f32 v225, v226, v227
  v_mfma_f32_16x16x32_bf16 a[136:139], a[176:179], a[204:207], a[136:139]
  ds_read_b64_tr_b16 a[244:245], v9 offset:20480
  ds_write_b64 v15, v[224:225] offset:28672
  v_accvgpr_read_b32 v32, a116
  v_mfma_f32_16x16x32_bf16 a[136:139], a[180:183], a[220:223], a[136:139]
  v_accvgpr_read_b32 v33, a117
  v_accvgpr_read_b32 v34, a118
  v_accvgpr_read_b32 v35, a119
  v_mfma_f32_16x16x32_bf16 a[140:143], a[180:183], a[224:227], a[140:143]
  ds_read_b64_tr_b16 a[246:247], v11 offset:20480
  v_mul_f32 v228, v228, v32
  v_mul_f32 v229, v229, v33
  v_mfma_f32_16x16x32_bf16 a[140:143], a[176:179], a[208:211], a[140:143]
  v_mul_f32 v230, v230, v34
  v_mul_f32 v231, v231, v35
  s_waitcnt lgkmcnt(6)
  s_waitcnt vmcnt(4)
  s_barrier
  v_mfma_f32_16x16x32_bf16 a[144:147], a[184:187], a[196:199], a[144:147]
  ds_read_b64_tr_b16 a[228:229], v60 offset:0
  v_cvt_pk_bf16_f32 v228, v228, v229
  v_cvt_pk_bf16_f32 v229, v230, v231
  v_mfma_f32_16x16x32_bf16 a[144:147], a[188:191], a[212:215], a[144:147]
  ds_write_b64 v15, v[228:229] offset:29696
  v_accvgpr_read_b32 v28, a120
  v_mfma_f32_16x16x4_4b_bf16 a[128:143], v[56:57], v[58:59], a[128:143] cbsz:2 abid:1
  v_accvgpr_read_b32 v29, a121
  v_accvgpr_read_b32 v30, a122
  v_accvgpr_read_b32 v31, a123
  v_mul_f32 v232, v232, v28
  v_mul_f32 v233, v233, v29
  v_mul_f32 v234, v234, v30
  v_mfma_f32_16x16x32_bf16 a[148:151], a[188:191], a[216:219], a[148:151]
  ds_read_b64_tr_b16 a[230:231], v61 offset:0
  v_mul_f32 v235, v235, v31
  v_cvt_pk_bf16_f32 v232, v232, v233
  v_mfma_f32_16x16x32_bf16 a[148:151], a[184:187], a[200:203], a[148:151]
  v_cvt_pk_bf16_f32 v233, v234, v235
  ds_write_b64 v15, v[232:233] offset:30720
  v_accvgpr_read_b32 v32, a124
  v_mfma_f32_16x16x32_bf16 a[152:155], a[184:187], a[204:207], a[152:155]
  ds_read_b64_tr_b16 a[232:233], v62 offset:0
  v_accvgpr_read_b32 v33, a125
  v_accvgpr_read_b32 v34, a126
  v_mfma_f32_16x16x32_bf16 a[152:155], a[188:191], a[220:223], a[152:155]
  v_accvgpr_read_b32 v35, a127
  v_mul_f32 v236, v236, v32
  v_mul_f32 v237, v237, v33
  v_mfma_f32_16x16x32_bf16 a[156:159], a[188:191], a[224:227], a[156:159]
  ds_read_b64_tr_b16 a[234:235], v63 offset:0
  v_mul_f32 v238, v238, v34
  v_mul_f32 v239, v239, v35
  v_mfma_f32_16x16x32_bf16 a[156:159], a[184:187], a[208:211], a[156:159]
  v_cvt_pk_bf16_f32 v236, v236, v237
  v_cvt_pk_bf16_f32 v237, v238, v239
  s_waitcnt lgkmcnt(6)
  v_mfma_f32_16x16x32_bf16 a[160:163], a[192:195], a[196:199], a[160:163]
  ds_read_b64_tr_b16 a[236:237], v60 offset:4096
  ds_write_b64 v15, v[236:237] offset:31744
  v_accvgpr_read_b32 v28, a128
  v_mfma_f32_16x16x32_bf16 a[160:163], a[244:247], a[212:215], a[160:163]
  v_accvgpr_read_b32 v29, a129
  v_accvgpr_read_b32 v30, a130
  v_mfma_f32_16x16x4_4b_bf16 a[144:159], v[56:57], v[58:59], a[144:159] cbsz:2 abid:2
  v_accvgpr_read_b32 v31, a131
  v_mul_f32 v240, v240, v28
  v_mul_f32 v241, v241, v29
  v_mul_f32 v242, v242, v30
  v_mul_f32 v243, v243, v31
  v_cvt_pk_bf16_f32 v240, v240, v241
  v_mfma_f32_16x16x32_bf16 a[164:167], a[244:247], a[216:219], a[164:167]
  ds_read_b64_tr_b16 a[238:239], v61 offset:4096
  v_cvt_pk_bf16_f32 v241, v242, v243
  ds_write_b64 v15, v[240:241] offset:32768
  v_mfma_f32_16x16x32_bf16 a[164:167], a[192:195], a[200:203], a[164:167]
  v_accvgpr_read_b32 v32, a132
  v_accvgpr_read_b32 v33, a133
  v_accvgpr_read_b32 v34, a134
  v_mfma_f32_16x16x32_bf16 a[168:171], a[192:195], a[204:207], a[168:171]
  ds_read_b64_tr_b16 a[240:241], v62 offset:4096
  v_accvgpr_read_b32 v35, a135
  v_mul_f32 v244, v244, v32
  v_mfma_f32_16x16x32_bf16 a[168:171], a[244:247], a[220:223], a[168:171]
  v_mul_f32 v245, v245, v33
  v_mul_f32 v246, v246, v34
  v_mul_f32 v247, v247, v35
  v_mfma_f32_16x16x32_bf16 a[172:175], a[244:247], a[224:227], a[172:175]
  ds_read_b64_tr_b16 a[242:243], v63 offset:4096
  v_cvt_pk_bf16_f32 v244, v244, v245
  v_cvt_pk_bf16_f32 v245, v246, v247
  v_mfma_f32_16x16x32_bf16 a[172:175], a[192:195], a[208:211], a[172:175]
  ds_write_b64 v15, v[244:245] offset:33792
  v_accvgpr_read_b32 v28, a136
  v_accvgpr_read_b32 v29, a137
  s_nop 2
  v_mfma_f32_16x16x4_4b_bf16 a[160:175], v[56:57], v[58:59], a[160:175] cbsz:2 abid:3
  v_accvgpr_read_b32 v30, a138
  v_accvgpr_read_b32 v31, a139
  v_mul_f32 v248, v248, v28
  v_mul_f32 v249, v249, v29
  v_mul_f32 v250, v250, v30
  v_mul_f32 v251, v251, v31
  s_mov_b64 exec, 0
  s_cmp_eq_u32 s66, 0
  s_cbranch_scc1 L_wc1_0
  s_cmp_eq_u32 s66, 1
  s_cbranch_scc1 L_wc1_1
  s_cmp_eq_u32 s66, 2
  s_cbranch_scc1 L_wr1
  s_branch L_wr1
L_wr1:
  s_mov_b64 exec, -1
  s_barrier
  ds_read_b64 v[114:115], v46 offset:0
  ds_read_b64 v[118:119], v46 offset:1024
  ds_read_b64 v[122:123], v46 offset:2048
  ds_read_b64 v[126:127], v46 offset:3072
  ds_read_b64 v[130:131], v46 offset:4096
  ds_read_b64 v[134:135], v46 offset:5120
  ds_read_b64 v[138:139], v46 offset:6144
  ds_read_b64 v[142:143], v46 offset:7168
  s_waitcnt lgkmcnt(7)
  v_mfma_f32_16x16x32_bf16 v[80:83], a[228:231], v[112:115], 0
  ds_read_b64_tr_b16 a[244:245], v60 offset:8192
  v_mov_b32 v2, v65
  s_add_u32 m0, s74, 0
  v_mfma_f32_16x16x32_bf16 v[84:87], a[232:235], v[112:115], 0
  ds_read_b64 v[146:147], v46 offset:8192
  ds_read_b64 v[150:151], v46 offset:9216
  s_waitcnt lgkmcnt(9)
  v_mfma_f32_16x16x32_bf16 v[88:91], a[228:231], v[116:119], 0
  ds_read_b64_tr_b16 a[246:247], v61 offset:8192
  v_cvt_pk_bf16_f32 v248, v248, v249
  v_cvt_pk_bf16_f32 v249, v250, v251
  v_mfma_f32_16x16x32_bf16 v[92:95], a[232:235], v[116:119], 0
  ds_read_b64 v[154:155], v46 offset:10240
  ds_read_b64 v[158:159], v46 offset:11264
  s_waitcnt lgkmcnt(11)
  v_mfma_f32_16x16x32_bf16 v[96:99], a[228:231], v[120:123], 0
  ds_read_b64_tr_b16 a[248:249], v62 offset:8192
  ds_write_b64 v15, v[248:249] offset:34816
  v_accvgpr_read_b32 v32, a140
  v_mfma_f32_16x16x32_bf16 v[100:103], a[232:235], v[120:123], 0
  ds_read_b64 v[162:163], v46 offset:12288
  ds_read_b64 v[166:167], v46 offset:13312
  s_waitcnt lgkmcnt(14)
  v_mfma_f32_16x16x32_bf16 v[104:107], a[228:231], v[124:127], 0
  ds_read_b64_tr_b16 a[250:251], v63 offset:8192
  v_accvgpr_read_b32 v33, a141
  v_accvgpr_read_b32 v34, a142
  v_mfma_f32_16x16x32_bf16 v[108:111], a[232:235], v[124:127], 0
  ds_read_b64 v[170:171], v46 offset:14336
  ds_read_b64 v[174:175], v46 offset:15360
  s_waitcnt lgkmcnt(15)
  v_mfma_f32_16x16x32_bf16 v[80:83], a[236:239], v[128:131], v[80:83]
  ds_read_b64_tr_b16 a[228:229], v60 offset:12288
  v_accvgpr_read_b32 v35, a143
  v_mul_f32 v252, v252, v32
  v_mfma_f32_16x16x32_bf16 v[84:87], a[240:243], v[128:131], v[84:87]
  ds_read_b64 v[178:179], v46 offset:16384
  ds_read_b64 v[182:183], v46 offset:17408
  v_mul_f32 v253, v253, v33
  v_mfma_f32_16x16x32_bf16 v[88:91], a[236:239], v[132:135], v[88:91]
  ds_read_b64_tr_b16 a[230:231], v61 offset:12288
  v_mul_f32 v254, v254, v34
  v_mul_f32 v255, v255, v35
  v_mfma_f32_16x16x32_bf16 v[92:95], a[240:243], v[132:135], v[92:95]
  ds_read_b64 v[186:187], v46 offset:18432
  ds_read_b64 v[190:191], v46 offset:19456
  s_waitcnt lgkmcnt(15)
  v_mfma_f32_16x16x32_bf16 v[96:99], a[236:239], v[136:139], v[96:99]
  ds_read_b64_tr_b16 a[232:233], v62 offset:12288
  v_cvt_pk_bf16_f32 v252, v252, v253
  v_cvt_pk_bf16_f32 v253, v254, v255
  v_mfma_f32_16x16x32_bf16 v[100:103], a[240:243], v[136:139], v[100:103]
  buffer_load_dwordx4 v2, s[20:23], s82 offen lds
  s_add_u32 s47, s82, 9216
  s_add_u32 m0, s74, 1024
  v_mfma_f32_16x16x32_bf16 v[104:107], a[236:239], v[140:143], v[104:107]
  ds_read_b64_tr_b16 a[234:235], v63 offset:12288
  ds_write_b64 v15, v[252:253] offset:35840
  v_mfma_f32_16x16x32_bf16 v[108:111], a[240:243], v[140:143], v[108:111]
  buffer_load_dwordx4 v2, s[20:23], s47 offen lds
  s_add_u32 m0, s74, 8192
  s_waitcnt lgkmcnt(11)
  v_mfma_f32_16x16x32_bf16 v[80:83], a[244:247], v[144:147], v[80:83]
  ds_read_b64_tr_b16 a[236:237], v60 offset:16384
  v_mfma_f32_16x16x32_bf16 v[84:87], a[248:251], v[144:147], v[84:87]
  v_mfma_f32_16x16x32_bf16 v[88:91], a[244:247], v[148:151], v[88:91]
  ds_read_b64_tr_b16 a[238:239], v61 offset:16384
  v_mfma_f32_16x16x32_bf16 v[92:95], a[248:251], v[148:151], v[92:95]
  buffer_load_dwordx4 v2, s[20:23], s83 offen lds
  s_add_u32 s47, s83, 9216
  s_add_u32 m0, s74, 9216
  v_mfma_f32_16x16x32_bf16 v[96:99], a[244:247], v[152:155], v[96:99]
  ds_read_b64_tr_b16 a[240:241], v62 offset:16384
  v_mfma_f32_16x16x32_bf16 v[100:103], a[248:251], v[152:155], v[100:103]
  v_mfma_f32_16x16x32_bf16 v[104:107], a[244:247], v[156:159], v[104:107]
  ds_read_b64_tr_b16 a[242:243], v63 offset:16384
  v_mfma_f32_16x16x32_bf16 v[108:111], a[248:251], v[156:159], v[108:111]
  buffer_load_dwordx4 v2, s[20:23], s47 offen lds
  s_add_u32 m0, s74, 20480
  s_waitcnt lgkmcnt(5)
  s_waitcnt lgkmcnt(4)
  s_waitcnt vmcnt(4)
  s_barrier
  v_mfma_f32_16x16x32_bf16 v[80:83], a[228:231], v[160:163], v[80:83]
  ds_read_b64_tr_b16 a[244:245], v60 offset:20480
  v_mfma_f32_16x16x32_bf16 v[84:87], a[232:235], v[160:163], v[84:87]
  ds_read_b64 v[194:195], v46 offset:20480
  ds_read_b64 v[198:199], v46 offset:21504
  v_mfma_f32_16x16x32_bf16 v[88:91], a[228:231], v[164:167], v[88:91]
  ds_read_b64_tr_b16 a[246:247], v61 offset:20480
  v_mfma_f32_16x16x32_bf16 v[92:95], a[232:235], v[164:167], v[92:95]
  ds_read_b64 v[202:203], v46 offset:22528
  ds_read_b64 v[206:207], v46 offset:23552
  v_mfma_f32_16x16x32_bf16 v[96:99], a[228:231], v[168:171], v[96:99]
  ds_read_b64_tr_b16 a[248:249], v62 offset:20480
  v_mfma_f32_16x16x32_bf16 v[100:103], a[232:235], v[168:171], v[100:103]
  ds_read_b64 v[210:211], v46 offset:24576
  ds_read_b64 v[214:215], v46 offset:25600
  v_mfma_f32_16x16x32_bf16 v[104:107], a[228:231], v[172:175], v[104:107]
  ds_read_b64_tr_b16 a[250:251], v63 offset:20480
  v_mfma_f32_16x16x32_bf16 v[108:111], a[232:235], v[172:175], v[108:111]
  ds_read_b64 v[218:219], v46 offset:26624
  ds_read_b64 v[222:223], v46 offset:27648
  s_waitcnt lgkmcnt(12)
  v_mfma_f32_16x16x32_bf16 v[80:83], a[236:239], v[176:179], v[80:83]
  ds_read_b64_tr_b16 a[228:229], v60 offset:24576
  v_mfma_f32_16x16x32_bf16 v[84:87], a[240:243], v[176:179], v[84:87]
  ds_read_b64 v[226:227], v46 offset:28672
  ds_read_b64 v[230:231], v46 offset:29696
  v_mfma_f32_16x16x32_bf16 v[88:91], a[236:239], v[180:183], v[88:91]
  ds_read_b64_tr_b16 a[230:231], v61 offset:24576
  v_mfma_f32_16x16x32_bf16 v[92:95], a[240:243], v[180:183], v[92:95]
  ds_read_b64 v[234:235], v46 offset:30720
  ds_read_b64 v[238:239], v46 offset:31744
  v_mfma_f32_16x16x32_bf16 v[96:99], a[236:239], v[184:187], v[96:99]
  ds_read_b64_tr_b16 a[232:233], v62 offset:24576
  v_mfma_f32_16x16x32_bf16 v[100:103], a[240:243], v[184:187], v[100:103]
  ds_read_b64 v[242:243], v46 offset:32768
  ds_read_b64 v[246:247], v46 offset:33792
  v_mfma_f32_16x16x32_bf16 v[104:107], a[236:239], v[188:191], v[104:107]
  ds_read_b64_tr_b16 a[234:235], v63 offset:24576
  v_mfma_f32_16x16x32_bf16 v[108:111], a[240:243], v[188:191], v[108:111]
  ds_read_b64 v[250:251], v46 offset:34816
  ds_read_b64 v[254:255], v46 offset:35840
  s_waitcnt lgkmcnt(14)
  v_mfma_f32_16x16x32_bf16 v[80:83], a[244:247], v[192:195], v[80:83]
  ds_read_b64_tr_b16 a[236:237], v60 offset:28672
  v_mul_f32 v43, v24, v42
  v_mfma_f32_16x16x32_bf16 v[84:87], a[248:251], v[192:195], v[84:87]
  buffer_load_dwordx4 v2, s[20:23], s84 offen lds
  s_add_u32 s47, s84, 9216
  v_mfma_f32_16x16x32_bf16 v[88:91], a[244:247], v[196:199], v[88:91]
  ds_read_b64_tr_b16 a[238:239], v61 offset:28672
  s_add_u32 m0, s74, 21504
  v_mfma_f32_16x16x32_bf16 v[92:95], a[248:251], v[196:199], v[92:95]
  buffer_load_dwordx4 v2, s[20:23], s47 offen lds
  s_add_u32 m0, s74, 28672
  v_mfma_f32_16x16x32_bf16 v[96:99], a[244:247], v[200:203], v[96:99]
  ds_read_b64_tr_b16 a[240:241], v62 offset:28672
  v_accvgpr_read_b32 v28, a160
  v_mfma_f32_16x16x32_bf16 v[100:103], a[248:251], v[200:203], v[100:103]
  v_accvgpr_read_b32 v29, a161
  v_accvgpr_read_b32 v30, a162
  v_mfma_f32_16x16x32_bf16 v[104:107], a[244:247], v[204:207], v[104:107]
  ds_read_b64_tr_b16 a[242:243], v63 offset:28672
  v_accvgpr_read_b32 v31, a163
  v_mfma_f32_16x16x32_bf16 v[108:111], a[248:251], v[204:207], v[108:111]
  buffer_load_dwordx4 v2, s[20:23], s85 offen lds
  s_waitcnt lgkmcnt(6)
  v_mfma_f32_16x16x32_bf16 v[80:83], a[228:231], v[208:211], v[80:83]
  ds_read_b64_tr_b16 a[244:245], v60 offset:32768
  s_add_u32 s47, s85, 9216
  v_mfma_f32_16x16x32_bf16 v[84:87], a[232:235], v[208:211], v[84:87]
  s_add_u32 m0, s74, 29696
  v_mul_f32 v28, v28, v43
  v_mfma_f32_16x16x32_bf16 v[88:91], a[228:231], v[212:215], v[88:91]
  ds_read_b64_tr_b16 a[246:247], v61 offset:32768
  v_mul_f32 v29, v29, v43
  v_mfma_f32_16x16x32_bf16 v[92:95], a[232:235], v[212:215], v[92:95]
  buffer_load_dwordx4 v2, s[20:23], s47 offen lds
  v_mul_f32 v30, v30, v43
  v_mfma_f32_16x16x32_bf16 v[96:99], a[228:231], v[216:219], v[96:99]
  ds_read_b64_tr_b16 a[248:249], v62 offset:32768
  v_mul_f32 v31, v31, v43
  v_mfma_f32_16x16x32_bf16 v[100:103], a[232:235], v[216:219], v[100:103]
  v_cvt_pk_bf16_f32 v28, v28, v29
  v_cvt_pk_bf16_f32 v29, v30, v31
  v_mfma_f32_16x16x32_bf16 v[104:107], a[228:231], v[220:223], v[104:107]
  ds_read_b64_tr_b16 a[250:251], v63 offset:32768
  v_mov_b32 v30, s53
  v_mfma_f32_16x16x32_bf16 v[108:111], a[232:235], v[220:223], v[108:111]
  v_cndmask_b32 v28, v28, v30, s[56:57]
  s_waitcnt lgkmcnt(4)
  s_waitcnt vmcnt(4)
  s_barrier
  v_mfma_f32_16x16x32_bf16 v[80:83], a[236:239], v[224:227], v[80:83]
  ds_read_b64_tr_b16 a[228:229], v16 offset:0
  s_add_u32 m0, s74, 40960
  v_mfma_f32_16x16x32_bf16 v[84:87], a[240:243], v[224:227], v[84:87]
  buffer_load_dwordx4 v2, s[20:23], s86 offen lds
  s_add_u32 s47, s86, 9216
  v_mfma_f32_16x16x32_bf16 v[88:91], a[236:239], v[228:231], v[88:91]
  ds_read_b64_tr_b16 a[230:231], v17 offset:0
  s_add_u32 m0, s74, 41984
  v_mfma_f32_16x16x32_bf16 v[92:95], a[240:243], v[228:231], v[92:95]
  buffer_load_dwordx4 v2, s[20:23], s47 offen lds
  s_add_u32 m0, s74, 49152
  v_mfma_f32_16x16x32_bf16 v[96:99], a[236:239], v[232:235], v[96:99]
  ds_read_b64_tr_b16 a[232:233], v16 offset:8192
  ds_write_b32 v37, v29 offset:0
  v_mfma_f32_16x16x32_bf16 v[100:103], a[240:243], v[232:235], v[100:103]
  ds_write_b64 v38, v[28:29] offset:0
  buffer_store_dwordx2 v[28:29], v39, s[28:31], 0 offen offset:0 sc1
  v_mfma_f32_16x16x32_bf16 v[104:107], a[236:239], v[236:239], v[104:107]
  ds_read_b64_tr_b16 a[234:235], v17 offset:8192
  v_mul_f32 v43, v25, v42
  v_mfma_f32_16x16x32_bf16 v[108:111], a[240:243], v[236:239], v[108:111]
  buffer_load_dwordx4 v2, s[20:23], s87 offen lds
  s_waitcnt lgkmcnt(6)
  v_mfma_f32_16x16x32_bf16 v[80:83], a[244:247], v[240:243], v[80:83]
  ds_read_b64_tr_b16 a[236:237], v18 offset:0
  s_add_u32 s47, s87, 9216
  v_mfma_f32_16x16x32_bf16 v[84:87], a[248:251], v[240:243], v[84:87]
  s_add_u32 m0, s74, 50176
  v_accvgpr_read_b32 v32, a164
  v_mfma_f32_16x16x32_bf16 v[88:91], a[244:247], v[244:247], v[88:91]
  ds_read_b64_tr_b16 a[238:239], v19 offset:0
  v_accvgpr_read_b32 v33, a165
  v_mfma_f32_16x16x32_bf16 v[92:95], a[248:251], v[244:247], v[92:95]
  buffer_load_dwordx4 v2, s[20:23], s47 offen lds
  v_accvgpr_read_b32 v34, a166
  v_mfma_f32_16x16x32_bf16 v[96:99], a[244:247], v[248:251], v[96:99]
  ds_read_b64_tr_b16 a[240:241], v18 offset:8192
  v_accvgpr_read_b32 v35, a167
  v_mfma_f32_16x16x32_bf16 v[100:103], a[248:251], v[248:251], v[100:103]
  v_mul_f32 v32, v32, v43
  v_mul_f32 v33, v33, v43
  v_mfma_f32_16x16x32_bf16 v[104:107], a[244:247], v[252:255], v[104:107]
  ds_read_b64_tr_b16 a[242:243], v19 offset:8192
  v_mul_f32 v34, v34, v43
  v_mfma_f32_16x16x32_bf16 v[108:111], a[248:251], v[252:255], v[108:111]
  v_mul_f32 v35, v35, v43
  s_waitcnt lgkmcnt(4)
  v_mfma_f32_16x16x32_bf16 v[48:51], a[228:231], v[112:115], 0
  ds_read_b64_tr_b16 a[244:245], v16 offset:512
  v_cvt_pk_bf16_f32 v32, v32, v33
  v_mfma_f32_16x16x32_bf16 v[48:51], a[232:235], v[128:131], v[48:51]
  v_cvt_pk_bf16_f32 v80, v80, v81
  v_cvt_pk_bf16_f32 v81, v82, v83
  v_accvgpr_write_b32 a0, v80
  v_mfma_f32_16x16x32_bf16 v[56:59], a[228:231], v[116:119], 0
  ds_read_b64_tr_b16 a[246:247], v17 offset:512
  v_accvgpr_write_b32 a1, v81
  v_cvt_pk_bf16_f32 v88, v88, v89
  v_mfma_f32_16x16x32_bf16 v[56:59], a[232:235], v[132:135], v[56:59]
  v_cvt_pk_bf16_f32 v89, v90, v91
  v_accvgpr_write_b32 a4, v88
  v_accvgpr_write_b32 a5, v89
  v_mfma_f32_16x16x32_bf16 v[64:67], a[228:231], v[120:123], 0
  ds_read_b64_tr_b16 a[248:249], v16 offset:8704
  v_cvt_pk_bf16_f32 v96, v96, v97
  v_cvt_pk_bf16_f32 v97, v98, v99
  v_mfma_f32_16x16x32_bf16 v[64:67], a[232:235], v[136:139], v[64:67]
  v_accvgpr_write_b32 a8, v96
  v_accvgpr_write_b32 a9, v97
  v_cvt_pk_bf16_f32 v104, v104, v105
  v_mfma_f32_16x16x32_bf16 v[72:75], a[228:231], v[124:127], 0
  ds_read_b64_tr_b16 a[250:251], v17 offset:8704
  v_cvt_pk_bf16_f32 v105, v106, v107
  v_accvgpr_write_b32 a12, v104
  v_mfma_f32_16x16x32_bf16 v[72:75], a[232:235], v[140:143], v[72:75]
  v_accvgpr_write_b32 a13, v105
  v_cvt_pk_bf16_f32 v84, v84, v85
  s_waitcnt lgkmcnt(4)
  v_mfma_f32_16x16x32_bf16 v[52:55], a[236:239], v[112:115], 0
  ds_read_b64_tr_b16 a[228:229], v18 offset:512
  v_cvt_pk_bf16_f32 v85, v86, v87
  v_accvgpr_write_b32 a2, v84
  v_mfma_f32_16x16x32_bf16 v[52:55], a[240:243], v[128:131], v[52:55]
  v_accvgpr_write_b32 a3, v85
  v_cvt_pk_bf16_f32 v92, v92, v93
  v_cvt_pk_bf16_f32 v93, v94, v95
  v_mfma_f32_16x16x32_bf16 v[60:63], a[236:239], v[116:119], 0
  ds_read_b64_tr_b16 a[230:231], v19 offset:512
  v_accvgpr_write_b32 a6, v92
  v_accvgpr_write_b32 a7, v93
  v_mfma_f32_16x16x32_bf16 v[60:63], a[240:243], v[132:135], v[60:63]
  v_cvt_pk_bf16_f32 v100, v100, v101
  v_cvt_pk_bf16_f32 v101, v102, v103
  v_accvgpr_write_b32 a10, v100
  v_mfma_f32_16x16x32_bf16 v[68:71], a[236:239], v[120:123], 0
  ds_read_b64_tr_b16 a[232:233], v18 offset:8704
  v_accvgpr_write_b32 a11, v101
  v_cvt_pk_bf16_f32 v108, v108, v109
  v_mfma_f32_16x16x32_bf16 v[68:71], a[240:243], v[136:139], v[68:71]
  v_cvt_pk_bf16_f32 v109, v110, v111
  v_accvgpr_write_b32 a14, v108
  v_accvgpr_write_b32 a15, v109
  v_mfma_f32_16x16x32_bf16 v[76:79], a[236:239], v[124:127], 0
  ds_read_b64_tr_b16 a[234:235], v19 offset:8704
  v_cvt_pk_bf16_f32 v33, v34, v35
  v_mov_b32 v34, s53
  v_mfma_f32_16x16x32_bf16 v[76:79], a[240:243], v[140:143], v[76:79]
  v_cndmask_b32 v32, v32, v34, s[56:57]
  s_waitcnt lgkmcnt(4)
  s_waitcnt vmcnt(5)
  s_barrier
  v_mfma_f32_16x16x32_bf16 v[80:83], a[244:247], v[112:115], 0
  ds_read_b64_tr_b16 a[236:237], v16 offset:20480
  s_add_u32 m0, s74, 61440
  v_mfma_f32_16x16x32_bf16 v[80:83], a[248:251], v[128:131], v[80:83]
L_pg8:
  s_cbranch_execz L_pg12
  buffer_load_dwordx4 v2, s[20:23], s88 offen lds
  s_add_u32 s47, s88, 9216
  v_mfma_f32_16x16x32_bf16 v[88:91], a[244:247], v[116:119], 0
  ds_read_b64_tr_b16 a[238:239], v17 offset:20480
  s_add_u32 m0, s74, 62464
  v_mfma_f32_16x16x32_bf16 v[88:91], a[248:251], v[132:135], v[88:91]
  buffer_load_dwordx4 v2, s[20:23], s47 offen lds
  s_add_u32 m0, s74, 69632
  v_mfma_f32_16x16x32_bf16 v[96:99], a[244:247], v[120:123], 0
  ds_read_b64_tr_b16 a[240:241], v16 offset:28672
  ds_write_b32 v37, v33 offset:64
  v_mfma_f32_16x16x32_bf16 v[96:99], a[248:251], v[136:139], v[96:99]
  ds_write_b64 v38, v[32:33] offset:256
  buffer_store_dwordx2 v[32:33], v39, s[28:31], 0 offen offset:256 sc1
  v_mfma_f32_16x16x32_bf16 v[104:107], a[244:247], v[124:127], 0
  ds_read_b64_tr_b16 a[242:243], v17 offset:28672
  v_mul_f32 v43, v26, v42
  v_mfma_f32_16x16x32_bf16 v[104:107], a[248:251], v[140:143], v[104:107]
  buffer_load_dwordx4 v2, s[20:23], s89 offen lds
  s_waitcnt lgkmcnt(6)
  v_mfma_f32_16x16x32_bf16 v[84:87], a[228:231], v[112:115], 0
  ds_read_b64_tr_b16 a[244:245], v18 offset:20480
  s_add_u32 s47, s89, 9216
  v_mfma_f32_16x16x32_bf16 v[84:87], a[232:235], v[128:131], v[84:87]
  s_add_u32 m0, s74, 70656
  v_accvgpr_read_b32 v28, a168
  v_mfma_f32_16x16x32_bf16 v[92:95], a[228:231], v[116:119], 0
  ds_read_b64_tr_b16 a[246:247], v19 offset:20480
  v_accvgpr_read_b32 v29, a169
  v_mfma_f32_16x16x32_bf16 v[92:95], a[232:235], v[132:135], v[92:95]
  buffer_load_dwordx4 v2, s[20:23], s47 offen lds
  v_accvgpr_read_b32 v30, a170
  v_mfma_f32_16x16x32_bf16 v[100:103], a[228:231], v[120:123], 0
  ds_read_b64_tr_b16 a[248:249], v18 offset:28672
  v_accvgpr_read_b32 v31, a171
  v_mfma_f32_16x16x32_bf16 v[100:103], a[232:235], v[136:139], v[100:103]
  v_mul_f32 v28, v28, v43
  v_mul_f32 v29, v29, v43
  v_mfma_f32_16x16x32_bf16 v[108:111], a[228:231], v[124:127], 0
  ds_read_b64_tr_b16 a[250:251], v19 offset:28672
  v_mul_f32 v30, v30, v43
  v_mfma_f32_16x16x32_bf16 v[108:111], a[232:235], v[140:143], v[108:111]
  v_mul_f32 v31, v31, v43
  s_waitcnt lgkmcnt(4)
  v_mfma_f32_16x16x32_bf16 v[48:51], a[236:239], v[144:147], v[48:51]
  ds_read_b64_tr_b16 a[228:229], v16 offset:20992
  v_cvt_pk_bf16_f32 v28, v28, v29
  v_mfma_f32_16x16x32_bf16 v[48:51], a[240:243], v[160:163], v[48:51]
  v_cvt_pk_bf16_f32 v29, v30, v31
  v_mov_b32 v30, s53
  v_mfma_f32_16x16x32_bf16 v[56:59], a[240:243], v[164:167], v[56:59]
  ds_read_b64_tr_b16 a[230:231], v17 offset:20992
  v_cndmask_b32 v28, v28, v30, s[56:57]
  v_mfma_f32_16x16x32_bf16 v[56:59], a[236:239], v[148:151], v[56:59]
  ds_write_b32 v37, v29 offset:128
  ds_write_b64 v38, v[28:29] offset:512
  v_mfma_f32_16x16x32_bf16 v[64:67], a[236:239], v[152:155], v[64:67]
  ds_read_b64_tr_b16 a[232:233], v16 offset:29184
  buffer_store_dwordx2 v[28:29], v40, s[28:31], 0 offen offset:0 sc1
  v_mfma_f32_16x16x32_bf16 v[64:67], a[240:243], v[168:171], v[64:67]
  v_mul_f32 v43, v27, v42
  v_accvgpr_read_b32 v32, a172
  v_mfma_f32_16x16x32_bf16 v[72:75], a[240:243], v[172:175], v[72:75]
  ds_read_b64_tr_b16 a[234:235], v17 offset:29184
  v_accvgpr_read_b32 v33, a173
  v_mfma_f32_16x16x32_bf16 v[72:75], a[236:239], v[156:159], v[72:75]
  v_accvgpr_read_b32 v34, a174
  s_waitcnt lgkmcnt(6)
  v_mfma_f32_16x16x32_bf16 v[52:55], a[244:247], v[144:147], v[52:55]
  ds_read_b64_tr_b16 a[236:237], v18 offset:20992
  v_accvgpr_read_b32 v35, a175
  v_mfma_f32_16x16x32_bf16 v[52:55], a[248:251], v[160:163], v[52:55]
  v_mul_f32 v32, v32, v43
  v_mul_f32 v33, v33, v43
  v_mfma_f32_16x16x32_bf16 v[60:63], a[248:251], v[164:167], v[60:63]
  ds_read_b64_tr_b16 a[238:239], v19 offset:20992
  v_mul_f32 v34, v34, v43
  v_mfma_f32_16x16x32_bf16 v[60:63], a[244:247], v[148:151], v[60:63]
  v_mul_f32 v35, v35, v43
  v_cvt_pk_bf16_f32 v32, v32, v33
  v_mfma_f32_16x16x32_bf16 v[68:71], a[244:247], v[152:155], v[68:71]
  ds_read_b64_tr_b16 a[240:241], v18 offset:29184
  v_cvt_pk_bf16_f32 v33, v34, v35
  v_mfma_f32_16x16x32_bf16 v[68:71], a[248:251], v[168:171], v[68:71]
  v_mov_b32 v34, s53
  v_cndmask_b32 v32, v32, v34, s[56:57]
  v_mfma_f32_16x16x32_bf16 v[76:79], a[248:251], v[172:175], v[76:79]
  ds_read_b64_tr_b16 a[242:243], v19 offset:29184
  ds_write_b32 v37, v33 offset:192
  v_mfma_f32_16x16x32_bf16 v[76:79], a[244:247], v[156:159], v[76:79]
  ds_write_b64 v38, v[32:33] offset:768
  s_waitcnt lgkmcnt(6)
  s_waitcnt vmcnt(6)
  s_barrier
  v_mfma_f32_16x16x32_bf16 v[80:83], a[228:231], v[144:147], v[80:83]
  ds_read_b64_tr_b16 a[244:245], v16 offset:40960
  s_add_u32 m0, s74, 0
  v_mfma_f32_16x16x32_bf16 v[80:83], a[232:235], v[160:163], v[80:83]
  buffer_load_dwordx4 v2, s[20:23], s90 offen lds
  s_add_u32 s47, s90, 9216
  v_mfma_f32_16x16x32_bf16 v[88:91], a[232:235], v[164:167], v[88:91]
  ds_read_b64_tr_b16 a[246:247], v17 offset:40960
  s_add_u32 m0, s74, 1024
  v_mfma_f32_16x16x32_bf16 v[88:91], a[228:231], v[148:151], v[88:91]
  buffer_load_dwordx4 v2, s[20:23], s47 offen lds
  s_add_u32 s91, s91, 1
  v_mfma_f32_16x16x32_bf16 v[96:99], a[228:231], v[152:155], v[96:99]
  ds_read_b64_tr_b16 a[248:249], v16 offset:49152
  s_cmp_eq_u32 s91, 4
  s_cselect_b32 s47, 4294966912, s49
  s_cselect_b32 s91, 0, s91
  v_mfma_f32_16x16x32_bf16 v[96:99], a[232:235], v[168:171], v[96:99]
  v_add_u32 v2, s47, v2
  s_add_u32 m0, s74, 8192
  v_mfma_f32_16x16x32_bf16 v[104:107], a[232:235], v[172:175], v[104:107]
  ds_read_b64_tr_b16 a[250:251], v17 offset:49152
  buffer_store_dwordx2 v[32:33], v40, s[28:31], 0 offen offset:256 sc1
  v_mfma_f32_16x16x32_bf16 v[104:107], a[228:231], v[156:159], v[104:107]
  buffer_load_dwordx4 v2, s[20:23], s82 offen lds
  s_waitcnt lgkmcnt(6)
  v_mfma_f32_16x16x32_bf16 v[84:87], a[236:239], v[144:147], v[84:87]
  ds_read_b64_tr_b16 a[228:229], v18 offset:40960
  s_add_u32 s47, s82, 9216
  v_mfma_f32_16x16x32_bf16 v[84:87], a[240:243], v[160:163], v[84:87]
  s_add_u32 m0, s74, 9216
  v_lshrrev_b32 v43, 4, v1
  v_mfma_f32_16x16x32_bf16 v[92:95], a[240:243], v[164:167], v[92:95]
  ds_read_b64_tr_b16 a[230:231], v19 offset:40960
  v_bfe_u32 v28, v1, 2, 2
  v_mfma_f32_16x16x32_bf16 v[92:95], a[236:239], v[148:151], v[92:95]
  buffer_load_dwordx4 v2, s[20:23], s47 offen lds
  v_lshl_add_u32 v28, v43, 3, v28
  v_mfma_f32_16x16x32_bf16 v[100:103], a[236:239], v[152:155], v[100:103]
  ds_read_b64_tr_b16 a[232:233], v18 offset:49152
  v_bfe_u32 v29, v1, 1, 1
  v_mfma_f32_16x16x32_bf16 v[100:103], a[240:243], v[168:171], v[100:103]
  v_lshl_add_u32 v28, v29, 2, v28
  v_lshlrev_b32 v28, 4, v28
  v_mfma_f32_16x16x32_bf16 v[108:111], a[240:243], v[172:175], v[108:111]
  ds_read_b64_tr_b16 a[234:235], v19 offset:49152
  v_and_b32 v29, 1, v1
  v_mfma_f32_16x16x32_bf16 v[108:111], a[236:239], v[156:159], v[108:111]
  v_lshl_add_u32 v28, v29, 3, v28
  s_waitcnt lgkmcnt(4)
  v_mfma_f32_16x16x32_bf16 v[48:51], a[244:247], v[176:179], v[48:51]
  ds_read_b64_tr_b16 a[236:237], v16 offset:41472
  s_add_u32 s79, s58, 2560
  v_mfma_f32_16x16x32_bf16 v[48:51], a[248:251], v[192:195], v[48:51]
  v_add_u32 v28, s79, v28
  v_mfma_f32_16x16x32_bf16 v[56:59], a[248:251], v[196:199], v[56:59]
  ds_read_b64_tr_b16 a[238:239], v17 offset:41472
  ds_read_b64_tr_b16 v[32:33], v28
  v_mfma_f32_16x16x32_bf16 v[56:59], a[244:247], v[180:183], v[56:59]
  ds_read_b64_tr_b16 v[34:35], v28 offset:512
  v_mul_f32 v43, 0x3eae1a93, v24
  v_mfma_f32_16x16x32_bf16 v[64:67], a[244:247], v[184:187], v[64:67]
  ds_read_b64_tr_b16 a[240:241], v16 offset:49664
  v_accvgpr_read_b32 v28, a144
  v_mfma_f32_16x16x32_bf16 v[64:67], a[248:251], v[200:203], v[64:67]
  v_accvgpr_read_b32 v29, a145
  v_accvgpr_read_b32 v30, a146
  v_mfma_f32_16x16x32_bf16 v[72:75], a[248:251], v[204:207], v[72:75]
  ds_read_b64_tr_b16 a[242:243], v17 offset:49664
  v_accvgpr_read_b32 v31, a147
  v_mfma_f32_16x16x32_bf16 v[72:75], a[244:247], v[188:191], v[72:75]
  v_mul_f32 v28, v28, v43
  s_waitcnt lgkmcnt(6)
  v_mfma_f32_16x16x32_bf16 v[52:55], a[228:231], v[176:179], v[52:55]
  ds_read_b64_tr_b16 a[244:245], v18 offset:41472
  v_mul_f32 v29, v29, v43
  v_mfma_f32_16x16x32_bf16 v[52:55], a[232:235], v[192:195], v[52:55]
  v_mul_f32 v30, v30, v43
  v_mul_f32 v31, v31, v43
  v_mfma_f32_16x16x32_bf16 v[60:63], a[232:235], v[196:199], v[60:63]
  ds_read_b64_tr_b16 a[246:247], v19 offset:41472
  v_cvt_pk_bf16_f32 v28, v28, v29
  v_mfma_f32_16x16x32_bf16 v[60:63], a[228:231], v[180:183], v[60:63]
  v_cvt_pk_bf16_f32 v29, v30, v31
  v_mfma_f32_16x16x32_bf16 v[68:71], a[228:231], v[184:187], v[68:71]
  ds_read_b64_tr_b16 a[248:249], v18 offset:49664
  ds_write_b64 v36, v[28:29] offset:0
  v_mfma_f32_16x16x32_bf16 v[68:71], a[232:235], v[200:203], v[68:71]
  s_waitcnt lgkmcnt(7)
  buffer_store_dwordx2 v[32:33], v41, s[28:31], 0 offen sc1
  s_waitcnt lgkmcnt(6)
  buffer_store_dwordx2 v[34:35], v41, s[28:31], 0 offen offset:1280 sc1
  v_mfma_f32_16x16x32_bf16 v[76:79], a[232:235], v[204:207], v[76:79]
  ds_read_b64_tr_b16 a[250:251], v19 offset:49664
  v_mul_f32 v43, 0x3eae1a93, v25
  v_mfma_f32_16x16x32_bf16 v[76:79], a[228:231], v[188:191], v[76:79]
  v_accvgpr_read_b32 v28, a148
  s_waitcnt lgkmcnt(5)
  s_waitcnt vmcnt(8)
  s_barrier
  v_mfma_f32_16x16x32_bf16 v[80:83], a[236:239], v[176:179], v[80:83]
  ds_read_b64_tr_b16 a[228:229], v20 offset:0
  s_add_u32 m0, s74, 20480
  v_mfma_f32_16x16x32_bf16 v[80:83], a[240:243], v[192:195], v[80:83]
  buffer_load_dwordx4 v2, s[20:23], s83 offen lds
  s_add_u32 s47, s83, 9216
  v_mfma_f32_16x16x32_bf16 v[88:91], a[240:243], v[196:199], v[88:91]
  ds_read_b64_tr_b16 a[230:231], v21 offset:0
  s_add_u32 m0, s74, 21504
  v_mfma_f32_16x16x32_bf16 v[88:91], a[236:239], v[180:183], v[88:91]
  buffer_load_dwordx4 v2, s[20:23], s47 offen lds
  s_add_u32 m0, s74, 28672
  v_mfma_f32_16x16x32_bf16 v[96:99], a[236:239], v[184:187], v[96:99]
  ds_read_b64_tr_b16 a[232:233], v20 offset:8192
  v_accvgpr_read_b32 v29, a149
  v_mfma_f32_16x16x32_bf16 v[96:99], a[240:243], v[200:203], v[96:99]
  v_accvgpr_read_b32 v30, a150
  v_accvgpr_read_b32 v31, a151
  v_mfma_f32_16x16x32_bf16 v[104:107], a[240:243], v[204:207], v[104:107]
  ds_read_b64_tr_b16 a[234:235], v21 offset:8192
  v_mul_f32 v28, v28, v43
  v_mfma_f32_16x16x32_bf16 v[104:107], a[236:239], v[188:191], v[104:107]
  buffer_load_dwordx4 v2, s[20:23], s84 offen lds
  s_waitcnt lgkmcnt(4)
  v_mfma_f32_16x16x32_bf16 v[84:87], a[244:247], v[176:179], v[84:87]
  ds_read_b64_tr_b16 a[236:237], v22 offset:0
  s_add_u32 s47, s84, 9216
  v_mfma_f32_16x16x32_bf16 v[84:87], a[248:251], v[192:195], v[84:87]
  s_add_u32 m0, s74, 29696
  v_mul_f32 v29, v29, v43
  v_mfma_f32_16x16x32_bf16 v[92:95], a[248:251], v[196:199], v[92:95]
  ds_read_b64_tr_b16 a[238:239], v23 offset:0
  v_mul_f32 v30, v30, v43
  v_mfma_f32_16x16x32_bf16 v[92:95], a[244:247], v[180:183], v[92:95]
  buffer_load_dwordx4 v2, s[20:23], s47 offen lds
  v_mul_f32 v31, v31, v43
  v_mfma_f32_16x16x32_bf16 v[100:103], a[244:247], v[184:187], v[100:103]
  ds_read_b64_tr_b16 a[240:241], v22 offset:8192
  v_cvt_pk_bf16_f32 v28, v28, v29
  v_mfma_f32_16x16x32_bf16 v[100:103], a[248:251], v[200:203], v[100:103]
  v_cvt_pk_bf16_f32 v29, v30, v31
  v_mfma_f32_16x16x32_bf16 v[108:111], a[248:251], v[204:207], v[108:111]
  ds_read_b64_tr_b16 a[242:243], v23 offset:8192
  ds_write_b64 v36, v[28:29] offset:512
  v_mfma_f32_16x16x32_bf16 v[108:111], a[244:247], v[188:191], v[108:111]
  v_mul_f32 v43, 0x3eae1a93, v26
  s_waitcnt lgkmcnt(5)
  v_mfma_f32_16x16x32_bf16 v[48:51], a[228:231], v[208:211], v[48:51]
  ds_read_b64_tr_b16 a[244:245], v20 offset:512
  v_accvgpr_read_b32 v32, a152
  v_mfma_f32_16x16x32_bf16 v[48:51], a[232:235], v[224:227], v[48:51]
  v_accvgpr_read_b32 v33, a153
  v_accvgpr_read_b32 v34, a154
  v_mfma_f32_16x16x32_bf16 v[56:59], a[232:235], v[228:231], v[56:59]
  ds_read_b64_tr_b16 a[246:247], v21 offset:512
  v_accvgpr_read_b32 v35, a155
  v_mfma_f32_16x16x32_bf16 v[56:59], a[228:231], v[212:215], v[56:59]
  v_mul_f32 v32, v32, v43
  v_mul_f32 v33, v33, v43
  v_mfma_f32_16x16x32_bf16 v[64:67], a[228:231], v[216:219], v[64:67]
  ds_read_b64_tr_b16 a[248:249], v20 offset:8704
  v_mul_f32 v34, v34, v43
  v_mfma_f32_16x16x32_bf16 v[64:67], a[232:235], v[232:235], v[64:67]
  v_mul_f32 v35, v35, v43
  v_cvt_pk_bf16_f32 v32, v32, v33
  v_mfma_f32_16x16x32_bf16 v[72:75], a[232:235], v[236:239], v[72:75]
  ds_read_b64_tr_b16 a[250:251], v21 offset:8704
  v_cvt_pk_bf16_f32 v33, v34, v35
  v_mfma_f32_16x16x32_bf16 v[72:75], a[228:231], v[220:223], v[72:75]
  ds_write_b64 v36, v[32:33] offset:1024
  s_waitcnt lgkmcnt(6)
  v_mfma_f32_16x16x32_bf16 v[52:55], a[236:239], v[208:211], v[52:55]
  ds_read_b64_tr_b16 a[228:229], v22 offset:512
  v_mul_f32 v43, 0x3eae1a93, v27
  v_mfma_f32_16x16x32_bf16 v[52:55], a[240:243], v[224:227], v[52:55]
  v_accvgpr_read_b32 v28, a156
  v_accvgpr_read_b32 v29, a157
  v_mfma_f32_16x16x32_bf16 v[60:63], a[240:243], v[228:231], v[60:63]
  ds_read_b64_tr_b16 a[230:231], v23 offset:512
  v_accvgpr_read_b32 v30, a158
  v_mfma_f32_16x16x32_bf16 v[60:63], a[236:239], v[212:215], v[60:63]
  v_accvgpr_read_b32 v31, a159
  v_mul_f32 v28, v28, v43
  v_mfma_f32_16x16x32_bf16 v[68:71], a[236:239], v[216:219], v[68:71]
  ds_read_b64_tr_b16 a[232:233], v22 offset:8704
  v_mul_f32 v29, v29, v43
  v_mfma_f32_16x16x32_bf16 v[68:71], a[240:243], v[232:235], v[68:71]
  v_mul_f32 v30, v30, v43
  v_mul_f32 v31, v31, v43
  v_mfma_f32_16x16x32_bf16 v[76:79], a[240:243], v[236:239], v[76:79]
  ds_read_b64_tr_b16 a[234:235], v23 offset:8704
  v_cvt_pk_bf16_f32 v28, v28, v29
  v_mfma_f32_16x16x32_bf16 v[76:79], a[236:239], v[220:223], v[76:79]
  v_cvt_pk_bf16_f32 v29, v30, v31
  s_waitcnt lgkmcnt(5)
  s_waitcnt vmcnt(6)
  s_barrier
  v_mfma_f32_16x16x32_bf16 v[80:83], a[244:247], v[208:211], v[80:83]
  ds_read_b64_tr_b16 a[236:237], v16 offset:0
  s_add_u32 m0, s74, 40960
  v_mfma_f32_16x16x32_bf16 v[80:83], a[248:251], v[224:227], v[80:83]
  buffer_load_dwordx4 v2, s[20:23], s85 offen lds
  s_add_u32 s47, s85, 9216
  v_mfma_f32_16x16x32_bf16 v[88:91], a[248:251], v[228:231], v[88:91]
  ds_read_b64_tr_b16 a[238:239], v17 offset:0
  s_add_u32 m0, s74, 41984
  v_mfma_f32_16x16x32_bf16 v[88:91], a[244:247], v[212:215], v[88:91]
  buffer_load_dwordx4 v2, s[20:23], s47 offen lds
  s_add_u32 m0, s74, 49152
  v_mfma_f32_16x16x32_bf16 v[96:99], a[244:247], v[216:219], v[96:99]
  ds_read_b64_tr_b16 a[240:241], v18 offset:0
  ds_write_b64 v36, v[28:29] offset:1536
  v_mfma_f32_16x16x32_bf16 v[96:99], a[248:251], v[232:235], v[96:99]
  v_and_b32 v29, 31, v1
  v_lshlrev_b32 v29, 5, v29
  v_mfma_f32_16x16x32_bf16 v[104:107], a[248:251], v[236:239], v[104:107]
  ds_read_b64_tr_b16 a[242:243], v19 offset:0
  v_lshrrev_b32 v30, 5, v1
  v_mfma_f32_16x16x32_bf16 v[104:107], a[244:247], v[220:223], v[104:107]
  buffer_load_dwordx4 v2, s[20:23], s86 offen lds
  s_waitcnt lgkmcnt(5)
  v_mfma_f32_16x16x32_bf16 v[84:87], a[228:231], v[208:211], v[84:87]
  ds_read_b64_tr_b16 a[244:245], v16 offset:512
  s_add_u32 s47, s86, 9216
  v_mfma_f32_16x16x32_bf16 v[84:87], a[232:235], v[224:227], v[84:87]
  s_add_u32 m0, s74, 50176
  v_lshl_add_u32 v29, v30, 4, v29
  v_mfma_f32_16x16x32_bf16 v[92:95], a[232:235], v[228:231], v[92:95]
  ds_read_b64_tr_b16 a[246:247], v17 offset:512
  v_add_u32 v29, s58, v29
  v_mfma_f32_16x16x32_bf16 v[92:95], a[228:231], v[212:215], v[92:95]
  buffer_load_dwordx4 v2, s[20:23], s47 offen lds
  v_lshlrev_b32 v30, 2, v1
  v_mfma_f32_16x16x32_bf16 v[100:103], a[228:231], v[216:219], v[100:103]
  ds_read_b64_tr_b16 a[248:249], v18 offset:512
  v_add_u32 v30, s58, v30
  v_mfma_f32_16x16x32_bf16 v[100:103], a[232:235], v[232:235], v[100:103]
  v_mov_b32 v44, 0
  v_mfma_f32_16x16x32_bf16 v[108:111], a[232:235], v[236:239], v[108:111]
  ds_read_b64_tr_b16 a[250:251], v19 offset:512
  ds_read_b128 v[36:39], v29
  v_mfma_f32_16x16x32_bf16 v[108:111], a[228:231], v[220:223], v[108:111]
  ds_read_b32 v45, v30 offset:2048
  s_waitcnt lgkmcnt(6)
  v_mfma_f32_16x16x32_bf16 v[48:51], a[236:239], v[240:243], v[48:51]
  ds_read_b64_tr_b16 a[228:229], v16 offset:8192
  ds_read_b128 v[40:43], v29 offset:1024
  v_mfma_f32_16x16x32_bf16 v[52:55], a[240:243], v[240:243], v[52:55]
  v_mfma_f32_16x16x32_bf16 v[56:59], a[236:239], v[244:247], v[56:59]
  ds_read_b64_tr_b16 a[230:231], v17 offset:8192
  v_mfma_f32_16x16x32_bf16 v[60:63], a[240:243], v[244:247], v[60:63]
  v_mfma_f32_16x16x32_bf16 v[64:67], a[236:239], v[248:251], v[64:67]
  ds_read_b64_tr_b16 a[232:233], v18 offset:8192
  v_mfma_f32_16x16x32_bf16 v[68:71], a[240:243], v[248:251], v[68:71]
  v_mfma_f32_16x16x32_bf16 v[72:75], a[236:239], v[252:255], v[72:75]
  ds_read_b64_tr_b16 a[234:235], v19 offset:8192
  v_mfma_f32_16x16x32_bf16 v[76:79], a[240:243], v[252:255], v[76:79]
  s_waitcnt lgkmcnt(7)
  v_mfma_f32_16x16x32_bf16 v[80:83], a[244:247], v[240:243], v[80:83]
  ds_read_b64_tr_b16 a[236:237], v16 offset:8704
  v_mfma_f32_16x16x32_bf16 v[84:87], a[248:251], v[240:243], v[84:87]
  v_cvt_pk_bf16_f32 v48, v48, v49
  v_cvt_pk_bf16_f32 v49, v50, v51
  v_accvgpr_write_b32 a16, v48
  v_mfma_f32_16x16x32_bf16 v[88:91], a[244:247], v[244:247], v[88:91]
  ds_read_b64_tr_b16 a[238:239], v17 offset:8704
  v_accvgpr_write_b32 a17, v49
  v_cvt_pk_bf16_f32 v56, v56, v57
  v_mfma_f32_16x16x32_bf16 v[92:95], a[248:251], v[244:247], v[92:95]
  v_cvt_pk_bf16_f32 v57, v58, v59
  v_accvgpr_write_b32 a20, v56
  v_accvgpr_write_b32 a21, v57
  v_mfma_f32_16x16x32_bf16 v[96:99], a[244:247], v[248:251], v[96:99]
  ds_read_b64_tr_b16 a[240:241], v18 offset:8704
  v_cvt_pk_bf16_f32 v64, v64, v65
  v_cvt_pk_bf16_f32 v65, v66, v67
  v_mfma_f32_16x16x32_bf16 v[100:103], a[248:251], v[248:251], v[100:103]
  v_accvgpr_write_b32 a24, v64
  v_accvgpr_write_b32 a25, v65
  v_cvt_pk_bf16_f32 v72, v72, v73
  v_mfma_f32_16x16x32_bf16 v[104:107], a[244:247], v[252:255], v[104:107]
  ds_read_b64_tr_b16 a[242:243], v19 offset:8704
  v_cvt_pk_bf16_f32 v73, v74, v75
  v_accvgpr_write_b32 a28, v72
  v_mfma_f32_16x16x32_bf16 v[108:111], a[248:251], v[252:255], v[108:111]
  v_accvgpr_write_b32 a29, v73
  v_cvt_pk_bf16_f32 v52, v52, v53
  s_waitcnt lgkmcnt(4)
  s_waitcnt vmcnt(4)
  s_barrier
  v_mfma_f32_16x16x32_bf16 v[48:51], a[228:231], v[112:115], 0
  ds_read_b64_tr_b16 a[244:245], v16 offset:20480
  s_add_u32 m0, s74, 61440
  v_cvt_pk_bf16_f32 v53, v54, v55
  v_accvgpr_write_b32 a18, v52
  v_accvgpr_write_b32 a19, v53
  v_cvt_pk_bf16_f32 v60, v60, v61
  v_mfma_f32_16x16x32_bf16 v[52:55], a[232:235], v[112:115], 0
  buffer_load_dwordx4 v2, s[20:23], s87 offen lds
  s_add_u32 s47, s87, 9216
  s_add_u32 m0, s74, 62464
  v_mfma_f32_16x16x32_bf16 v[56:59], a[228:231], v[116:119], 0
  ds_read_b64_tr_b16 a[246:247], v17 offset:20480
  v_cvt_pk_bf16_f32 v61, v62, v63
  v_accvgpr_write_b32 a22, v60
  v_accvgpr_write_b32 a23, v61
  v_cvt_pk_bf16_f32 v68, v68, v69
  v_mfma_f32_16x16x32_bf16 v[60:63], a[232:235], v[116:119], 0
  buffer_load_dwordx4 v2, s[20:23], s47 offen lds
  s_add_u32 m0, s74, 69632
  v_cvt_pk_bf16_f32 v69, v70, v71
  v_mfma_f32_16x16x32_bf16 v[64:67], a[228:231], v[120:123], 0
  ds_read_b64_tr_b16 a[248:249], v16 offset:28672
  v_accvgpr_write_b32 a26, v68
  v_accvgpr_write_b32 a27, v69
  v_cvt_pk_bf16_f32 v76, v76, v77
  v_mfma_f32_16x16x32_bf16 v[68:71], a[232:235], v[120:123], 0
  v_cvt_pk_bf16_f32 v77, v78, v79
  v_accvgpr_write_b32 a30, v76
  v_accvgpr_write_b32 a31, v77
  v_mfma_f32_16x16x32_bf16 v[72:75], a[228:231], v[124:127], 0
  ds_read_b64_tr_b16 a[250:251], v17 offset:28672
  v_cvt_pk_bf16_f32 v80, v80, v81
  v_cvt_pk_bf16_f32 v81, v82, v83
  v_mfma_f32_16x16x32_bf16 v[76:79], a[232:235], v[124:127], 0
  buffer_load_dwordx4 v2, s[20:23], s88 offen lds
  s_add_u32 s47, s88, 9216
  s_waitcnt lgkmcnt(4)
  v_accvgpr_write_b32 a32, v80
  v_accvgpr_write_b32 a33, v81
  v_cvt_pk_bf16_f32 v88, v88, v89
  v_mfma_f32_16x16x32_bf16 v[80:83], a[236:239], v[112:115], 0
  ds_read_b64_tr_b16 a[228:229], v18 offset:20480
  s_add_u32 m0, s74, 70656
  v_cvt_pk_bf16_f32 v89, v90, v91
  v_accvgpr_write_b32 a36, v88
  v_accvgpr_write_b32 a37, v89
  v_cvt_pk_bf16_f32 v96, v96, v97
  v_cvt_pk_bf16_f32 v97, v98, v99
  v_accvgpr_write_b32 a40, v96
  v_accvgpr_write_b32 a41, v97
  v_cvt_pk_bf16_f32 v104, v104, v105
  v_cvt_pk_bf16_f32 v105, v106, v107
  v_accvgpr_write_b32 a44, v104
  v_accvgpr_write_b32 a45, v105
  v_cvt_pk_bf16_f32 v84, v84, v85
  v_cvt_pk_bf16_f32 v85, v86, v87
  v_accvgpr_write_b32 a34, v84
  v_accvgpr_write_b32 a35, v85
  v_cvt_pk_bf16_f32 v92, v92, v93
  v_mfma_f32_16x16x32_bf16 v[84:87], a[240:243], v[112:115], 0
  v_cvt_pk_bf16_f32 v93, v94, v95
  v_accvgpr_write_b32 a38, v92
  v_accvgpr_write_b32 a39, v93
  v_mfma_f32_16x16x32_bf16 v[88:91], a[236:239], v[116:119], 0
  ds_read_b64_tr_b16 a[230:231], v19 offset:20480
  v_cvt_pk_bf16_f32 v100, v100, v101
  v_cvt_pk_bf16_f32 v101, v102, v103
  v_mfma_f32_16x16x32_bf16 v[92:95], a[240:243], v[116:119], 0
  buffer_load_dwordx4 v2, s[20:23], s47 offen lds
  v_accvgpr_write_b32 a42, v100
  v_accvgpr_write_b32 a43, v101
  v_mfma_f32_16x16x32_bf16 v[96:99], a[236:239], v[120:123], 0
  ds_read_b64_tr_b16 a[232:233], v18 offset:28672
  v_cvt_pk_bf16_f32 v108, v108, v109
  v_cvt_pk_bf16_f32 v109, v110, v111
  v_mfma_f32_16x16x32_bf16 v[100:103], a[240:243], v[120:123], 0
  v_accvgpr_write_b32 a46, v108
  v_accvgpr_write_b32 a47, v109
  v_mfma_f32_16x16x32_bf16 v[104:107], a[236:239], v[124:127], 0
  ds_read_b64_tr_b16 a[234:235], v19 offset:28672
  v_mfma_f32_16x16x32_bf16 v[108:111], a[240:243], v[124:127], 0
  s_waitcnt lgkmcnt(4)
  v_mfma_f32_16x16x32_bf16 v[48:51], a[244:247], v[128:131], v[48:51]
  ds_read_b64_tr_b16 a[236:237], v16 offset:20992
  v_mfma_f32_16x16x32_bf16 v[48:51], a[248:251], v[144:147], v[48:51]
  v_mfma_f32_16x16x32_bf16 v[56:59], a[248:251], v[148:151], v[56:59]
  ds_read_b64_tr_b16 a[238:239], v17 offset:20992
  v_mfma_f32_16x16x32_bf16 v[56:59], a[244:247], v[132:135], v[56:59]
  v_mfma_f32_16x16x32_bf16 v[64:67], a[244:247], v[136:139], v[64:67]
  ds_read_b64_tr_b16 a[240:241], v16 offset:29184
  v_mfma_f32_16x16x32_bf16 v[64:67], a[248:251], v[152:155], v[64:67]
  v_mfma_f32_16x16x32_bf16 v[72:75], a[248:251], v[156:159], v[72:75]
  ds_read_b64_tr_b16 a[242:243], v17 offset:29184
  v_mfma_f32_16x16x32_bf16 v[72:75], a[244:247], v[140:143], v[72:75]
  s_waitcnt lgkmcnt(4)
  v_mfma_f32_16x16x32_bf16 v[52:55], a[228:231], v[128:131], v[52:55]
  ds_read_b64_tr_b16 a[244:245], v18 offset:20992
  v_mfma_f32_16x16x32_bf16 v[52:55], a[232:235], v[144:147], v[52:55]
  v_mfma_f32_16x16x32_bf16 v[60:63], a[232:235], v[148:151], v[60:63]
  ds_read_b64_tr_b16 a[246:247], v19 offset:20992
  v_mfma_f32_16x16x32_bf16 v[60:63], a[228:231], v[132:135], v[60:63]
  v_mfma_f32_16x16x32_bf16 v[68:71], a[228:231], v[136:139], v[68:71]
  ds_read_b64_tr_b16 a[248:249], v18 offset:29184
  v_mfma_f32_16x16x32_bf16 v[68:71], a[232:235], v[152:155], v[68:71]
  v_mfma_f32_16x16x32_bf16 v[76:79], a[232:235], v[156:159], v[76:79]
  ds_read_b64_tr_b16 a[250:251], v19 offset:29184
  v_mfma_f32_16x16x32_bf16 v[76:79], a[228:231], v[140:143], v[76:79]
  s_waitcnt lgkmcnt(4)
  s_waitcnt vmcnt(4)
  s_barrier
  v_mfma_f32_16x16x32_bf16 v[80:83], a[236:239], v[128:131], v[80:83]
  ds_read_b64_tr_b16 a[228:229], v16 offset:40960
  s_add_u32 m0, s74, 0
  v_mfma_f32_16x16x32_bf16 v[80:83], a[240:243], v[144:147], v[80:83]
  buffer_load_dwordx4 v2, s[20:23], s89 offen lds
  s_add_u32 s47, s89, 9216
  v_mfma_f32_16x16x32_bf16 v[88:91], a[240:243], v[148:151], v[88:91]
  ds_read_b64_tr_b16 a[230:231], v17 offset:40960
  s_add_u32 m0, s74, 1024
  v_mfma_f32_16x16x32_bf16 v[88:91], a[236:239], v[132:135], v[88:91]
  buffer_load_dwordx4 v2, s[20:23], s47 offen lds
  s_add_u32 m0, s74, 8192
  v_mfma_f32_16x16x32_bf16 v[96:99], a[236:239], v[136:139], v[96:99]
  ds_read_b64_tr_b16 a[232:233], v16 offset:49152
  v_mfma_f32_16x16x32_bf16 v[96:99], a[240:243], v[152:155], v[96:99]
  v_mfma_f32_16x16x32_bf16 v[104:107], a[240:243], v[156:159], v[104:107]
  ds_read_b64_tr_b16 a[234:235], v17 offset:49152
  v_mfma_f32_16x16x32_bf16 v[104:107], a[236:239], v[140:143], v[104:107]
  buffer_load_dwordx4 v2, s[20:23], s90 offen lds
  s_waitcnt lgkmcnt(4)
  v_mfma_f32_16x16x32_bf16 v[84:87], a[244:247], v[128:131], v[84:87]
  ds_read_b64_tr_b16 a[236:237], v18 offset:40960
  s_add_u32 s47, s90, 9216
  v_mfma_f32_16x16x32_bf16 v[84:87], a[248:251], v[144:147], v[84:87]
  s_add_u32 m0, s74, 9216
  v_mfma_f32_16x16x32_bf16 v[92:95], a[248:251], v[148:151], v[92:95]
  ds_read_b64_tr_b16 a[238:239], v19 offset:40960
  v_mfma_f32_16x16x32_bf16 v[92:95], a[244:247], v[132:135], v[92:95]
  buffer_load_dwordx4 v2, s[20:23], s47 offen lds
  v_mfma_f32_16x16x32_bf16 v[100:103], a[244:247], v[136:139], v[100:103]
  ds_read_b64_tr_b16 a[240:241], v18 offset:49152
  v_mfma_f32_16x16x32_bf16 v[100:103], a[248:251], v[152:155], v[100:103]
  v_mfma_f32_16x16x32_bf16 v[108:111], a[248:251], v[156:159], v[108:111]
  ds_read_b64_tr_b16 a[242:243], v19 offset:49152
  v_mfma_f32_16x16x32_bf16 v[108:111], a[244:247], v[140:143], v[108:111]
  s_waitcnt lgkmcnt(4)
  v_mfma_f32_16x16x32_bf16 v[48:51], a[228:231], v[160:163], v[48:51]
  ds_read_b64_tr_b16 a[244:245], v16 offset:41472
  s_add_u32 s99, s60, 32768
  v_mov_b32 v5, s59
  s_mov_b64 exec, 1
  buffer_store_dword v5, off, s[28:31], s99 sc1
  s_mov_b64 exec, -1
  v_mfma_f32_16x16x32_bf16 v[48:51], a[232:235], v[176:179], v[48:51]
  buffer_store_dwordx4 a[0:3], v4, s[28:31], s3 offen offset:0 sc1
  v_mov_b32 v14, 0xdddd
  v_mfma_f32_16x16x32_bf16 v[56:59], a[232:235], v[180:183], v[56:59]
  ds_read_b64_tr_b16 a[246:247], v17 offset:41472
  s_mul_i32 s94, s66, 5120
  v_mfma_f32_16x16x32_bf16 v[56:59], a[228:231], v[164:167], v[56:59]
  s_add_u32 s101, s94, 1048576
  v_add_u32 v3, 61440, v4
  v_mfma_f32_16x16x32_bf16 v[64:67], a[228:231], v[168:171], v[64:67]
  ds_read_b64_tr_b16 a[248:249], v16 offset:49664
  v_and_b32 v28, 31, v1
  v_mfma_f32_16x16x32_bf16 v[64:67], a[232:235], v[184:187], v[64:67]
  v_lshlrev_b32 v9, 4, v28
  v_add_u32 v9, 8192, v9
  v_mfma_f32_16x16x32_bf16 v[72:75], a[232:235], v[188:191], v[72:75]
L_pg9:
  s_cbranch_execz L_pg13
  ds_read_b64_tr_b16 a[250:251], v17 offset:49664
  v_add_u32 v10, 61440, v9
  v_mfma_f32_16x16x32_bf16 v[72:75], a[228:231], v[172:175], v[72:75]
  v_lshrrev_b32 v29, 2, v28
  s_waitcnt lgkmcnt(4)
  v_mfma_f32_16x16x32_bf16 v[52:55], a[236:239], v[160:163], v[52:55]
  ds_read_b64_tr_b16 a[228:229], v18 offset:41472
  v_lshlrev_b32 v29, 3, v29
  v_mfma_f32_16x16x32_bf16 v[52:55], a[240:243], v[176:179], v[52:55]
  v_mov_b32 v30, 0x04081000
  v_lshrrev_b32 v29, v29, v30
  v_mfma_f32_16x16x32_bf16 v[60:63], a[240:243], v[180:183], v[60:63]
  ds_read_b64_tr_b16 a[230:231], v19 offset:41472
  v_and_b32 v29, 0xff, v29
  v_mfma_f32_16x16x32_bf16 v[60:63], a[236:239], v[164:167], v[60:63]
  v_and_b32 v30, 3, v28
  v_add_u32 v29, v29, v30
  v_mfma_f32_16x16x32_bf16 v[68:71], a[236:239], v[168:171], v[68:71]
  ds_read_b64_tr_b16 a[232:233], v18 offset:49664
  v_subrev_u32 v30, 4, v28
  v_mfma_f32_16x16x32_bf16 v[68:71], a[240:243], v[184:187], v[68:71]
  v_min_u32 v30, 15, v30
  v_cmp_gt_u32 vcc, 16, v28
  v_mfma_f32_16x16x32_bf16 v[76:79], a[240:243], v[188:191], v[76:79]
  ds_read_b64_tr_b16 a[234:235], v19 offset:49664
  v_lshrrev_b32 v31, 5, v1
  v_mfma_f32_16x16x32_bf16 v[76:79], a[236:239], v[172:175], v[76:79]
  s_lshr_b32 s45, s65, 2
  s_waitcnt lgkmcnt(4)
  s_waitcnt vmcnt(6)
  s_barrier
  v_mfma_f32_16x16x32_bf16 v[80:83], a[244:247], v[160:163], v[80:83]
  ds_read_b64_tr_b16 a[236:237], v20 offset:0
  s_add_u32 s91, s91, 1
  v_mfma_f32_16x16x32_bf16 v[80:83], a[248:251], v[176:179], v[80:83]
  s_cmp_eq_u32 s91, 4
  s_cselect_b32 s47, 4294966912, s49
  s_cselect_b32 s91, 0, s91
  v_mfma_f32_16x16x32_bf16 v[88:91], a[248:251], v[180:183], v[88:91]
  ds_read_b64_tr_b16 a[238:239], v21 offset:0
  v_add_u32 v2, s47, v2
  v_mfma_f32_16x16x32_bf16 v[88:91], a[244:247], v[164:167], v[88:91]
  s_add_u32 m0, s74, 20480
  v_cndmask_b32 v29, v30, v29, vcc
  v_mfma_f32_16x16x32_bf16 v[96:99], a[244:247], v[168:171], v[96:99]
  ds_read_b64_tr_b16 a[240:241], v20 offset:8192
  v_mul_u32_u24 v30, 320, v31
  v_mfma_f32_16x16x32_bf16 v[96:99], a[248:251], v[184:187], v[96:99]
  buffer_load_dwordx4 v2, s[20:23], s82 offen lds
  s_add_u32 s47, s82, 9216
  v_mfma_f32_16x16x32_bf16 v[104:107], a[248:251], v[188:191], v[104:107]
  ds_read_b64_tr_b16 a[242:243], v21 offset:8192
  s_add_u32 m0, s74, 21504
  v_mfma_f32_16x16x32_bf16 v[104:107], a[244:247], v[172:175], v[104:107]
  buffer_load_dwordx4 v2, s[20:23], s47 offen lds
  s_waitcnt lgkmcnt(4)
  v_mfma_f32_16x16x32_bf16 v[84:87], a[228:231], v[160:163], v[84:87]
  ds_read_b64_tr_b16 a[244:245], v22 offset:0
  s_add_u32 m0, s74, 28672
  v_mfma_f32_16x16x32_bf16 v[84:87], a[232:235], v[176:179], v[84:87]
  v_lshl_add_u32 v29, v29, 4, v30
  v_add_u32 v11, 10240, v29
  v_mfma_f32_16x16x32_bf16 v[92:95], a[232:235], v[180:183], v[92:95]
  ds_read_b64_tr_b16 a[246:247], v23 offset:0
  v_add_u32 v12, 61440, v11
  v_mfma_f32_16x16x32_bf16 v[92:95], a[228:231], v[164:167], v[92:95]
  buffer_load_dwordx4 v2, s[20:23], s83 offen lds
  s_add_u32 s47, s83, 9216
  v_mfma_f32_16x16x32_bf16 v[100:103], a[228:231], v[168:171], v[100:103]
  ds_read_b64_tr_b16 a[248:249], v22 offset:8192
  s_add_u32 m0, s74, 29696
  v_mfma_f32_16x16x32_bf16 v[100:103], a[232:235], v[184:187], v[100:103]
  s_and_b32 s46, s65, 3
  s_mul_i32 s79, s46, 9
  v_mfma_f32_16x16x32_bf16 v[108:111], a[232:235], v[188:191], v[108:111]
  ds_read_b64_tr_b16 a[250:251], v23 offset:8192
  s_add_u32 s79, s79, 1
  v_mfma_f32_16x16x32_bf16 v[108:111], a[228:231], v[172:175], v[108:111]
  buffer_load_dwordx4 v2, s[20:23], s47 offen lds
  s_waitcnt lgkmcnt(4)
  v_mfma_f32_16x16x32_bf16 v[48:51], a[236:239], v[192:195], v[48:51]
  ds_read_b64_tr_b16 a[228:229], v20 offset:512
  s_lshr_b32 s51, s79, 1
  v_mfma_f32_16x16x32_bf16 v[48:51], a[240:243], v[208:211], v[48:51]
  s_mov_b32 s62, s51
  s_bitcmp1_b32 s46, 0
  s_cselect_b32 s63, 1073741824, 0
  v_mfma_f32_16x16x32_bf16 v[56:59], a[240:243], v[212:215], v[56:59]
  ds_read_b64_tr_b16 a[230:231], v21 offset:512
  s_lshl_b32 s79, s51, 6
  v_mfma_f32_16x16x32_bf16 v[56:59], a[236:239], v[196:199], v[56:59]
  v_lshrrev_b32 v29, 2, v1
  v_and_b32 v30, 3, v1
  v_mfma_f32_16x16x32_bf16 v[64:67], a[236:239], v[200:203], v[64:67]
  ds_read_b64_tr_b16 a[232:233], v20 offset:8704
  v_lshlrev_b32 v30, 4, v30
  v_mfma_f32_16x16x32_bf16 v[64:67], a[240:243], v[216:219], v[64:67]
  v_add_u32 v30, s79, v30
  v_mul_u32_u24 v13, 1152, v29
  v_mfma_f32_16x16x32_bf16 v[72:75], a[240:243], v[220:223], v[72:75]
  ds_read_b64_tr_b16 a[234:235], v21 offset:8704
  v_add_u32 v13, v13, v30
  v_mfma_f32_16x16x32_bf16 v[72:75], a[236:239], v[204:207], v[72:75]
  v_lshrrev_b32 v15, 3, v1
  s_waitcnt lgkmcnt(4)
  v_mfma_f32_16x16x32_bf16 v[52:55], a[244:247], v[192:195], v[52:55]
  ds_read_b64_tr_b16 a[236:237], v22 offset:512
  v_mul_u32_u24 v15, 18, v15
  v_mfma_f32_16x16x32_bf16 v[52:55], a[248:251], v[208:211], v[52:55]
  v_and_b32 v29, 1, v29
  v_add3_u32 v15, v15, v29, 16
  v_mfma_f32_16x16x32_bf16 v[60:63], a[248:251], v[212:215], v[60:63]
  ds_read_b64_tr_b16 a[238:239], v23 offset:512
  v_mul_u32_u24 v15, 1152, v15
  v_mfma_f32_16x16x32_bf16 v[60:63], a[244:247], v[196:199], v[60:63]
  v_add_u32 v15, v15, v30
  s_mul_i32 s41, s66, 165888
  v_mfma_f32_16x16x32_bf16 v[68:71], a[244:247], v[200:203], v[68:71]
  ds_read_b64_tr_b16 a[240:241], v22 offset:8704
  s_mul_i32 s42, s66, 20480
  v_mfma_f32_16x16x32_bf16 v[68:71], a[248:251], v[216:219], v[68:71]
  s_add_u32 s42, s42, 81920
  s_add_u32 s48, s94, 61440
  v_mfma_f32_16x16x32_bf16 v[76:79], a[248:251], v[220:223], v[76:79]
  ds_read_b64_tr_b16 a[242:243], v23 offset:8704
  v_bfe_u32 v29, v1, 2, 2
  v_mfma_f32_16x16x32_bf16 v[76:79], a[244:247], v[204:207], v[76:79]
  v_lshl_add_u32 v29, v31, 3, v29
  s_waitcnt lgkmcnt(4)
  s_waitcnt vmcnt(6)
  s_barrier
  v_mfma_f32_16x16x32_bf16 v[80:83], a[228:231], v[192:195], v[80:83]
  ds_read_b64_tr_b16 a[244:245], v16 offset:0
  s_add_u32 m0, s74, 40960
  v_mfma_f32_16x16x32_bf16 v[80:83], a[232:235], v[208:211], v[80:83]
  buffer_load_dwordx4 v2, s[20:23], s84 offen lds
  s_add_u32 s47, s84, 9216
  v_mfma_f32_16x16x32_bf16 v[88:91], a[232:235], v[212:215], v[88:91]
  ds_read_b64_tr_b16 a[246:247], v17 offset:0
  s_add_u32 m0, s74, 41984
  v_mfma_f32_16x16x32_bf16 v[88:91], a[228:231], v[196:199], v[88:91]
  buffer_load_dwordx4 v2, s[20:23], s47 offen lds
  s_add_u32 m0, s74, 49152
  v_mfma_f32_16x16x32_bf16 v[96:99], a[228:231], v[200:203], v[96:99]
  ds_read_b64_tr_b16 a[248:249], v16 offset:8192
  v_lshlrev_b32 v29, 6, v29
  v_mfma_f32_16x16x32_bf16 v[96:99], a[232:235], v[216:219], v[96:99]
  v_bfe_u32 v30, v1, 4, 1
  v_lshl_add_u32 v29, v30, 5, v29
  v_mfma_f32_16x16x32_bf16 v[104:107], a[232:235], v[220:223], v[104:107]
  ds_read_b64_tr_b16 a[250:251], v17 offset:8192
  v_and_b32 v46, 3, v1
  v_mfma_f32_16x16x32_bf16 v[104:107], a[228:231], v[204:207], v[104:107]
  buffer_load_dwordx4 v2, s[20:23], s85 offen lds
  s_waitcnt lgkmcnt(4)
  v_mfma_f32_16x16x32_bf16 v[84:87], a[236:239], v[192:195], v[84:87]
  ds_read_b64_tr_b16 a[228:229], v18 offset:0
  s_add_u32 s47, s85, 9216
  v_mfma_f32_16x16x32_bf16 v[84:87], a[240:243], v[208:211], v[84:87]
  s_add_u32 m0, s74, 50176
  v_lshl_add_u32 v29, v46, 3, v29
  v_mfma_f32_16x16x32_bf16 v[92:95], a[240:243], v[212:215], v[92:95]
  ds_read_b64_tr_b16 a[230:231], v19 offset:0
  v_add_u32 v46, s42, v29
  v_mfma_f32_16x16x32_bf16 v[92:95], a[236:239], v[196:199], v[92:95]
  buffer_load_dwordx4 v2, s[20:23], s47 offen lds
  v_lshlrev_b32 v30, 10, v30
  v_mfma_f32_16x16x32_bf16 v[100:103], a[236:239], v[200:203], v[100:103]
  ds_read_b64_tr_b16 a[232:233], v18 offset:8192
  v_lshl_add_u32 v30, v31, 8, v30
  v_mfma_f32_16x16x32_bf16 v[100:103], a[240:243], v[216:219], v[100:103]
  v_and_b32 v29, 15, v1
  v_lshl_add_u32 v24, v29, 4, v30
  v_mfma_f32_16x16x32_bf16 v[108:111], a[240:243], v[220:223], v[108:111]
  ds_read_b64_tr_b16 a[234:235], v19 offset:8192
  s_mul_i32 s40, s64, 2359296
  v_mfma_f32_16x16x32_bf16 v[108:111], a[236:239], v[204:207], v[108:111]
  s_lshl_b32 s79, s51, 17
  s_waitcnt lgkmcnt(4)
  v_mfma_f32_16x16x32_bf16 v[48:51], a[244:247], v[224:227], v[48:51]
  ds_read_b64_tr_b16 a[236:237], v16 offset:512
  buffer_store_dwordx4 a[4:7], v4, s[28:31], s3 offen offset:1024 sc1
  v_mfma_f32_16x16x32_bf16 v[48:51], a[248:251], v[240:243], v[48:51]
  s_add_u32 s40, s40, s79
  s_lshl_b32 s79, s66, 15
  v_mfma_f32_16x16x32_bf16 v[56:59], a[248:251], v[244:247], v[56:59]
  ds_read_b64_tr_b16 a[238:239], v17 offset:512
  s_add_u32 s40, s40, s79
  v_mfma_f32_16x16x32_bf16 v[56:59], a[244:247], v[228:231], v[56:59]
  s_lshl_b32 s79, s45, 11
  s_add_u32 s40, s40, s79
  v_mfma_f32_16x16x32_bf16 v[64:67], a[244:247], v[232:235], v[64:67]
  ds_read_b64_tr_b16 a[240:241], v16 offset:8704
  s_add_u32 s40, s40, 4194304
  v_mfma_f32_16x16x32_bf16 v[64:67], a[248:251], v[248:251], v[64:67]
  s_mov_b32 s70, s40
  s_add_u32 s71, s40, 131072
  v_mfma_f32_16x16x32_bf16 v[72:75], a[248:251], v[252:255], v[72:75]
  ds_read_b64_tr_b16 a[242:243], v17 offset:8704
  s_add_u32 s72, s40, 262144
  v_mfma_f32_16x16x32_bf16 v[72:75], a[244:247], v[236:239], v[72:75]
  s_add_u32 s73, s40, 393216
  s_waitcnt lgkmcnt(4)
  v_mfma_f32_16x16x32_bf16 v[52:55], a[228:231], v[224:227], v[52:55]
  ds_read_b64_tr_b16 a[244:245], v18 offset:512
  s_add_u32 s75, s40, 524288
  v_mfma_f32_16x16x32_bf16 v[52:55], a[232:235], v[240:243], v[52:55]
  v_cvt_pk_bf16_f32 v48, v48, v49
  v_cvt_pk_bf16_f32 v49, v50, v51
  v_accvgpr_write_b32 a48, v48
  v_mfma_f32_16x16x32_bf16 v[60:63], a[232:235], v[244:247], v[60:63]
  ds_read_b64_tr_b16 a[246:247], v19 offset:512
  v_accvgpr_write_b32 a49, v49
  v_cvt_pk_bf16_f32 v56, v56, v57
  v_mfma_f32_16x16x32_bf16 v[60:63], a[228:231], v[228:231], v[60:63]
  v_cvt_pk_bf16_f32 v57, v58, v59
  v_accvgpr_write_b32 a52, v56
  v_accvgpr_write_b32 a53, v57
  v_mfma_f32_16x16x32_bf16 v[68:71], a[228:231], v[232:235], v[68:71]
  ds_read_b64_tr_b16 a[248:249], v18 offset:8704
  v_cvt_pk_bf16_f32 v64, v64, v65
  v_cvt_pk_bf16_f32 v65, v66, v67
  v_mfma_f32_16x16x32_bf16 v[68:71], a[232:235], v[248:251], v[68:71]
  v_accvgpr_write_b32 a56, v64
  v_accvgpr_write_b32 a57, v65
  v_cvt_pk_bf16_f32 v72, v72, v73
  v_mfma_f32_16x16x32_bf16 v[76:79], a[232:235], v[252:255], v[76:79]
  ds_read_b64_tr_b16 a[250:251], v19 offset:8704
  v_cvt_pk_bf16_f32 v73, v74, v75
  v_accvgpr_write_b32 a60, v72
  v_mfma_f32_16x16x32_bf16 v[76:79], a[228:231], v[236:239], v[76:79]
  v_accvgpr_write_b32 a61, v73
  s_add_u32 s75, s75, s63
  s_waitcnt lgkmcnt(4)
  s_waitcnt vmcnt(5)
  s_barrier
  v_mfma_f32_16x16x32_bf16 v[80:83], a[236:239], v[224:227], v[80:83]
  ds_read_b64_tr_b16 a[228:229], v16 offset:20480
  s_add_u32 m0, s74, 61440
  v_mfma_f32_16x16x32_bf16 v[80:83], a[240:243], v[240:243], v[80:83]
  buffer_load_dwordx4 v2, s[20:23], s86 offen lds
  s_add_u32 s47, s86, 9216
  s_add_u32 m0, s74, 62464
  v_mfma_f32_16x16x32_bf16 v[88:91], a[240:243], v[244:247], v[88:91]
  ds_read_b64_tr_b16 a[230:231], v17 offset:20480
  v_cvt_pk_bf16_f32 v52, v52, v53
  v_cvt_pk_bf16_f32 v53, v54, v55
  v_mfma_f32_16x16x32_bf16 v[88:91], a[236:239], v[228:231], v[88:91]
  buffer_load_dwordx4 v2, s[20:23], s47 offen lds
  s_add_u32 m0, s74, 69632
  v_accvgpr_write_b32 a50, v52
  v_mfma_f32_16x16x32_bf16 v[96:99], a[236:239], v[232:235], v[96:99]
  ds_read_b64_tr_b16 a[232:233], v16 offset:28672
  v_accvgpr_write_b32 a51, v53
  v_cvt_pk_bf16_f32 v60, v60, v61
  v_mfma_f32_16x16x32_bf16 v[96:99], a[240:243], v[248:251], v[96:99]
  v_cvt_pk_bf16_f32 v61, v62, v63
  v_accvgpr_write_b32 a54, v60
  v_accvgpr_write_b32 a55, v61
  v_mfma_f32_16x16x32_bf16 v[104:107], a[240:243], v[252:255], v[104:107]
  ds_read_b64_tr_b16 a[234:235], v17 offset:28672
  v_cvt_pk_bf16_f32 v68, v68, v69
  v_cvt_pk_bf16_f32 v69, v70, v71
  v_mfma_f32_16x16x32_bf16 v[104:107], a[236:239], v[236:239], v[104:107]
  buffer_load_dwordx4 v2, s[20:23], s87 offen lds
  s_add_u32 s47, s87, 9216
  s_waitcnt lgkmcnt(4)
  v_mfma_f32_16x16x32_bf16 v[84:87], a[244:247], v[224:227], v[84:87]
  ds_read_b64_tr_b16 a[236:237], v18 offset:20480
  s_add_u32 m0, s74, 70656
  v_accvgpr_write_b32 a58, v68
  v_mfma_f32_16x16x32_bf16 v[84:87], a[248:251], v[240:243], v[84:87]
  v_accvgpr_write_b32 a59, v69
  v_cvt_pk_bf16_f32 v76, v76, v77
  v_cvt_pk_bf16_f32 v77, v78, v79
  v_mfma_f32_16x16x32_bf16 v[92:95], a[248:251], v[244:247], v[92:95]
  ds_read_b64_tr_b16 a[238:239], v19 offset:20480
  v_accvgpr_write_b32 a62, v76
  v_accvgpr_write_b32 a63, v77
  v_mfma_f32_16x16x32_bf16 v[92:95], a[244:247], v[228:231], v[92:95]
  buffer_load_dwordx4 v2, s[20:23], s47 offen lds
  v_cvt_pk_bf16_f32 v80, v80, v81
  v_cvt_pk_bf16_f32 v81, v82, v83
  v_mfma_f32_16x16x32_bf16 v[100:103], a[244:247], v[232:235], v[100:103]
  ds_read_b64_tr_b16 a[240:241], v18 offset:28672
  v_accvgpr_write_b32 a64, v80
  v_accvgpr_write_b32 a65, v81
  v_mfma_f32_16x16x32_bf16 v[100:103], a[248:251], v[248:251], v[100:103]
  v_cvt_pk_bf16_f32 v88, v88, v89
  v_cvt_pk_bf16_f32 v89, v90, v91
  v_accvgpr_write_b32 a68, v88
  v_mfma_f32_16x16x32_bf16 v[108:111], a[248:251], v[252:255], v[108:111]
  ds_read_b64_tr_b16 a[242:243], v19 offset:28672
  v_accvgpr_write_b32 a69, v89
  v_cvt_pk_bf16_f32 v96, v96, v97
  v_mfma_f32_16x16x32_bf16 v[108:111], a[244:247], v[236:239], v[108:111]
  v_cvt_pk_bf16_f32 v97, v98, v99
  v_accvgpr_write_b32 a72, v96
  s_waitcnt lgkmcnt(4)
  v_mfma_f32_16x16x32_bf16 v[48:51], a[228:231], v[112:115], 0
  ds_read_b64_tr_b16 a[244:245], v16 offset:20992
  v_accvgpr_write_b32 a73, v97
  v_cvt_pk_bf16_f32 v104, v104, v105
  v_mfma_f32_16x16x32_bf16 v[48:51], a[232:235], v[128:131], v[48:51]
  v_cvt_pk_bf16_f32 v105, v106, v107
  v_accvgpr_write_b32 a76, v104
  v_accvgpr_write_b32 a77, v105
  v_mfma_f32_16x16x32_bf16 v[56:59], a[228:231], v[116:119], 0
  ds_read_b64_tr_b16 a[246:247], v17 offset:20992
  v_cvt_pk_bf16_f32 v84, v84, v85
  v_cvt_pk_bf16_f32 v85, v86, v87
  v_mfma_f32_16x16x32_bf16 v[56:59], a[232:235], v[132:135], v[56:59]
  v_accvgpr_write_b32 a66, v84
  v_accvgpr_write_b32 a67, v85
  v_cvt_pk_bf16_f32 v92, v92, v93
  v_mfma_f32_16x16x32_bf16 v[64:67], a[228:231], v[120:123], 0
  ds_read_b64_tr_b16 a[248:249], v16 offset:29184
  v_cvt_pk_bf16_f32 v93, v94, v95
  v_accvgpr_write_b32 a70, v92
  v_mfma_f32_16x16x32_bf16 v[64:67], a[232:235], v[136:139], v[64:67]
  v_accvgpr_write_b32 a71, v93
  v_cvt_pk_bf16_f32 v100, v100, v101
  v_cvt_pk_bf16_f32 v101, v102, v103
  v_mfma_f32_16x16x32_bf16 v[72:75], a[228:231], v[124:127], 0
  ds_read_b64_tr_b16 a[250:251], v17 offset:29184
  v_accvgpr_write_b32 a74, v100
  v_accvgpr_write_b32 a75, v101
  v_mfma_f32_16x16x32_bf16 v[72:75], a[232:235], v[140:143], v[72:75]
  v_cvt_pk_bf16_f32 v108, v108, v109
  v_cvt_pk_bf16_f32 v109, v110, v111
  s_waitcnt lgkmcnt(4)
  v_mfma_f32_16x16x32_bf16 v[52:55], a[236:239], v[112:115], 0
  ds_read_b64_tr_b16 a[228:229], v18 offset:20992
  v_accvgpr_write_b32 a78, v108
  v_accvgpr_write_b32 a79, v109
  v_mfma_f32_16x16x32_bf16 v[52:55], a[240:243], v[128:131], v[52:55]
  s_lshl_b32 s53, s64, 11
  s_lshl_b32 s79, s64, 2
  s_add_u32 s79, s79, s45
  v_mfma_f32_16x16x32_bf16 v[60:63], a[236:239], v[116:119], 0
  ds_read_b64_tr_b16 a[230:231], v19 offset:20992
  s_mul_i32 s51, s79, 36864
  v_mfma_f32_16x16x32_bf16 v[60:63], a[240:243], v[132:135], v[60:63]
  s_add_u32 s51, s51, 1310720
  s_lshl_b32 s79, s66, 10
  v_mfma_f32_16x16x32_bf16 v[68:71], a[236:239], v[120:123], 0
  ds_read_b64_tr_b16 a[232:233], v18 offset:29184
  s_add_u32 s50, s51, s79
  v_mfma_f32_16x16x32_bf16 v[68:71], a[240:243], v[136:139], v[68:71]
  s_add_u32 s50, s50, 32768
  s_lshl_b32 s79, s66, 13
  v_mfma_f32_16x16x32_bf16 v[76:79], a[236:239], v[124:127], 0
  ds_read_b64_tr_b16 a[234:235], v19 offset:29184
  s_add_u32 s51, s51, s79
  v_mfma_f32_16x16x32_bf16 v[76:79], a[240:243], v[140:143], v[76:79]
  v_lshlrev_b32 v27, 2, v31
  s_waitcnt lgkmcnt(4)
  s_waitcnt vmcnt(5)
  s_barrier
  v_mfma_f32_16x16x32_bf16 v[80:83], a[244:247], v[112:115], 0
  ds_read_b64_tr_b16 a[236:237], v16 offset:40960
  s_add_u32 m0, s74, 0
  v_mfma_f32_16x16x32_bf16 v[80:83], a[248:251], v[128:131], v[80:83]
  buffer_load_dwordx4 v2, s[20:23], s88 offen lds
  s_add_u32 s47, s88, 9216
  v_mfma_f32_16x16x32_bf16 v[88:91], a[244:247], v[116:119], 0
  ds_read_b64_tr_b16 a[238:239], v17 offset:40960
  s_add_u32 m0, s74, 1024
  v_mfma_f32_16x16x32_bf16 v[88:91], a[248:251], v[132:135], v[88:91]
  buffer_load_dwordx4 v2, s[20:23], s47 offen lds
  s_add_u32 m0, s74, 8192
  v_mfma_f32_16x16x32_bf16 v[96:99], a[244:247], v[120:123], 0
  ds_read_b64_tr_b16 a[240:241], v16 offset:49152
  v_sub_u32 v27, v28, v27
  v_mfma_f32_16x16x32_bf16 v[96:99], a[248:251], v[136:139], v[96:99]
  v_lshlrev_b32 v27, v27, 1
  v_bfe_u32 v28, v27, 0, 2
  v_mfma_f32_16x16x32_bf16 v[104:107], a[244:247], v[124:127], 0
  ds_read_b64_tr_b16 a[242:243], v17 offset:49152
  v_mul_u32_u24 v28, 0x8001, v28
  v_mfma_f32_16x16x32_bf16 v[104:107], a[248:251], v[140:143], v[104:107]
  buffer_load_dwordx4 v2, s[20:23], s89 offen lds
  s_waitcnt lgkmcnt(4)
  v_mfma_f32_16x16x32_bf16 v[84:87], a[228:231], v[112:115], 0
  ds_read_b64_tr_b16 a[244:245], v18 offset:40960
  s_add_u32 s47, s89, 9216
  v_mfma_f32_16x16x32_bf16 v[84:87], a[232:235], v[128:131], v[84:87]
  s_add_u32 m0, s74, 9216
  v_and_b32 v28, 0x10001, v28
  v_mfma_f32_16x16x32_bf16 v[92:95], a[228:231], v[116:119], 0
  ds_read_b64_tr_b16 a[246:247], v19 offset:40960
  v_mul_u32_u24 v28, 0x3f80, v28
  v_mfma_f32_16x16x32_bf16 v[92:95], a[232:235], v[132:135], v[92:95]
  buffer_load_dwordx4 v2, s[20:23], s47 offen lds
  v_bfe_u32 v29, v27, 2, 2
  v_mfma_f32_16x16x32_bf16 v[100:103], a[228:231], v[120:123], 0
  ds_read_b64_tr_b16 a[248:249], v18 offset:49152
  v_mul_u32_u24 v29, 0x8001, v29
  v_mfma_f32_16x16x32_bf16 v[100:103], a[232:235], v[136:139], v[100:103]
  v_and_b32 v29, 0x10001, v29
  v_mul_u32_u24 v29, 0x3f80, v29
  v_mfma_f32_16x16x32_bf16 v[108:111], a[228:231], v[124:127], 0
  ds_read_b64_tr_b16 a[250:251], v19 offset:49152
  v_bfe_u32 v30, v27, 16, 2
  v_mfma_f32_16x16x32_bf16 v[108:111], a[232:235], v[140:143], v[108:111]
  v_mul_u32_u24 v30, 0x8001, v30
  s_waitcnt lgkmcnt(4)
  v_mfma_f32_16x16x32_bf16 v[48:51], a[236:239], v[144:147], v[48:51]
  ds_read_b64_tr_b16 a[228:229], v16 offset:41472
  buffer_store_dwordx4 a[8:11], v4, s[28:31], s3 offen offset:2048 sc1
  v_mfma_f32_16x16x32_bf16 v[48:51], a[240:243], v[160:163], v[48:51]
  v_and_b32 v30, 0x10001, v30
  v_mul_u32_u24 v30, 0x3f80, v30
  v_mfma_f32_16x16x32_bf16 v[56:59], a[240:243], v[164:167], v[56:59]
  ds_read_b64_tr_b16 a[230:231], v17 offset:41472
  v_bfe_u32 v31, v27, 18, 2
  v_mfma_f32_16x16x32_bf16 v[56:59], a[236:239], v[148:151], v[56:59]
  v_mul_u32_u24 v31, 0x8001, v31
  v_and_b32 v31, 0x10001, v31
  v_mfma_f32_16x16x32_bf16 v[64:67], a[236:239], v[152:155], v[64:67]
  ds_read_b64_tr_b16 a[232:233], v16 offset:49664
  v_mul_u32_u24 v31, 0x3f80, v31
  v_mfma_f32_16x16x32_bf16 v[64:67], a[240:243], v[168:171], v[64:67]
  v_bfe_u32 v32, v27, 8, 2
  v_mul_u32_u24 v32, 0x8001, v32
  v_mfma_f32_16x16x32_bf16 v[72:75], a[240:243], v[172:175], v[72:75]
  ds_read_b64_tr_b16 a[234:235], v17 offset:49664
  v_and_b32 v32, 0x10001, v32
  v_mfma_f32_16x16x32_bf16 v[72:75], a[236:239], v[156:159], v[72:75]
  v_mul_u32_u24 v32, 0x3f80, v32
  s_waitcnt lgkmcnt(4)
  v_mfma_f32_16x16x32_bf16 v[52:55], a[244:247], v[144:147], v[52:55]
  ds_read_b64_tr_b16 a[236:237], v18 offset:41472
  v_bfe_u32 v33, v27, 10, 2
  v_mfma_f32_16x16x32_bf16 v[52:55], a[248:251], v[160:163], v[52:55]
  v_mul_u32_u24 v33, 0x8001, v33
  v_and_b32 v33, 0x10001, v33
  v_mfma_f32_16x16x32_bf16 v[60:63], a[248:251], v[164:167], v[60:63]
  ds_read_b64_tr_b16 a[238:239], v19 offset:41472
  v_mul_u32_u24 v33, 0x3f80, v33
  v_mfma_f32_16x16x32_bf16 v[60:63], a[244:247], v[148:151], v[60:63]
  v_bfe_u32 v34, v27, 24, 2
  v_mul_u32_u24 v34, 0x8001, v34
  v_mfma_f32_16x16x32_bf16 v[68:71], a[244:247], v[152:155], v[68:71]
  ds_read_b64_tr_b16 a[240:241], v18 offset:49664
  v_and_b32 v34, 0x10001, v34
  v_mfma_f32_16x16x32_bf16 v[68:71], a[248:251], v[168:171], v[68:71]
  v_mul_u32_u24 v34, 0x3f80, v34
  v_bfe_u32 v35, v27, 26, 2
  v_mfma_f32_16x16x32_bf16 v[76:79], a[248:251], v[172:175], v[76:79]
  ds_read_b64_tr_b16 a[242:243], v19 offset:49664
  v_mul_u32_u24 v35, 0x8001, v35
  v_mfma_f32_16x16x32_bf16 v[76:79], a[244:247], v[156:159], v[76:79]
  v_and_b32 v35, 0x10001, v35
  s_waitcnt lgkmcnt(4)
  s_waitcnt vmcnt(5)
  s_barrier
  v_mfma_f32_16x16x32_bf16 v[80:83], a[228:231], v[144:147], v[80:83]
  ds_read_b64_tr_b16 a[244:245], v20 offset:0
  s_add_u32 m0, s74, 20480
  v_mfma_f32_16x16x32_bf16 v[80:83], a[232:235], v[160:163], v[80:83]
  buffer_load_dwordx4 v2, s[20:23], s90 offen lds
  s_add_u32 s47, s90, 9216
  v_mfma_f32_16x16x32_bf16 v[88:91], a[232:235], v[164:167], v[88:91]
  ds_read_b64_tr_b16 a[246:247], v21 offset:0
  s_add_u32 m0, s74, 21504
  v_mfma_f32_16x16x32_bf16 v[88:91], a[228:231], v[148:151], v[88:91]
  buffer_load_dwordx4 v2, s[20:23], s47 offen lds
  s_add_u32 s91, s91, 1
  v_mfma_f32_16x16x32_bf16 v[96:99], a[228:231], v[152:155], v[96:99]
  ds_read_b64_tr_b16 a[248:249], v20 offset:8192
  s_cmp_eq_u32 s91, 4
  s_cselect_b32 s47, 4294966912, s49
  s_cselect_b32 s91, 0, s91
  v_mfma_f32_16x16x32_bf16 v[96:99], a[232:235], v[168:171], v[96:99]
  v_add_u32 v2, s47, v2
  s_add_u32 m0, s74, 28672
  v_mfma_f32_16x16x32_bf16 v[104:107], a[232:235], v[172:175], v[104:107]
  ds_read_b64_tr_b16 a[250:251], v21 offset:8192
  v_mul_u32_u24 v35, 0x3f80, v35
  v_mfma_f32_16x16x32_bf16 v[104:107], a[228:231], v[156:159], v[104:107]
  buffer_load_dwordx4 v2, s[20:23], s82 offen lds
  s_waitcnt lgkmcnt(4)
  v_mfma_f32_16x16x32_bf16 v[84:87], a[236:239], v[144:147], v[84:87]
  ds_read_b64_tr_b16 a[228:229], v22 offset:0
  s_add_u32 s47, s82, 9216
  v_mfma_f32_16x16x32_bf16 v[84:87], a[240:243], v[160:163], v[84:87]
  s_add_u32 m0, s74, 29696
  v_mfma_f32_16x16x32_bf16 v[92:95], a[240:243], v[164:167], v[92:95]
  ds_read_b64_tr_b16 a[230:231], v23 offset:0
  v_mfma_f32_16x16x32_bf16 v[92:95], a[236:239], v[148:151], v[92:95]
  buffer_load_dwordx4 v2, s[20:23], s47 offen lds
  v_mfma_f32_16x16x32_bf16 v[100:103], a[236:239], v[152:155], v[100:103]
  ds_read_b64_tr_b16 a[232:233], v22 offset:8192
  v_mfma_f32_16x16x32_bf16 v[100:103], a[240:243], v[168:171], v[100:103]
  v_mfma_f32_16x16x32_bf16 v[108:111], a[240:243], v[172:175], v[108:111]
  ds_read_b64_tr_b16 a[234:235], v23 offset:8192
  v_mfma_f32_16x16x32_bf16 v[108:111], a[236:239], v[156:159], v[108:111]
  s_waitcnt lgkmcnt(4)
  v_mfma_f32_16x16x32_bf16 v[48:51], a[244:247], v[176:179], v[48:51]
  ds_read_b64_tr_b16 a[236:237], v20 offset:512
  buffer_store_dwordx4 a[12:15], v4, s[28:31], s3 offen offset:3072 sc1
  v_mfma_f32_16x16x32_bf16 v[48:51], a[248:251], v[192:195], v[48:51]
  v_mfma_f32_16x16x32_bf16 v[56:59], a[248:251], v[196:199], v[56:59]
  ds_read_b64_tr_b16 a[238:239], v21 offset:512
  v_mfma_f32_16x16x32_bf16 v[56:59], a[244:247], v[180:183], v[56:59]
  v_mfma_f32_16x16x32_bf16 v[64:67], a[244:247], v[184:187], v[64:67]
  ds_read_b64_tr_b16 a[240:241], v20 offset:8704
  v_mfma_f32_16x16x32_bf16 v[64:67], a[248:251], v[200:203], v[64:67]
  v_mfma_f32_16x16x32_bf16 v[72:75], a[248:251], v[204:207], v[72:75]
  ds_read_b64_tr_b16 a[242:243], v21 offset:8704
  v_mfma_f32_16x16x32_bf16 v[72:75], a[244:247], v[188:191], v[72:75]
  s_waitcnt lgkmcnt(4)
  v_mfma_f32_16x16x32_bf16 v[52:55], a[228:231], v[176:179], v[52:55]
  ds_read_b64_tr_b16 a[244:245], v22 offset:512
  v_mfma_f32_16x16x32_bf16 v[52:55], a[232:235], v[192:195], v[52:55]
  v_mfma_f32_16x16x32_bf16 v[60:63], a[232:235], v[196:199], v[60:63]
  ds_read_b64_tr_b16 a[246:247], v23 offset:512
  v_mfma_f32_16x16x32_bf16 v[60:63], a[228:231], v[180:183], v[60:63]
  v_mfma_f32_16x16x32_bf16 v[68:71], a[228:231], v[184:187], v[68:71]
  ds_read_b64_tr_b16 a[248:249], v22 offset:8704
  v_mfma_f32_16x16x32_bf16 v[68:71], a[232:235], v[200:203], v[68:71]
  v_mfma_f32_16x16x32_bf16 v[76:79], a[232:235], v[204:207], v[76:79]
  ds_read_b64_tr_b16 a[250:251], v23 offset:8704
  v_mfma_f32_16x16x32_bf16 v[76:79], a[228:231], v[188:191], v[76:79]
  s_waitcnt lgkmcnt(4)
  s_waitcnt vmcnt(6)
  s_barrier
  v_mfma_f32_16x16x32_bf16 v[80:83], a[236:239], v[176:179], v[80:83]
  ds_read_b64_tr_b16 a[228:229], v16 offset:0
  s_add_u32 m0, s74, 40960
  v_mfma_f32_16x16x32_bf16 v[80:83], a[240:243], v[192:195], v[80:83]
  buffer_load_dwordx4 v2, s[20:23], s83 offen lds
  s_add_u32 s47, s83, 9216
  v_mfma_f32_16x16x32_bf16 v[88:91], a[240:243], v[196:199], v[88:91]
  ds_read_b64_tr_b16 a[230:231], v17 offset:0
  s_add_u32 m0, s74, 41984
  v_mfma_f32_16x16x32_bf16 v[88:91], a[236:239], v[180:183], v[88:91]
  buffer_load_dwordx4 v2, s[20:23], s47 offen lds
  s_add_u32 m0, s74, 49152
  v_mfma_f32_16x16x32_bf16 v[96:99], a[236:239], v[184:187], v[96:99]
  ds_read_b64_tr_b16 a[232:233], v16 offset:8192
  v_mfma_f32_16x16x32_bf16 v[96:99], a[240:243], v[200:203], v[96:99]
  v_mfma_f32_16x16x32_bf16 v[104:107], a[240:243], v[204:207], v[104:107]
  ds_read_b64_tr_b16 a[234:235], v17 offset:8192
  v_mfma_f32_16x16x32_bf16 v[104:107], a[236:239], v[188:191], v[104:107]
  buffer_load_dwordx4 v2, s[20:23], s84 offen lds
  s_waitcnt lgkmcnt(4)
  v_mfma_f32_16x16x32_bf16 v[84:87], a[244:247], v[176:179], v[84:87]
  ds_read_b64_tr_b16 a[236:237], v18 offset:0
  s_add_u32 s47, s84, 9216
  v_mfma_f32_16x16x32_bf16 v[84:87], a[248:251], v[192:195], v[84:87]
  s_add_u32 m0, s74, 50176
  v_mfma_f32_16x16x32_bf16 v[92:95], a[248:251], v[196:199], v[92:95]
  ds_read_b64_tr_b16 a[238:239], v19 offset:0
  v_mfma_f32_16x16x32_bf16 v[92:95], a[244:247], v[180:183], v[92:95]
  buffer_load_dwordx4 v2, s[20:23], s47 offen lds
  v_mfma_f32_16x16x32_bf16 v[100:103], a[244:247], v[184:187], v[100:103]
L_pg10:
  s_cbranch_execz L_wr0
  ds_read_b64_tr_b16 a[240:241], v18 offset:8192
  v_mfma_f32_16x16x32_bf16 v[100:103], a[248:251], v[200:203], v[100:103]
  v_mfma_f32_16x16x32_bf16 v[108:111], a[248:251], v[204:207], v[108:111]
  ds_read_b64_tr_b16 a[242:243], v19 offset:8192
  v_mfma_f32_16x16x32_bf16 v[108:111], a[244:247], v[188:191], v[108:111]
  s_waitcnt lgkmcnt(4)
  v_mfma_f32_16x16x32_bf16 v[48:51], a[228:231], v[208:211], v[48:51]
  ds_read_b64_tr_b16 a[244:245], v16 offset:512
  v_mfma_f32_16x16x32_bf16 v[48:51], a[232:235], v[224:227], v[48:51]
  v_mfma_f32_16x16x32_bf16 v[56:59], a[232:235], v[228:231], v[56:59]
  ds_read_b64_tr_b16 a[246:247], v17 offset:512
  v_mfma_f32_16x16x32_bf16 v[56:59], a[228:231], v[212:215], v[56:59]
  v_mfma_f32_16x16x32_bf16 v[64:67], a[228:231], v[216:219], v[64:67]
  ds_read_b64_tr_b16 a[248:249], v16 offset:8704
  v_mfma_f32_16x16x32_bf16 v[64:67], a[232:235], v[232:235], v[64:67]
  v_mfma_f32_16x16x32_bf16 v[72:75], a[232:235], v[236:239], v[72:75]
  ds_read_b64_tr_b16 a[250:251], v17 offset:8704
  v_mfma_f32_16x16x32_bf16 v[72:75], a[228:231], v[220:223], v[72:75]
  s_waitcnt lgkmcnt(4)
  v_mfma_f32_16x16x32_bf16 v[52:55], a[236:239], v[208:211], v[52:55]
  ds_read_b64_tr_b16 a[228:229], v18 offset:512
  v_mfma_f32_16x16x32_bf16 v[52:55], a[240:243], v[224:227], v[52:55]
  v_mfma_f32_16x16x32_bf16 v[60:63], a[240:243], v[228:231], v[60:63]
  ds_read_b64_tr_b16 a[230:231], v19 offset:512
  v_mfma_f32_16x16x32_bf16 v[60:63], a[236:239], v[212:215], v[60:63]
  v_mfma_f32_16x16x32_bf16 v[68:71], a[236:239], v[216:219], v[68:71]
  ds_read_b64_tr_b16 a[232:233], v18 offset:8704
  v_mfma_f32_16x16x32_bf16 v[68:71], a[240:243], v[232:235], v[68:71]
  v_mfma_f32_16x16x32_bf16 v[76:79], a[240:243], v[236:239], v[76:79]
  ds_read_b64_tr_b16 a[234:235], v19 offset:8704
  v_mfma_f32_16x16x32_bf16 v[76:79], a[236:239], v[220:223], v[76:79]
  s_waitcnt lgkmcnt(4)
  s_waitcnt vmcnt(5)
  s_barrier
  v_mfma_f32_16x16x32_bf16 v[80:83], a[244:247], v[208:211], v[80:83]
  ds_read_b64_tr_b16 a[236:237], v16 offset:20480
  s_add_u32 m0, s74, 61440
  v_mfma_f32_16x16x32_bf16 v[80:83], a[248:251], v[224:227], v[80:83]
  buffer_load_dwordx4 v2, s[20:23], s85 offen lds
  s_add_u32 s47, s85, 9216
  v_mfma_f32_16x16x32_bf16 v[88:91], a[248:251], v[228:231], v[88:91]
  ds_read_b64_tr_b16 a[238:239], v17 offset:20480
  s_add_u32 m0, s74, 62464
  v_mfma_f32_16x16x32_bf16 v[88:91], a[244:247], v[212:215], v[88:91]
  buffer_load_dwordx4 v2, s[20:23], s47 offen lds
  s_add_u32 m0, s74, 69632
  v_mfma_f32_16x16x32_bf16 v[96:99], a[244:247], v[216:219], v[96:99]
  ds_read_b64_tr_b16 a[240:241], v18 offset:20480
  v_mfma_f32_16x16x32_bf16 v[96:99], a[248:251], v[232:235], v[96:99]
  v_mfma_f32_16x16x32_bf16 v[104:107], a[248:251], v[236:239], v[104:107]
  ds_read_b64_tr_b16 a[242:243], v19 offset:20480
  v_mfma_f32_16x16x32_bf16 v[104:107], a[244:247], v[220:223], v[104:107]
  buffer_load_dwordx4 v2, s[20:23], s86 offen lds
  s_waitcnt lgkmcnt(4)
  v_mfma_f32_16x16x32_bf16 v[84:87], a[228:231], v[208:211], v[84:87]
  ds_read_b64_tr_b16 a[244:245], v16 offset:20992
  s_add_u32 s47, s86, 9216
  v_mfma_f32_16x16x32_bf16 v[84:87], a[232:235], v[224:227], v[84:87]
  s_add_u32 m0, s74, 70656
  v_mfma_f32_16x16x32_bf16 v[92:95], a[232:235], v[228:231], v[92:95]
  ds_read_b64_tr_b16 a[246:247], v17 offset:20992
  v_mfma_f32_16x16x32_bf16 v[92:95], a[228:231], v[212:215], v[92:95]
  buffer_load_dwordx4 v2, s[20:23], s47 offen lds
  v_mfma_f32_16x16x32_bf16 v[100:103], a[228:231], v[216:219], v[100:103]
  ds_read_b64_tr_b16 a[248:249], v18 offset:20992
  v_mfma_f32_16x16x32_bf16 v[100:103], a[232:235], v[232:235], v[100:103]
  v_mfma_f32_16x16x32_bf16 v[108:111], a[232:235], v[236:239], v[108:111]
  ds_read_b64_tr_b16 a[250:251], v19 offset:20992
  v_mfma_f32_16x16x32_bf16 v[108:111], a[228:231], v[220:223], v[108:111]
  s_waitcnt lgkmcnt(4)
  v_mfma_f32_16x16x32_bf16 v[48:51], a[236:239], v[240:243], v[48:51]
  ds_read_b64_tr_b16 a[228:229], v16 offset:28672
  s_lshl_b32 s92, s44, 18
  s_add_u32 s92, s92, s93
  buffer_store_dwordx4 a[16:19], v4, s[28:31], s92 offen offset:0 sc1
  v_mfma_f32_16x16x32_bf16 v[52:55], a[240:243], v[240:243], v[52:55]
  v_lshrrev_b32 v26, 2, v1
  v_lshlrev_b32 v26, 11, v26
  v_mfma_f32_16x16x32_bf16 v[56:59], a[236:239], v[244:247], v[56:59]
  ds_read_b64_tr_b16 a[230:231], v17 offset:28672
  v_and_b32 v25, 3, v1
  v_mfma_f32_16x16x32_bf16 v[60:63], a[240:243], v[244:247], v[60:63]
  v_lshl_add_u32 v26, v25, 7, v26
  v_mfma_f32_16x16x32_bf16 v[64:67], a[236:239], v[248:251], v[64:67]
  ds_read_b64_tr_b16 a[232:233], v18 offset:28672
  s_mov_b32 s99, 884736
  buffer_load_dword v25, v26, s[28:31], s99 offen
  v_mfma_f32_16x16x32_bf16 v[68:71], a[240:243], v[248:251], v[68:71]
  v_mfma_f32_16x16x32_bf16 v[72:75], a[236:239], v[252:255], v[72:75]
  ds_read_b64_tr_b16 a[234:235], v19 offset:28672
  v_mfma_f32_16x16x32_bf16 v[76:79], a[240:243], v[252:255], v[76:79]
  s_waitcnt lgkmcnt(4)
  v_mfma_f32_16x16x32_bf16 v[80:83], a[244:247], v[240:243], v[80:83]
  ds_read_b64_tr_b16 a[236:237], v16 offset:29184
  v_mfma_f32_16x16x32_bf16 v[84:87], a[248:251], v[240:243], v[84:87]
  v_cvt_pk_bf16_f32 v48, v48, v49
  v_cvt_pk_bf16_f32 v49, v50, v51
  v_accvgpr_write_b32 a80, v48
  v_mfma_f32_16x16x32_bf16 v[88:91], a[244:247], v[244:247], v[88:91]
  ds_read_b64_tr_b16 a[238:239], v17 offset:29184
  v_accvgpr_write_b32 a81, v49
  v_cvt_pk_bf16_f32 v56, v56, v57
  v_mfma_f32_16x16x32_bf16 v[92:95], a[248:251], v[244:247], v[92:95]
  v_cvt_pk_bf16_f32 v57, v58, v59
  v_accvgpr_write_b32 a84, v56
  v_accvgpr_write_b32 a85, v57
  v_mfma_f32_16x16x32_bf16 v[96:99], a[244:247], v[248:251], v[96:99]
  ds_read_b64_tr_b16 a[240:241], v18 offset:29184
  v_cvt_pk_bf16_f32 v64, v64, v65
  v_cvt_pk_bf16_f32 v65, v66, v67
  v_mfma_f32_16x16x32_bf16 v[100:103], a[248:251], v[248:251], v[100:103]
  v_accvgpr_write_b32 a88, v64
  v_accvgpr_write_b32 a89, v65
  v_cvt_pk_bf16_f32 v72, v72, v73
  v_mfma_f32_16x16x32_bf16 v[104:107], a[244:247], v[252:255], v[104:107]
  ds_read_b64_tr_b16 a[242:243], v19 offset:29184
  v_cvt_pk_bf16_f32 v73, v74, v75
  v_accvgpr_write_b32 a92, v72
  v_mfma_f32_16x16x32_bf16 v[108:111], a[248:251], v[252:255], v[108:111]
  v_accvgpr_write_b32 a93, v73
  v_cvt_pk_bf16_f32 v52, v52, v53
  s_waitcnt lgkmcnt(4)
  s_waitcnt vmcnt(6)
  s_barrier
  v_mfma_f32_16x16x32_bf16 v[48:51], a[228:231], v[112:115], 0
  ds_read_b64_tr_b16 a[244:245], v16 offset:40960
  s_add_u32 m0, s74, 0
  v_cvt_pk_bf16_f32 v53, v54, v55
  v_accvgpr_write_b32 a82, v52
  v_accvgpr_write_b32 a83, v53
  v_cvt_pk_bf16_f32 v60, v60, v61
  v_mfma_f32_16x16x32_bf16 v[52:55], a[232:235], v[112:115], 0
  buffer_load_dwordx4 v2, s[20:23], s87 offen lds
  s_add_u32 s47, s87, 9216
  s_add_u32 m0, s74, 1024
  v_mfma_f32_16x16x32_bf16 v[56:59], a[228:231], v[116:119], 0
  ds_read_b64_tr_b16 a[246:247], v17 offset:40960
  v_cvt_pk_bf16_f32 v61, v62, v63
  v_accvgpr_write_b32 a86, v60
  v_accvgpr_write_b32 a87, v61
  v_cvt_pk_bf16_f32 v68, v68, v69
  v_mfma_f32_16x16x32_bf16 v[60:63], a[232:235], v[116:119], 0
  buffer_load_dwordx4 v2, s[20:23], s47 offen lds
  s_add_u32 m0, s74, 8192
  v_cvt_pk_bf16_f32 v69, v70, v71
  v_mfma_f32_16x16x32_bf16 v[64:67], a[228:231], v[120:123], 0
  ds_read_b64_tr_b16 a[248:249], v16 offset:49152
  v_accvgpr_write_b32 a90, v68
  v_accvgpr_write_b32 a91, v69
  v_cvt_pk_bf16_f32 v76, v76, v77
  v_mfma_f32_16x16x32_bf16 v[68:71], a[232:235], v[120:123], 0
  v_cvt_pk_bf16_f32 v77, v78, v79
  v_accvgpr_write_b32 a94, v76
  v_accvgpr_write_b32 a95, v77
  v_mfma_f32_16x16x32_bf16 v[72:75], a[228:231], v[124:127], 0
  ds_read_b64_tr_b16 a[250:251], v17 offset:49152
  v_cvt_pk_bf16_f32 v80, v80, v81
  v_cvt_pk_bf16_f32 v81, v82, v83
  v_mfma_f32_16x16x32_bf16 v[76:79], a[232:235], v[124:127], 0
  buffer_load_dwordx4 v2, s[20:23], s88 offen lds
  s_add_u32 s47, s88, 9216
  s_waitcnt lgkmcnt(4)
  v_accvgpr_write_b32 a96, v80
  v_accvgpr_write_b32 a97, v81
  v_cvt_pk_bf16_f32 v88, v88, v89
  v_mfma_f32_16x16x32_bf16 v[80:83], a[236:239], v[112:115], 0
  ds_read_b64_tr_b16 a[228:229], v18 offset:40960
  s_add_u32 m0, s74, 9216
  v_cvt_pk_bf16_f32 v89, v90, v91
  v_accvgpr_write_b32 a100, v88
  v_accvgpr_write_b32 a101, v89
  v_cvt_pk_bf16_f32 v96, v96, v97
  v_cvt_pk_bf16_f32 v97, v98, v99
  v_accvgpr_write_b32 a104, v96
  v_accvgpr_write_b32 a105, v97
  v_cvt_pk_bf16_f32 v104, v104, v105
  v_cvt_pk_bf16_f32 v105, v106, v107
  v_accvgpr_write_b32 a108, v104
  v_accvgpr_write_b32 a109, v105
  v_cvt_pk_bf16_f32 v84, v84, v85
  v_cvt_pk_bf16_f32 v85, v86, v87
  v_accvgpr_write_b32 a98, v84
  v_accvgpr_write_b32 a99, v85
  v_cvt_pk_bf16_f32 v92, v92, v93
  v_mfma_f32_16x16x32_bf16 v[84:87], a[240:243], v[112:115], 0
  v_cvt_pk_bf16_f32 v93, v94, v95
  v_accvgpr_write_b32 a102, v92
  v_accvgpr_write_b32 a103, v93
  v_mfma_f32_16x16x32_bf16 v[88:91], a[236:239], v[116:119], 0
  ds_read_b64_tr_b16 a[230:231], v19 offset:40960
  v_cvt_pk_bf16_f32 v100, v100, v101
  v_cvt_pk_bf16_f32 v101, v102, v103
  v_mfma_f32_16x16x32_bf16 v[92:95], a[240:243], v[116:119], 0
  buffer_load_dwordx4 v2, s[20:23], s47 offen lds
  v_accvgpr_write_b32 a106, v100
  v_accvgpr_write_b32 a107, v101
  v_mfma_f32_16x16x32_bf16 v[96:99], a[236:239], v[120:123], 0
  ds_read_b64_tr_b16 a[232:233], v18 offset:49152
  v_cvt_pk_bf16_f32 v108, v108, v109
  v_cvt_pk_bf16_f32 v109, v110, v111
  v_mfma_f32_16x16x32_bf16 v[100:103], a[240:243], v[120:123], 0
  v_accvgpr_write_b32 a110, v108
  v_accvgpr_write_b32 a111, v109
  v_mfma_f32_16x16x32_bf16 v[104:107], a[236:239], v[124:127], 0
  ds_read_b64_tr_b16 a[234:235], v19 offset:49152
  v_mfma_f32_16x16x32_bf16 v[108:111], a[240:243], v[124:127], 0
  s_waitcnt lgkmcnt(4)
  v_mfma_f32_16x16x32_bf16 v[48:51], a[244:247], v[128:131], v[48:51]
  ds_read_b64_tr_b16 a[236:237], v16 offset:41472
  v_mfma_f32_16x16x32_bf16 v[48:51], a[248:251], v[144:147], v[48:51]
  v_mfma_f32_16x16x32_bf16 v[56:59], a[248:251], v[148:151], v[56:59]
  ds_read_b64_tr_b16 a[238:239], v17 offset:41472
  v_mfma_f32_16x16x32_bf16 v[56:59], a[244:247], v[132:135], v[56:59]
  v_mfma_f32_16x16x32_bf16 v[64:67], a[244:247], v[136:139], v[64:67]
  ds_read_b64_tr_b16 a[240:241], v16 offset:49664
  v_mfma_f32_16x16x32_bf16 v[64:67], a[248:251], v[152:155], v[64:67]
  v_mfma_f32_16x16x32_bf16 v[72:75], a[248:251], v[156:159], v[72:75]
  ds_read_b64_tr_b16 a[242:243], v17 offset:49664
  v_mfma_f32_16x16x32_bf16 v[72:75], a[244:247], v[140:143], v[72:75]
  s_waitcnt lgkmcnt(4)
  v_mfma_f32_16x16x32_bf16 v[52:55], a[228:231], v[128:131], v[52:55]
  ds_read_b64_tr_b16 a[244:245], v18 offset:41472
  v_mfma_f32_16x16x32_bf16 v[52:55], a[232:235], v[144:147], v[52:55]
  v_mfma_f32_16x16x32_bf16 v[60:63], a[232:235], v[148:151], v[60:63]
  ds_read_b64_tr_b16 a[246:247], v19 offset:41472
  v_mfma_f32_16x16x32_bf16 v[60:63], a[228:231], v[132:135], v[60:63]
  v_mfma_f32_16x16x32_bf16 v[68:71], a[228:231], v[136:139], v[68:71]
  ds_read_b64_tr_b16 a[248:249], v18 offset:49664
  v_mfma_f32_16x16x32_bf16 v[68:71], a[232:235], v[152:155], v[68:71]
  v_mfma_f32_16x16x32_bf16 v[76:79], a[232:235], v[156:159], v[76:79]
  ds_read_b64_tr_b16 a[250:251], v19 offset:49664
  v_mfma_f32_16x16x32_bf16 v[76:79], a[228:231], v[140:143], v[76:79]
  s_waitcnt lgkmcnt(4)
  s_waitcnt vmcnt(6)
  s_barrier
  v_mfma_f32_16x16x32_bf16 v[80:83], a[236:239], v[128:131], v[80:83]
  ds_read_b64_tr_b16 a[228:229], v20 offset:0
  s_add_u32 m0, s74, 20480
  v_mfma_f32_16x16x32_bf16 v[80:83], a[240:243], v[144:147], v[80:83]
  buffer_load_dwordx4 v2, s[20:23], s89 offen lds
  s_add_u32 s47, s89, 9216
  v_mfma_f32_16x16x32_bf16 v[88:91], a[240:243], v[148:151], v[88:91]
  ds_read_b64_tr_b16 a[230:231], v21 offset:0
  s_add_u32 m0, s74, 21504
  v_mfma_f32_16x16x32_bf16 v[88:91], a[236:239], v[132:135], v[88:91]
  buffer_load_dwordx4 v2, s[20:23], s47 offen lds
  s_add_u32 m0, s74, 28672
  v_mfma_f32_16x16x32_bf16 v[96:99], a[236:239], v[136:139], v[96:99]
  ds_read_b64_tr_b16 a[232:233], v20 offset:8192
  v_mfma_f32_16x16x32_bf16 v[96:99], a[240:243], v[152:155], v[96:99]
  v_mfma_f32_16x16x32_bf16 v[104:107], a[240:243], v[156:159], v[104:107]
  ds_read_b64_tr_b16 a[234:235], v21 offset:8192
  v_mfma_f32_16x16x32_bf16 v[104:107], a[236:239], v[140:143], v[104:107]
  buffer_load_dwordx4 v2, s[20:23], s90 offen lds
  s_waitcnt lgkmcnt(4)
  v_mfma_f32_16x16x32_bf16 v[84:87], a[244:247], v[128:131], v[84:87]
  ds_read_b64_tr_b16 a[236:237], v22 offset:0
  s_add_u32 s47, s90, 9216
  v_mfma_f32_16x16x32_bf16 v[84:87], a[248:251], v[144:147], v[84:87]
  s_add_u32 m0, s74, 29696
  v_mfma_f32_16x16x32_bf16 v[92:95], a[248:251], v[148:151], v[92:95]
  ds_read_b64_tr_b16 a[238:239], v23 offset:0
  v_mfma_f32_16x16x32_bf16 v[92:95], a[244:247], v[132:135], v[92:95]
  buffer_load_dwordx4 v2, s[20:23], s47 offen lds
  v_mfma_f32_16x16x32_bf16 v[100:103], a[244:247], v[136:139], v[100:103]
  ds_read_b64_tr_b16 a[240:241], v22 offset:8192
  v_mfma_f32_16x16x32_bf16 v[100:103], a[248:251], v[152:155], v[100:103]
  v_mfma_f32_16x16x32_bf16 v[108:111], a[248:251], v[156:159], v[108:111]
  ds_read_b64_tr_b16 a[242:243], v23 offset:8192
  v_mfma_f32_16x16x32_bf16 v[108:111], a[244:247], v[140:143], v[108:111]
  s_waitcnt lgkmcnt(4)
  v_mfma_f32_16x16x32_bf16 v[48:51], a[228:231], v[160:163], v[48:51]
  ds_read_b64_tr_b16 a[244:245], v20 offset:512
  buffer_store_dwordx4 a[20:23], v4, s[28:31], s92 offen offset:1024 sc1
  v_mfma_f32_16x16x32_bf16 v[48:51], a[232:235], v[176:179], v[48:51]
  v_mfma_f32_16x16x32_bf16 v[56:59], a[232:235], v[180:183], v[56:59]
  ds_read_b64_tr_b16 a[246:247], v21 offset:512
  v_mfma_f32_16x16x32_bf16 v[56:59], a[228:231], v[164:167], v[56:59]
  v_mfma_f32_16x16x32_bf16 v[64:67], a[228:231], v[168:171], v[64:67]
  ds_read_b64_tr_b16 a[248:249], v20 offset:8704
  v_mfma_f32_16x16x32_bf16 v[64:67], a[232:235], v[184:187], v[64:67]
  v_mfma_f32_16x16x32_bf16 v[72:75], a[232:235], v[188:191], v[72:75]
  ds_read_b64_tr_b16 a[250:251], v21 offset:8704
  v_mfma_f32_16x16x32_bf16 v[72:75], a[228:231], v[172:175], v[72:75]
  s_waitcnt lgkmcnt(4)
  v_mfma_f32_16x16x32_bf16 v[52:55], a[236:239], v[160:163], v[52:55]
  ds_read_b64_tr_b16 a[228:229], v22 offset:512
  v_mfma_f32_16x16x32_bf16 v[52:55], a[240:243], v[176:179], v[52:55]
  v_mfma_f32_16x16x32_bf16 v[60:63], a[240:243], v[180:183], v[60:63]
  ds_read_b64_tr_b16 a[230:231], v23 offset:512
  v_mfma_f32_16x16x32_bf16 v[60:63], a[236:239], v[164:167], v[60:63]
  v_mfma_f32_16x16x32_bf16 v[68:71], a[236:239], v[168:171], v[68:71]
  ds_read_b64_tr_b16 a[232:233], v22 offset:8704
  v_mfma_f32_16x16x32_bf16 v[68:71], a[240:243], v[184:187], v[68:71]
  v_mfma_f32_16x16x32_bf16 v[76:79], a[240:243], v[188:191], v[76:79]
  ds_read_b64_tr_b16 a[234:235], v23 offset:8704
  v_mfma_f32_16x16x32_bf16 v[76:79], a[236:239], v[172:175], v[76:79]
  s_waitcnt lgkmcnt(4)
  s_waitcnt vmcnt(9)
  v_cmp_ne_u32 vcc, s59, v25
  s_nop 0
  s_cmp_eq_u64 vcc, 0
  s_cbranch_scc0 L_B_spin
L_B_ok:
  s_waitcnt vmcnt(5)
  s_barrier
  v_mfma_f32_16x16x32_bf16 v[80:83], a[244:247], v[160:163], v[80:83]
  ds_read_b64_tr_b16 a[236:237], v16 offset:0
  v_mfma_f32_16x16x32_bf16 v[80:83], a[248:251], v[176:179], v[80:83]
  s_add_u32 m0, s94, 40960
  s_add_u32 s47, s101, 0
  buffer_load_dwordx4 v4, s[28:31], s47 offen offset:0 sc1 lds
  buffer_load_dwordx4 v4, s[28:31], s47 offen offset:1024 sc1 lds
  v_mfma_f32_16x16x32_bf16 v[88:91], a[248:251], v[180:183], v[88:91]
  ds_read_b64_tr_b16 a[238:239], v17 offset:0
  v_mfma_f32_16x16x32_bf16 v[88:91], a[244:247], v[164:167], v[88:91]
  s_add_u32 m0, s94, 43008
  s_add_u32 s47, s101, 2048
  buffer_load_dwordx4 v4, s[28:31], s47 offen offset:0 sc1 lds
  buffer_load_dwordx4 v4, s[28:31], s47 offen offset:1024 sc1 lds
  v_mfma_f32_16x16x32_bf16 v[96:99], a[244:247], v[168:171], v[96:99]
  ds_read_b64_tr_b16 a[240:241], v16 offset:8192
  v_mfma_f32_16x16x32_bf16 v[96:99], a[248:251], v[184:187], v[96:99]
  v_mfma_f32_16x16x32_bf16 v[104:107], a[248:251], v[188:191], v[104:107]
  ds_read_b64_tr_b16 a[242:243], v17 offset:8192
  v_mfma_f32_16x16x32_bf16 v[104:107], a[244:247], v[172:175], v[104:107]
  s_add_u32 m0, s94, 45056
  s_add_u32 s47, s101, 4096
  buffer_load_dwordx4 v4, s[28:31], s47 offen offset:0 sc1 lds
  s_waitcnt lgkmcnt(4)
  v_mfma_f32_16x16x32_bf16 v[84:87], a[228:231], v[160:163], v[84:87]
  ds_read_b64_tr_b16 a[244:245], v18 offset:0
  v_mfma_f32_16x16x32_bf16 v[84:87], a[232:235], v[176:179], v[84:87]
  v_mfma_f32_16x16x32_bf16 v[92:95], a[232:235], v[180:183], v[92:95]
  ds_read_b64_tr_b16 a[246:247], v19 offset:0
  v_mfma_f32_16x16x32_bf16 v[92:95], a[228:231], v[164:167], v[92:95]
  v_mfma_f32_16x16x32_bf16 v[100:103], a[228:231], v[168:171], v[100:103]
  ds_read_b64_tr_b16 a[248:249], v18 offset:8192
  v_mfma_f32_16x16x32_bf16 v[100:103], a[232:235], v[184:187], v[100:103]
  v_mfma_f32_16x16x32_bf16 v[108:111], a[232:235], v[188:191], v[108:111]
  ds_read_b64_tr_b16 a[250:251], v19 offset:8192
  v_mfma_f32_16x16x32_bf16 v[108:111], a[228:231], v[172:175], v[108:111]
  s_waitcnt lgkmcnt(4)
  v_mfma_f32_16x16x32_bf16 v[48:51], a[236:239], v[192:195], v[48:51]
  ds_read_b64_tr_b16 a[228:229], v16 offset:512
  v_mfma_f32_16x16x32_bf16 v[48:51], a[240:243], v[208:211], v[48:51]
  v_mfma_f32_16x16x32_bf16 v[56:59], a[240:243], v[212:215], v[56:59]
  ds_read_b64_tr_b16 a[230:231], v17 offset:512
  v_mfma_f32_16x16x32_bf16 v[56:59], a[236:239], v[196:199], v[56:59]
  v_mfma_f32_16x16x32_bf16 v[64:67], a[236:239], v[200:203], v[64:67]
  ds_read_b64_tr_b16 a[232:233], v16 offset:8704
  v_mfma_f32_16x16x32_bf16 v[64:67], a[240:243], v[216:219], v[64:67]
  v_mfma_f32_16x16x32_bf16 v[72:75], a[240:243], v[220:223], v[72:75]
  ds_read_b64_tr_b16 a[234:235], v17 offset:8704
  v_mfma_f32_16x16x32_bf16 v[72:75], a[236:239], v[204:207], v[72:75]
  s_waitcnt lgkmcnt(4)
  v_mfma_f32_16x16x32_bf16 v[52:55], a[244:247], v[192:195], v[52:55]
  ds_read_b64_tr_b16 a[236:237], v18 offset:512
  v_mfma_f32_16x16x32_bf16 v[52:55], a[248:251], v[208:211], v[52:55]
  v_mfma_f32_16x16x32_bf16 v[60:63], a[248:251], v[212:215], v[60:63]
  ds_read_b64_tr_b16 a[238:239], v19 offset:512
  v_mfma_f32_16x16x32_bf16 v[60:63], a[244:247], v[196:199], v[60:63]
  v_mfma_f32_16x16x32_bf16 v[68:71], a[244:247], v[200:203], v[68:71]
  ds_read_b64_tr_b16 a[240:241], v18 offset:8704
  v_mfma_f32_16x16x32_bf16 v[68:71], a[248:251], v[216:219], v[68:71]
  v_mfma_f32_16x16x32_bf16 v[76:79], a[248:251], v[220:223], v[76:79]
  ds_read_b64_tr_b16 a[242:243], v19 offset:8704
  v_mfma_f32_16x16x32_bf16 v[76:79], a[244:247], v[204:207], v[76:79]
  s_waitcnt lgkmcnt(4)
  s_waitcnt vmcnt(6)
  s_barrier
  v_mfma_f32_16x16x32_bf16 v[80:83], a[228:231], v[192:195], v[80:83]
  ds_read_b64_tr_b16 a[244:245], v16 offset:20480
  v_mfma_f32_16x16x32_bf16 v[80:83], a[232:235], v[208:211], v[80:83]
  s_add_u32 m0, s94, 61440
  s_add_u32 s47, s101, 20480
  buffer_load_dwordx4 v4, s[28:31], s47 offen offset:0 sc1 lds
  buffer_load_dwordx4 v4, s[28:31], s47 offen offset:1024 sc1 lds
  v_mfma_f32_16x16x32_bf16 v[88:91], a[232:235], v[212:215], v[88:91]
  ds_read_b64_tr_b16 a[246:247], v17 offset:20480
  v_mfma_f32_16x16x32_bf16 v[88:91], a[228:231], v[196:199], v[88:91]
  s_add_u32 m0, s94, 63488
  s_add_u32 s47, s101, 22528
  buffer_load_dwordx4 v4, s[28:31], s47 offen offset:0 sc1 lds
  buffer_load_dwordx4 v4, s[28:31], s47 offen offset:1024 sc1 lds
  v_mfma_f32_16x16x32_bf16 v[96:99], a[228:231], v[200:203], v[96:99]
  ds_read_b64_tr_b16 a[248:249], v16 offset:28672
  v_mfma_f32_16x16x32_bf16 v[96:99], a[232:235], v[216:219], v[96:99]
  v_mfma_f32_16x16x32_bf16 v[104:107], a[232:235], v[220:223], v[104:107]
  ds_read_b64_tr_b16 a[250:251], v17 offset:28672
  v_mfma_f32_16x16x32_bf16 v[104:107], a[228:231], v[204:207], v[104:107]
  s_add_u32 m0, s94, 65536
  s_add_u32 s47, s101, 24576
  buffer_load_dwordx4 v4, s[28:31], s47 offen offset:0 sc1 lds
  s_waitcnt lgkmcnt(4)
  v_mfma_f32_16x16x32_bf16 v[84:87], a[236:239], v[192:195], v[84:87]
  ds_read_b64_tr_b16 a[228:229], v18 offset:20480
  v_mfma_f32_16x16x32_bf16 v[84:87], a[240:243], v[208:211], v[84:87]
  v_mfma_f32_16x16x32_bf16 v[92:95], a[240:243], v[212:215], v[92:95]
  ds_read_b64_tr_b16 a[230:231], v19 offset:20480
  v_mfma_f32_16x16x32_bf16 v[92:95], a[236:239], v[196:199], v[92:95]
  v_mfma_f32_16x16x32_bf16 v[100:103], a[236:239], v[200:203], v[100:103]
  ds_read_b64_tr_b16 a[232:233], v18 offset:28672
  v_mfma_f32_16x16x32_bf16 v[100:103], a[240:243], v[216:219], v[100:103]
  v_mfma_f32_16x16x32_bf16 v[108:111], a[240:243], v[220:223], v[108:111]
  ds_read_b64_tr_b16 a[234:235], v19 offset:28672
  v_mfma_f32_16x16x32_bf16 v[108:111], a[236:239], v[204:207], v[108:111]
  s_waitcnt lgkmcnt(4)
  v_mfma_f32_16x16x32_bf16 v[48:51], a[244:247], v[224:227], v[48:51]
  ds_read_b64_tr_b16 a[236:237], v16 offset:20992
  buffer_store_dwordx4 a[24:27], v4, s[28:31], s92 offen offset:2048 sc1
  v_mfma_f32_16x16x32_bf16 v[48:51], a[248:251], v[240:243], v[48:51]
  v_mov_b32 v112, 0
  v_mov_b32 v113, 0
  v_mfma_f32_16x16x32_bf16 v[56:59], a[248:251], v[244:247], v[56:59]
  ds_read_b64_tr_b16 a[238:239], v17 offset:20992
  v_mov_b32 v114, 0
  v_mfma_f32_16x16x32_bf16 v[56:59], a[244:247], v[228:231], v[56:59]
  v_mov_b32 v115, 0
  v_mov_b32 v116, 0
  v_mfma_f32_16x16x32_bf16 v[64:67], a[244:247], v[232:235], v[64:67]
  ds_read_b64_tr_b16 a[240:241], v16 offset:29184
  v_mov_b32 v117, 0
  v_mfma_f32_16x16x32_bf16 v[64:67], a[248:251], v[248:251], v[64:67]
  v_mov_b32 v118, 0
  v_mov_b32 v119, 0
  v_mfma_f32_16x16x32_bf16 v[72:75], a[248:251], v[252:255], v[72:75]
  ds_read_b64_tr_b16 a[242:243], v17 offset:29184
  v_mov_b32 v120, 0
  v_mfma_f32_16x16x32_bf16 v[72:75], a[244:247], v[236:239], v[72:75]
  v_mov_b32 v121, 0
  s_waitcnt lgkmcnt(4)
  v_mfma_f32_16x16x32_bf16 v[52:55], a[228:231], v[224:227], v[52:55]
  ds_read_b64_tr_b16 a[244:245], v18 offset:20992
  v_mov_b32 v122, 0
  v_mfma_f32_16x16x32_bf16 v[52:55], a[232:235], v[240:243], v[52:55]
  v_cvt_pk_bf16_f32 v48, v48, v49
  v_cvt_pk_bf16_f32 v49, v50, v51
  v_accvgpr_write_b32 a112, v48
  v_mfma_f32_16x16x32_bf16 v[60:63], a[232:235], v[244:247], v[60:63]
  ds_read_b64_tr_b16 a[246:247], v19 offset:20992
  v_accvgpr_write_b32 a113, v49
  v_cvt_pk_bf16_f32 v56, v56, v57
  v_mfma_f32_16x16x32_bf16 v[60:63], a[228:231], v[228:231], v[60:63]
  v_cvt_pk_bf16_f32 v57, v58, v59
  v_accvgpr_write_b32 a116, v56
  v_accvgpr_write_b32 a117, v57
  v_mfma_f32_16x16x32_bf16 v[68:71], a[228:231], v[232:235], v[68:71]
  ds_read_b64_tr_b16 a[248:249], v18 offset:29184
  v_cvt_pk_bf16_f32 v64, v64, v65
  v_cvt_pk_bf16_f32 v65, v66, v67
  v_mfma_f32_16x16x32_bf16 v[68:71], a[232:235], v[248:251], v[68:71]
  v_accvgpr_write_b32 a120, v64
  v_accvgpr_write_b32 a121, v65
  v_cvt_pk_bf16_f32 v72, v72, v73
  v_mfma_f32_16x16x32_bf16 v[76:79], a[232:235], v[252:255], v[76:79]
  ds_read_b64_tr_b16 a[250:251], v19 offset:29184
  v_cvt_pk_bf16_f32 v73, v74, v75
  v_accvgpr_write_b32 a124, v72
  v_mfma_f32_16x16x32_bf16 v[76:79], a[228:231], v[236:239], v[76:79]
  v_accvgpr_write_b32 a125, v73
  v_mov_b32 v123, 0
  s_waitcnt lgkmcnt(4)
  s_waitcnt vmcnt(6)
  s_barrier
  v_mfma_f32_16x16x32_bf16 v[80:83], a[236:239], v[224:227], v[80:83]
  ds_read_b128 a[188:191], v9 offset:40960
  v_mov_b32 v124, 0
  v_mfma_f32_16x16x32_bf16 v[80:83], a[240:243], v[240:243], v[80:83]
  ds_read_b128 a[180:183], v4 offset:40960
  v_cvt_pk_bf16_f32 v52, v52, v53
  v_cvt_pk_bf16_f32 v53, v54, v55
  v_mfma_f32_16x16x32_bf16 v[88:91], a[240:243], v[244:247], v[88:91]
  ds_read_b128 a[184:187], v4 offset:41984
  v_accvgpr_write_b32 a114, v52
  v_accvgpr_write_b32 a115, v53
  v_mfma_f32_16x16x32_bf16 v[88:91], a[236:239], v[228:231], v[88:91]
  ds_read_b128 a[212:215], v11 offset:40960
  v_cvt_pk_bf16_f32 v60, v60, v61
  v_cvt_pk_bf16_f32 v61, v62, v63
  v_mfma_f32_16x16x32_bf16 v[96:99], a[236:239], v[232:235], v[96:99]
  ds_read_b128 a[216:219], v11 offset:41600
  v_accvgpr_write_b32 a118, v60
  v_accvgpr_write_b32 a119, v61
  v_mfma_f32_16x16x32_bf16 v[96:99], a[240:243], v[248:251], v[96:99]
  s_add_u32 m0, s94, 0
  s_add_u32 s47, s101, 40960
  buffer_load_dwordx4 v4, s[28:31], s47 offen offset:0 sc1 lds
  buffer_load_dwordx4 v4, s[28:31], s47 offen offset:1024 sc1 lds
  v_cvt_pk_bf16_f32 v68, v68, v69
  v_cvt_pk_bf16_f32 v69, v70, v71
  v_mfma_f32_16x16x32_bf16 v[104:107], a[240:243], v[252:255], v[104:107]
  s_add_u32 m0, s94, 2048
  s_add_u32 s47, s101, 43008
  buffer_load_dwordx4 v4, s[28:31], s47 offen offset:0 sc1 lds
  buffer_load_dwordx4 v4, s[28:31], s47 offen offset:1024 sc1 lds
  v_accvgpr_write_b32 a122, v68
  v_accvgpr_write_b32 a123, v69
  v_mfma_f32_16x16x32_bf16 v[104:107], a[236:239], v[236:239], v[104:107]
  v_cvt_pk_bf16_f32 v76, v76, v77
  v_cvt_pk_bf16_f32 v77, v78, v79
  s_waitcnt lgkmcnt(5)
  v_mfma_f32_16x16x32_bf16 v[84:87], a[244:247], v[224:227], v[84:87]
  v_accvgpr_write_b32 a126, v76
  v_accvgpr_write_b32 a127, v77
  v_mov_b32 v125, 0
  v_mfma_f32_16x16x32_bf16 v[84:87], a[248:251], v[240:243], v[84:87]
  v_cvt_pk_bf16_f32 v80, v80, v81
  v_cvt_pk_bf16_f32 v81, v82, v83
  v_accvgpr_write_b32 a128, v80
  v_mfma_f32_16x16x32_bf16 v[92:95], a[248:251], v[244:247], v[92:95]
  s_add_u32 m0, s94, 4096
  s_add_u32 s47, s101, 45056
  buffer_load_dwordx4 v4, s[28:31], s47 offen offset:0 sc1 lds
  v_accvgpr_write_b32 a129, v81
  v_cvt_pk_bf16_f32 v88, v88, v89
  v_mfma_f32_16x16x32_bf16 v[92:95], a[244:247], v[228:231], v[92:95]
  v_cvt_pk_bf16_f32 v89, v90, v91
  v_accvgpr_write_b32 a132, v88
  v_accvgpr_write_b32 a133, v89
  v_mfma_f32_16x16x32_bf16 v[100:103], a[244:247], v[232:235], v[100:103]
  v_cvt_pk_bf16_f32 v96, v96, v97
  v_cvt_pk_bf16_f32 v97, v98, v99
  v_accvgpr_write_b32 a136, v96
  v_mfma_f32_16x16x32_bf16 v[100:103], a[248:251], v[248:251], v[100:103]
  v_accvgpr_write_b32 a137, v97
  v_cvt_pk_bf16_f32 v104, v104, v105
  v_cvt_pk_bf16_f32 v105, v106, v107
  v_mfma_f32_16x16x32_bf16 v[108:111], a[248:251], v[252:255], v[108:111]
  v_accvgpr_write_b32 a140, v104
  v_accvgpr_write_b32 a141, v105
  v_mov_b32 v126, 0
  v_mfma_f32_16x16x32_bf16 v[108:111], a[244:247], v[236:239], v[108:111]
  v_mov_b32 v127, 0
  v_mov_b32 v128, 0
  s_waitcnt lgkmcnt(4)
  v_mfma_f32_32x32x4_2b_bf16 v[48:79], a[188:189], v[44:45], 0
  v_cvt_pk_bf16_f32 v84, v84, v85
  v_cvt_pk_bf16_f32 v85, v86, v87
  v_accvgpr_write_b32 a130, v84
  v_accvgpr_write_b32 a131, v85
  v_cvt_pk_bf16_f32 v92, v92, v93
  v_cvt_pk_bf16_f32 v93, v94, v95
  v_accvgpr_write_b32 a134, v92
  v_accvgpr_write_b32 a135, v93
  v_cvt_pk_bf16_f32 v100, v100, v101
L_pg11:
  s_cbranch_execz L_wr0
  v_cvt_pk_bf16_f32 v101, v102, v103
  v_accvgpr_write_b32 a138, v100
  v_accvgpr_write_b32 a139, v101
  v_cvt_pk_bf16_f32 v108, v108, v109
  v_cvt_pk_bf16_f32 v109, v110, v111
  v_accvgpr_write_b32 a142, v108
  v_accvgpr_write_b32 a143, v109
  v_mov_b32 v129, 0
  v_mov_b32 v130, 0
  v_mov_b32 v131, 0
  v_mov_b32 v132, 0
  v_mov_b32 v133, 0
  v_mov_b32 v134, 0
  v_mov_b32 v135, 0
  v_mov_b32 v136, 0
  v_mov_b32 v137, 0
  v_mov_b32 v138, 0
  v_mov_b32 v139, 0
  v_mov_b32 v140, 0
  v_mov_b32 v141, 0
  v_mov_b32 v142, 0
  v_mov_b32 v143, 0
  s_waitcnt lgkmcnt(3)
  v_mfma_f32_32x32x16_bf16 v[48:63], a[180:183], v[36:39], v[48:63]
  v_mfma_f32_32x32x16_bf16 v[64:79], a[180:183], v[40:43], v[64:79]
  v_add_u32 v168, 0, v24
  v_add_u32 v169, 8192, v24
  v_add_u32 v170, 16384, v24
  v_add_u32 v171, 24576, v24
  v_add_u32 v172, s63, v13
  v_add_u32 v173, s63, v15
  s_waitcnt lgkmcnt(0)
  s_nop 3
  v_exp_f32 v48, v48
  v_exp_f32 v49, v49
  s_waitcnt lgkmcnt(0)
  ds_read_b128 a[192:195], v9 offset:41472
  v_exp_f32 v50, v50
  v_exp_f32 v51, v51
  v_exp_f32 v52, v52
  v_mfma_f32_32x32x4_2b_bf16 v[80:111], a[190:191], v[44:45], 0
  ds_read_b128 a[180:183], v4 offset:43008
  v_exp_f32 v53, v53
  v_exp_f32 v54, v54
  v_exp_f32 v55, v55
  v_exp_f32 v56, v56
  v_exp_f32 v57, v57
  v_exp_f32 v58, v58
  v_exp_f32 v59, v59
  v_smfmac_f32_32x32x32_bf16 v[112:127], a[212:215], v[48:55], v14
  ds_read_b128 a[220:223], v11 offset:42240
  ds_read_b128 a[224:227], v11 offset:42880
  v_exp_f32 v60, v60
  v_exp_f32 v61, v61
  v_exp_f32 v62, v62
  v_exp_f32 v63, v63
  v_exp_f32 v64, v64
  v_exp_f32 v65, v65
  v_smfmac_f32_32x32x32_bf16 v[112:127], a[216:219], v[56:63], v14
  buffer_store_dwordx4 a[28:31], v4, s[28:31], s92 offen offset:3072 sc1
  v_exp_f32 v66, v66
  v_exp_f32 v67, v67
  v_exp_f32 v68, v68
  v_mfma_f32_32x32x16_bf16 v[80:95], a[184:187], v[36:39], v[80:95]
  v_exp_f32 v69, v69
  v_exp_f32 v70, v70
  v_exp_f32 v71, v71
  v_mfma_f32_32x32x16_bf16 v[96:111], a[184:187], v[40:43], v[96:111]
  v_exp_f32 v72, v72
  v_exp_f32 v73, v73
  v_exp_f32 v74, v74
  v_smfmac_f32_32x32x32_bf16 v[128:143], a[212:215], v[64:71], v14
  v_exp_f32 v75, v75
  v_exp_f32 v76, v76
  v_exp_f32 v77, v77
  v_exp_f32 v78, v78
  v_exp_f32 v79, v79
  v_exp_f32 v80, v80
  v_exp_f32 v81, v81
  v_smfmac_f32_32x32x32_bf16 v[128:143], a[216:219], v[72:79], v14
  s_waitcnt lgkmcnt(0)
  ds_read_b128 a[184:187], v4 offset:44032
  v_exp_f32 v82, v82
  v_exp_f32 v83, v83
  v_exp_f32 v84, v84
  v_mfma_f32_32x32x4_2b_bf16 v[48:79], a[192:193], v[44:45], 0
  ds_read_b128 a[212:215], v11 offset:43520
  v_exp_f32 v85, v85
  v_exp_f32 v86, v86
  v_exp_f32 v87, v87
  v_exp_f32 v88, v88
  v_exp_f32 v89, v89
  v_exp_f32 v90, v90
  v_exp_f32 v91, v91
  v_smfmac_f32_32x32x32_bf16 v[112:127], a[220:223], v[80:87], v14
  ds_read_b128 a[216:219], v11 offset:44160
  s_add_u32 s92, s92, 131072
  buffer_store_dwordx4 a[32:35], v4, s[28:31], s92 offen offset:0 sc1
  v_exp_f32 v92, v92
  v_exp_f32 v93, v93
  v_exp_f32 v94, v94
  v_exp_f32 v95, v95
  v_exp_f32 v96, v96
  v_exp_f32 v97, v97
  v_smfmac_f32_32x32x32_bf16 v[112:127], a[224:227], v[88:95], v14
  v_exp_f32 v98, v98
  v_exp_f32 v99, v99
  v_exp_f32 v100, v100
  v_mfma_f32_32x32x16_bf16 v[48:63], a[180:183], v[36:39], v[48:63]
  v_exp_f32 v101, v101
  v_exp_f32 v102, v102
  v_exp_f32 v103, v103
  v_mfma_f32_32x32x16_bf16 v[64:79], a[180:183], v[40:43], v[64:79]
  v_exp_f32 v104, v104
  v_exp_f32 v105, v105
  v_exp_f32 v106, v106
  v_smfmac_f32_32x32x32_bf16 v[128:143], a[220:223], v[96:103], v14
  v_exp_f32 v107, v107
  v_exp_f32 v108, v108
  v_exp_f32 v109, v109
  v_exp_f32 v110, v110
  v_exp_f32 v111, v111
  v_exp_f32 v48, v48
  v_exp_f32 v49, v49
  v_smfmac_f32_32x32x32_bf16 v[128:143], a[224:227], v[104:111], v14
  s_waitcnt lgkmcnt(0)
  ds_read_b128 a[188:191], v9 offset:41984
  v_exp_f32 v50, v50
  v_exp_f32 v51, v51
  v_exp_f32 v52, v52
  v_mfma_f32_32x32x4_2b_bf16 v[80:111], a[194:195], v[44:45], 0
  ds_read_b128 a[180:183], v4 offset:45056
  v_exp_f32 v53, v53
  v_exp_f32 v54, v54
  v_exp_f32 v55, v55
  v_exp_f32 v56, v56
  v_exp_f32 v57, v57
  v_exp_f32 v58, v58
  v_exp_f32 v59, v59
  v_smfmac_f32_32x32x32_bf16 v[112:127], a[212:215], v[48:55], v14
  ds_read_b128 a[220:223], v11 offset:44800
  ds_read_b128 a[224:227], v11 offset:45440
  v_exp_f32 v60, v60
  v_exp_f32 v61, v61
  v_exp_f32 v62, v62
  v_exp_f32 v63, v63
  v_exp_f32 v64, v64
  v_exp_f32 v65, v65
  v_smfmac_f32_32x32x32_bf16 v[112:127], a[216:219], v[56:63], v14
  buffer_store_dwordx4 a[36:39], v4, s[28:31], s92 offen offset:1024 sc1
  v_exp_f32 v66, v66
  v_exp_f32 v67, v67
  v_exp_f32 v68, v68
  v_mfma_f32_32x32x16_bf16 v[80:95], a[184:187], v[36:39], v[80:95]
  v_exp_f32 v69, v69
  v_exp_f32 v70, v70
  v_exp_f32 v71, v71
  v_mfma_f32_32x32x16_bf16 v[96:111], a[184:187], v[40:43], v[96:111]
  v_exp_f32 v72, v72
  v_exp_f32 v73, v73
  v_exp_f32 v74, v74
  v_smfmac_f32_32x32x32_bf16 v[128:143], a[212:215], v[64:71], v14
  v_exp_f32 v75, v75
  v_exp_f32 v76, v76
  v_exp_f32 v77, v77
  v_exp_f32 v78, v78
  v_exp_f32 v79, v79
  v_exp_f32 v80, v80
  v_exp_f32 v81, v81
  v_smfmac_f32_32x32x32_bf16 v[128:143], a[216:219], v[72:79], v14
  s_waitcnt lgkmcnt(0)
  ds_read_b128 a[184:187], v4 offset:46080
  v_exp_f32 v82, v82
  v_exp_f32 v83, v83
  v_exp_f32 v84, v84
  v_mfma_f32_32x32x4_2b_bf16 v[48:79], a[188:189], v[44:45], 0
  ds_read_b128 a[212:215], v11 offset:46080
  v_exp_f32 v85, v85
  v_exp_f32 v86, v86
  v_exp_f32 v87, v87
  v_exp_f32 v88, v88
  v_exp_f32 v89, v89
  v_exp_f32 v90, v90
  v_exp_f32 v91, v91
  v_smfmac_f32_32x32x32_bf16 v[112:127], a[220:223], v[80:87], v14
  ds_read_b128 a[216:219], v11 offset:46720
  buffer_store_dwordx4 a[40:43], v4, s[28:31], s92 offen offset:2048 sc1
  v_exp_f32 v92, v92
  v_exp_f32 v93, v93
  v_exp_f32 v94, v94
  v_exp_f32 v95, v95
  v_exp_f32 v96, v96
  v_exp_f32 v97, v97
  v_smfmac_f32_32x32x32_bf16 v[112:127], a[224:227], v[88:95], v14
  v_exp_f32 v98, v98
  v_exp_f32 v99, v99
  v_exp_f32 v100, v100
  v_mfma_f32_32x32x16_bf16 v[48:63], a[180:183], v[36:39], v[48:63]
  v_exp_f32 v101, v101
  v_exp_f32 v102, v102
  v_exp_f32 v103, v103
  v_mfma_f32_32x32x16_bf16 v[64:79], a[180:183], v[40:43], v[64:79]
  v_exp_f32 v104, v104
  v_exp_f32 v105, v105
  v_exp_f32 v106, v106
  v_smfmac_f32_32x32x32_bf16 v[128:143], a[220:223], v[96:103], v14
  v_exp_f32 v107, v107
  v_exp_f32 v108, v108
  v_exp_f32 v109, v109
  v_exp_f32 v110, v110
  v_exp_f32 v111, v111
  v_exp_f32 v48, v48
  v_exp_f32 v49, v49
  v_smfmac_f32_32x32x32_bf16 v[128:143], a[224:227], v[104:111], v14
  s_waitcnt lgkmcnt(0)
  ds_read_b128 a[192:195], v9 offset:42496
  v_exp_f32 v50, v50
  v_exp_f32 v51, v51
  v_exp_f32 v52, v52
  v_mfma_f32_32x32x4_2b_bf16 v[80:111], a[190:191], v[44:45], 0
  ds_read_b128 a[180:183], v4 offset:47104
  v_exp_f32 v53, v53
  v_exp_f32 v54, v54
  v_exp_f32 v55, v55
  v_exp_f32 v56, v56
  v_exp_f32 v57, v57
  v_exp_f32 v58, v58
  v_exp_f32 v59, v59
  v_smfmac_f32_32x32x32_bf16 v[112:127], a[212:215], v[48:55], v14
  ds_read_b128 a[220:223], v11 offset:47360
  ds_read_b128 a[224:227], v11 offset:48000
  v_exp_f32 v60, v60
  v_exp_f32 v61, v61
  v_exp_f32 v62, v62
  v_exp_f32 v63, v63
  v_exp_f32 v64, v64
  v_exp_f32 v65, v65
  v_smfmac_f32_32x32x32_bf16 v[112:127], a[216:219], v[56:63], v14
  buffer_store_dwordx4 a[44:47], v4, s[28:31], s92 offen offset:3072 sc1
  s_add_u32 s44, s44, 1
  s_and_b32 s44, s44, 3
  v_exp_f32 v66, v66
  v_exp_f32 v67, v67
  v_exp_f32 v68, v68
  v_mfma_f32_32x32x16_bf16 v[80:95], a[184:187], v[36:39], v[80:95]
  v_exp_f32 v69, v69
  v_exp_f32 v70, v70
  v_exp_f32 v71, v71
  v_mfma_f32_32x32x16_bf16 v[96:111], a[184:187], v[40:43], v[96:111]
  v_exp_f32 v72, v72
  v_exp_f32 v73, v73
  v_exp_f32 v74, v74
  v_smfmac_f32_32x32x32_bf16 v[128:143], a[212:215], v[64:71], v14
  v_exp_f32 v75, v75
  v_exp_f32 v76, v76
  v_exp_f32 v77, v77
  v_exp_f32 v78, v78
  v_exp_f32 v79, v79
  v_exp_f32 v80, v80
  v_exp_f32 v81, v81
  v_smfmac_f32_32x32x32_bf16 v[128:143], a[216:219], v[72:79], v14
  s_waitcnt lgkmcnt(0)
  ds_read_b128 a[184:187], v4 offset:48128
  v_exp_f32 v82, v82
  v_exp_f32 v83, v83
  v_exp_f32 v84, v84
  v_mfma_f32_32x32x4_2b_bf16 v[48:79], a[192:193], v[44:45], 0
  ds_read_b128 a[212:215], v11 offset:48640
  v_exp_f32 v85, v85
  v_exp_f32 v86, v86
  v_exp_f32 v87, v87
  v_exp_f32 v88, v88
  v_exp_f32 v89, v89
  v_exp_f32 v90, v90
  v_exp_f32 v91, v91
  v_smfmac_f32_32x32x32_bf16 v[112:127], a[220:223], v[80:87], v14
  ds_read_b128 a[216:219], v11 offset:49280
  s_lshl_b32 s92, s44, 18
  s_add_u32 s92, s92, s93
  buffer_store_dwordx4 a[48:51], v4, s[28:31], s92 offen offset:0 sc1
  v_exp_f32 v92, v92
  v_exp_f32 v93, v93
  v_exp_f32 v94, v94
  v_exp_f32 v95, v95
  v_exp_f32 v96, v96
  v_exp_f32 v97, v97
  v_smfmac_f32_32x32x32_bf16 v[112:127], a[224:227], v[88:95], v14
  buffer_store_dwordx4 a[52:55], v4, s[28:31], s92 offen offset:1024 sc1
  v_exp_f32 v98, v98
  v_exp_f32 v99, v99
  v_exp_f32 v100, v100
  v_mfma_f32_32x32x16_bf16 v[48:63], a[180:183], v[36:39], v[48:63]
  v_exp_f32 v101, v101
  v_exp_f32 v102, v102
  v_exp_f32 v103, v103
  v_mfma_f32_32x32x16_bf16 v[64:79], a[180:183], v[40:43], v[64:79]
  v_exp_f32 v104, v104
  v_exp_f32 v105, v105
  v_exp_f32 v106, v106
  v_smfmac_f32_32x32x32_bf16 v[128:143], a[220:223], v[96:103], v14
  v_exp_f32 v107, v107
  v_exp_f32 v108, v108
  v_exp_f32 v109, v109
  v_exp_f32 v110, v110
  v_exp_f32 v111, v111
  v_exp_f32 v48, v48
  v_exp_f32 v49, v49
  v_smfmac_f32_32x32x32_bf16 v[128:143], a[224:227], v[104:111], v14
  s_waitcnt lgkmcnt(0)
  s_waitcnt vmcnt(13)
  s_barrier
  ds_read_b128 a[188:191], v10 offset:0
  v_exp_f32 v50, v50
  v_exp_f32 v51, v51
  v_exp_f32 v52, v52
  v_mfma_f32_32x32x4_2b_bf16 v[80:111], a[194:195], v[44:45], 0
  ds_read_b128 a[180:183], v3 offset:0
  v_exp_f32 v53, v53
  v_exp_f32 v54, v54
  v_exp_f32 v55, v55
  v_exp_f32 v56, v56
  v_exp_f32 v57, v57
  v_exp_f32 v58, v58
  v_exp_f32 v59, v59
  v_smfmac_f32_32x32x32_bf16 v[112:127], a[212:215], v[48:55], v14
  ds_read_b128 a[220:223], v11 offset:49920
  ds_read_b128 a[224:227], v11 offset:50560
  v_exp_f32 v60, v60
  v_exp_f32 v61, v61
  v_exp_f32 v62, v62
  v_exp_f32 v63, v63
  v_exp_f32 v64, v64
  v_exp_f32 v65, v65
  v_smfmac_f32_32x32x32_bf16 v[112:127], a[216:219], v[56:63], v14
  buffer_store_dwordx4 a[56:59], v4, s[28:31], s92 offen offset:2048 sc1
  v_exp_f32 v66, v66
  v_exp_f32 v67, v67
  v_exp_f32 v68, v68
  v_mfma_f32_32x32x16_bf16 v[80:95], a[184:187], v[36:39], v[80:95]
  v_exp_f32 v69, v69
  v_exp_f32 v70, v70
  v_exp_f32 v71, v71
  v_mfma_f32_32x32x16_bf16 v[96:111], a[184:187], v[40:43], v[96:111]
  v_exp_f32 v72, v72
  v_exp_f32 v73, v73
  v_exp_f32 v74, v74
  v_smfmac_f32_32x32x32_bf16 v[128:143], a[212:215], v[64:71], v14
  v_exp_f32 v75, v75
  v_exp_f32 v76, v76
  v_exp_f32 v77, v77
  v_exp_f32 v78, v78
  v_exp_f32 v79, v79
  v_exp_f32 v80, v80
  v_exp_f32 v81, v81
  v_smfmac_f32_32x32x32_bf16 v[128:143], a[216:219], v[72:79], v14
  s_waitcnt lgkmcnt(0)
  ds_read_b128 a[184:187], v3 offset:1024
  v_exp_f32 v82, v82
  v_exp_f32 v83, v83
  v_exp_f32 v84, v84
  v_mfma_f32_32x32x4_2b_bf16 v[48:79], a[188:189], v[44:45], 0
  ds_read_b128 a[212:215], v12 offset:0
  v_exp_f32 v85, v85
  v_exp_f32 v86, v86
  v_exp_f32 v87, v87
  v_exp_f32 v88, v88
  v_exp_f32 v89, v89
  v_exp_f32 v90, v90
  v_exp_f32 v91, v91
  v_smfmac_f32_32x32x32_bf16 v[112:127], a[220:223], v[80:87], v14
  ds_read_b128 a[216:219], v12 offset:640
  buffer_store_dwordx4 a[60:63], v4, s[28:31], s92 offen offset:3072 sc1
  v_exp_f32 v92, v92
  v_exp_f32 v93, v93
  v_exp_f32 v94, v94
  v_exp_f32 v95, v95
  v_exp_f32 v96, v96
  v_exp_f32 v97, v97
  v_smfmac_f32_32x32x32_bf16 v[112:127], a[224:227], v[88:95], v14
  s_add_u32 m0, s94, 20480
  s_add_u32 s47, s101, 61440
  buffer_load_dwordx4 v4, s[28:31], s47 offen offset:0 sc1 lds
  buffer_load_dwordx4 v4, s[28:31], s47 offen offset:1024 sc1 lds
  v_exp_f32 v98, v98
  v_exp_f32 v99, v99
  v_exp_f32 v100, v100
  v_mfma_f32_32x32x16_bf16 v[48:63], a[180:183], v[36:39], v[48:63]
  v_exp_f32 v101, v101
  v_exp_f32 v102, v102
  v_exp_f32 v103, v103
  v_mfma_f32_32x32x16_bf16 v[64:79], a[180:183], v[40:43], v[64:79]
  v_exp_f32 v104, v104
  v_exp_f32 v105, v105
  v_exp_f32 v106, v106
  v_smfmac_f32_32x32x32_bf16 v[128:143], a[220:223], v[96:103], v14
  v_exp_f32 v107, v107
  v_exp_f32 v108, v108
  v_exp_f32 v109, v109
  v_exp_f32 v110, v110
  v_exp_f32 v111, v111
  v_exp_f32 v48, v48
  v_exp_f32 v49, v49
  v_smfmac_f32_32x32x32_bf16 v[128:143], a[224:227], v[104:111], v14
  s_waitcnt lgkmcnt(0)
  ds_read_b128 a[192:195], v10 offset:512
  v_exp_f32 v50, v50
  v_exp_f32 v51, v51
  v_exp_f32 v52, v52
  v_mfma_f32_32x32x4_2b_bf16 v[80:111], a[190:191], v[44:45], 0
  ds_read_b128 a[180:183], v3 offset:2048
  v_exp_f32 v53, v53
  v_exp_f32 v54, v54
  v_exp_f32 v55, v55
  v_exp_f32 v56, v56
  v_exp_f32 v57, v57
  v_exp_f32 v58, v58
  v_exp_f32 v59, v59
  v_smfmac_f32_32x32x32_bf16 v[112:127], a[212:215], v[48:55], v14
  ds_read_b128 a[220:223], v12 offset:1280
  ds_read_b128 a[224:227], v12 offset:1920
  v_exp_f32 v60, v60
  v_exp_f32 v61, v61
  v_exp_f32 v62, v62
  v_exp_f32 v63, v63
  v_exp_f32 v64, v64
  v_exp_f32 v65, v65
  v_smfmac_f32_32x32x32_bf16 v[112:127], a[216:219], v[56:63], v14
  s_add_u32 s92, s92, 131072
  buffer_store_dwordx4 a[64:67], v4, s[28:31], s92 offen offset:0 sc1
  s_add_u32 m0, s94, 22528
  s_add_u32 s47, s101, 63488
  buffer_load_dwordx4 v4, s[28:31], s47 offen offset:0 sc1 lds
  buffer_load_dwordx4 v4, s[28:31], s47 offen offset:1024 sc1 lds
  v_exp_f32 v66, v66
  v_exp_f32 v67, v67
  v_exp_f32 v68, v68
  v_mfma_f32_32x32x16_bf16 v[80:95], a[184:187], v[36:39], v[80:95]
  v_exp_f32 v69, v69
  v_exp_f32 v70, v70
  v_exp_f32 v71, v71
  v_mfma_f32_32x32x16_bf16 v[96:111], a[184:187], v[40:43], v[96:111]
  v_exp_f32 v72, v72
  v_exp_f32 v73, v73
  v_exp_f32 v74, v74
  v_smfmac_f32_32x32x32_bf16 v[128:143], a[212:215], v[64:71], v14
  v_exp_f32 v75, v75
  v_exp_f32 v76, v76
  v_exp_f32 v77, v77
  v_exp_f32 v78, v78
  v_exp_f32 v79, v79
  v_exp_f32 v80, v80
  v_exp_f32 v81, v81
  v_smfmac_f32_32x32x32_bf16 v[128:143], a[216:219], v[72:79], v14
  s_waitcnt lgkmcnt(0)
  ds_read_b128 a[184:187], v3 offset:3072
  v_exp_f32 v82, v82
  v_exp_f32 v83, v83
  v_exp_f32 v84, v84
  v_mfma_f32_32x32x4_2b_bf16 v[48:79], a[192:193], v[44:45], 0
  ds_read_b128 a[212:215], v12 offset:2560
  v_exp_f32 v85, v85
  v_exp_f32 v86, v86
  v_exp_f32 v87, v87
  v_exp_f32 v88, v88
  v_exp_f32 v89, v89
  v_exp_f32 v90, v90
  v_exp_f32 v91, v91
  v_smfmac_f32_32x32x32_bf16 v[112:127], a[220:223], v[80:87], v14
  ds_read_b128 a[216:219], v12 offset:3200
  buffer_store_dwordx4 a[68:71], v4, s[28:31], s92 offen offset:1024 sc1
  v_exp_f32 v92, v92
  v_exp_f32 v93, v93
  v_exp_f32 v94, v94
  v_exp_f32 v95, v95
  v_exp_f32 v96, v96
  v_exp_f32 v97, v97
  v_smfmac_f32_32x32x32_bf16 v[112:127], a[224:227], v[88:95], v14
  s_add_u32 m0, s94, 24576
  s_add_u32 s47, s101, 65536
  buffer_load_dwordx4 v4, s[28:31], s47 offen offset:0 sc1 lds
  v_exp_f32 v98, v98
  v_exp_f32 v99, v99
  v_exp_f32 v100, v100
  v_mfma_f32_32x32x16_bf16 v[48:63], a[180:183], v[36:39], v[48:63]
  v_exp_f32 v101, v101
  v_exp_f32 v102, v102
  v_exp_f32 v103, v103
  v_mfma_f32_32x32x16_bf16 v[64:79], a[180:183], v[40:43], v[64:79]
  v_exp_f32 v104, v104
  v_exp_f32 v105, v105
  v_exp_f32 v106, v106
  v_smfmac_f32_32x32x32_bf16 v[128:143], a[220:223], v[96:103], v14
  v_exp_f32 v107, v107
  v_exp_f32 v108, v108
  v_exp_f32 v109, v109
  v_exp_f32 v110, v110
  v_exp_f32 v111, v111
  v_exp_f32 v48, v48
  v_exp_f32 v49, v49
  v_smfmac_f32_32x32x32_bf16 v[128:143], a[224:227], v[104:111], v14
  s_waitcnt lgkmcnt(0)
  ds_read_b128 a[188:191], v10 offset:1024
  v_exp_f32 v50, v50
  v_exp_f32 v51, v51
  v_exp_f32 v52, v52
  v_mfma_f32_32x32x4_2b_bf16 v[80:111], a[194:195], v[44:45], 0
  ds_read_b128 a[180:183], v3 offset:4096
  v_exp_f32 v53, v53
  v_exp_f32 v54, v54
  v_exp_f32 v55, v55
  v_exp_f32 v56, v56
  v_exp_f32 v57, v57
  v_exp_f32 v58, v58
  v_exp_f32 v59, v59
  v_smfmac_f32_32x32x32_bf16 v[112:127], a[212:215], v[48:55], v14
  ds_read_b128 a[220:223], v12 offset:3840
  ds_read_b128 a[224:227], v12 offset:4480
  v_exp_f32 v60, v60
  v_exp_f32 v61, v61
  v_exp_f32 v62, v62
  v_exp_f32 v63, v63
  v_exp_f32 v64, v64
  v_exp_f32 v65, v65
  v_smfmac_f32_32x32x32_bf16 v[112:127], a[216:219], v[56:63], v14
  buffer_store_dwordx4 a[72:75], v4, s[28:31], s92 offen offset:2048 sc1
  buffer_store_dwordx4 a[76:79], v4, s[28:31], s92 offen offset:3072 sc1
  s_add_u32 s44, s44, 1
  s_and_b32 s44, s44, 3
  v_exp_f32 v66, v66
  v_exp_f32 v67, v67
  v_exp_f32 v68, v68
  v_mfma_f32_32x32x16_bf16 v[80:95], a[184:187], v[36:39], v[80:95]
  v_exp_f32 v69, v69
  v_exp_f32 v70, v70
  v_exp_f32 v71, v71
  v_mfma_f32_32x32x16_bf16 v[96:111], a[184:187], v[40:43], v[96:111]
  v_exp_f32 v72, v72
  v_exp_f32 v73, v73
  v_exp_f32 v74, v74
  v_smfmac_f32_32x32x32_bf16 v[128:143], a[212:215], v[64:71], v14
  v_exp_f32 v75, v75
  v_exp_f32 v76, v76
  v_exp_f32 v77, v77
  v_exp_f32 v78, v78
  v_exp_f32 v79, v79
  v_exp_f32 v80, v80
  v_exp_f32 v81, v81
  v_smfmac_f32_32x32x32_bf16 v[128:143], a[216:219], v[72:79], v14
  s_waitcnt lgkmcnt(0)
  ds_read_b128 a[184:187], v3 offset:5120
  v_exp_f32 v82, v82
  v_exp_f32 v83, v83
  v_exp_f32 v84, v84
  v_mfma_f32_32x32x4_2b_bf16 v[48:79], a[188:189], v[44:45], 0
  ds_read_b128 a[212:215], v12 offset:5120
  v_exp_f32 v85, v85
  v_exp_f32 v86, v86
  v_exp_f32 v87, v87
  v_exp_f32 v88, v88
  v_exp_f32 v89, v89
  v_exp_f32 v90, v90
  v_exp_f32 v91, v91
  v_smfmac_f32_32x32x32_bf16 v[112:127], a[220:223], v[80:87], v14
  ds_read_b128 a[216:219], v12 offset:5760
  s_lshl_b32 s92, s44, 18
  s_add_u32 s92, s92, s93
  buffer_store_dwordx4 a[80:83], v4, s[28:31], s92 offen offset:0 sc1
  v_exp_f32 v92, v92
  v_exp_f32 v93, v93
  v_exp_f32 v94, v94
  v_exp_f32 v95, v95
  v_exp_f32 v96, v96
  v_exp_f32 v97, v97
  v_smfmac_f32_32x32x32_bf16 v[112:127], a[224:227], v[88:95], v14
  v_exp_f32 v98, v98
  v_exp_f32 v99, v99
  v_exp_f32 v100, v100
  v_mfma_f32_32x32x16_bf16 v[48:63], a[180:183], v[36:39], v[48:63]
  v_exp_f32 v101, v101
  v_exp_f32 v102, v102
  v_exp_f32 v103, v103
  v_mfma_f32_32x32x16_bf16 v[64:79], a[180:183], v[40:43], v[64:79]
  v_exp_f32 v104, v104
  v_exp_f32 v105, v105
  v_exp_f32 v106, v106
  v_smfmac_f32_32x32x32_bf16 v[128:143], a[220:223], v[96:103], v14
  v_exp_f32 v107, v107
  v_exp_f32 v108, v108
  v_exp_f32 v109, v109
  v_exp_f32 v110, v110
  v_exp_f32 v111, v111
  v_exp_f32 v48, v48
  v_exp_f32 v49, v49
  v_smfmac_f32_32x32x32_bf16 v[128:143], a[224:227], v[104:111], v14
  s_waitcnt lgkmcnt(0)
  ds_read_b128 a[192:195], v10 offset:1536
  v_exp_f32 v50, v50
  v_exp_f32 v51, v51
  v_exp_f32 v52, v52
  v_mfma_f32_32x32x4_2b_bf16 v[80:111], a[190:191], v[44:45], 0
  ds_read_b128 a[180:183], v3 offset:6144
  v_exp_f32 v53, v53
  v_exp_f32 v54, v54
  v_exp_f32 v55, v55
  v_exp_f32 v56, v56
  v_exp_f32 v57, v57
  v_exp_f32 v58, v58
  v_exp_f32 v59, v59
  v_smfmac_f32_32x32x32_bf16 v[112:127], a[212:215], v[48:55], v14
  ds_read_b128 a[220:223], v12 offset:6400
  ds_read_b128 a[224:227], v12 offset:7040
  v_exp_f32 v60, v60
  v_exp_f32 v61, v61
  v_exp_f32 v62, v62
  v_exp_f32 v63, v63
  v_exp_f32 v64, v64
  v_exp_f32 v65, v65
  v_smfmac_f32_32x32x32_bf16 v[112:127], a[216:219], v[56:63], v14
  buffer_store_dwordx4 a[84:87], v4, s[28:31], s92 offen offset:1024 sc1
  v_exp_f32 v66, v66
  v_exp_f32 v67, v67
  v_exp_f32 v68, v68
  v_mfma_f32_32x32x16_bf16 v[80:95], a[184:187], v[36:39], v[80:95]
  v_exp_f32 v69, v69
  v_exp_f32 v70, v70
  v_exp_f32 v71, v71
  v_mfma_f32_32x32x16_bf16 v[96:111], a[184:187], v[40:43], v[96:111]
  v_exp_f32 v72, v72
  v_exp_f32 v73, v73
  v_exp_f32 v74, v74
  v_smfmac_f32_32x32x32_bf16 v[128:143], a[212:215], v[64:71], v14
  v_exp_f32 v75, v75
  v_exp_f32 v76, v76
  v_exp_f32 v77, v77
  v_exp_f32 v78, v78
  v_exp_f32 v79, v79
  v_exp_f32 v80, v80
  v_exp_f32 v81, v81
  v_smfmac_f32_32x32x32_bf16 v[128:143], a[216:219], v[72:79], v14
  s_waitcnt lgkmcnt(0)
  ds_read_b128 a[184:187], v3 offset:7168
  v_exp_f32 v82, v82
  v_exp_f32 v83, v83
  v_exp_f32 v84, v84
  v_mfma_f32_32x32x4_2b_bf16 v[48:79], a[192:193], v[44:45], 0
  ds_read_b128 a[212:215], v12 offset:7680
  v_exp_f32 v85, v85
  v_exp_f32 v86, v86
  v_exp_f32 v87, v87
  v_exp_f32 v88, v88
  v_exp_f32 v89, v89
  v_exp_f32 v90, v90
  v_exp_f32 v91, v91
  v_smfmac_f32_32x32x32_bf16 v[112:127], a[220:223], v[80:87], v14
  ds_read_b128 a[216:219], v12 offset:8320
  buffer_store_dwordx4 a[88:91], v4, s[28:31], s92 offen offset:2048 sc1
  v_exp_f32 v92, v92
  v_exp_f32 v93, v93
  v_exp_f32 v94, v94
  v_exp_f32 v95, v95
  v_exp_f32 v96, v96
  v_exp_f32 v97, v97
  v_smfmac_f32_32x32x32_bf16 v[112:127], a[224:227], v[88:95], v14
  v_exp_f32 v98, v98
  v_exp_f32 v99, v99
  v_exp_f32 v100, v100
  v_mfma_f32_32x32x16_bf16 v[48:63], a[180:183], v[36:39], v[48:63]
  v_exp_f32 v101, v101
  v_exp_f32 v102, v102
  v_exp_f32 v103, v103
  v_mfma_f32_32x32x16_bf16 v[64:79], a[180:183], v[40:43], v[64:79]
  v_exp_f32 v104, v104
  v_exp_f32 v105, v105
  v_exp_f32 v106, v106
  v_smfmac_f32_32x32x32_bf16 v[128:143], a[220:223], v[96:103], v14
  v_exp_f32 v107, v107
  v_exp_f32 v108, v108
  v_exp_f32 v109, v109
  v_exp_f32 v110, v110
  v_exp_f32 v111, v111
  v_exp_f32 v48, v48
  v_exp_f32 v49, v49
  v_smfmac_f32_32x32x32_bf16 v[128:143], a[224:227], v[104:111], v14
  s_waitcnt lgkmcnt(0)
  s_waitcnt vmcnt(21)
  s_barrier
  ds_read_b128 a[188:191], v9 offset:0
  v_exp_f32 v50, v50
  v_exp_f32 v51, v51
  v_exp_f32 v52, v52
  v_mfma_f32_32x32x4_2b_bf16 v[80:111], a[194:195], v[44:45], 0
  ds_read_b128 a[180:183], v4 offset:0
  v_exp_f32 v53, v53
  v_exp_f32 v54, v54
  v_exp_f32 v55, v55
  v_exp_f32 v56, v56
  v_exp_f32 v57, v57
  v_exp_f32 v58, v58
  v_exp_f32 v59, v59
  v_smfmac_f32_32x32x32_bf16 v[112:127], a[212:215], v[48:55], v14
  ds_read_b128 a[220:223], v12 offset:8960
  ds_read_b128 a[224:227], v12 offset:9600
  v_exp_f32 v60, v60
  v_exp_f32 v61, v61
  v_exp_f32 v62, v62
  v_exp_f32 v63, v63
  v_exp_f32 v64, v64
  v_exp_f32 v65, v65
  v_smfmac_f32_32x32x32_bf16 v[112:127], a[216:219], v[56:63], v14
  buffer_store_dwordx4 a[92:95], v4, s[28:31], s92 offen offset:3072 sc1
  v_exp_f32 v66, v66
  v_exp_f32 v67, v67
  v_exp_f32 v68, v68
  v_mfma_f32_32x32x16_bf16 v[80:95], a[184:187], v[36:39], v[80:95]
  v_exp_f32 v69, v69
  v_exp_f32 v70, v70
  v_exp_f32 v71, v71
  v_mfma_f32_32x32x16_bf16 v[96:111], a[184:187], v[40:43], v[96:111]
  v_exp_f32 v72, v72
  v_exp_f32 v73, v73
  v_exp_f32 v74, v74
  v_smfmac_f32_32x32x32_bf16 v[128:143], a[212:215], v[64:71], v14
  v_exp_f32 v75, v75
  v_exp_f32 v76, v76
  v_exp_f32 v77, v77
  v_exp_f32 v78, v78
  v_exp_f32 v79, v79
  v_exp_f32 v80, v80
  v_exp_f32 v81, v81
  v_smfmac_f32_32x32x32_bf16 v[128:143], a[216:219], v[72:79], v14
  s_waitcnt lgkmcnt(0)
  ds_read_b128 a[184:187], v4 offset:1024
  v_exp_f32 v82, v82
  v_exp_f32 v83, v83
  v_exp_f32 v84, v84
  v_mfma_f32_32x32x4_2b_bf16 v[48:79], a[188:189], v[44:45], 0
  ds_read_b128 a[212:215], v11 offset:0
  v_exp_f32 v85, v85
  v_exp_f32 v86, v86
  v_exp_f32 v87, v87
  v_exp_f32 v88, v88
  v_exp_f32 v89, v89
  v_exp_f32 v90, v90
  v_exp_f32 v91, v91
  v_smfmac_f32_32x32x32_bf16 v[112:127], a[220:223], v[80:87], v14
  ds_read_b128 a[216:219], v11 offset:640
  s_add_u32 s92, s92, 131072
  buffer_store_dwordx4 a[96:99], v4, s[28:31], s92 offen offset:0 sc1
  v_exp_f32 v92, v92
  v_exp_f32 v93, v93
  v_exp_f32 v94, v94
  v_exp_f32 v95, v95
  v_exp_f32 v96, v96
  v_exp_f32 v97, v97
  v_smfmac_f32_32x32x32_bf16 v[112:127], a[224:227], v[88:95], v14
  buffer_store_dwordx4 a[100:103], v4, s[28:31], s92 offen offset:1024 sc1
  s_add_u32 m0, s94, 40960
  s_add_u32 s47, s101, 81920
  buffer_load_dwordx4 v4, s[28:31], s47 offen offset:0 sc1 lds
  buffer_load_dwordx4 v4, s[28:31], s47 offen offset:1024 sc1 lds
  v_exp_f32 v98, v98
  v_exp_f32 v99, v99
  v_exp_f32 v100, v100
  v_mfma_f32_32x32x16_bf16 v[48:63], a[180:183], v[36:39], v[48:63]
  v_exp_f32 v101, v101
  v_exp_f32 v102, v102
  v_exp_f32 v103, v103
  v_mfma_f32_32x32x16_bf16 v[64:79], a[180:183], v[40:43], v[64:79]
  v_exp_f32 v104, v104
  v_exp_f32 v105, v105
  v_exp_f32 v106, v106
  v_smfmac_f32_32x32x32_bf16 v[128:143], a[220:223], v[96:103], v14
  v_exp_f32 v107, v107
  v_exp_f32 v108, v108
  v_exp_f32 v109, v109
  v_exp_f32 v110, v110
  v_exp_f32 v111, v111
  v_exp_f32 v48, v48
  v_exp_f32 v49, v49
  v_smfmac_f32_32x32x32_bf16 v[128:143], a[224:227], v[104:111], v14
  s_waitcnt lgkmcnt(0)
  ds_read_b128 a[192:195], v9 offset:512
  v_exp_f32 v50, v50
  v_exp_f32 v51, v51
  v_exp_f32 v52, v52
  v_mfma_f32_32x32x4_2b_bf16 v[80:111], a[190:191], v[44:45], 0
  ds_read_b128 a[180:183], v4 offset:2048
  v_exp_f32 v53, v53
  v_exp_f32 v54, v54
  v_exp_f32 v55, v55
  v_exp_f32 v56, v56
  v_exp_f32 v57, v57
  v_exp_f32 v58, v58
  v_exp_f32 v59, v59
  v_smfmac_f32_32x32x32_bf16 v[112:127], a[212:215], v[48:55], v14
  ds_read_b128 a[220:223], v11 offset:1280
  ds_read_b128 a[224:227], v11 offset:1920
  v_exp_f32 v60, v60
  v_exp_f32 v61, v61
  v_exp_f32 v62, v62
L_pg12:
  s_cbranch_execz L_wr0
  v_exp_f32 v63, v63
  v_exp_f32 v64, v64
  v_exp_f32 v65, v65
  v_smfmac_f32_32x32x32_bf16 v[112:127], a[216:219], v[56:63], v14
  buffer_store_dwordx4 a[104:107], v4, s[28:31], s92 offen offset:2048 sc1
  s_add_u32 m0, s94, 43008
  s_add_u32 s47, s101, 83968
  buffer_load_dwordx4 v4, s[28:31], s47 offen offset:0 sc1 lds
  buffer_load_dwordx4 v4, s[28:31], s47 offen offset:1024 sc1 lds
  v_exp_f32 v66, v66
  v_exp_f32 v67, v67
  v_exp_f32 v68, v68
  v_mfma_f32_32x32x16_bf16 v[80:95], a[184:187], v[36:39], v[80:95]
  v_exp_f32 v69, v69
  v_exp_f32 v70, v70
  v_exp_f32 v71, v71
  v_mfma_f32_32x32x16_bf16 v[96:111], a[184:187], v[40:43], v[96:111]
  v_exp_f32 v72, v72
  v_exp_f32 v73, v73
  v_exp_f32 v74, v74
  v_smfmac_f32_32x32x32_bf16 v[128:143], a[212:215], v[64:71], v14
  v_exp_f32 v75, v75
  v_exp_f32 v76, v76
  v_exp_f32 v77, v77
  v_exp_f32 v78, v78
  v_exp_f32 v79, v79
  v_exp_f32 v80, v80
  v_exp_f32 v81, v81
  v_smfmac_f32_32x32x32_bf16 v[128:143], a[216:219], v[72:79], v14
  s_waitcnt lgkmcnt(0)
  ds_read_b128 a[184:187], v4 offset:3072
  v_exp_f32 v82, v82
  v_exp_f32 v83, v83
  v_exp_f32 v84, v84
  v_mfma_f32_32x32x4_2b_bf16 v[48:79], a[192:193], v[44:45], 0
  ds_read_b128 a[212:215], v11 offset:2560
  v_exp_f32 v85, v85
  v_exp_f32 v86, v86
  v_exp_f32 v87, v87
  v_exp_f32 v88, v88
  v_exp_f32 v89, v89
  v_exp_f32 v90, v90
  v_exp_f32 v91, v91
  v_smfmac_f32_32x32x32_bf16 v[112:127], a[220:223], v[80:87], v14
  ds_read_b128 a[216:219], v11 offset:3200
  buffer_store_dwordx4 a[108:111], v4, s[28:31], s92 offen offset:3072 sc1
  s_add_u32 s44, s44, 1
  s_and_b32 s44, s44, 3
  v_exp_f32 v92, v92
  v_exp_f32 v93, v93
  v_exp_f32 v94, v94
  v_exp_f32 v95, v95
  v_exp_f32 v96, v96
  v_exp_f32 v97, v97
  v_smfmac_f32_32x32x32_bf16 v[112:127], a[224:227], v[88:95], v14
  s_add_u32 m0, s94, 45056
  s_add_u32 s47, s101, 86016
  buffer_load_dwordx4 v4, s[28:31], s47 offen offset:0 sc1 lds
  v_exp_f32 v98, v98
  v_exp_f32 v99, v99
  v_exp_f32 v100, v100
  v_mfma_f32_32x32x16_bf16 v[48:63], a[180:183], v[36:39], v[48:63]
  v_exp_f32 v101, v101
  v_exp_f32 v102, v102
  v_exp_f32 v103, v103
  v_mfma_f32_32x32x16_bf16 v[64:79], a[180:183], v[40:43], v[64:79]
  v_exp_f32 v104, v104
  v_exp_f32 v105, v105
  v_exp_f32 v106, v106
  v_smfmac_f32_32x32x32_bf16 v[128:143], a[220:223], v[96:103], v14
  v_exp_f32 v107, v107
  v_exp_f32 v108, v108
  v_exp_f32 v109, v109
  v_exp_f32 v110, v110
  v_exp_f32 v111, v111
  v_exp_f32 v48, v48
  v_exp_f32 v49, v49
  v_smfmac_f32_32x32x32_bf16 v[128:143], a[224:227], v[104:111], v14
  s_waitcnt lgkmcnt(0)
  ds_read_b128 a[188:191], v9 offset:1024
  v_exp_f32 v50, v50
  v_exp_f32 v51, v51
  v_exp_f32 v52, v52
  v_mfma_f32_32x32x4_2b_bf16 v[80:111], a[194:195], v[44:45], 0
  ds_read_b128 a[180:183], v4 offset:4096
  v_exp_f32 v53, v53
  v_exp_f32 v54, v54
  v_exp_f32 v55, v55
  v_exp_f32 v56, v56
  v_exp_f32 v57, v57
  v_exp_f32 v58, v58
  v_exp_f32 v59, v59
  v_smfmac_f32_32x32x32_bf16 v[112:127], a[212:215], v[48:55], v14
  ds_read_b128 a[220:223], v11 offset:3840
  ds_read_b128 a[224:227], v11 offset:4480
  v_exp_f32 v60, v60
  v_exp_f32 v61, v61
  v_exp_f32 v62, v62
  v_exp_f32 v63, v63
  v_exp_f32 v64, v64
  v_exp_f32 v65, v65
  v_smfmac_f32_32x32x32_bf16 v[112:127], a[216:219], v[56:63], v14
  s_lshl_b32 s92, s44, 18
  s_add_u32 s92, s92, s93
  buffer_store_dwordx4 a[112:115], v4, s[28:31], s92 offen offset:0 sc1
  v_exp_f32 v66, v66
  v_exp_f32 v67, v67
  v_exp_f32 v68, v68
  v_mfma_f32_32x32x16_bf16 v[80:95], a[184:187], v[36:39], v[80:95]
  v_exp_f32 v69, v69
  v_exp_f32 v70, v70
  v_exp_f32 v71, v71
  v_mfma_f32_32x32x16_bf16 v[96:111], a[184:187], v[40:43], v[96:111]
  v_exp_f32 v72, v72
  v_exp_f32 v73, v73
  v_exp_f32 v74, v74
  v_smfmac_f32_32x32x32_bf16 v[128:143], a[212:215], v[64:71], v14
  v_exp_f32 v75, v75
  v_exp_f32 v76, v76
  v_exp_f32 v77, v77
  v_exp_f32 v78, v78
  v_exp_f32 v79, v79
  v_exp_f32 v80, v80
  v_exp_f32 v81, v81
  v_smfmac_f32_32x32x32_bf16 v[128:143], a[216:219], v[72:79], v14
  s_waitcnt lgkmcnt(0)
  ds_read_b128 a[184:187], v4 offset:5120
  v_exp_f32 v82, v82
  v_exp_f32 v83, v83
  v_exp_f32 v84, v84
  v_mfma_f32_32x32x4_2b_bf16 v[48:79], a[188:189], v[44:45], 0
  ds_read_b128 a[212:215], v11 offset:5120
  v_exp_f32 v85, v85
  v_exp_f32 v86, v86
  v_exp_f32 v87, v87
  v_exp_f32 v88, v88
  v_exp_f32 v89, v89
  v_exp_f32 v90, v90
  v_exp_f32 v91, v91
  v_smfmac_f32_32x32x32_bf16 v[112:127], a[220:223], v[80:87], v14
  ds_read_b128 a[216:219], v11 offset:5760
  buffer_store_dwordx4 a[116:119], v4, s[28:31], s92 offen offset:1024 sc1
  v_exp_f32 v92, v92
  v_exp_f32 v93, v93
  v_exp_f32 v94, v94
  v_exp_f32 v95, v95
  v_exp_f32 v96, v96
  v_exp_f32 v97, v97
  v_smfmac_f32_32x32x32_bf16 v[112:127], a[224:227], v[88:95], v14
  v_exp_f32 v98, v98
  v_exp_f32 v99, v99
  v_exp_f32 v100, v100
  v_mfma_f32_32x32x16_bf16 v[48:63], a[180:183], v[36:39], v[48:63]
  v_exp_f32 v101, v101
  v_exp_f32 v102, v102
  v_exp_f32 v103, v103
  v_mfma_f32_32x32x16_bf16 v[64:79], a[180:183], v[40:43], v[64:79]
  v_exp_f32 v104, v104
  v_exp_f32 v105, v105
  v_exp_f32 v106, v106
  v_smfmac_f32_32x32x32_bf16 v[128:143], a[220:223], v[96:103], v14
  v_exp_f32 v107, v107
  v_exp_f32 v108, v108
  v_exp_f32 v109, v109
  v_exp_f32 v110, v110
  v_exp_f32 v111, v111
  v_exp_f32 v48, v48
  v_exp_f32 v49, v49
  v_smfmac_f32_32x32x32_bf16 v[128:143], a[224:227], v[104:111], v14
  s_waitcnt lgkmcnt(0)
  ds_read_b128 a[192:195], v9 offset:1536
  v_exp_f32 v50, v50
  v_exp_f32 v51, v51
  v_exp_f32 v52, v52
  v_mfma_f32_32x32x4_2b_bf16 v[80:111], a[190:191], v[44:45], 0
  ds_read_b128 a[180:183], v4 offset:6144
  v_exp_f32 v53, v53
  v_exp_f32 v54, v54
  v_exp_f32 v55, v55
  v_exp_f32 v56, v56
  v_exp_f32 v57, v57
  v_exp_f32 v58, v58
  v_exp_f32 v59, v59
  v_smfmac_f32_32x32x32_bf16 v[112:127], a[212:215], v[48:55], v14
  ds_read_b128 a[220:223], v11 offset:6400
  ds_read_b128 a[224:227], v11 offset:7040
  v_exp_f32 v60, v60
  v_exp_f32 v61, v61
  v_exp_f32 v62, v62
  v_exp_f32 v63, v63
  v_exp_f32 v64, v64
  v_exp_f32 v65, v65
  v_smfmac_f32_32x32x32_bf16 v[112:127], a[216:219], v[56:63], v14
  buffer_store_dwordx4 a[120:123], v4, s[28:31], s92 offen offset:2048 sc1
  buffer_store_dwordx4 a[124:127], v4, s[28:31], s92 offen offset:3072 sc1
  v_exp_f32 v66, v66
  v_exp_f32 v67, v67
  v_exp_f32 v68, v68
  v_mfma_f32_32x32x16_bf16 v[80:95], a[184:187], v[36:39], v[80:95]
  v_exp_f32 v69, v69
  v_exp_f32 v70, v70
  v_exp_f32 v71, v71
  v_mfma_f32_32x32x16_bf16 v[96:111], a[184:187], v[40:43], v[96:111]
  v_exp_f32 v72, v72
  v_exp_f32 v73, v73
  v_exp_f32 v74, v74
  v_smfmac_f32_32x32x32_bf16 v[128:143], a[212:215], v[64:71], v14
  v_exp_f32 v75, v75
  v_exp_f32 v76, v76
  v_exp_f32 v77, v77
  v_exp_f32 v78, v78
  v_exp_f32 v79, v79
  v_exp_f32 v80, v80
  v_exp_f32 v81, v81
  v_smfmac_f32_32x32x32_bf16 v[128:143], a[216:219], v[72:79], v14
  s_waitcnt lgkmcnt(0)
  ds_read_b128 a[184:187], v4 offset:7168
  v_exp_f32 v82, v82
  v_exp_f32 v83, v83
  v_exp_f32 v84, v84
  v_mfma_f32_32x32x4_2b_bf16 v[48:79], a[192:193], v[44:45], 0
  ds_read_b128 a[212:215], v11 offset:7680
  v_exp_f32 v85, v85
  v_exp_f32 v86, v86
  v_exp_f32 v87, v87
  v_exp_f32 v88, v88
  v_exp_f32 v89, v89
  v_exp_f32 v90, v90
  v_exp_f32 v91, v91
  v_smfmac_f32_32x32x32_bf16 v[112:127], a[220:223], v[80:87], v14
  ds_read_b128 a[216:219], v11 offset:8320
  s_add_u32 s92, s92, 131072
  buffer_store_dwordx4 a[128:131], v4, s[28:31], s92 offen offset:0 sc1
  v_exp_f32 v92, v92
  v_exp_f32 v93, v93
  v_exp_f32 v94, v94
  v_exp_f32 v95, v95
  v_exp_f32 v96, v96
  v_exp_f32 v97, v97
  v_smfmac_f32_32x32x32_bf16 v[112:127], a[224:227], v[88:95], v14
  v_exp_f32 v98, v98
  v_exp_f32 v99, v99
  v_exp_f32 v100, v100
  v_mfma_f32_32x32x16_bf16 v[48:63], a[180:183], v[36:39], v[48:63]
  v_exp_f32 v101, v101
  v_exp_f32 v102, v102
  v_exp_f32 v103, v103
  v_mfma_f32_32x32x16_bf16 v[64:79], a[180:183], v[40:43], v[64:79]
  v_exp_f32 v104, v104
  v_exp_f32 v105, v105
  v_exp_f32 v106, v106
  v_smfmac_f32_32x32x32_bf16 v[128:143], a[220:223], v[96:103], v14
  v_exp_f32 v107, v107
  v_exp_f32 v108, v108
  v_exp_f32 v109, v109
  v_exp_f32 v110, v110
  v_exp_f32 v111, v111
  v_exp_f32 v48, v48
  v_exp_f32 v49, v49
  v_smfmac_f32_32x32x32_bf16 v[128:143], a[224:227], v[104:111], v14
  s_waitcnt lgkmcnt(0)
  s_waitcnt vmcnt(20)
  s_barrier
  ds_read_b128 a[188:191], v9 offset:20480
  v_exp_f32 v50, v50
  v_exp_f32 v51, v51
  v_exp_f32 v52, v52
  v_mfma_f32_32x32x4_2b_bf16 v[80:111], a[194:195], v[44:45], 0
  ds_read_b128 a[180:183], v4 offset:20480
  v_exp_f32 v53, v53
  v_exp_f32 v54, v54
  v_exp_f32 v55, v55
  v_exp_f32 v56, v56
  v_exp_f32 v57, v57
  v_exp_f32 v58, v58
  v_exp_f32 v59, v59
  v_smfmac_f32_32x32x32_bf16 v[112:127], a[212:215], v[48:55], v14
  ds_read_b128 a[220:223], v11 offset:8960
  ds_read_b128 a[224:227], v11 offset:9600
  v_exp_f32 v60, v60
  v_exp_f32 v61, v61
  v_exp_f32 v62, v62
  v_exp_f32 v63, v63
  v_exp_f32 v64, v64
  v_exp_f32 v65, v65
  v_smfmac_f32_32x32x32_bf16 v[112:127], a[216:219], v[56:63], v14
  buffer_store_dwordx4 a[132:135], v4, s[28:31], s92 offen offset:1024 sc1
  v_exp_f32 v66, v66
  v_exp_f32 v67, v67
  v_exp_f32 v68, v68
  v_mfma_f32_32x32x16_bf16 v[80:95], a[184:187], v[36:39], v[80:95]
  v_exp_f32 v69, v69
  v_exp_f32 v70, v70
  v_exp_f32 v71, v71
  v_mfma_f32_32x32x16_bf16 v[96:111], a[184:187], v[40:43], v[96:111]
  v_exp_f32 v72, v72
  v_exp_f32 v73, v73
  v_exp_f32 v74, v74
  v_smfmac_f32_32x32x32_bf16 v[128:143], a[212:215], v[64:71], v14
  v_exp_f32 v75, v75
  v_exp_f32 v76, v76
  v_exp_f32 v77, v77
  v_exp_f32 v78, v78
  v_exp_f32 v79, v79
  v_exp_f32 v80, v80
  v_exp_f32 v81, v81
  v_smfmac_f32_32x32x32_bf16 v[128:143], a[216:219], v[72:79], v14
  s_waitcnt lgkmcnt(0)
  ds_read_b128 a[184:187], v4 offset:21504
  v_exp_f32 v82, v82
  v_exp_f32 v83, v83
  v_exp_f32 v84, v84
  v_mfma_f32_32x32x4_2b_bf16 v[48:79], a[188:189], v[44:45], 0
  ds_read_b128 a[212:215], v11 offset:20480
  v_exp_f32 v85, v85
  v_exp_f32 v86, v86
  v_exp_f32 v87, v87
  v_exp_f32 v88, v88
  v_exp_f32 v89, v89
  v_exp_f32 v90, v90
  v_exp_f32 v91, v91
  v_smfmac_f32_32x32x32_bf16 v[112:127], a[220:223], v[80:87], v14
  ds_read_b128 a[216:219], v11 offset:21120
  buffer_store_dwordx4 a[136:139], v4, s[28:31], s92 offen offset:2048 sc1
  v_exp_f32 v92, v92
  v_exp_f32 v93, v93
  v_exp_f32 v94, v94
  v_exp_f32 v95, v95
  v_exp_f32 v96, v96
  v_exp_f32 v97, v97
  v_smfmac_f32_32x32x32_bf16 v[112:127], a[224:227], v[88:95], v14
  v_exp_f32 v98, v98
  v_exp_f32 v99, v99
  v_exp_f32 v100, v100
  v_mfma_f32_32x32x16_bf16 v[48:63], a[180:183], v[36:39], v[48:63]
  v_exp_f32 v101, v101
  v_exp_f32 v102, v102
  v_exp_f32 v103, v103
  v_mfma_f32_32x32x16_bf16 v[64:79], a[180:183], v[40:43], v[64:79]
  v_exp_f32 v104, v104
  v_exp_f32 v105, v105
  v_exp_f32 v106, v106
  v_smfmac_f32_32x32x32_bf16 v[128:143], a[220:223], v[96:103], v14
  v_exp_f32 v107, v107
  v_exp_f32 v108, v108
  v_exp_f32 v109, v109
  v_exp_f32 v110, v110
  v_exp_f32 v111, v111
  v_exp_f32 v48, v48
  v_exp_f32 v49, v49
  v_smfmac_f32_32x32x32_bf16 v[128:143], a[224:227], v[104:111], v14
  s_waitcnt lgkmcnt(0)
  ds_read_b128 a[192:195], v9 offset:20992
  v_exp_f32 v50, v50
  v_exp_f32 v51, v51
  v_exp_f32 v52, v52
  v_mfma_f32_32x32x4_2b_bf16 v[80:111], a[190:191], v[44:45], 0
  ds_read_b128 a[180:183], v4 offset:22528
  v_exp_f32 v53, v53
  v_exp_f32 v54, v54
  v_exp_f32 v55, v55
  v_exp_f32 v56, v56
  v_exp_f32 v57, v57
  v_exp_f32 v58, v58
  v_exp_f32 v59, v59
  v_smfmac_f32_32x32x32_bf16 v[112:127], a[212:215], v[48:55], v14
  ds_read_b128 a[220:223], v11 offset:21760
  ds_read_b128 a[224:227], v11 offset:22400
  v_exp_f32 v60, v60
  v_exp_f32 v61, v61
  v_exp_f32 v62, v62
  v_exp_f32 v63, v63
  v_exp_f32 v64, v64
  v_exp_f32 v65, v65
  v_smfmac_f32_32x32x32_bf16 v[112:127], a[216:219], v[56:63], v14
  buffer_store_dwordx4 a[140:143], v4, s[28:31], s92 offen offset:3072 sc1
  s_add_u32 s44, s44, 1
  s_and_b32 s44, s44, 3
  v_exp_f32 v66, v66
  v_exp_f32 v67, v67
  v_exp_f32 v68, v68
  v_mfma_f32_32x32x16_bf16 v[80:95], a[184:187], v[36:39], v[80:95]
  v_exp_f32 v69, v69
  v_exp_f32 v70, v70
  v_exp_f32 v71, v71
  v_mfma_f32_32x32x16_bf16 v[96:111], a[184:187], v[40:43], v[96:111]
  v_exp_f32 v72, v72
  v_exp_f32 v73, v73
  v_exp_f32 v74, v74
  v_smfmac_f32_32x32x32_bf16 v[128:143], a[212:215], v[64:71], v14
  v_exp_f32 v75, v75
  v_exp_f32 v76, v76
  v_exp_f32 v77, v77
  v_exp_f32 v78, v78
  v_exp_f32 v79, v79
  v_exp_f32 v80, v80
  v_exp_f32 v81, v81
  v_smfmac_f32_32x32x32_bf16 v[128:143], a[216:219], v[72:79], v14
  s_waitcnt lgkmcnt(0)
  ds_read_b128 a[184:187], v4 offset:23552
  v_exp_f32 v82, v82
  v_exp_f32 v83, v83
  v_exp_f32 v84, v84
  v_mfma_f32_32x32x4_2b_bf16 v[48:79], a[192:193], v[44:45], 0
  ds_read_b128 a[212:215], v11 offset:23040
  v_exp_f32 v85, v85
  v_exp_f32 v86, v86
  v_exp_f32 v87, v87
  v_exp_f32 v88, v88
  v_exp_f32 v89, v89
  v_exp_f32 v90, v90
  v_exp_f32 v91, v91
  v_smfmac_f32_32x32x32_bf16 v[112:127], a[220:223], v[80:87], v14
  ds_read_b128 a[216:219], v11 offset:23680
  s_add_u32 m0, s42, 0
  s_add_u32 s76, s41, 0
  buffer_load_dwordx4 v13, s[24:27], s76 offen offset:0 lds
  v_exp_f32 v92, v92
  v_exp_f32 v93, v93
  v_exp_f32 v94, v94
  v_exp_f32 v95, v95
  v_exp_f32 v96, v96
  v_exp_f32 v97, v97
  v_smfmac_f32_32x32x32_bf16 v[112:127], a[224:227], v[88:95], v14
  s_add_u32 m0, s42, 960
  s_nop 0
  buffer_load_dwordx4 v13, s[24:27], s76 offen offset:64 lds
  s_add_u32 m0, s42, 1920
  s_nop 0
  buffer_load_dwordx4 v13, s[24:27], s76 offen offset:128 lds
  v_exp_f32 v98, v98
  v_exp_f32 v99, v99
  v_exp_f32 v100, v100
  v_mfma_f32_32x32x16_bf16 v[48:63], a[180:183], v[36:39], v[48:63]
  s_add_u32 m0, s42, 2880
  s_nop 0
  buffer_load_dwordx4 v13, s[24:27], s76 offen offset:192 lds
  v_exp_f32 v101, v101
  v_exp_f32 v102, v102
  v_exp_f32 v103, v103
  v_mfma_f32_32x32x16_bf16 v[64:79], a[180:183], v[40:43], v[64:79]
  v_exp_f32 v104, v104
  v_exp_f32 v105, v105
  v_exp_f32 v106, v106
  v_smfmac_f32_32x32x32_bf16 v[128:143], a[220:223], v[96:103], v14
  v_exp_f32 v107, v107
  v_exp_f32 v108, v108
  v_exp_f32 v109, v109
  v_exp_f32 v110, v110
  v_exp_f32 v111, v111
  v_exp_f32 v48, v48
  v_exp_f32 v49, v49
  v_smfmac_f32_32x32x32_bf16 v[128:143], a[224:227], v[104:111], v14
  s_waitcnt lgkmcnt(0)
  ds_read_b128 a[188:191], v9 offset:21504
  v_exp_f32 v50, v50
  v_exp_f32 v51, v51
  v_exp_f32 v52, v52
  v_mfma_f32_32x32x4_2b_bf16 v[80:111], a[194:195], v[44:45], 0
  ds_read_b128 a[180:183], v4 offset:24576
  v_exp_f32 v53, v53
  v_exp_f32 v54, v54
  v_exp_f32 v55, v55
  v_exp_f32 v56, v56
  v_exp_f32 v57, v57
  v_exp_f32 v58, v58
  v_exp_f32 v59, v59
  v_smfmac_f32_32x32x32_bf16 v[112:127], a[212:215], v[48:55], v14
  ds_read_b128 a[220:223], v11 offset:24320
  ds_read_b128 a[224:227], v11 offset:24960
  v_exp_f32 v60, v60
  v_exp_f32 v61, v61
  v_exp_f32 v62, v62
  v_exp_f32 v63, v63
  v_exp_f32 v64, v64
  v_exp_f32 v65, v65
  v_smfmac_f32_32x32x32_bf16 v[112:127], a[216:219], v[56:63], v14
  s_add_u32 m0, s42, 3840
  s_nop 0
  buffer_load_dwordx4 v172, s[24:27], s76 offen offset:256 lds
  s_add_u32 m0, s42, 5120
  s_add_u32 s76, s41, 20736
  buffer_load_dwordx4 v13, s[24:27], s76 offen offset:0 lds
  v_exp_f32 v66, v66
  v_exp_f32 v67, v67
  v_exp_f32 v68, v68
  v_mfma_f32_32x32x16_bf16 v[80:95], a[184:187], v[36:39], v[80:95]
  s_add_u32 m0, s42, 6080
  s_nop 0
  buffer_load_dwordx4 v13, s[24:27], s76 offen offset:64 lds
  v_exp_f32 v69, v69
  v_exp_f32 v70, v70
  v_exp_f32 v71, v71
  v_mfma_f32_32x32x16_bf16 v[96:111], a[184:187], v[40:43], v[96:111]
  s_add_u32 m0, s42, 7040
  s_nop 0
  buffer_load_dwordx4 v13, s[24:27], s76 offen offset:128 lds
  v_exp_f32 v72, v72
  v_exp_f32 v73, v73
  v_exp_f32 v74, v74
  v_smfmac_f32_32x32x32_bf16 v[128:143], a[212:215], v[64:71], v14
  v_exp_f32 v75, v75
  v_exp_f32 v76, v76
  v_exp_f32 v77, v77
  v_exp_f32 v78, v78
  v_exp_f32 v79, v79
  v_exp_f32 v80, v80
  v_exp_f32 v81, v81
  v_smfmac_f32_32x32x32_bf16 v[128:143], a[216:219], v[72:79], v14
  s_waitcnt lgkmcnt(0)
  ds_read_b128 a[184:187], v4 offset:25600
  v_exp_f32 v82, v82
  v_exp_f32 v83, v83
  v_exp_f32 v84, v84
  v_mfma_f32_32x32x4_2b_bf16 v[48:79], a[188:189], v[44:45], 0
  ds_read_b128 a[212:215], v11 offset:25600
  v_exp_f32 v85, v85
  v_exp_f32 v86, v86
  v_exp_f32 v87, v87
  v_exp_f32 v88, v88
  v_exp_f32 v89, v89
  v_exp_f32 v90, v90
  v_exp_f32 v91, v91
  v_smfmac_f32_32x32x32_bf16 v[112:127], a[220:223], v[80:87], v14
  ds_read_b128 a[216:219], v11 offset:26240
  s_add_u32 m0, s42, 8000
  s_nop 0
  buffer_load_dwordx4 v13, s[24:27], s76 offen offset:192 lds
  v_exp_f32 v92, v92
  v_exp_f32 v93, v93
  v_exp_f32 v94, v94
  v_exp_f32 v95, v95
  v_exp_f32 v96, v96
  v_exp_f32 v97, v97
  v_smfmac_f32_32x32x32_bf16 v[112:127], a[224:227], v[88:95], v14
  s_add_u32 m0, s42, 8960
  s_nop 0
  buffer_load_dwordx4 v172, s[24:27], s76 offen offset:256 lds
  s_add_u32 m0, s42, 10240
  s_add_u32 s76, s41, 41472
  buffer_load_dwordx4 v13, s[24:27], s76 offen offset:0 lds
  v_exp_f32 v98, v98
  v_exp_f32 v99, v99
  v_exp_f32 v100, v100
  v_mfma_f32_32x32x16_bf16 v[48:63], a[180:183], v[36:39], v[48:63]
  s_add_u32 m0, s42, 11200
  s_nop 0
  buffer_load_dwordx4 v13, s[24:27], s76 offen offset:64 lds
  v_exp_f32 v101, v101
  v_exp_f32 v102, v102
  v_exp_f32 v103, v103
  v_mfma_f32_32x32x16_bf16 v[64:79], a[180:183], v[40:43], v[64:79]
  v_exp_f32 v104, v104
  v_exp_f32 v105, v105
  v_exp_f32 v106, v106
  v_smfmac_f32_32x32x32_bf16 v[128:143], a[220:223], v[96:103], v14
  v_exp_f32 v107, v107
  v_exp_f32 v108, v108
  v_exp_f32 v109, v109
  v_exp_f32 v110, v110
  v_exp_f32 v111, v111
  v_exp_f32 v48, v48
  v_exp_f32 v49, v49
  v_smfmac_f32_32x32x32_bf16 v[128:143], a[224:227], v[104:111], v14
  s_waitcnt lgkmcnt(0)
  ds_read_b128 a[192:195], v9 offset:22016
  v_exp_f32 v50, v50
  v_exp_f32 v51, v51
  v_exp_f32 v52, v52
  v_mfma_f32_32x32x4_2b_bf16 v[80:111], a[190:191], v[44:45], 0
  ds_read_b128 a[180:183], v4 offset:26624
  v_exp_f32 v53, v53
  v_exp_f32 v54, v54
  v_exp_f32 v55, v55
  v_exp_f32 v56, v56
  v_exp_f32 v57, v57
  v_exp_f32 v58, v58
  v_exp_f32 v59, v59
  v_smfmac_f32_32x32x32_bf16 v[112:127], a[212:215], v[48:55], v14
  ds_read_b128 a[220:223], v11 offset:26880
  ds_read_b128 a[224:227], v11 offset:27520
  v_exp_f32 v60, v60
  v_exp_f32 v61, v61
  v_exp_f32 v62, v62
  v_exp_f32 v63, v63
  v_exp_f32 v64, v64
  v_exp_f32 v65, v65
  v_smfmac_f32_32x32x32_bf16 v[112:127], a[216:219], v[56:63], v14
  s_add_u32 m0, s42, 12160
  s_nop 0
  buffer_load_dwordx4 v13, s[24:27], s76 offen offset:128 lds
  s_add_u32 m0, s42, 13120
  s_nop 0
  buffer_load_dwordx4 v13, s[24:27], s76 offen offset:192 lds
  v_exp_f32 v66, v66
  v_exp_f32 v67, v67
  v_exp_f32 v68, v68
  v_mfma_f32_32x32x16_bf16 v[80:95], a[184:187], v[36:39], v[80:95]
  s_add_u32 m0, s42, 14080
  s_nop 0
  buffer_load_dwordx4 v172, s[24:27], s76 offen offset:256 lds
  v_exp_f32 v69, v69
  v_exp_f32 v70, v70
  v_exp_f32 v71, v71
  v_mfma_f32_32x32x16_bf16 v[96:111], a[184:187], v[40:43], v[96:111]
  s_add_u32 m0, s42, 15360
  s_add_u32 s76, s41, 62208
  buffer_load_dwordx4 v13, s[24:27], s76 offen offset:0 lds
  v_exp_f32 v72, v72
  v_exp_f32 v73, v73
  v_exp_f32 v74, v74
  v_smfmac_f32_32x32x32_bf16 v[128:143], a[212:215], v[64:71], v14
  v_exp_f32 v75, v75
  v_exp_f32 v76, v76
  v_exp_f32 v77, v77
  v_exp_f32 v78, v78
  v_exp_f32 v79, v79
  v_exp_f32 v80, v80
  v_exp_f32 v81, v81
  v_smfmac_f32_32x32x32_bf16 v[128:143], a[216:219], v[72:79], v14
  s_waitcnt lgkmcnt(0)
  s_waitcnt vmcnt(16)
  s_barrier
  ds_read_b128 a[184:187], v4 offset:27648
  v_exp_f32 v82, v82
  v_exp_f32 v83, v83
  v_exp_f32 v84, v84
  v_mfma_f32_32x32x4_2b_bf16 v[48:79], a[192:193], v[44:45], 0
  ds_read_b128 a[212:215], v11 offset:28160
  v_exp_f32 v85, v85
  v_exp_f32 v86, v86
  v_exp_f32 v87, v87
  v_exp_f32 v88, v88
  v_exp_f32 v89, v89
  v_exp_f32 v90, v90
  v_exp_f32 v91, v91
  v_smfmac_f32_32x32x32_bf16 v[112:127], a[220:223], v[80:87], v14
  ds_read_b128 a[216:219], v11 offset:28800
  s_add_u32 m0, s42, 16320
  s_nop 0
  buffer_load_dwordx4 v13, s[24:27], s76 offen offset:64 lds
  v_exp_f32 v92, v92
  v_exp_f32 v93, v93
  v_exp_f32 v94, v94
  v_exp_f32 v95, v95
  v_exp_f32 v96, v96
  v_exp_f32 v97, v97
  v_smfmac_f32_32x32x32_bf16 v[112:127], a[224:227], v[88:95], v14
  s_add_u32 m0, s42, 17280
  s_nop 0
  buffer_load_dwordx4 v13, s[24:27], s76 offen offset:128 lds
  s_add_u32 m0, s42, 18240
  s_nop 0
  buffer_load_dwordx4 v13, s[24:27], s76 offen offset:192 lds
  v_exp_f32 v98, v98
  v_exp_f32 v99, v99
  v_exp_f32 v100, v100
  v_mfma_f32_32x32x16_bf16 v[48:63], a[180:183], v[36:39], v[48:63]
  s_add_u32 m0, s42, 19200
  s_nop 0
  buffer_load_dwordx4 v172, s[24:27], s76 offen offset:256 lds
  v_exp_f32 v101, v101
  v_exp_f32 v102, v102
  v_exp_f32 v103, v103
  v_mfma_f32_32x32x16_bf16 v[64:79], a[180:183], v[40:43], v[64:79]
  s_add_u32 s99, s60, 65536
  v_mov_b32 v21, s59
  s_mov_b64 exec, 1
  buffer_store_dword v21, off, s[28:31], s99 sc1
  s_mov_b64 exec, -1
  v_exp_f32 v104, v104
  v_exp_f32 v105, v105
  v_exp_f32 v106, v106
  v_smfmac_f32_32x32x32_bf16 v[128:143], a[220:223], v[96:103], v14
  v_and_b32 v22, 15, v1
  v_lshlrev_b32 v22, 7, v22
  v_exp_f32 v107, v107
  v_exp_f32 v108, v108
  v_exp_f32 v109, v109
  v_exp_f32 v110, v110
  v_exp_f32 v111, v111
  v_exp_f32 v48, v48
  v_exp_f32 v49, v49
  v_smfmac_f32_32x32x32_bf16 v[128:143], a[224:227], v[104:111], v14
  s_waitcnt lgkmcnt(0)
  s_barrier
  ds_read_b128 a[188:191], v9 offset:40960
  v_exp_f32 v50, v50
  v_exp_f32 v51, v51
  v_exp_f32 v52, v52
  v_mfma_f32_32x32x4_2b_bf16 v[80:111], a[194:195], v[44:45], 0
  ds_read_b128 a[180:183], v4 offset:40960
  v_exp_f32 v53, v53
  v_exp_f32 v54, v54
  v_exp_f32 v55, v55
  v_exp_f32 v56, v56
  v_exp_f32 v57, v57
  v_exp_f32 v58, v58
  v_exp_f32 v59, v59
  v_smfmac_f32_32x32x32_bf16 v[112:127], a[212:215], v[48:55], v14
  ds_read_b128 a[220:223], v11 offset:29440
  ds_read_b128 a[224:227], v11 offset:30080
  v_exp_f32 v60, v60
  v_exp_f32 v61, v61
  v_exp_f32 v62, v62
  v_exp_f32 v63, v63
  v_exp_f32 v64, v64
  v_exp_f32 v65, v65
  v_smfmac_f32_32x32x32_bf16 v[112:127], a[216:219], v[56:63], v14
  v_add_u32 v22, s53, v22
  v_exp_f32 v66, v66
  v_exp_f32 v67, v67
  v_exp_f32 v68, v68
  v_mfma_f32_32x32x16_bf16 v[80:95], a[184:187], v[36:39], v[80:95]
  v_exp_f32 v69, v69
  v_exp_f32 v70, v70
  v_exp_f32 v71, v71
  v_mfma_f32_32x32x16_bf16 v[96:111], a[184:187], v[40:43], v[96:111]
  v_exp_f32 v72, v72
  v_exp_f32 v73, v73
  v_exp_f32 v74, v74
  v_smfmac_f32_32x32x32_bf16 v[128:143], a[212:215], v[64:71], v14
  v_exp_f32 v75, v75
  v_exp_f32 v76, v76
  v_exp_f32 v77, v77
  v_exp_f32 v78, v78
  v_exp_f32 v79, v79
  v_exp_f32 v80, v80
  v_exp_f32 v81, v81
  v_smfmac_f32_32x32x32_bf16 v[128:143], a[216:219], v[72:79], v14
  s_waitcnt vmcnt(1)
  s_waitcnt lgkmcnt(0)
  ds_read_b128 a[184:187], v4 offset:41984
  ds_read_b128 a[212:215], v11 offset:40960
  v_exp_f32 v82, v82
  v_exp_f32 v83, v83
  v_exp_f32 v84, v84
  v_mfma_f32_32x32x4_2b_bf16 v[48:79], a[188:189], v[44:45], 0
  ds_read_b128 a[216:219], v11 offset:41600
  ds_read_b64_tr_b16 a[0:1], v46 offset:0
  v_exp_f32 v85, v85
  v_exp_f32 v86, v86
  v_exp_f32 v87, v87
  v_exp_f32 v88, v88
  v_exp_f32 v89, v89
  v_exp_f32 v90, v90
  v_exp_f32 v91, v91
  v_smfmac_f32_32x32x32_bf16 v[112:127], a[220:223], v[80:87], v14
  ds_read_b64_tr_b16 a[2:3], v46 offset:256
  ds_read_b64_tr_b16 a[4:5], v46 offset:1024
  ds_read_b64_tr_b16 a[6:7], v46 offset:1280
  ds_read_b64_tr_b16 a[8:9], v46 offset:2048
  v_exp_f32 v92, v92
  v_exp_f32 v93, v93
  v_exp_f32 v94, v94
  v_exp_f32 v95, v95
  v_exp_f32 v96, v96
  v_exp_f32 v97, v97
  v_smfmac_f32_32x32x32_bf16 v[112:127], a[224:227], v[88:95], v14
  ds_read_b64_tr_b16 a[10:11], v46 offset:2304
  ds_read_b64_tr_b16 a[12:13], v46 offset:3072
  ds_read_b64_tr_b16 a[14:15], v46 offset:3328
  s_add_u32 m0, s48, 0
  s_add_u32 s76, s41, 0
  buffer_load_dwordx4 v15, s[24:27], s76 offen offset:0 lds
  v_exp_f32 v98, v98
  v_exp_f32 v99, v99
  v_exp_f32 v100, v100
  v_mfma_f32_32x32x16_bf16 v[48:63], a[180:183], v[36:39], v[48:63]
  s_add_u32 m0, s48, 960
  s_nop 0
  buffer_load_dwordx4 v15, s[24:27], s76 offen offset:64 lds
  v_exp_f32 v101, v101
  v_exp_f32 v102, v102
  v_exp_f32 v103, v103
  v_mfma_f32_32x32x16_bf16 v[64:79], a[180:183], v[40:43], v[64:79]
  s_add_u32 m0, s48, 1920
  s_nop 0
  buffer_load_dwordx4 v15, s[24:27], s76 offen offset:128 lds
  v_exp_f32 v104, v104
  v_exp_f32 v105, v105
  v_exp_f32 v106, v106
  v_smfmac_f32_32x32x32_bf16 v[128:143], a[220:223], v[96:103], v14
  s_add_u32 m0, s48, 2880
  s_nop 0
  buffer_load_dwordx4 v15, s[24:27], s76 offen offset:192 lds
L_pg13:
  s_cbranch_execz L_wr0
  s_add_u32 m0, s94, 0
  s_add_u32 s47, s101, 102400
  buffer_load_dwordx4 v4, s[28:31], s47 offen offset:0 sc1 lds
  buffer_load_dwordx4 v4, s[28:31], s47 offen offset:1024 sc1 lds
  v_exp_f32 v107, v107
  v_exp_f32 v108, v108
  v_exp_f32 v109, v109
  v_exp_f32 v110, v110
  v_exp_f32 v111, v111
  v_exp_f32 v48, v48
  v_exp_f32 v49, v49
  v_smfmac_f32_32x32x32_bf16 v[128:143], a[224:227], v[104:111], v14
  s_waitcnt lgkmcnt(0)
  ds_read_b128 a[192:195], v9 offset:41472
  ds_read_b128 a[180:183], v4 offset:43008
  v_exp_f32 v50, v50
  v_exp_f32 v51, v51
  v_exp_f32 v52, v52
  v_mfma_f32_32x32x4_2b_bf16 v[80:111], a[190:191], v[44:45], 0
  ds_read_b128 a[220:223], v11 offset:42240
  ds_read_b128 a[224:227], v11 offset:42880
  v_exp_f32 v53, v53
  v_exp_f32 v54, v54
  v_exp_f32 v55, v55
  v_exp_f32 v56, v56
  v_exp_f32 v57, v57
  v_exp_f32 v58, v58
  v_exp_f32 v59, v59
  v_smfmac_f32_32x32x32_bf16 v[112:127], a[212:215], v[48:55], v14
  ds_read_b64_tr_b16 a[16:17], v46 offset:4096
  ds_read_b64_tr_b16 a[18:19], v46 offset:4352
  ds_read_b64_tr_b16 a[20:21], v46 offset:5120
  ds_read_b64_tr_b16 a[22:23], v46 offset:5376
  v_exp_f32 v60, v60
  v_exp_f32 v61, v61
  v_exp_f32 v62, v62
  v_exp_f32 v63, v63
  v_exp_f32 v64, v64
  v_exp_f32 v65, v65
  v_smfmac_f32_32x32x32_bf16 v[112:127], a[216:219], v[56:63], v14
  ds_read_b64_tr_b16 a[24:25], v46 offset:6144
  ds_read_b64_tr_b16 a[26:27], v46 offset:6400
  v_exp_f32 v66, v66
  v_exp_f32 v67, v67
  v_exp_f32 v68, v68
  v_mfma_f32_32x32x16_bf16 v[80:95], a[184:187], v[36:39], v[80:95]
  ds_read_b64_tr_b16 a[28:29], v46 offset:7168
  v_exp_f32 v69, v69
  v_exp_f32 v70, v70
  v_exp_f32 v71, v71
  v_mfma_f32_32x32x16_bf16 v[96:111], a[184:187], v[40:43], v[96:111]
  ds_read_b64_tr_b16 a[30:31], v46 offset:7424
  v_exp_f32 v72, v72
  v_exp_f32 v73, v73
  v_exp_f32 v74, v74
  v_smfmac_f32_32x32x32_bf16 v[128:143], a[212:215], v[64:71], v14
  s_add_u32 m0, s48, 3840
  s_nop 0
  buffer_load_dwordx4 v173, s[24:27], s76 offen offset:256 lds
  s_add_u32 m0, s94, 2048
  s_add_u32 s47, s101, 104448
  buffer_load_dwordx4 v4, s[28:31], s47 offen offset:0 sc1 lds
  buffer_load_dwordx4 v4, s[28:31], s47 offen offset:1024 sc1 lds
  v_exp_f32 v75, v75
  v_exp_f32 v76, v76
  v_exp_f32 v77, v77
  v_exp_f32 v78, v78
  v_exp_f32 v79, v79
  v_exp_f32 v80, v80
  v_exp_f32 v81, v81
  v_smfmac_f32_32x32x32_bf16 v[128:143], a[216:219], v[72:79], v14
  s_waitcnt lgkmcnt(0)
  ds_read_b128 a[184:187], v4 offset:44032
  ds_read_b128 a[212:215], v11 offset:43520
  v_exp_f32 v82, v82
  v_exp_f32 v83, v83
  v_exp_f32 v84, v84
  v_mfma_f32_32x32x4_2b_bf16 v[48:79], a[192:193], v[44:45], 0
  ds_read_b128 a[216:219], v11 offset:44160
  ds_read_b64_tr_b16 a[32:33], v46 offset:8192
  v_exp_f32 v85, v85
  v_exp_f32 v86, v86
  v_exp_f32 v87, v87
  v_exp_f32 v88, v88
  v_exp_f32 v89, v89
  v_exp_f32 v90, v90
  v_exp_f32 v91, v91
  v_smfmac_f32_32x32x32_bf16 v[112:127], a[220:223], v[80:87], v14
  ds_read_b64_tr_b16 a[34:35], v46 offset:8448
  ds_read_b64_tr_b16 a[36:37], v46 offset:9216
  ds_read_b64_tr_b16 a[38:39], v46 offset:9472
  ds_read_b64_tr_b16 a[40:41], v46 offset:10240
  v_exp_f32 v92, v92
  v_exp_f32 v93, v93
  v_exp_f32 v94, v94
  v_exp_f32 v95, v95
  v_exp_f32 v96, v96
  v_exp_f32 v97, v97
  v_smfmac_f32_32x32x32_bf16 v[112:127], a[224:227], v[88:95], v14
  ds_read_b64_tr_b16 a[42:43], v46 offset:10496
  ds_read_b64_tr_b16 a[44:45], v46 offset:11264
  ds_read_b64_tr_b16 a[46:47], v46 offset:11520
  s_add_u32 m0, s42, 0
  s_add_u32 s76, s41, 82944
  buffer_load_dwordx4 v13, s[24:27], s76 offen offset:0 lds
  v_exp_f32 v98, v98
  v_exp_f32 v99, v99
  v_exp_f32 v100, v100
  v_mfma_f32_32x32x16_bf16 v[48:63], a[180:183], v[36:39], v[48:63]
  s_add_u32 m0, s42, 960
  s_nop 0
  buffer_load_dwordx4 v13, s[24:27], s76 offen offset:64 lds
  s_add_u32 m0, s42, 1920
  s_nop 0
  buffer_load_dwordx4 v13, s[24:27], s76 offen offset:128 lds
  v_exp_f32 v101, v101
  v_exp_f32 v102, v102
  v_exp_f32 v103, v103
  v_mfma_f32_32x32x16_bf16 v[64:79], a[180:183], v[40:43], v[64:79]
  s_add_u32 m0, s42, 2880
  s_nop 0
  buffer_load_dwordx4 v13, s[24:27], s76 offen offset:192 lds
  s_add_u32 m0, s42, 3840
  s_nop 0
  buffer_load_dwordx4 v172, s[24:27], s76 offen offset:256 lds
  v_exp_f32 v104, v104
  v_exp_f32 v105, v105
  v_exp_f32 v106, v106
  v_smfmac_f32_32x32x32_bf16 v[128:143], a[220:223], v[96:103], v14
  s_mov_b32 s99, 917504
  buffer_load_dword v21, v22, s[28:31], s99 offen
  s_add_u32 m0, s94, 4096
  s_add_u32 s47, s101, 106496
  buffer_load_dwordx4 v4, s[28:31], s47 offen offset:0 sc1 lds
  v_exp_f32 v107, v107
  v_exp_f32 v108, v108
  v_exp_f32 v109, v109
  v_exp_f32 v110, v110
  v_exp_f32 v111, v111
  v_exp_f32 v48, v48
  v_exp_f32 v49, v49
  v_smfmac_f32_32x32x32_bf16 v[128:143], a[224:227], v[104:111], v14
  s_waitcnt lgkmcnt(0)
  ds_read_b128 a[188:191], v9 offset:41984
  ds_read_b128 a[180:183], v4 offset:45056
  v_exp_f32 v50, v50
  v_exp_f32 v51, v51
  v_exp_f32 v52, v52
  v_mfma_f32_32x32x4_2b_bf16 v[80:111], a[194:195], v[44:45], 0
  ds_read_b128 a[220:223], v11 offset:44800
  ds_read_b128 a[224:227], v11 offset:45440
  v_exp_f32 v53, v53
  v_exp_f32 v54, v54
  v_exp_f32 v55, v55
  v_exp_f32 v56, v56
  v_exp_f32 v57, v57
  v_exp_f32 v58, v58
  v_exp_f32 v59, v59
  v_smfmac_f32_32x32x32_bf16 v[112:127], a[212:215], v[48:55], v14
  ds_read_b64_tr_b16 a[48:49], v46 offset:12288
  ds_read_b64_tr_b16 a[50:51], v46 offset:12544
  ds_read_b64_tr_b16 a[52:53], v46 offset:13312
  ds_read_b64_tr_b16 a[54:55], v46 offset:13568
  v_exp_f32 v60, v60
  v_exp_f32 v61, v61
  v_exp_f32 v62, v62
  v_exp_f32 v63, v63
  v_exp_f32 v64, v64
  v_exp_f32 v65, v65
  v_smfmac_f32_32x32x32_bf16 v[112:127], a[216:219], v[56:63], v14
  ds_read_b64_tr_b16 a[56:57], v46 offset:14336
  ds_read_b64_tr_b16 a[58:59], v46 offset:14592
  ds_read_b64_tr_b16 a[60:61], v46 offset:15360
  ds_read_b64_tr_b16 a[62:63], v46 offset:15616
  v_exp_f32 v66, v66
  v_exp_f32 v67, v67
  v_exp_f32 v68, v68
  v_mfma_f32_32x32x16_bf16 v[80:95], a[184:187], v[36:39], v[80:95]
  s_add_u32 m0, s42, 5120
  s_add_u32 s76, s41, 103680
  buffer_load_dwordx4 v13, s[24:27], s76 offen offset:0 lds
  v_exp_f32 v69, v69
  v_exp_f32 v70, v70
  v_exp_f32 v71, v71
  v_mfma_f32_32x32x16_bf16 v[96:111], a[184:187], v[40:43], v[96:111]
  s_add_u32 m0, s42, 6080
  s_nop 0
  buffer_load_dwordx4 v13, s[24:27], s76 offen offset:64 lds
  v_exp_f32 v72, v72
  v_exp_f32 v73, v73
  v_exp_f32 v74, v74
  v_smfmac_f32_32x32x32_bf16 v[128:143], a[212:215], v[64:71], v14
  s_add_u32 m0, s42, 7040
  s_nop 0
  buffer_load_dwordx4 v13, s[24:27], s76 offen offset:128 lds
  s_add_u32 m0, s42, 8000
  s_nop 0
  buffer_load_dwordx4 v13, s[24:27], s76 offen offset:192 lds
  v_exp_f32 v75, v75
  v_exp_f32 v76, v76
  v_exp_f32 v77, v77
  v_exp_f32 v78, v78
  v_exp_f32 v79, v79
  v_exp_f32 v80, v80
  v_exp_f32 v81, v81
  v_smfmac_f32_32x32x32_bf16 v[128:143], a[216:219], v[72:79], v14
  s_waitcnt lgkmcnt(0)
  ds_read_b128 a[184:187], v4 offset:46080
  ds_read_b128 a[212:215], v11 offset:46080
  v_exp_f32 v82, v82
  v_exp_f32 v83, v83
  v_exp_f32 v84, v84
  v_mfma_f32_32x32x4_2b_bf16 v[48:79], a[188:189], v[44:45], 0
  ds_read_b128 a[216:219], v11 offset:46720
  ds_read_b64_tr_b16 a[64:65], v46 offset:16384
  v_exp_f32 v85, v85
  v_exp_f32 v86, v86
  v_exp_f32 v87, v87
  v_exp_f32 v88, v88
  v_exp_f32 v89, v89
  v_exp_f32 v90, v90
  v_exp_f32 v91, v91
  v_smfmac_f32_32x32x32_bf16 v[112:127], a[220:223], v[80:87], v14
  ds_read_b64_tr_b16 a[66:67], v46 offset:16640
  ds_read_b64_tr_b16 a[68:69], v46 offset:17408
  ds_read_b64_tr_b16 a[70:71], v46 offset:17664
  ds_read_b64_tr_b16 a[72:73], v46 offset:18432
  v_exp_f32 v92, v92
  v_exp_f32 v93, v93
  v_exp_f32 v94, v94
  v_exp_f32 v95, v95
  v_exp_f32 v96, v96
  v_exp_f32 v97, v97
  v_smfmac_f32_32x32x32_bf16 v[112:127], a[224:227], v[88:95], v14
  ds_read_b64_tr_b16 a[74:75], v46 offset:18688
  ds_read_b64_tr_b16 a[76:77], v46 offset:19456
  ds_read_b64_tr_b16 a[78:79], v46 offset:19712
  v_exp_f32 v98, v98
  v_exp_f32 v99, v99
  v_exp_f32 v100, v100
  v_mfma_f32_32x32x16_bf16 v[48:63], a[180:183], v[36:39], v[48:63]
  s_add_u32 m0, s42, 8960
  s_nop 0
  buffer_load_dwordx4 v172, s[24:27], s76 offen offset:256 lds
  v_exp_f32 v101, v101
  v_exp_f32 v102, v102
  v_exp_f32 v103, v103
  v_mfma_f32_32x32x16_bf16 v[64:79], a[180:183], v[40:43], v[64:79]
  s_add_u32 m0, s42, 10240
  s_add_u32 s76, s41, 124416
  buffer_load_dwordx4 v13, s[24:27], s76 offen offset:0 lds
  v_exp_f32 v104, v104
  v_exp_f32 v105, v105
  v_exp_f32 v106, v106
  v_smfmac_f32_32x32x32_bf16 v[128:143], a[220:223], v[96:103], v14
  s_add_u32 m0, s42, 11200
  s_nop 0
  buffer_load_dwordx4 v13, s[24:27], s76 offen offset:64 lds
  s_add_u32 m0, s42, 12160
  s_nop 0
  buffer_load_dwordx4 v13, s[24:27], s76 offen offset:128 lds
  v_exp_f32 v107, v107
  v_exp_f32 v108, v108
  v_exp_f32 v109, v109
  v_exp_f32 v110, v110
  v_exp_f32 v111, v111
  s_waitcnt vmcnt(9)
  v_cmp_ne_u32 vcc, s59, v21
  s_nop 0
  s_cmp_eq_u64 vcc, 0
  s_cbranch_scc0 L_C_spin
L_C_ok:
  v_exp_f32 v48, v48
  v_exp_f32 v49, v49
  v_smfmac_f32_32x32x32_bf16 v[128:143], a[224:227], v[104:111], v14
  s_waitcnt lgkmcnt(0)
  ds_read_b128 a[192:195], v9 offset:42496
  v_exp_f32 v50, v50
  v_exp_f32 v51, v51
  v_exp_f32 v52, v52
  v_mfma_f32_32x32x4_2b_bf16 v[80:111], a[190:191], v[44:45], 0
  ds_read_b128 a[180:183], v4 offset:47104
  v_exp_f32 v53, v53
  v_exp_f32 v54, v54
  v_exp_f32 v55, v55
  v_exp_f32 v56, v56
  v_exp_f32 v57, v57
  v_exp_f32 v58, v58
  v_exp_f32 v59, v59
  v_smfmac_f32_32x32x32_bf16 v[112:127], a[212:215], v[48:55], v14
  ds_read_b128 a[220:223], v11 offset:47360
  ds_read_b128 a[224:227], v11 offset:48000
  v_exp_f32 v60, v60
  v_exp_f32 v61, v61
  v_exp_f32 v62, v62
  v_exp_f32 v63, v63
  v_exp_f32 v64, v64
  v_exp_f32 v65, v65
  v_smfmac_f32_32x32x32_bf16 v[112:127], a[216:219], v[56:63], v14
  s_add_u32 m0, s42, 13120
  s_nop 0
  buffer_load_dwordx4 v13, s[24:27], s76 offen offset:192 lds
  s_add_u32 m0, s42, 14080
  s_nop 0
  buffer_load_dwordx4 v172, s[24:27], s76 offen offset:256 lds
  v_exp_f32 v66, v66
  v_exp_f32 v67, v67
  v_exp_f32 v68, v68
  v_mfma_f32_32x32x16_bf16 v[80:95], a[184:187], v[36:39], v[80:95]
  s_add_u32 m0, s42, 15360
  s_add_u32 s76, s41, 145152
  buffer_load_dwordx4 v13, s[24:27], s76 offen offset:0 lds
  v_exp_f32 v69, v69
  v_exp_f32 v70, v70
  v_exp_f32 v71, v71
  v_mfma_f32_32x32x16_bf16 v[96:111], a[184:187], v[40:43], v[96:111]
  s_add_u32 m0, s42, 16320
  s_nop 0
  buffer_load_dwordx4 v13, s[24:27], s76 offen offset:64 lds
  v_exp_f32 v72, v72
  v_exp_f32 v73, v73
  v_exp_f32 v74, v74
  v_smfmac_f32_32x32x32_bf16 v[128:143], a[212:215], v[64:71], v14
  buffer_load_dwordx4 a[196:199], v168, s[28:31], s70 offen offset:0 sc1
  v_exp_f32 v75, v75
  v_exp_f32 v76, v76
  v_exp_f32 v77, v77
  v_exp_f32 v78, v78
  v_exp_f32 v79, v79
  v_exp_f32 v80, v80
  v_exp_f32 v81, v81
  v_smfmac_f32_32x32x32_bf16 v[128:143], a[216:219], v[72:79], v14
  s_waitcnt lgkmcnt(0)
  ds_read_b128 a[184:187], v4 offset:48128
  v_exp_f32 v82, v82
  v_exp_f32 v83, v83
  v_exp_f32 v84, v84
  v_mfma_f32_32x32x4_2b_bf16 v[48:79], a[192:193], v[44:45], 0
  ds_read_b128 a[212:215], v11 offset:48640
  v_exp_f32 v85, v85
  v_exp_f32 v86, v86
  v_exp_f32 v87, v87
  v_exp_f32 v88, v88
  v_exp_f32 v89, v89
  v_exp_f32 v90, v90
  v_exp_f32 v91, v91
  v_smfmac_f32_32x32x32_bf16 v[112:127], a[220:223], v[80:87], v14
  ds_read_b128 a[216:219], v11 offset:49280
  s_add_u32 m0, s42, 17280
  s_nop 0
  buffer_load_dwordx4 v13, s[24:27], s76 offen offset:128 lds
  v_exp_f32 v92, v92
  v_exp_f32 v93, v93
  v_exp_f32 v94, v94
  v_exp_f32 v95, v95
  v_exp_f32 v96, v96
  v_exp_f32 v97, v97
  v_smfmac_f32_32x32x32_bf16 v[112:127], a[224:227], v[88:95], v14
  s_add_u32 m0, s42, 18240
  s_nop 0
  buffer_load_dwordx4 v13, s[24:27], s76 offen offset:192 lds
  s_add_u32 m0, s42, 19200
  s_nop 0
  buffer_load_dwordx4 v172, s[24:27], s76 offen offset:256 lds
  v_exp_f32 v98, v98
  v_exp_f32 v99, v99
  v_exp_f32 v100, v100
  v_mfma_f32_32x32x16_bf16 v[48:63], a[180:183], v[36:39], v[48:63]
  buffer_load_dwordx4 a[200:203], v168, s[28:31], s70 offen offset:512 sc1
  v_exp_f32 v101, v101
  v_exp_f32 v102, v102
  v_exp_f32 v103, v103
  v_mfma_f32_32x32x16_bf16 v[64:79], a[180:183], v[40:43], v[64:79]
  buffer_load_dwordx4 a[204:207], v169, s[28:31], s70 offen offset:0 sc1
  v_exp_f32 v104, v104
  v_exp_f32 v105, v105
  v_exp_f32 v106, v106
  v_smfmac_f32_32x32x32_bf16 v[128:143], a[220:223], v[96:103], v14
  v_exp_f32 v107, v107
  v_exp_f32 v108, v108
  v_exp_f32 v109, v109
  v_exp_f32 v110, v110
  v_exp_f32 v111, v111
  v_exp_f32 v48, v48
  v_exp_f32 v49, v49
  v_smfmac_f32_32x32x32_bf16 v[128:143], a[224:227], v[104:111], v14
  s_waitcnt lgkmcnt(0)
  s_waitcnt vmcnt(18)
  s_barrier
  ds_read_b128 a[188:191], v9 offset:0
  v_exp_f32 v50, v50
  v_exp_f32 v51, v51
  v_exp_f32 v52, v52
  v_mfma_f32_32x32x4_2b_bf16 v[80:111], a[194:195], v[44:45], 0
  ds_read_b128 a[180:183], v4 offset:0
  v_exp_f32 v53, v53
  v_exp_f32 v54, v54
  v_exp_f32 v55, v55
  v_exp_f32 v56, v56
  v_exp_f32 v57, v57
  v_exp_f32 v58, v58
  v_exp_f32 v59, v59
  v_smfmac_f32_32x32x32_bf16 v[112:127], a[212:215], v[48:55], v14
  ds_read_b128 a[220:223], v11 offset:49920
  ds_read_b128 a[224:227], v11 offset:50560
  v_exp_f32 v60, v60
  v_exp_f32 v61, v61
  v_exp_f32 v62, v62
  v_exp_f32 v63, v63
  v_exp_f32 v64, v64
  v_exp_f32 v65, v65
  v_smfmac_f32_32x32x32_bf16 v[112:127], a[216:219], v[56:63], v14
  buffer_load_dwordx4 a[208:211], v169, s[28:31], s70 offen offset:512 sc1
  v_exp_f32 v66, v66
  v_exp_f32 v67, v67
  v_exp_f32 v68, v68
  v_mfma_f32_32x32x16_bf16 v[80:95], a[184:187], v[36:39], v[80:95]
  v_exp_f32 v69, v69
  v_exp_f32 v70, v70
  v_exp_f32 v71, v71
  v_mfma_f32_32x32x16_bf16 v[96:111], a[184:187], v[40:43], v[96:111]
  v_exp_f32 v72, v72
  v_exp_f32 v73, v73
  v_exp_f32 v74, v74
  v_smfmac_f32_32x32x32_bf16 v[128:143], a[212:215], v[64:71], v14
  v_exp_f32 v75, v75
  v_exp_f32 v76, v76
  v_exp_f32 v77, v77
  v_exp_f32 v78, v78
  v_exp_f32 v79, v79
  v_exp_f32 v80, v80
  v_exp_f32 v81, v81
  v_smfmac_f32_32x32x32_bf16 v[128:143], a[216:219], v[72:79], v14
  s_waitcnt lgkmcnt(0)
  ds_read_b128 a[184:187], v4 offset:1024
  v_exp_f32 v82, v82
  v_exp_f32 v83, v83
  v_exp_f32 v84, v84
  v_mfma_f32_32x32x4_2b_bf16 v[48:79], a[188:189], v[44:45], 0
  ds_read_b128 a[212:215], v11 offset:0
  v_exp_f32 v85, v85
  v_exp_f32 v86, v86
  v_exp_f32 v87, v87
  v_exp_f32 v88, v88
  v_exp_f32 v89, v89
  v_exp_f32 v90, v90
  v_exp_f32 v91, v91
  v_smfmac_f32_32x32x32_bf16 v[112:127], a[220:223], v[80:87], v14
  ds_read_b128 a[216:219], v11 offset:640
  buffer_load_dwordx4 a[228:231], v170, s[28:31], s70 offen offset:0 sc1
  v_exp_f32 v92, v92
  v_exp_f32 v93, v93
  v_exp_f32 v94, v94
  v_exp_f32 v95, v95
  v_exp_f32 v96, v96
  v_exp_f32 v97, v97
  v_smfmac_f32_32x32x32_bf16 v[112:127], a[224:227], v[88:95], v14
  buffer_load_dwordx4 a[232:235], v170, s[28:31], s70 offen offset:512 sc1
  s_add_u32 m0, s94, 20480
  s_add_u32 s47, s101, 122880
  buffer_load_dwordx4 v4, s[28:31], s47 offen offset:0 sc1 lds
  buffer_load_dwordx4 v4, s[28:31], s47 offen offset:1024 sc1 lds
  v_exp_f32 v98, v98
  v_exp_f32 v99, v99
  v_exp_f32 v100, v100
  v_mfma_f32_32x32x16_bf16 v[48:63], a[180:183], v[36:39], v[48:63]
  v_exp_f32 v101, v101
  v_exp_f32 v102, v102
  v_exp_f32 v103, v103
  v_mfma_f32_32x32x16_bf16 v[64:79], a[180:183], v[40:43], v[64:79]
  v_exp_f32 v104, v104
  v_exp_f32 v105, v105
  v_exp_f32 v106, v106
  v_smfmac_f32_32x32x32_bf16 v[128:143], a[220:223], v[96:103], v14
  v_exp_f32 v107, v107
  v_exp_f32 v108, v108
  v_exp_f32 v109, v109
  v_exp_f32 v110, v110
  v_exp_f32 v111, v111
  v_exp_f32 v48, v48
  v_exp_f32 v49, v49
  v_smfmac_f32_32x32x32_bf16 v[128:143], a[224:227], v[104:111], v14
  s_waitcnt lgkmcnt(0)
  ds_read_b128 a[192:195], v9 offset:512
  v_exp_f32 v50, v50
  v_exp_f32 v51, v51
  v_exp_f32 v52, v52
  v_mfma_f32_32x32x4_2b_bf16 v[80:111], a[190:191], v[44:45], 0
  ds_read_b128 a[180:183], v4 offset:2048
  v_exp_f32 v53, v53
  v_exp_f32 v54, v54
  v_exp_f32 v55, v55
  v_exp_f32 v56, v56
  v_exp_f32 v57, v57
  v_exp_f32 v58, v58
  v_exp_f32 v59, v59
  v_smfmac_f32_32x32x32_bf16 v[112:127], a[212:215], v[48:55], v14
  ds_read_b128 a[220:223], v11 offset:1280
  ds_read_b128 a[224:227], v11 offset:1920
  v_exp_f32 v60, v60
  v_exp_f32 v61, v61
  v_exp_f32 v62, v62
  v_exp_f32 v63, v63
  v_exp_f32 v64, v64
  v_exp_f32 v65, v65
  v_smfmac_f32_32x32x32_bf16 v[112:127], a[216:219], v[56:63], v14
  buffer_load_dwordx4 a[236:239], v171, s[28:31], s70 offen offset:0 sc1
  buffer_load_dwordx4 a[240:243], v171, s[28:31], s70 offen offset:512 sc1
  v_exp_f32 v66, v66
  v_exp_f32 v67, v67
  v_exp_f32 v68, v68
  v_mfma_f32_32x32x16_bf16 v[80:95], a[184:187], v[36:39], v[80:95]
  s_add_u32 m0, s94, 22528
  s_add_u32 s47, s101, 124928
  buffer_load_dwordx4 v4, s[28:31], s47 offen offset:0 sc1 lds
  buffer_load_dwordx4 v4, s[28:31], s47 offen offset:1024 sc1 lds
  v_exp_f32 v69, v69
  v_exp_f32 v70, v70
  v_exp_f32 v71, v71
  v_mfma_f32_32x32x16_bf16 v[96:111], a[184:187], v[40:43], v[96:111]
  v_exp_f32 v72, v72
  v_exp_f32 v73, v73
  v_exp_f32 v74, v74
  v_smfmac_f32_32x32x32_bf16 v[128:143], a[212:215], v[64:71], v14
  v_exp_f32 v75, v75
  v_exp_f32 v76, v76
  v_exp_f32 v77, v77
  v_exp_f32 v78, v78
  v_exp_f32 v79, v79
  v_exp_f32 v80, v80
  v_exp_f32 v81, v81
  v_smfmac_f32_32x32x32_bf16 v[128:143], a[216:219], v[72:79], v14
  s_waitcnt lgkmcnt(0)
  ds_read_b128 a[184:187], v4 offset:3072
  v_exp_f32 v82, v82
  v_exp_f32 v83, v83
  v_exp_f32 v84, v84
  v_mfma_f32_32x32x4_2b_bf16 v[48:79], a[192:193], v[44:45], 0
  ds_read_b128 a[212:215], v11 offset:2560
  v_exp_f32 v85, v85
  v_exp_f32 v86, v86
  v_exp_f32 v87, v87
  v_exp_f32 v88, v88
  v_exp_f32 v89, v89
  v_exp_f32 v90, v90
  v_exp_f32 v91, v91
  v_smfmac_f32_32x32x32_bf16 v[112:127], a[220:223], v[80:87], v14
  ds_read_b128 a[216:219], v11 offset:3200
  buffer_load_dwordx4 a[244:247], v168, s[28:31], s71 offen offset:0 sc1
  v_exp_f32 v92, v92
  v_exp_f32 v93, v93
  v_exp_f32 v94, v94
  s_waitcnt vmcnt(15)
  v_mfma_f32_32x32x16_bf16 v[176:191], v[28:31], a[196:199], 0
  v_exp_f32 v95, v95
  v_exp_f32 v96, v96
  v_exp_f32 v97, v97
  v_smfmac_f32_32x32x32_bf16 v[112:127], a[224:227], v[88:95], v14
  s_add_u32 m0, s94, 24576
  s_add_u32 s47, s101, 126976
  buffer_load_dwordx4 v4, s[28:31], s47 offen offset:0 sc1 lds
  v_exp_f32 v98, v98
  v_exp_f32 v99, v99
  v_exp_f32 v100, v100
  v_mfma_f32_32x32x16_bf16 v[48:63], a[180:183], v[36:39], v[48:63]
  v_exp_f32 v101, v101
  v_exp_f32 v102, v102
  v_exp_f32 v103, v103
  v_mfma_f32_32x32x16_bf16 v[64:79], a[180:183], v[40:43], v[64:79]
  v_exp_f32 v104, v104
  v_exp_f32 v105, v105
  v_exp_f32 v106, v106
  v_smfmac_f32_32x32x32_bf16 v[128:143], a[220:223], v[96:103], v14
  v_exp_f32 v107, v107
  v_exp_f32 v108, v108
  v_exp_f32 v109, v109
  v_exp_f32 v110, v110
  v_exp_f32 v111, v111
  v_exp_f32 v48, v48
  v_exp_f32 v49, v49
  v_smfmac_f32_32x32x32_bf16 v[128:143], a[224:227], v[104:111], v14
  s_waitcnt lgkmcnt(0)
  ds_read_b128 a[188:191], v9 offset:1024
  v_exp_f32 v50, v50
  v_exp_f32 v51, v51
  v_exp_f32 v52, v52
  v_mfma_f32_32x32x4_2b_bf16 v[80:111], a[194:195], v[44:45], 0
  ds_read_b128 a[180:183], v4 offset:4096
  v_exp_f32 v53, v53
  v_exp_f32 v54, v54
  v_exp_f32 v55, v55
  v_exp_f32 v56, v56
  v_exp_f32 v57, v57
  v_exp_f32 v58, v58
  v_exp_f32 v59, v59
  v_smfmac_f32_32x32x32_bf16 v[112:127], a[212:215], v[48:55], v14
  ds_read_b128 a[220:223], v11 offset:3840
  ds_read_b128 a[224:227], v11 offset:4480
  v_exp_f32 v60, v60
  v_exp_f32 v61, v61
  v_exp_f32 v62, v62
  s_waitcnt vmcnt(12)
  v_mfma_f32_32x32x16_bf16 v[176:191], v[32:35], a[200:203], v[176:191]
  v_exp_f32 v63, v63
  v_exp_f32 v64, v64
  v_exp_f32 v65, v65
  v_smfmac_f32_32x32x32_bf16 v[112:127], a[216:219], v[56:63], v14
  buffer_load_dwordx4 a[248:251], v168, s[28:31], s71 offen offset:512 sc1
  buffer_load_dwordx4 a[144:147], v169, s[28:31], s71 offen offset:0 sc1
  v_exp_f32 v66, v66
  v_exp_f32 v67, v67
  v_exp_f32 v68, v68
  v_mfma_f32_32x32x16_bf16 v[80:95], a[184:187], v[36:39], v[80:95]
  v_exp_f32 v69, v69
  v_exp_f32 v70, v70
  v_exp_f32 v71, v71
  v_mfma_f32_32x32x16_bf16 v[96:111], a[184:187], v[40:43], v[96:111]
  v_exp_f32 v72, v72
  v_exp_f32 v73, v73
  v_exp_f32 v74, v74
  v_smfmac_f32_32x32x32_bf16 v[128:143], a[212:215], v[64:71], v14
  v_exp_f32 v75, v75
  v_exp_f32 v76, v76
  v_exp_f32 v77, v77
  s_waitcnt vmcnt(13)
  v_mfma_f32_32x32x16_bf16 v[176:191], v[28:31], a[204:207], v[176:191]
  v_exp_f32 v78, v78
  v_exp_f32 v79, v79
  v_exp_f32 v80, v80
  v_exp_f32 v81, v81
  v_smfmac_f32_32x32x32_bf16 v[128:143], a[216:219], v[72:79], v14
  s_waitcnt lgkmcnt(0)
  ds_read_b128 a[184:187], v4 offset:5120
  v_exp_f32 v82, v82
  v_exp_f32 v83, v83
  v_exp_f32 v84, v84
  v_mfma_f32_32x32x4_2b_bf16 v[48:79], a[188:189], v[44:45], 0
  ds_read_b128 a[212:215], v11 offset:5120
  v_exp_f32 v85, v85
  v_exp_f32 v86, v86
  v_exp_f32 v87, v87
  v_exp_f32 v88, v88
  v_exp_f32 v89, v89
  v_exp_f32 v90, v90
  v_exp_f32 v91, v91
  v_smfmac_f32_32x32x32_bf16 v[112:127], a[220:223], v[80:87], v14
  ds_read_b128 a[216:219], v11 offset:5760
  buffer_load_dwordx4 a[148:151], v169, s[28:31], s71 offen offset:512 sc1
  v_exp_f32 v92, v92
  v_exp_f32 v93, v93
  v_exp_f32 v94, v94
  s_waitcnt vmcnt(13)
  v_mfma_f32_32x32x16_bf16 v[176:191], v[32:35], a[208:211], v[176:191]
  v_exp_f32 v95, v95
  v_exp_f32 v96, v96
  v_exp_f32 v97, v97
  v_smfmac_f32_32x32x32_bf16 v[112:127], a[224:227], v[88:95], v14
  v_exp_f32 v98, v98
  v_exp_f32 v99, v99
  v_exp_f32 v100, v100
  v_mfma_f32_32x32x16_bf16 v[48:63], a[180:183], v[36:39], v[48:63]
  v_exp_f32 v101, v101
  v_exp_f32 v102, v102
  v_exp_f32 v103, v103
  v_mfma_f32_32x32x16_bf16 v[64:79], a[180:183], v[40:43], v[64:79]
  v_exp_f32 v104, v104
  v_exp_f32 v105, v105
  v_exp_f32 v106, v106
  v_smfmac_f32_32x32x32_bf16 v[128:143], a[220:223], v[96:103], v14
  v_exp_f32 v107, v107
  v_exp_f32 v108, v108
  v_exp_f32 v109, v109
  v_exp_f32 v110, v110
  v_exp_f32 v111, v111
  v_exp_f32 v48, v48
  v_exp_f32 v49, v49
  v_smfmac_f32_32x32x32_bf16 v[128:143], a[224:227], v[104:111], v14
  s_waitcnt lgkmcnt(0)
  ds_read_b128 a[192:195], v9 offset:1536
  v_exp_f32 v50, v50
  v_exp_f32 v51, v51
  v_exp_f32 v52, v52
  v_mfma_f32_32x32x4_2b_bf16 v[80:111], a[190:191], v[44:45], 0
  ds_read_b128 a[180:183], v4 offset:6144
  v_exp_f32 v53, v53
  v_exp_f32 v54, v54
  v_exp_f32 v55, v55
  v_exp_f32 v56, v56
  v_exp_f32 v57, v57
  v_exp_f32 v58, v58
  v_exp_f32 v59, v59
  v_smfmac_f32_32x32x32_bf16 v[112:127], a[212:215], v[48:55], v14
  ds_read_b128 a[220:223], v11 offset:6400
  ds_read_b128 a[224:227], v11 offset:7040
  v_exp_f32 v60, v60
  v_exp_f32 v61, v61
  v_exp_f32 v62, v62
  s_waitcnt vmcnt(12)
  v_mfma_f32_32x32x16_bf16 v[176:191], v[28:31], a[228:231], v[176:191]
  v_exp_f32 v63, v63
  v_exp_f32 v64, v64
  v_exp_f32 v65, v65
  v_smfmac_f32_32x32x32_bf16 v[112:127], a[216:219], v[56:63], v14
  buffer_load_dwordx4 a[152:155], v170, s[28:31], s71 offen offset:0 sc1
  buffer_load_dwordx4 a[156:159], v170, s[28:31], s71 offen offset:512 sc1
  v_exp_f32 v66, v66
  v_exp_f32 v67, v67
  v_exp_f32 v68, v68
  v_mfma_f32_32x32x16_bf16 v[80:95], a[184:187], v[36:39], v[80:95]
  v_exp_f32 v69, v69
  v_exp_f32 v70, v70
  v_exp_f32 v71, v71
  v_mfma_f32_32x32x16_bf16 v[96:111], a[184:187], v[40:43], v[96:111]
  v_exp_f32 v72, v72
  v_exp_f32 v73, v73
  v_exp_f32 v74, v74
  v_smfmac_f32_32x32x32_bf16 v[128:143], a[212:215], v[64:71], v14
  v_exp_f32 v75, v75
  v_exp_f32 v76, v76
  v_exp_f32 v77, v77
  s_waitcnt vmcnt(13)
  v_mfma_f32_32x32x16_bf16 v[176:191], v[32:35], a[232:235], v[176:191]
  v_exp_f32 v78, v78
  v_exp_f32 v79, v79
  v_exp_f32 v80, v80
  v_exp_f32 v81, v81
  v_smfmac_f32_32x32x32_bf16 v[128:143], a[216:219], v[72:79], v14
  s_waitcnt lgkmcnt(0)
  ds_read_b128 a[184:187], v4 offset:7168
  v_exp_f32 v82, v82
  v_exp_f32 v83, v83
  v_exp_f32 v84, v84
  v_mfma_f32_32x32x4_2b_bf16 v[48:79], a[192:193], v[44:45], 0
  ds_read_b128 a[212:215], v11 offset:7680
  v_exp_f32 v85, v85
  v_exp_f32 v86, v86
  v_exp_f32 v87, v87
  v_exp_f32 v88, v88
  v_exp_f32 v89, v89
  v_exp_f32 v90, v90
  v_exp_f32 v91, v91
  v_smfmac_f32_32x32x32_bf16 v[112:127], a[220:223], v[80:87], v14
  ds_read_b128 a[216:219], v11 offset:8320
  buffer_load_dwordx4 a[160:163], v171, s[28:31], s71 offen offset:0 sc1
  v_exp_f32 v92, v92
  v_exp_f32 v93, v93
  v_exp_f32 v94, v94
  s_waitcnt vmcnt(11)
  v_mfma_f32_32x32x16_bf16 v[176:191], v[28:31], a[236:239], v[176:191]
  v_exp_f32 v95, v95
  v_exp_f32 v96, v96
  v_exp_f32 v97, v97
  v_smfmac_f32_32x32x32_bf16 v[112:127], a[224:227], v[88:95], v14
  buffer_load_dwordx4 a[164:167], v171, s[28:31], s71 offen offset:512 sc1
  v_exp_f32 v98, v98
  v_exp_f32 v99, v99
L_wc1_0:
L_pg14:
  s_cbranch_execz L_wr1
  v_exp_f32 v100, v100
  v_mfma_f32_32x32x16_bf16 v[48:63], a[180:183], v[36:39], v[48:63]
  v_exp_f32 v101, v101
  v_exp_f32 v102, v102
  v_exp_f32 v103, v103
  v_mfma_f32_32x32x16_bf16 v[64:79], a[180:183], v[40:43], v[64:79]
  v_exp_f32 v104, v104
  v_exp_f32 v105, v105
  v_exp_f32 v106, v106
  v_smfmac_f32_32x32x32_bf16 v[128:143], a[220:223], v[96:103], v14
  v_exp_f32 v107, v107
  v_exp_f32 v108, v108
  v_exp_f32 v109, v109
  s_waitcnt vmcnt(11)
  v_mfma_f32_32x32x16_bf16 v[176:191], v[32:35], a[240:243], v[176:191]
  v_exp_f32 v110, v110
  v_exp_f32 v111, v111
  v_exp_f32 v48, v48
  v_exp_f32 v49, v49
  v_smfmac_f32_32x32x32_bf16 v[128:143], a[224:227], v[104:111], v14
  s_waitcnt lgkmcnt(0)
  s_waitcnt vmcnt(7)
  s_barrier
  ds_read_b128 a[188:191], v9 offset:20480
  v_exp_f32 v50, v50
  v_exp_f32 v51, v51
  v_exp_f32 v52, v52
  v_mfma_f32_32x32x4_2b_bf16 v[80:111], a[194:195], v[44:45], 0
  ds_read_b128 a[180:183], v4 offset:20480
  v_exp_f32 v53, v53
  v_exp_f32 v54, v54
  v_exp_f32 v55, v55
  v_exp_f32 v56, v56
  v_exp_f32 v57, v57
  v_exp_f32 v58, v58
  v_exp_f32 v59, v59
  v_smfmac_f32_32x32x32_bf16 v[112:127], a[212:215], v[48:55], v14
  ds_read_b128 a[220:223], v11 offset:8960
  ds_read_b128 a[224:227], v11 offset:9600
  v_exp_f32 v60, v60
  v_exp_f32 v61, v61
  v_exp_f32 v62, v62
  v_mfma_f32_32x32x16_bf16 v[192:207], v[28:31], a[244:247], 0
  v_exp_f32 v63, v63
  v_exp_f32 v64, v64
  v_exp_f32 v65, v65
  v_smfmac_f32_32x32x32_bf16 v[112:127], a[216:219], v[56:63], v14
  buffer_load_dwordx4 a[168:171], v168, s[28:31], s72 offen offset:0 sc1
  v_exp_f32 v66, v66
  v_exp_f32 v67, v67
  v_exp_f32 v68, v68
  v_mfma_f32_32x32x16_bf16 v[80:95], a[184:187], v[36:39], v[80:95]
  v_exp_f32 v69, v69
  v_exp_f32 v70, v70
  v_exp_f32 v71, v71
  v_mfma_f32_32x32x16_bf16 v[96:111], a[184:187], v[40:43], v[96:111]
  v_exp_f32 v72, v72
  v_exp_f32 v73, v73
  v_exp_f32 v74, v74
  v_smfmac_f32_32x32x32_bf16 v[128:143], a[212:215], v[64:71], v14
  v_exp_f32 v75, v75
  v_exp_f32 v76, v76
  v_exp_f32 v77, v77
  v_exp_f32 v78, v78
  v_exp_f32 v79, v79
  v_exp_f32 v80, v80
  v_exp_f32 v81, v81
  v_smfmac_f32_32x32x32_bf16 v[128:143], a[216:219], v[72:79], v14
  s_waitcnt lgkmcnt(0)
  ds_read_b128 a[184:187], v4 offset:21504
  v_exp_f32 v82, v82
  v_exp_f32 v83, v83
  v_exp_f32 v84, v84
  v_mfma_f32_32x32x4_2b_bf16 v[48:79], a[188:189], v[44:45], 0
  ds_read_b128 a[212:215], v11 offset:20480
  v_exp_f32 v85, v85
  v_exp_f32 v86, v86
  v_exp_f32 v87, v87
  v_exp_f32 v88, v88
  v_exp_f32 v89, v89
  v_exp_f32 v90, v90
  v_exp_f32 v91, v91
  v_smfmac_f32_32x32x32_bf16 v[112:127], a[220:223], v[80:87], v14
  ds_read_b128 a[216:219], v11 offset:21120
  buffer_load_dwordx4 a[172:175], v168, s[28:31], s72 offen offset:512 sc1
  v_exp_f32 v92, v92
  v_exp_f32 v93, v93
  v_exp_f32 v94, v94
  s_waitcnt vmcnt(8)
  v_mfma_f32_32x32x16_bf16 v[192:207], v[32:35], a[248:251], v[192:207]
  v_exp_f32 v95, v95
  v_exp_f32 v96, v96
  v_exp_f32 v97, v97
  v_smfmac_f32_32x32x32_bf16 v[112:127], a[224:227], v[88:95], v14
  buffer_load_dwordx4 a[196:199], v169, s[28:31], s72 offen offset:0 sc1
  s_add_u32 m0, s94, 40960
  s_add_u32 s47, s101, 143360
  buffer_load_dwordx4 v4, s[28:31], s47 offen offset:0 sc1 lds
  buffer_load_dwordx4 v4, s[28:31], s47 offen offset:1024 sc1 lds
  v_exp_f32 v98, v98
  v_exp_f32 v99, v99
  v_exp_f32 v100, v100
  v_mfma_f32_32x32x16_bf16 v[48:63], a[180:183], v[36:39], v[48:63]
  v_exp_f32 v101, v101
  v_exp_f32 v102, v102
  v_exp_f32 v103, v103
  v_mfma_f32_32x32x16_bf16 v[64:79], a[180:183], v[40:43], v[64:79]
  v_exp_f32 v104, v104
  v_exp_f32 v105, v105
  v_exp_f32 v106, v106
  v_smfmac_f32_32x32x32_bf16 v[128:143], a[220:223], v[96:103], v14
  v_exp_f32 v107, v107
  v_exp_f32 v108, v108
  v_exp_f32 v109, v109
  s_waitcnt vmcnt(10)
  v_mfma_f32_32x32x16_bf16 v[192:207], v[28:31], a[144:147], v[192:207]
  v_exp_f32 v110, v110
  v_exp_f32 v111, v111
  v_exp_f32 v48, v48
  v_exp_f32 v49, v49
  v_smfmac_f32_32x32x32_bf16 v[128:143], a[224:227], v[104:111], v14
  s_waitcnt lgkmcnt(0)
  ds_read_b128 a[192:195], v9 offset:20992
  v_exp_f32 v50, v50
  v_exp_f32 v51, v51
  v_exp_f32 v52, v52
  v_mfma_f32_32x32x4_2b_bf16 v[80:111], a[190:191], v[44:45], 0
  ds_read_b128 a[180:183], v4 offset:22528
  v_exp_f32 v53, v53
  v_exp_f32 v54, v54
  v_exp_f32 v55, v55
  v_exp_f32 v56, v56
  v_exp_f32 v57, v57
  v_exp_f32 v58, v58
  v_exp_f32 v59, v59
  v_smfmac_f32_32x32x32_bf16 v[112:127], a[212:215], v[48:55], v14
  ds_read_b128 a[220:223], v11 offset:21760
  ds_read_b128 a[224:227], v11 offset:22400
  v_exp_f32 v60, v60
  v_exp_f32 v61, v61
  v_exp_f32 v62, v62
  s_waitcnt vmcnt(9)
  v_mfma_f32_32x32x16_bf16 v[192:207], v[32:35], a[148:151], v[192:207]
  v_exp_f32 v63, v63
  v_exp_f32 v64, v64
  v_exp_f32 v65, v65
  v_smfmac_f32_32x32x32_bf16 v[112:127], a[216:219], v[56:63], v14
  buffer_load_dwordx4 a[200:203], v169, s[28:31], s72 offen offset:512 sc1
  s_add_u32 m0, s94, 43008
  s_add_u32 s47, s101, 145408
  buffer_load_dwordx4 v4, s[28:31], s47 offen offset:0 sc1 lds
  buffer_load_dwordx4 v4, s[28:31], s47 offen offset:1024 sc1 lds
  v_exp_f32 v66, v66
  v_exp_f32 v67, v67
  v_exp_f32 v68, v68
  v_mfma_f32_32x32x16_bf16 v[80:95], a[184:187], v[36:39], v[80:95]
  v_exp_f32 v69, v69
  v_exp_f32 v70, v70
  v_exp_f32 v71, v71
  v_mfma_f32_32x32x16_bf16 v[96:111], a[184:187], v[40:43], v[96:111]
  v_exp_f32 v72, v72
  v_exp_f32 v73, v73
  v_exp_f32 v74, v74
  v_smfmac_f32_32x32x32_bf16 v[128:143], a[212:215], v[64:71], v14
  v_exp_f32 v75, v75
  v_exp_f32 v76, v76
  v_exp_f32 v77, v77
  v_exp_f32 v78, v78
  v_exp_f32 v79, v79
  v_exp_f32 v80, v80
  v_exp_f32 v81, v81
  v_smfmac_f32_32x32x32_bf16 v[128:143], a[216:219], v[72:79], v14
  s_waitcnt lgkmcnt(0)
  ds_read_b128 a[184:187], v4 offset:23552
  v_exp_f32 v82, v82
  v_exp_f32 v83, v83
  v_exp_f32 v84, v84
  v_mfma_f32_32x32x4_2b_bf16 v[48:79], a[192:193], v[44:45], 0
  ds_read_b128 a[212:215], v11 offset:23040
  v_exp_f32 v85, v85
  v_exp_f32 v86, v86
  v_exp_f32 v87, v87
  v_exp_f32 v88, v88
  v_exp_f32 v89, v89
  v_exp_f32 v90, v90
  v_exp_f32 v91, v91
  v_smfmac_f32_32x32x32_bf16 v[112:127], a[220:223], v[80:87], v14
  ds_read_b128 a[216:219], v11 offset:23680
  buffer_load_dwordx4 a[204:207], v170, s[28:31], s72 offen offset:0 sc1
  v_exp_f32 v92, v92
  v_exp_f32 v93, v93
  v_exp_f32 v94, v94
  s_waitcnt vmcnt(12)
  v_mfma_f32_32x32x16_bf16 v[192:207], v[28:31], a[152:155], v[192:207]
  v_exp_f32 v95, v95
  v_exp_f32 v96, v96
  v_exp_f32 v97, v97
  v_smfmac_f32_32x32x32_bf16 v[112:127], a[224:227], v[88:95], v14
  buffer_load_dwordx4 a[208:211], v170, s[28:31], s72 offen offset:512 sc1
  s_add_u32 m0, s94, 45056
  s_add_u32 s47, s101, 147456
  buffer_load_dwordx4 v4, s[28:31], s47 offen offset:0 sc1 lds
  v_exp_f32 v98, v98
  v_exp_f32 v99, v99
  v_exp_f32 v100, v100
  v_mfma_f32_32x32x16_bf16 v[48:63], a[180:183], v[36:39], v[48:63]
  v_exp_f32 v101, v101
  v_exp_f32 v102, v102
  v_exp_f32 v103, v103
  v_mfma_f32_32x32x16_bf16 v[64:79], a[180:183], v[40:43], v[64:79]
  v_exp_f32 v104, v104
  v_exp_f32 v105, v105
  v_exp_f32 v106, v106
  v_smfmac_f32_32x32x32_bf16 v[128:143], a[220:223], v[96:103], v14
  v_exp_f32 v107, v107
  v_exp_f32 v108, v108
  v_exp_f32 v109, v109
  s_waitcnt vmcnt(13)
  v_mfma_f32_32x32x16_bf16 v[192:207], v[32:35], a[156:159], v[192:207]
  v_exp_f32 v110, v110
  v_exp_f32 v111, v111
  v_exp_f32 v48, v48
  v_exp_f32 v49, v49
  v_smfmac_f32_32x32x32_bf16 v[128:143], a[224:227], v[104:111], v14
  s_waitcnt lgkmcnt(0)
  ds_read_b128 a[188:191], v9 offset:21504
  v_exp_f32 v50, v50
  v_exp_f32 v51, v51
  v_exp_f32 v52, v52
  v_mfma_f32_32x32x4_2b_bf16 v[80:111], a[194:195], v[44:45], 0
  ds_read_b128 a[180:183], v4 offset:24576
  v_exp_f32 v53, v53
  v_exp_f32 v54, v54
  v_exp_f32 v55, v55
  v_exp_f32 v56, v56
  v_exp_f32 v57, v57
  v_exp_f32 v58, v58
  v_exp_f32 v59, v59
  v_smfmac_f32_32x32x32_bf16 v[112:127], a[212:215], v[48:55], v14
  ds_read_b128 a[220:223], v11 offset:24320
  ds_read_b128 a[224:227], v11 offset:24960
  v_exp_f32 v60, v60
  v_exp_f32 v61, v61
  v_exp_f32 v62, v62
  s_waitcnt vmcnt(12)
  v_mfma_f32_32x32x16_bf16 v[192:207], v[28:31], a[160:163], v[192:207]
  v_exp_f32 v63, v63
  v_exp_f32 v64, v64
  v_exp_f32 v65, v65
  v_smfmac_f32_32x32x32_bf16 v[112:127], a[216:219], v[56:63], v14
  buffer_load_dwordx4 a[228:231], v171, s[28:31], s72 offen offset:0 sc1
  buffer_load_dwordx4 a[232:235], v171, s[28:31], s72 offen offset:512 sc1
  v_exp_f32 v66, v66
  v_exp_f32 v67, v67
  v_exp_f32 v68, v68
  v_mfma_f32_32x32x16_bf16 v[80:95], a[184:187], v[36:39], v[80:95]
  v_exp_f32 v69, v69
  v_exp_f32 v70, v70
  v_exp_f32 v71, v71
  v_mfma_f32_32x32x16_bf16 v[96:111], a[184:187], v[40:43], v[96:111]
  v_exp_f32 v72, v72
  v_exp_f32 v73, v73
  v_exp_f32 v74, v74
  v_smfmac_f32_32x32x32_bf16 v[128:143], a[212:215], v[64:71], v14
  v_exp_f32 v75, v75
  v_exp_f32 v76, v76
  v_exp_f32 v77, v77
  s_waitcnt vmcnt(13)
  v_mfma_f32_32x32x16_bf16 v[192:207], v[32:35], a[164:167], v[192:207]
  v_exp_f32 v78, v78
  v_exp_f32 v79, v79
  v_exp_f32 v80, v80
  v_exp_f32 v81, v81
  v_smfmac_f32_32x32x32_bf16 v[128:143], a[216:219], v[72:79], v14
  s_waitcnt lgkmcnt(0)
  ds_read_b128 a[184:187], v4 offset:25600
  v_exp_f32 v82, v82
  v_exp_f32 v83, v83
  v_exp_f32 v84, v84
  v_mfma_f32_32x32x4_2b_bf16 v[48:79], a[188:189], v[44:45], 0
  ds_read_b128 a[212:215], v11 offset:25600
  v_exp_f32 v85, v85
  v_exp_f32 v86, v86
  v_exp_f32 v87, v87
  v_exp_f32 v88, v88
  v_exp_f32 v89, v89
  v_exp_f32 v90, v90
  v_exp_f32 v91, v91
  v_smfmac_f32_32x32x32_bf16 v[112:127], a[220:223], v[80:87], v14
  ds_read_b128 a[216:219], v11 offset:26240
  buffer_load_dwordx4 a[236:239], v168, s[28:31], s73 offen offset:0 sc1
  v_exp_f32 v92, v92
  v_exp_f32 v93, v93
  v_exp_f32 v94, v94
  s_waitcnt vmcnt(13)
  v_mfma_f32_32x32x16_bf16 v[208:223], v[28:31], a[168:171], 0
  v_exp_f32 v95, v95
  v_exp_f32 v96, v96
  v_exp_f32 v97, v97
  v_smfmac_f32_32x32x32_bf16 v[112:127], a[224:227], v[88:95], v14
  v_exp_f32 v98, v98
  v_exp_f32 v99, v99
  v_exp_f32 v100, v100
  v_mfma_f32_32x32x16_bf16 v[48:63], a[180:183], v[36:39], v[48:63]
  v_exp_f32 v101, v101
  v_exp_f32 v102, v102
  v_exp_f32 v103, v103
  v_mfma_f32_32x32x16_bf16 v[64:79], a[180:183], v[40:43], v[64:79]
  v_exp_f32 v104, v104
  v_exp_f32 v105, v105
  v_exp_f32 v106, v106
  v_smfmac_f32_32x32x32_bf16 v[128:143], a[220:223], v[96:103], v14
  v_exp_f32 v107, v107
  v_exp_f32 v108, v108
  v_exp_f32 v109, v109
  v_exp_f32 v110, v110
  v_exp_f32 v111, v111
  v_exp_f32 v48, v48
  v_exp_f32 v49, v49
  v_smfmac_f32_32x32x32_bf16 v[128:143], a[224:227], v[104:111], v14
  s_waitcnt lgkmcnt(0)
  ds_read_b128 a[192:195], v9 offset:22016
  v_exp_f32 v50, v50
  v_exp_f32 v51, v51
  v_exp_f32 v52, v52
  v_mfma_f32_32x32x4_2b_bf16 v[80:111], a[190:191], v[44:45], 0
  ds_read_b128 a[180:183], v4 offset:26624
  v_exp_f32 v53, v53
  v_exp_f32 v54, v54
  v_exp_f32 v55, v55
  v_exp_f32 v56, v56
  v_exp_f32 v57, v57
  v_exp_f32 v58, v58
  v_exp_f32 v59, v59
  v_smfmac_f32_32x32x32_bf16 v[112:127], a[212:215], v[48:55], v14
  ds_read_b128 a[220:223], v11 offset:26880
  ds_read_b128 a[224:227], v11 offset:27520
  v_exp_f32 v60, v60
  v_exp_f32 v61, v61
  v_exp_f32 v62, v62
  s_waitcnt vmcnt(12)
  v_mfma_f32_32x32x16_bf16 v[208:223], v[32:35], a[172:175], v[208:223]
  v_exp_f32 v63, v63
  v_exp_f32 v64, v64
  v_exp_f32 v65, v65
  v_smfmac_f32_32x32x32_bf16 v[112:127], a[216:219], v[56:63], v14
  buffer_load_dwordx4 a[240:243], v168, s[28:31], s73 offen offset:512 sc1
  buffer_load_dwordx4 a[244:247], v169, s[28:31], s73 offen offset:0 sc1
  v_exp_f32 v66, v66
  v_exp_f32 v67, v67
  v_exp_f32 v68, v68
  v_mfma_f32_32x32x16_bf16 v[80:95], a[184:187], v[36:39], v[80:95]
  v_exp_f32 v69, v69
  v_exp_f32 v70, v70
  v_exp_f32 v71, v71
  v_mfma_f32_32x32x16_bf16 v[96:111], a[184:187], v[40:43], v[96:111]
  v_exp_f32 v72, v72
  v_exp_f32 v73, v73
  v_exp_f32 v74, v74
  v_smfmac_f32_32x32x32_bf16 v[128:143], a[212:215], v[64:71], v14
  v_exp_f32 v75, v75
  v_exp_f32 v76, v76
  v_exp_f32 v77, v77
  s_waitcnt vmcnt(13)
  v_mfma_f32_32x32x16_bf16 v[208:223], v[28:31], a[196:199], v[208:223]
  v_exp_f32 v78, v78
  v_exp_f32 v79, v79
  v_exp_f32 v80, v80
  v_exp_f32 v81, v81
  v_smfmac_f32_32x32x32_bf16 v[128:143], a[216:219], v[72:79], v14
  s_waitcnt lgkmcnt(0)
  ds_read_b128 a[184:187], v4 offset:27648
  v_exp_f32 v82, v82
  v_exp_f32 v83, v83
  v_exp_f32 v84, v84
  v_mfma_f32_32x32x4_2b_bf16 v[48:79], a[192:193], v[44:45], 0
  ds_read_b128 a[212:215], v11 offset:28160
  v_exp_f32 v85, v85
  v_exp_f32 v86, v86
  v_exp_f32 v87, v87
  v_exp_f32 v88, v88
  v_exp_f32 v89, v89
  v_exp_f32 v90, v90
  v_exp_f32 v91, v91
  v_smfmac_f32_32x32x32_bf16 v[112:127], a[220:223], v[80:87], v14
  ds_read_b128 a[216:219], v11 offset:28800
  buffer_load_dwordx4 a[248:251], v169, s[28:31], s73 offen offset:512 sc1
  v_exp_f32 v92, v92
  v_exp_f32 v93, v93
  v_exp_f32 v94, v94
  s_waitcnt vmcnt(11)
  v_mfma_f32_32x32x16_bf16 v[208:223], v[32:35], a[200:203], v[208:223]
  v_exp_f32 v95, v95
  v_exp_f32 v96, v96
  v_exp_f32 v97, v97
  v_smfmac_f32_32x32x32_bf16 v[112:127], a[224:227], v[88:95], v14
  v_exp_f32 v98, v98
  v_exp_f32 v99, v99
  v_exp_f32 v100, v100
  v_mfma_f32_32x32x16_bf16 v[48:63], a[180:183], v[36:39], v[48:63]
  v_exp_f32 v101, v101
  v_exp_f32 v102, v102
  v_exp_f32 v103, v103
  v_mfma_f32_32x32x16_bf16 v[64:79], a[180:183], v[40:43], v[64:79]
  v_exp_f32 v104, v104
  v_exp_f32 v105, v105
  v_exp_f32 v106, v106
  v_smfmac_f32_32x32x32_bf16 v[128:143], a[220:223], v[96:103], v14
  v_exp_f32 v107, v107
  v_exp_f32 v108, v108
  v_exp_f32 v109, v109
  v_exp_f32 v110, v110
  v_exp_f32 v111, v111
  v_exp_f32 v48, v48
  v_exp_f32 v49, v49
  v_smfmac_f32_32x32x32_bf16 v[128:143], a[224:227], v[104:111], v14
  s_waitcnt lgkmcnt(0)
  s_waitcnt vmcnt(6)
  s_barrier
  ds_read_b128 a[188:191], v9 offset:40960
  v_exp_f32 v50, v50
  v_exp_f32 v51, v51
  v_exp_f32 v52, v52
  v_mfma_f32_32x32x4_2b_bf16 v[80:111], a[194:195], v[44:45], 0
  ds_read_b128 a[180:183], v4 offset:40960
  v_exp_f32 v53, v53
  v_exp_f32 v54, v54
  v_exp_f32 v55, v55
  v_exp_f32 v56, v56
  v_exp_f32 v57, v57
  v_exp_f32 v58, v58
  v_exp_f32 v59, v59
  v_smfmac_f32_32x32x32_bf16 v[112:127], a[212:215], v[48:55], v14
  ds_read_b128 a[220:223], v11 offset:29440
  ds_read_b128 a[224:227], v11 offset:30080
  v_exp_f32 v60, v60
  v_exp_f32 v61, v61
  v_exp_f32 v62, v62
  v_mfma_f32_32x32x16_bf16 v[208:223], v[28:31], a[204:207], v[208:223]
  v_exp_f32 v63, v63
  v_exp_f32 v64, v64
  v_exp_f32 v65, v65
  v_smfmac_f32_32x32x32_bf16 v[112:127], a[216:219], v[56:63], v14
  buffer_load_dwordx4 a[144:147], v170, s[28:31], s73 offen offset:0 sc1
  buffer_load_dwordx4 a[148:151], v170, s[28:31], s73 offen offset:512 sc1
  v_exp_f32 v66, v66
  v_exp_f32 v67, v67
  v_exp_f32 v68, v68
  v_mfma_f32_32x32x16_bf16 v[80:95], a[184:187], v[36:39], v[80:95]
  v_exp_f32 v69, v69
  v_exp_f32 v70, v70
  v_exp_f32 v71, v71
  v_mfma_f32_32x32x16_bf16 v[96:111], a[184:187], v[40:43], v[96:111]
  v_exp_f32 v72, v72
  v_exp_f32 v73, v73
  v_exp_f32 v74, v74
  v_smfmac_f32_32x32x32_bf16 v[128:143], a[212:215], v[64:71], v14
  v_exp_f32 v75, v75
  v_exp_f32 v76, v76
  v_exp_f32 v77, v77
  v_mfma_f32_32x32x16_bf16 v[208:223], v[32:35], a[208:211], v[208:223]
  v_exp_f32 v78, v78
  v_exp_f32 v79, v79
  v_exp_f32 v80, v80
  v_exp_f32 v81, v81
  v_smfmac_f32_32x32x32_bf16 v[128:143], a[216:219], v[72:79], v14
  s_waitcnt lgkmcnt(0)
  ds_read_b128 a[184:187], v4 offset:41984
  v_exp_f32 v82, v82
  v_exp_f32 v83, v83
  v_exp_f32 v84, v84
  v_mfma_f32_32x32x4_2b_bf16 v[48:79], a[188:189], v[44:45], 0
  ds_read_b128 a[212:215], v11 offset:40960
  v_exp_f32 v85, v85
  v_exp_f32 v86, v86
  v_exp_f32 v87, v87
  v_exp_f32 v88, v88
  v_exp_f32 v89, v89
  v_exp_f32 v90, v90
  v_exp_f32 v91, v91
  v_smfmac_f32_32x32x32_bf16 v[112:127], a[220:223], v[80:87], v14
  ds_read_b128 a[216:219], v11 offset:41600
  buffer_load_dwordx4 a[152:155], v171, s[28:31], s73 offen offset:0 sc1
  v_exp_f32 v92, v92
  v_exp_f32 v93, v93
  v_exp_f32 v94, v94
  s_waitcnt vmcnt(8)
  v_mfma_f32_32x32x16_bf16 v[208:223], v[28:31], a[228:231], v[208:223]
  v_exp_f32 v95, v95
  v_exp_f32 v96, v96
  v_exp_f32 v97, v97
  v_smfmac_f32_32x32x32_bf16 v[112:127], a[224:227], v[88:95], v14
  buffer_load_dwordx4 a[156:159], v171, s[28:31], s73 offen offset:512 sc1
  v_exp_f32 v98, v98
  v_exp_f32 v99, v99
  v_exp_f32 v100, v100
  v_mfma_f32_32x32x16_bf16 v[48:63], a[180:183], v[36:39], v[48:63]
  v_exp_f32 v101, v101
  v_exp_f32 v102, v102
  v_exp_f32 v103, v103
  v_mfma_f32_32x32x16_bf16 v[64:79], a[180:183], v[40:43], v[64:79]
  v_exp_f32 v104, v104
  v_exp_f32 v105, v105
  v_exp_f32 v106, v106
  v_smfmac_f32_32x32x32_bf16 v[128:143], a[220:223], v[96:103], v14
  v_exp_f32 v107, v107
  v_exp_f32 v108, v108
  v_exp_f32 v109, v109
  s_waitcnt vmcnt(8)
  v_mfma_f32_32x32x16_bf16 v[208:223], v[32:35], a[232:235], v[208:223]
  v_exp_f32 v110, v110
  v_exp_f32 v111, v111
  v_exp_f32 v48, v48
  v_exp_f32 v49, v49
  v_smfmac_f32_32x32x32_bf16 v[128:143], a[224:227], v[104:111], v14
  s_waitcnt lgkmcnt(0)
  ds_read_b128 a[192:195], v9 offset:41472
  v_exp_f32 v50, v50
  v_exp_f32 v51, v51
  v_exp_f32 v52, v52
  v_mfma_f32_32x32x4_2b_bf16 v[80:111], a[190:191], v[44:45], 0
  ds_read_b128 a[180:183], v4 offset:43008
  v_exp_f32 v53, v53
  v_exp_f32 v54, v54
  v_exp_f32 v55, v55
  v_exp_f32 v56, v56
  v_exp_f32 v57, v57
  v_exp_f32 v58, v58
  v_exp_f32 v59, v59
  v_smfmac_f32_32x32x32_bf16 v[112:127], a[212:215], v[48:55], v14
  ds_read_b128 a[220:223], v11 offset:42240
  ds_read_b128 a[224:227], v11 offset:42880
  v_exp_f32 v60, v60
  v_exp_f32 v61, v61
  v_exp_f32 v62, v62
  s_waitcnt vmcnt(7)
  v_mfma_f32_32x32x16_bf16 v[224:239], v[28:31], a[236:239], 0
  v_exp_f32 v63, v63
  v_exp_f32 v64, v64
  v_exp_f32 v65, v65
  v_smfmac_f32_32x32x32_bf16 v[112:127], a[216:219], v[56:63], v14
  buffer_load_dwordx4 a[160:163], v168, s[28:31], s75 offen offset:0 sc1
  v_exp_f32 v66, v66
  v_exp_f32 v67, v67
  v_exp_f32 v68, v68
  v_mfma_f32_32x32x16_bf16 v[80:95], a[184:187], v[36:39], v[80:95]
  v_exp_f32 v69, v69
  v_exp_f32 v70, v70
  v_exp_f32 v71, v71
  v_mfma_f32_32x32x16_bf16 v[96:111], a[184:187], v[40:43], v[96:111]
  v_exp_f32 v72, v72
  v_exp_f32 v73, v73
  v_exp_f32 v74, v74
  v_smfmac_f32_32x32x32_bf16 v[128:143], a[212:215], v[64:71], v14
  v_exp_f32 v75, v75
  v_exp_f32 v76, v76
  v_exp_f32 v77, v77
  v_exp_f32 v78, v78
  v_exp_f32 v79, v79
  v_exp_f32 v80, v80
  v_exp_f32 v81, v81
  v_smfmac_f32_32x32x32_bf16 v[128:143], a[216:219], v[72:79], v14
  s_waitcnt lgkmcnt(0)
  ds_read_b128 a[184:187], v4 offset:44032
  v_exp_f32 v82, v82
  v_exp_f32 v83, v83
  v_exp_f32 v84, v84
  v_mfma_f32_32x32x4_2b_bf16 v[48:79], a[192:193], v[44:45], 0
  ds_read_b128 a[212:215], v11 offset:43520
  v_exp_f32 v85, v85
  v_exp_f32 v86, v86
  v_exp_f32 v87, v87
  v_exp_f32 v88, v88
  v_exp_f32 v89, v89
  v_exp_f32 v90, v90
  v_exp_f32 v91, v91
  v_smfmac_f32_32x32x32_bf16 v[112:127], a[220:223], v[80:87], v14
  ds_read_b128 a[216:219], v11 offset:44160
  buffer_load_dwordx4 a[164:167], v168, s[28:31], s75 offen offset:512 sc1
  v_exp_f32 v92, v92
  v_exp_f32 v93, v93
  v_exp_f32 v94, v94
  s_waitcnt vmcnt(8)
  v_mfma_f32_32x32x16_bf16 v[224:239], v[32:35], a[240:243], v[224:239]
  v_exp_f32 v95, v95
  v_exp_f32 v96, v96
  v_exp_f32 v97, v97
  v_smfmac_f32_32x32x32_bf16 v[112:127], a[224:227], v[88:95], v14
  buffer_load_dwordx4 a[168:171], v169, s[28:31], s75 offen offset:0 sc1
  v_exp_f32 v98, v98
  v_exp_f32 v99, v99
  v_exp_f32 v100, v100
  v_mfma_f32_32x32x16_bf16 v[48:63], a[180:183], v[36:39], v[48:63]
  v_exp_f32 v101, v101
  v_exp_f32 v102, v102
  v_exp_f32 v103, v103
  v_mfma_f32_32x32x16_bf16 v[64:79], a[180:183], v[40:43], v[64:79]
  v_exp_f32 v104, v104
  v_exp_f32 v105, v105
  v_exp_f32 v106, v106
  v_smfmac_f32_32x32x32_bf16 v[128:143], a[220:223], v[96:103], v14
  v_exp_f32 v107, v107
  v_exp_f32 v108, v108
  v_exp_f32 v109, v109
  s_waitcnt vmcnt(8)
  v_mfma_f32_32x32x16_bf16 v[224:239], v[28:31], a[244:247], v[224:239]
  v_exp_f32 v110, v110
  v_exp_f32 v111, v111
  v_exp_f32 v48, v48
  v_exp_f32 v49, v49
  v_smfmac_f32_32x32x32_bf16 v[128:143], a[224:227], v[104:111], v14
  s_waitcnt lgkmcnt(0)
  ds_read_b128 a[188:191], v9 offset:41984
  v_exp_f32 v50, v50
  v_exp_f32 v51, v51
  v_exp_f32 v52, v52
  v_mfma_f32_32x32x4_2b_bf16 v[80:111], a[194:195], v[44:45], 0
  ds_read_b128 a[180:183], v4 offset:45056
  v_exp_f32 v53, v53
  v_exp_f32 v54, v54
  v_exp_f32 v55, v55
  v_exp_f32 v56, v56
  v_exp_f32 v57, v57
  v_exp_f32 v58, v58
  v_exp_f32 v59, v59
  v_smfmac_f32_32x32x32_bf16 v[112:127], a[212:215], v[48:55], v14
  ds_read_b128 a[220:223], v11 offset:44800
  ds_read_b128 a[224:227], v11 offset:45440
  v_exp_f32 v60, v60
  v_exp_f32 v61, v61
  v_exp_f32 v62, v62
  s_waitcnt vmcnt(7)
  v_mfma_f32_32x32x16_bf16 v[224:239], v[32:35], a[248:251], v[224:239]
  v_exp_f32 v63, v63
  v_exp_f32 v64, v64
  v_exp_f32 v65, v65
  v_smfmac_f32_32x32x32_bf16 v[112:127], a[216:219], v[56:63], v14
  buffer_load_dwordx4 a[172:175], v169, s[28:31], s75 offen offset:512 sc1
  v_exp_f32 v66, v66
  v_exp_f32 v67, v67
  v_exp_f32 v68, v68
  v_mfma_f32_32x32x16_bf16 v[80:95], a[184:187], v[36:39], v[80:95]
  v_exp_f32 v69, v69
  v_exp_f32 v70, v70
  v_exp_f32 v71, v71
  v_mfma_f32_32x32x16_bf16 v[96:111], a[184:187], v[40:43], v[96:111]
  v_exp_f32 v72, v72
  v_exp_f32 v73, v73
  v_exp_f32 v74, v74
  v_smfmac_f32_32x32x32_bf16 v[128:143], a[212:215], v[64:71], v14
  v_exp_f32 v75, v75
  v_exp_f32 v76, v76
  v_exp_f32 v77, v77
  v_exp_f32 v78, v78
  v_exp_f32 v79, v79
  v_exp_f32 v80, v80
  v_exp_f32 v81, v81
  v_smfmac_f32_32x32x32_bf16 v[128:143], a[216:219], v[72:79], v14
  s_waitcnt lgkmcnt(0)
  ds_read_b128 a[184:187], v4 offset:46080
  v_exp_f32 v82, v82
  v_exp_f32 v83, v83
  v_exp_f32 v84, v84
  v_mfma_f32_32x32x4_2b_bf16 v[48:79], a[188:189], v[44:45], 0
  ds_read_b128 a[212:215], v11 offset:46080
  v_exp_f32 v85, v85
  v_exp_f32 v86, v86
  v_exp_f32 v87, v87
  v_exp_f32 v88, v88
  v_exp_f32 v89, v89
  v_exp_f32 v90, v90
  v_exp_f32 v91, v91
  v_smfmac_f32_32x32x32_bf16 v[112:127], a[220:223], v[80:87], v14
  ds_read_b128 a[216:219], v11 offset:46720
  buffer_load_dwordx4 a[196:199], v170, s[28:31], s75 offen offset:0 sc1
  v_exp_f32 v92, v92
  v_exp_f32 v93, v93
  v_exp_f32 v94, v94
  s_waitcnt vmcnt(8)
  v_mfma_f32_32x32x16_bf16 v[224:239], v[28:31], a[144:147], v[224:239]
  v_exp_f32 v95, v95
  v_exp_f32 v96, v96
  v_exp_f32 v97, v97
  v_smfmac_f32_32x32x32_bf16 v[112:127], a[224:227], v[88:95], v14
  buffer_load_dwordx4 a[200:203], v170, s[28:31], s75 offen offset:512 sc1
  v_exp_f32 v98, v98
  v_exp_f32 v99, v99
  v_exp_f32 v100, v100
  v_mfma_f32_32x32x16_bf16 v[48:63], a[180:183], v[36:39], v[48:63]
  v_exp_f32 v101, v101
  v_exp_f32 v102, v102
  v_exp_f32 v103, v103
  v_mfma_f32_32x32x16_bf16 v[64:79], a[180:183], v[40:43], v[64:79]
  v_exp_f32 v104, v104
  v_exp_f32 v105, v105
  v_exp_f32 v106, v106
  v_smfmac_f32_32x32x32_bf16 v[128:143], a[220:223], v[96:103], v14
  v_exp_f32 v107, v107
  v_exp_f32 v108, v108
  v_exp_f32 v109, v109
  s_waitcnt vmcnt(8)
  v_mfma_f32_32x32x16_bf16 v[224:239], v[32:35], a[148:151], v[224:239]
  v_exp_f32 v110, v110
  v_exp_f32 v111, v111
  v_exp_f32 v48, v48
  v_exp_f32 v49, v49
  v_smfmac_f32_32x32x32_bf16 v[128:143], a[224:227], v[104:111], v14
  s_waitcnt lgkmcnt(0)
  ds_read_b128 a[192:195], v9 offset:42496
  v_exp_f32 v50, v50
  v_exp_f32 v51, v51
  v_exp_f32 v52, v52
  v_mfma_f32_32x32x4_2b_bf16 v[80:111], a[190:191], v[44:45], 0
  ds_read_b128 a[180:183], v4 offset:47104
  v_exp_f32 v53, v53
  v_exp_f32 v54, v54
  v_exp_f32 v55, v55
  v_exp_f32 v56, v56
  v_exp_f32 v57, v57
  v_exp_f32 v58, v58
  v_exp_f32 v59, v59
  v_smfmac_f32_32x32x32_bf16 v[112:127], a[212:215], v[48:55], v14
  ds_read_b128 a[220:223], v11 offset:47360
  ds_read_b128 a[224:227], v11 offset:48000
  v_exp_f32 v60, v60
  v_exp_f32 v61, v61
  v_exp_f32 v62, v62
  s_waitcnt vmcnt(7)
  v_mfma_f32_32x32x16_bf16 v[224:239], v[28:31], a[152:155], v[224:239]
  v_exp_f32 v63, v63
  v_exp_f32 v64, v64
  v_exp_f32 v65, v65
  v_smfmac_f32_32x32x32_bf16 v[112:127], a[216:219], v[56:63], v14
  buffer_load_dwordx4 a[204:207], v171, s[28:31], s75 offen offset:0 sc1
  buffer_load_dwordx4 a[208:211], v171, s[28:31], s75 offen offset:512 sc1
  v_exp_f32 v66, v66
  v_exp_f32 v67, v67
  v_exp_f32 v68, v68
  v_mfma_f32_32x32x16_bf16 v[80:95], a[184:187], v[36:39], v[80:95]
  v_exp_f32 v69, v69
  v_exp_f32 v70, v70
  v_exp_f32 v71, v71
  v_mfma_f32_32x32x16_bf16 v[96:111], a[184:187], v[40:43], v[96:111]
  v_exp_f32 v72, v72
  v_exp_f32 v73, v73
  v_exp_f32 v74, v74
  v_smfmac_f32_32x32x32_bf16 v[128:143], a[212:215], v[64:71], v14
  v_exp_f32 v75, v75
  v_exp_f32 v76, v76
  v_exp_f32 v77, v77
  s_waitcnt vmcnt(8)
  v_mfma_f32_32x32x16_bf16 v[224:239], v[32:35], a[156:159], v[224:239]
  v_exp_f32 v78, v78
  v_exp_f32 v79, v79
  v_exp_f32 v80, v80
  v_exp_f32 v81, v81
  v_smfmac_f32_32x32x32_bf16 v[128:143], a[216:219], v[72:79], v14
  s_waitcnt lgkmcnt(0)
  ds_read_b128 a[184:187], v4 offset:48128
  v_exp_f32 v82, v82
  v_exp_f32 v83, v83
  v_exp_f32 v84, v84
  v_mfma_f32_32x32x4_2b_bf16 v[48:79], a[192:193], v[44:45], 0
  ds_read_b128 a[212:215], v11 offset:48640
  v_exp_f32 v85, v85
  v_exp_f32 v86, v86
  v_exp_f32 v87, v87
  v_exp_f32 v88, v88
  v_exp_f32 v89, v89
  v_exp_f32 v90, v90
  v_exp_f32 v91, v91
  v_smfmac_f32_32x32x32_bf16 v[112:127], a[220:223], v[80:87], v14
  ds_read_b128 a[216:219], v11 offset:49280
  v_exp_f32 v92, v92
  v_exp_f32 v93, v93
  v_exp_f32 v94, v94
  s_waitcnt vmcnt(7)
  v_mfma_f32_32x32x16_bf16 v[240:255], v[28:31], a[160:163], 0
  v_exp_f32 v95, v95
  v_exp_f32 v96, v96
  v_exp_f32 v97, v97
  v_smfmac_f32_32x32x32_bf16 v[112:127], a[224:227], v[88:95], v14
  v_exp_f32 v98, v98
  v_exp_f32 v99, v99
  v_exp_f32 v100, v100
  v_mfma_f32_32x32x16_bf16 v[48:63], a[180:183], v[36:39], v[48:63]
  v_exp_f32 v101, v101
  v_exp_f32 v102, v102
  v_exp_f32 v103, v103
  v_mfma_f32_32x32x16_bf16 v[64:79], a[180:183], v[40:43], v[64:79]
  v_exp_f32 v104, v104
  v_exp_f32 v105, v105
L_wc1_1:
L_pg15:
  s_cbranch_execz L_wr1
  v_exp_f32 v106, v106
  v_smfmac_f32_32x32x32_bf16 v[128:143], a[220:223], v[96:103], v14
  v_exp_f32 v107, v107
  v_exp_f32 v108, v108
  v_exp_f32 v109, v109
  v_exp_f32 v110, v110
  v_exp_f32 v111, v111
  v_exp_f32 v48, v48
  v_exp_f32 v49, v49
  v_smfmac_f32_32x32x32_bf16 v[128:143], a[224:227], v[104:111], v14
  s_waitcnt lgkmcnt(0)
  ds_read_b128 a[220:223], v11 offset:49920
  v_exp_f32 v50, v50
  v_exp_f32 v51, v51
  v_exp_f32 v52, v52
  v_mfma_f32_32x32x4_2b_bf16 v[80:111], a[194:195], v[44:45], 0
  ds_read_b128 a[224:227], v11 offset:50560
  v_exp_f32 v53, v53
  v_exp_f32 v54, v54
  v_exp_f32 v55, v55
  v_exp_f32 v56, v56
  v_exp_f32 v57, v57
  v_exp_f32 v58, v58
  v_exp_f32 v59, v59
  v_smfmac_f32_32x32x32_bf16 v[112:127], a[212:215], v[48:55], v14
  v_accvgpr_read_b32 v16, a252
  v_accvgpr_read_b32 v17, a253
  v_exp_f32 v60, v60
  v_exp_f32 v61, v61
  v_exp_f32 v62, v62
  s_waitcnt vmcnt(6)
  v_mfma_f32_32x32x16_bf16 v[240:255], v[32:35], a[164:167], v[240:255]
  v_exp_f32 v63, v63
  v_exp_f32 v64, v64
  v_exp_f32 v65, v65
  v_smfmac_f32_32x32x32_bf16 v[112:127], a[216:219], v[56:63], v14
  v_accvgpr_read_b32 v18, a254
  v_accvgpr_read_b32 v19, a255
  v_exp_f32 v66, v66
  v_exp_f32 v67, v67
  v_exp_f32 v68, v68
  v_mfma_f32_32x32x16_bf16 v[80:95], a[184:187], v[36:39], v[80:95]
  v_exp_f32 v69, v69
  v_exp_f32 v70, v70
  v_exp_f32 v71, v71
  v_mfma_f32_32x32x16_bf16 v[96:111], a[184:187], v[40:43], v[96:111]
  v_exp_f32 v72, v72
  v_exp_f32 v73, v73
  v_exp_f32 v74, v74
  v_smfmac_f32_32x32x32_bf16 v[128:143], a[212:215], v[64:71], v14
  v_exp_f32 v75, v75
  v_exp_f32 v76, v76
  v_exp_f32 v77, v77
  s_waitcnt vmcnt(5)
  v_mfma_f32_32x32x16_bf16 v[240:255], v[28:31], a[168:171], v[240:255]
  v_exp_f32 v78, v78
  v_exp_f32 v79, v79
  v_exp_f32 v80, v80
  v_exp_f32 v81, v81
  v_smfmac_f32_32x32x32_bf16 v[128:143], a[216:219], v[72:79], v14
  s_waitcnt lgkmcnt(0)
  v_exp_f32 v82, v82
  v_exp_f32 v83, v83
  v_exp_f32 v84, v84
  v_exp_f32 v85, v85
  v_exp_f32 v86, v86
  v_exp_f32 v87, v87
  v_exp_f32 v88, v88
  v_exp_f32 v89, v89
  v_exp_f32 v90, v90
  v_exp_f32 v91, v91
  v_smfmac_f32_32x32x32_bf16 v[112:127], a[220:223], v[80:87], v14
  v_exp_f32 v92, v92
  v_exp_f32 v93, v93
  v_exp_f32 v94, v94
  s_waitcnt vmcnt(4)
  v_mfma_f32_32x32x16_bf16 v[240:255], v[32:35], a[172:175], v[240:255]
  v_exp_f32 v95, v95
  v_exp_f32 v96, v96
  v_exp_f32 v97, v97
  v_smfmac_f32_32x32x32_bf16 v[112:127], a[224:227], v[88:95], v14
  v_exp_f32 v98, v98
  v_exp_f32 v99, v99
  v_exp_f32 v100, v100
  v_exp_f32 v101, v101
  v_exp_f32 v102, v102
  v_exp_f32 v103, v103
  v_exp_f32 v104, v104
  v_exp_f32 v105, v105
  v_exp_f32 v106, v106
  v_smfmac_f32_32x32x32_bf16 v[128:143], a[220:223], v[96:103], v14
  v_exp_f32 v107, v107
  v_exp_f32 v108, v108
  v_exp_f32 v109, v109
  v_exp_f32 v110, v110
  v_exp_f32 v111, v111
  s_nop 1
  v_smfmac_f32_32x32x32_bf16 v[128:143], a[224:227], v[104:111], v14
  s_add_u32 s47, s51, 4096
  v_mov_b32 v22, v122
  s_mov_b32 s79, 0x2b800000
  s_mov_b32 s80, 0x5d800000
  v_permlane32_swap_b32 v22, v122
  v_mul_f32 v18, v18, v18
  v_mul_f32 v19, v19, v19
  v_cmp_nle_f32 s[96:97], s79, v22
  v_cmp_nge_f32 s[98:99], s80, v22
  v_mul_f32 v22, v22, v18
  v_rcp_f32 v22, v22
  s_nop 0
  v_mul_f32 v112, v112, v22
  v_mul_f32 v113, v113, v22
  v_mul_f32 v114, v114, v22
  v_mul_f32 v115, v115, v22
  v_mul_f32 v116, v116, v22
  v_mul_f32 v117, v117, v22
  v_mul_f32 v118, v118, v22
  v_mul_f32 v119, v119, v22
  v_mul_f32 v120, v120, v22
  v_mul_f32 v121, v121, v22
  v_cvt_pk_bf16_f32 v112, v112, v113
  v_cvt_pk_bf16_f32 v113, v114, v115
  v_cvt_pk_bf16_f32 v114, v116, v117
  v_cvt_pk_bf16_f32 v115, v118, v119
  v_cvt_pk_bf16_f32 v116, v120, v121
  v_mov_b32 v23, v138
  s_or_b64 s[96:97], s[96:97], s[98:99]
  s_add_u32 s78, s43, 36864
  v_permlane32_swap_b32 v23, v138
  v_cmp_nle_f32 vcc, s79, v23
  v_cmp_nge_f32 s[98:99], s80, v23
  s_or_b64 s[96:97], s[96:97], vcc
  s_or_b64 s[96:97], s[96:97], s[98:99]
  s_cbranch_scc1 L_slow
L_slow_back:
  v_mul_f32 v23, v23, v19
  v_rcp_f32 v23, v23
  buffer_store_dwordx4 v[112:115], v16, s[28:31], s43 offen sc1
  v_pk_mul_f32 v[136:137], v[136:137], v[22:23] op_sel:[0,1] op_sel_hi:[1,1]
  v_pk_mul_f32 v[128:129], v[128:129], v[22:23] op_sel:[0,1] op_sel_hi:[1,1]
  v_pk_mul_f32 v[130:131], v[130:131], v[22:23] op_sel:[0,1] op_sel_hi:[1,1]
  v_pk_mul_f32 v[132:133], v[132:133], v[22:23] op_sel:[0,1] op_sel_hi:[1,1]
  v_pk_mul_f32 v[134:135], v[134:135], v[22:23] op_sel:[0,1] op_sel_hi:[1,1]
  v_cvt_pk_bf16_f32 v128, v128, v129
  v_cvt_pk_bf16_f32 v129, v130, v131
  v_cvt_pk_bf16_f32 v130, v132, v133
  v_cvt_pk_bf16_f32 v131, v134, v135
  v_cvt_pk_bf16_f32 v132, v136, v137
  buffer_store_dwordx4 v[128:131], v16, s[28:31], s78 offen sc1
  s_nop 0
  v_permlane32_swap_b32 v116, v132
  buffer_store_dword v116, v17, s[28:31], s43 offen sc1
  s_add_u32 s79, s51, 4096
  v_and_b32 v21, 31, v1
  v_lshrrev_b32 v25, 5, v1
  v_mul_u32_u24 v24, 656, v21
  v_lshlrev_b32 v21, 2, v21
  v_lshl_add_u32 v21, v25, 9, v21
  v_lshl_add_u32 v24, v25, 4, v24
  s_mul_i32 s78, s66, 20992
  v_add_u32 v20, s78, v24
  s_lshl_b32 s78, s64, 7
  s_lshl_b32 s80, s45, 5
  s_add_u32 s78, s78, s80
  s_lshl_b32 s80, s66, 3
  s_add_u32 s52, s78, s80
  s_lshl_b32 s53, s62, 6
  s_mul_i32 s58, s80, 656
  s_bitcmp1_b32 s46, 0
  s_cselect_b32 s78, 16, 20
  s_waitcnt vmcnt(6)
  v_mfma_f32_32x32x16_bf16 v[240:255], v[28:31], a[196:199], v[240:255]
  s_waitcnt vmcnt(5)
  v_mfma_f32_32x32x16_bf16 v[240:255], v[32:35], a[200:203], v[240:255]
  s_waitcnt vmcnt(4)
  v_mfma_f32_32x32x16_bf16 v[240:255], v[28:31], a[204:207], v[240:255]
  s_waitcnt vmcnt(3)
  v_mfma_f32_32x32x16_bf16 v[240:255], v[32:35], a[208:211], v[240:255]
  s_sub_u32 s81, s48, s42
  v_add_u32 v15, s81, v46
  ds_read_b64_tr_b16 a[80:81], v46 offset:0
  ds_read_b64_tr_b16 a[82:83], v46 offset:256
  ds_read_b64_tr_b16 a[84:85], v46 offset:1024
  ds_read_b64_tr_b16 a[86:87], v46 offset:1280
  ds_read_b64_tr_b16 a[88:89], v46 offset:2048
  ds_read_b64_tr_b16 a[90:91], v46 offset:2304
  ds_read_b64_tr_b16 a[92:93], v46 offset:3072
  ds_read_b64_tr_b16 a[94:95], v46 offset:3328
  ds_read_b64_tr_b16 a[96:97], v46 offset:4096
  ds_read_b64_tr_b16 a[98:99], v46 offset:4352
  ds_read_b64_tr_b16 a[100:101], v46 offset:5120
  ds_read_b64_tr_b16 a[102:103], v46 offset:5376
  ds_read_b64_tr_b16 a[104:105], v46 offset:6144
  ds_read_b64_tr_b16 a[106:107], v46 offset:6400
  ds_read_b64_tr_b16 a[108:109], v46 offset:7168
  ds_read_b64_tr_b16 a[110:111], v46 offset:7424
  ds_read_b64_tr_b16 a[112:113], v46 offset:8192
  ds_read_b64_tr_b16 a[114:115], v46 offset:8448
  ds_read_b64_tr_b16 a[116:117], v46 offset:9216
  ds_read_b64_tr_b16 a[118:119], v46 offset:9472
  ds_read_b64_tr_b16 a[120:121], v46 offset:10240
  ds_read_b64_tr_b16 a[122:123], v46 offset:10496
  ds_read_b64_tr_b16 a[124:125], v46 offset:11264
  ds_read_b64_tr_b16 a[126:127], v46 offset:11520
  ds_read_b64_tr_b16 a[128:129], v46 offset:12288
  ds_read_b64_tr_b16 a[130:131], v46 offset:12544
  ds_read_b64_tr_b16 a[132:133], v46 offset:13312
  ds_read_b64_tr_b16 a[134:135], v46 offset:13568
  ds_read_b64_tr_b16 a[136:137], v46 offset:14336
  ds_read_b64_tr_b16 a[138:139], v46 offset:14592
  ds_read_b64_tr_b16 a[140:141], v46 offset:15360
  ds_read_b64_tr_b16 a[142:143], v46 offset:15616
  ds_read_b64_tr_b16 a[144:145], v46 offset:16384
  ds_read_b64_tr_b16 a[146:147], v46 offset:16640
  ds_read_b64_tr_b16 a[148:149], v46 offset:17408
  ds_read_b64_tr_b16 a[150:151], v46 offset:17664
  ds_read_b64_tr_b16 a[152:153], v46 offset:18432
  ds_read_b64_tr_b16 a[154:155], v46 offset:18688
  ds_read_b64_tr_b16 a[156:157], v46 offset:19456
  ds_read_b64_tr_b16 a[158:159], v46 offset:19712
  ds_read_b64_tr_b16 a[160:161], v15 offset:0
  ds_read_b64_tr_b16 a[162:163], v15 offset:256
  ds_read_b64_tr_b16 a[164:165], v15 offset:1024
  ds_read_b64_tr_b16 a[166:167], v15 offset:1280
  ds_read_b64_tr_b16 a[168:169], v15 offset:2048
  ds_read_b64_tr_b16 a[170:171], v15 offset:2304
  ds_read_b64_tr_b16 a[172:173], v15 offset:3072
  ds_read_b64_tr_b16 a[174:175], v15 offset:3328
  ds_read_b64_tr_b16 a[176:177], v15 offset:4096
  ds_read_b64_tr_b16 a[178:179], v15 offset:4352
  v_add_u32 v24, 0, v1
  v_mul_u32_u24 v25, 3277, v24
  v_lshrrev_b32 v25, 16, v25
  v_mul_u32_u24 v26, 20, v25
  v_sub_u32 v26, v24, v26
  v_cmp_gt_u32 vcc, s78, v26
  v_min_u32 v27, 7, v25
  v_mul_u32_u24 v150, 656, v27
  v_lshl_add_u32 v150, v26, 5, v150
  v_add_u32 v150, s58, v150
  v_add_u32 v27, s52, v27
  v_mul_u32_u24 v149, 1152, v27
  v_lshl_add_u32 v149, v26, 4, v149
  v_add_u32 v149, s53, v149
  v_lshlrev_b32 v151, 3, v27
  v_mov_b32 v26, 1073741824
  v_cndmask_b32 v149, v26, v149, vcc
  v_add_u32 v24, 64, v1
  v_mul_u32_u24 v25, 3277, v24
  v_lshrrev_b32 v25, 16, v25
  v_mul_u32_u24 v26, 20, v25
  v_sub_u32 v26, v24, v26
  v_cmp_gt_u32 vcc, s78, v26
  v_min_u32 v27, 7, v25
  v_mul_u32_u24 v158, 656, v27
  v_lshl_add_u32 v158, v26, 5, v158
  v_add_u32 v158, s58, v158
  v_add_u32 v27, s52, v27
  v_mul_u32_u24 v157, 1152, v27
  v_lshl_add_u32 v157, v26, 4, v157
  v_add_u32 v157, s53, v157
  v_lshlrev_b32 v159, 3, v27
  v_mov_b32 v26, 1073741824
  v_cndmask_b32 v157, v26, v157, vcc
  buffer_load_dwordx4 v[48:51], v4, s[28:31], s51 offen offset:0 sc1
  buffer_load_dwordx4 v[52:55], v4, s[28:31], s51 offen offset:1024 sc1
  buffer_load_dwordx4 v[56:59], v4, s[28:31], s51 offen offset:2048 sc1
  buffer_load_dwordx4 v[60:63], v4, s[28:31], s51 offen offset:3072 sc1
  buffer_load_dwordx4 v[64:67], v4, s[28:31], s79 offen offset:0 sc1
  buffer_load_dwordx4 v[68:71], v4, s[28:31], s79 offen offset:1024 sc1
  buffer_load_dwordx4 v[72:75], v4, s[28:31], s79 offen offset:2048 sc1
  buffer_load_dwordx4 v[76:79], v4, s[28:31], s79 offen offset:3072 sc1
  buffer_load_dword v80, v21, s[28:31], s50 offen offset:0 sc1
  buffer_load_dword v81, v21, s[28:31], s50 offen offset:128 sc1
  buffer_load_dword v82, v21, s[28:31], s50 offen offset:256 sc1
  buffer_load_dword v83, v21, s[28:31], s50 offen offset:384 sc1
  v_add_u32 v24, 128, v1
  v_mul_u32_u24 v25, 3277, v24
  v_lshrrev_b32 v25, 16, v25
  v_mul_u32_u24 v26, 20, v25
  v_sub_u32 v26, v24, v26
  v_cmp_gt_u32 vcc, s78, v26
  v_min_u32 v27, 7, v25
  v_mul_u32_u24 v166, 656, v27
  v_lshl_add_u32 v166, v26, 5, v166
  v_add_u32 v166, s58, v166
  v_add_u32 v27, s52, v27
  v_mul_u32_u24 v165, 1152, v27
  v_lshl_add_u32 v165, v26, 4, v165
  v_add_u32 v165, s53, v165
  v_lshlrev_b32 v167, 3, v27
  v_mov_b32 v26, 1073741824
  v_cndmask_b32 v165, v26, v165, vcc
  v_cmp_gt_u32 vcc, 32, v1
  s_nop 1
  v_cndmask_b32 v165, v26, v165, vcc
  s_waitcnt lgkmcnt(0)
  s_barrier
  s_waitcnt vmcnt(11)
  v_max3_u32 v26, v48, v49, v50
  s_waitcnt vmcnt(10)
  v_max3_u32 v27, v51, v52, v53
  v_max3_u32 v27, v27, v54, v55
  s_waitcnt vmcnt(9)
  v_max3_u32 v26, v26, v56, v57
  v_max3_u32 v27, v27, v58, v59
  s_waitcnt vmcnt(8)
  v_max3_u32 v26, v26, v60, v61
  v_max3_u32 v27, v27, v62, v63
  v_max_u32 v26, v26, v27
  v_cmp_eq_u32 vcc, -1, v26
  s_nop 0
  s_cmp_eq_u64 vcc, 0
  s_cbranch_scc0 L_O0_spin
L_O0_ok:
  s_waitcnt vmcnt(7)
  v_max3_u32 v26, v64, v65, v66
  s_waitcnt vmcnt(6)
  v_max3_u32 v27, v67, v68, v69
  v_max3_u32 v27, v27, v70, v71
  s_waitcnt vmcnt(5)
  v_max3_u32 v26, v26, v72, v73
  v_max3_u32 v27, v27, v74, v75
  s_waitcnt vmcnt(4)
  v_max3_u32 v26, v26, v76, v77
  v_max3_u32 v27, v27, v78, v79
  s_waitcnt vmcnt(2)
  v_max3_u32 v26, v26, v80, v81
  s_waitcnt vmcnt(0)
  v_max3_u32 v27, v27, v82, v83
  v_max_u32 v26, v26, v27
  v_cmp_eq_u32 vcc, -1, v26
  s_nop 0
  s_cmp_eq_u64 vcc, 0
  s_cbranch_scc0 L_O3_spin
L_O3_ok:
  v_mfma_f32_32x32x16_bf16 v[176:191], a[0:3], v[48:51], v[176:191]
  buffer_load_dwordx4 v[144:147], v149, s[8:11], 0 offen
  v_mfma_f32_32x32x16_bf16 v[176:191], a[20:23], v[52:55], v[176:191]
  buffer_load_dword v148, v151, s[28:31], 0 offen offset:4 sc1
  v_mfma_f32_32x32x16_bf16 v[176:191], a[40:43], v[56:59], v[176:191]
  buffer_load_dwordx4 v[152:155], v157, s[8:11], 0 offen
  v_mfma_f32_32x32x16_bf16 v[176:191], a[60:63], v[60:63], v[176:191]
  buffer_load_dword v156, v159, s[28:31], 0 offen offset:4 sc1
  v_mfma_f32_32x32x16_bf16 v[176:191], a[80:83], v[64:67], v[176:191]
  buffer_load_dwordx4 v[160:163], v165, s[8:11], 0 offen
  v_mfma_f32_32x32x16_bf16 v[176:191], a[100:103], v[68:71], v[176:191]
  buffer_load_dword v164, v167, s[28:31], 0 offen offset:4 sc1
  v_mfma_f32_32x32x16_bf16 v[176:191], a[120:123], v[72:75], v[176:191]
  v_mfma_f32_32x32x16_bf16 v[176:191], a[140:143], v[76:79], v[176:191]
  v_mfma_f32_32x32x16_bf16 v[176:191], a[160:163], v[80:83], v[176:191]
  v_mfma_f32_32x32x16_bf16 v[192:207], a[4:7], v[48:51], v[192:207]
  v_mfma_f32_32x32x16_bf16 v[192:207], a[24:27], v[52:55], v[192:207]
  v_mfma_f32_32x32x16_bf16 v[192:207], a[44:47], v[56:59], v[192:207]
  v_mfma_f32_32x32x16_bf16 v[192:207], a[64:67], v[60:63], v[192:207]
  v_mfma_f32_32x32x16_bf16 v[192:207], a[84:87], v[64:67], v[192:207]
  v_mfma_f32_32x32x16_bf16 v[192:207], a[104:107], v[68:71], v[192:207]
  s_nop 5
  ds_write_b128 v20, v[176:179] offset:0
  v_mfma_f32_32x32x16_bf16 v[192:207], a[124:127], v[72:75], v[192:207]
  ds_write_b128 v20, v[180:183] offset:32
  v_mfma_f32_32x32x16_bf16 v[192:207], a[144:147], v[76:79], v[192:207]
  ds_write_b128 v20, v[184:187] offset:64
  v_mfma_f32_32x32x16_bf16 v[192:207], a[164:167], v[80:83], v[192:207]
  ds_write_b128 v20, v[188:191] offset:96
  v_mfma_f32_32x32x16_bf16 v[208:223], a[8:11], v[48:51], v[208:223]
  v_mfma_f32_32x32x16_bf16 v[208:223], a[28:31], v[52:55], v[208:223]
  v_mfma_f32_32x32x16_bf16 v[208:223], a[48:51], v[56:59], v[208:223]
  v_mfma_f32_32x32x16_bf16 v[208:223], a[68:71], v[60:63], v[208:223]
  v_mfma_f32_32x32x16_bf16 v[208:223], a[88:91], v[64:67], v[208:223]
  v_mfma_f32_32x32x16_bf16 v[208:223], a[108:111], v[68:71], v[208:223]
  s_nop 4
  ds_write_b128 v20, v[192:195] offset:128
  v_mfma_f32_32x32x16_bf16 v[208:223], a[128:131], v[72:75], v[208:223]
  ds_write_b128 v20, v[196:199] offset:160
  v_mfma_f32_32x32x16_bf16 v[208:223], a[148:151], v[76:79], v[208:223]
  ds_write_b128 v20, v[200:203] offset:192
  v_mfma_f32_32x32x16_bf16 v[208:223], a[168:171], v[80:83], v[208:223]
  ds_write_b128 v20, v[204:207] offset:224
  v_mfma_f32_32x32x16_bf16 v[224:239], a[12:15], v[48:51], v[224:239]
  s_waitcnt vmcnt(4)
  v_mul_f32 v148, v148, v148
  v_lshlrev_b32 v112, 16, v144
  v_and_b32 v113, 0xffff0000, v144
  v_lshlrev_b32 v114, 16, v145
  v_and_b32 v115, 0xffff0000, v145
  v_mfma_f32_32x32x16_bf16 v[224:239], a[32:35], v[52:55], v[224:239]
  v_lshlrev_b32 v116, 16, v146
  v_and_b32 v117, 0xffff0000, v146
  v_lshlrev_b32 v118, 16, v147
  v_and_b32 v119, 0xffff0000, v147
  s_waitcnt vmcnt(2)
  v_mul_f32 v156, v156, v156
  v_mfma_f32_32x32x16_bf16 v[224:239], a[52:55], v[56:59], v[224:239]
  v_lshlrev_b32 v120, 16, v152
  v_and_b32 v121, 0xffff0000, v152
  v_lshlrev_b32 v122, 16, v153
  v_and_b32 v123, 0xffff0000, v153
  v_lshlrev_b32 v124, 16, v154
  v_mfma_f32_32x32x16_bf16 v[224:239], a[72:75], v[60:63], v[224:239]
  v_mfma_f32_32x32x16_bf16 v[224:239], a[92:95], v[64:67], v[224:239]
  v_mfma_f32_32x32x16_bf16 v[224:239], a[112:115], v[68:71], v[224:239]
  ds_write_b128 v20, v[208:211] offset:256
  v_mfma_f32_32x32x16_bf16 v[224:239], a[132:135], v[72:75], v[224:239]
  ds_write_b128 v20, v[212:215] offset:288
  v_mfma_f32_32x32x16_bf16 v[224:239], a[152:155], v[76:79], v[224:239]
  ds_write_b128 v20, v[216:219] offset:320
  v_mfma_f32_32x32x16_bf16 v[224:239], a[172:175], v[80:83], v[224:239]
  ds_write_b128 v20, v[220:223] offset:352
  v_mfma_f32_32x32x16_bf16 v[240:255], a[16:19], v[48:51], v[240:255]
  v_and_b32 v125, 0xffff0000, v154
  v_lshlrev_b32 v126, 16, v155
  v_and_b32 v127, 0xffff0000, v155
  s_waitcnt vmcnt(0)
  v_mul_f32 v164, v164, v164
  v_lshlrev_b32 v128, 16, v160
  v_mfma_f32_32x32x16_bf16 v[240:255], a[36:39], v[52:55], v[240:255]
  v_and_b32 v129, 0xffff0000, v160
  v_lshlrev_b32 v130, 16, v161
  v_and_b32 v131, 0xffff0000, v161
  v_lshlrev_b32 v132, 16, v162
  v_and_b32 v133, 0xffff0000, v162
  v_mfma_f32_32x32x16_bf16 v[240:255], a[56:59], v[56:59], v[240:255]
  v_lshlrev_b32 v134, 16, v163
  v_and_b32 v135, 0xffff0000, v163
  v_mfma_f32_32x32x16_bf16 v[240:255], a[76:79], v[60:63], v[240:255]
  v_mfma_f32_32x32x16_bf16 v[240:255], a[96:99], v[64:67], v[240:255]
  v_mfma_f32_32x32x16_bf16 v[240:255], a[116:119], v[68:71], v[240:255]
  ds_write_b128 v20, v[224:227] offset:384
  v_mfma_f32_32x32x16_bf16 v[240:255], a[136:139], v[72:75], v[240:255]
  ds_write_b128 v20, v[228:231] offset:416
  v_mfma_f32_32x32x16_bf16 v[240:255], a[156:159], v[76:79], v[240:255]
  ds_write_b128 v20, v[232:235] offset:448
  v_mfma_f32_32x32x16_bf16 v[240:255], a[176:179], v[80:83], v[240:255]
  ds_write_b128 v20, v[236:239] offset:480
  s_nop 10
  ds_write_b128 v20, v[240:243] offset:512
  ds_write_b128 v20, v[244:247] offset:544
  ds_write_b128 v20, v[248:251] offset:576
  ds_write_b128 v20, v[252:255] offset:608
  s_waitcnt lgkmcnt(0)
  s_barrier
  ds_read_b128 v[48:51], v150 offset:0
  ds_read_b128 v[52:55], v150 offset:16
  ds_read_b128 v[56:59], v150 offset:20992
  ds_read_b128 v[60:63], v150 offset:21008
  ds_read_b128 v[64:67], v150 offset:41984
  ds_read_b128 v[68:71], v150 offset:42000
  ds_read_b128 v[72:75], v150 offset:62976
  ds_read_b128 v[76:79], v150 offset:62992
  ds_read_b128 v[80:83], v158 offset:0
  ds_read_b128 v[84:87], v158 offset:16
  ds_read_b128 v[88:91], v158 offset:20992
  ds_read_b128 v[92:95], v158 offset:21008
  ds_read_b128 v[96:99], v158 offset:41984
  ds_read_b128 v[100:103], v158 offset:42000
  ds_read_b128 v[104:107], v158 offset:62976
  ds_read_b128 v[108:111], v158 offset:62992
  s_waitcnt lgkmcnt(13)
  v_pk_add_f32 v[48:49], v[48:49], v[56:57]
  s_waitcnt lgkmcnt(9)
  v_pk_add_f32 v[64:65], v[64:65], v[72:73]
  v_pk_add_f32 v[50:51], v[50:51], v[58:59]
  v_pk_add_f32 v[66:67], v[66:67], v[74:75]
  v_pk_add_f32 v[52:53], v[52:53], v[60:61]
  s_waitcnt lgkmcnt(8)
  v_pk_add_f32 v[68:69], v[68:69], v[76:77]
  v_pk_add_f32 v[54:55], v[54:55], v[62:63]
  v_pk_add_f32 v[70:71], v[70:71], v[78:79]
  v_pk_add_f32 v[32:33], v[48:49], v[64:65]
  v_pk_add_f32 v[34:35], v[50:51], v[66:67]
  v_pk_add_f32 v[36:37], v[52:53], v[68:69]
  v_pk_add_f32 v[38:39], v[54:55], v[70:71]
  ds_read_b128 v[48:51], v166 offset:0
  ds_read_b128 v[52:55], v166 offset:16
  ds_read_b128 v[56:59], v166 offset:20992
  ds_read_b128 v[60:63], v166 offset:21008
  ds_read_b128 v[64:67], v166 offset:41984
  ds_read_b128 v[68:71], v166 offset:42000
  ds_read_b128 v[72:75], v166 offset:62976
  ds_read_b128 v[76:79], v166 offset:62992
  v_fmac_f32 v112, v32, v148
  v_fmac_f32 v113, v33, v148
  v_fmac_f32 v114, v34, v148
  v_fmac_f32 v115, v35, v148
  v_fmac_f32 v116, v36, v148
  v_fmac_f32 v117, v37, v148
  v_fmac_f32 v118, v38, v148
  v_fmac_f32 v119, v39, v148
  v_cvt_pk_bf16_f32 v144, v112, v113
  v_cvt_pk_bf16_f32 v145, v114, v115
  v_cvt_pk_bf16_f32 v146, v116, v117
  v_cvt_pk_bf16_f32 v147, v118, v119
  buffer_store_dwordx4 v[144:147], v149, s[32:35], 0 offen sc1
  s_waitcnt lgkmcnt(13)
  v_pk_add_f32 v[80:81], v[80:81], v[88:89]
  s_waitcnt lgkmcnt(9)
  v_pk_add_f32 v[96:97], v[96:97], v[104:105]
  v_pk_add_f32 v[82:83], v[82:83], v[90:91]
  v_pk_add_f32 v[98:99], v[98:99], v[106:107]
  v_pk_add_f32 v[84:85], v[84:85], v[92:93]
  s_waitcnt lgkmcnt(8)
  v_pk_add_f32 v[100:101], v[100:101], v[108:109]
  v_pk_add_f32 v[86:87], v[86:87], v[94:95]
  v_pk_add_f32 v[102:103], v[102:103], v[110:111]
  v_pk_add_f32 v[32:33], v[80:81], v[96:97]
  v_pk_add_f32 v[34:35], v[82:83], v[98:99]
  v_pk_add_f32 v[36:37], v[84:85], v[100:101]
  v_pk_add_f32 v[38:39], v[86:87], v[102:103]
  v_fmac_f32 v120, v32, v156
  v_fmac_f32 v121, v33, v156
  v_fmac_f32 v122, v34, v156
  v_fmac_f32 v123, v35, v156
  v_fmac_f32 v124, v36, v156
  v_fmac_f32 v125, v37, v156
  v_fmac_f32 v126, v38, v156
  v_fmac_f32 v127, v39, v156
  v_cvt_pk_bf16_f32 v152, v120, v121
  v_cvt_pk_bf16_f32 v153, v122, v123
  v_cvt_pk_bf16_f32 v154, v124, v125
  v_cvt_pk_bf16_f32 v155, v126, v127
  buffer_store_dwordx4 v[152:155], v157, s[32:35], 0 offen sc1
  s_waitcnt lgkmcnt(5)
  v_pk_add_f32 v[48:49], v[48:49], v[56:57]
  s_waitcnt lgkmcnt(1)
  v_pk_add_f32 v[64:65], v[64:65], v[72:73]
  v_pk_add_f32 v[50:51], v[50:51], v[58:59]
  v_pk_add_f32 v[66:67], v[66:67], v[74:75]
  v_pk_add_f32 v[52:53], v[52:53], v[60:61]
  s_waitcnt lgkmcnt(0)
  v_pk_add_f32 v[68:69], v[68:69], v[76:77]
  v_pk_add_f32 v[54:55], v[54:55], v[62:63]
  v_pk_add_f32 v[70:71], v[70:71], v[78:79]
  v_pk_add_f32 v[32:33], v[48:49], v[64:65]
  v_pk_add_f32 v[34:35], v[50:51], v[66:67]
  v_pk_add_f32 v[36:37], v[52:53], v[68:69]
  v_pk_add_f32 v[38:39], v[54:55], v[70:71]
  v_fmac_f32 v128, v32, v164
  v_fmac_f32 v129, v33, v164
  v_fmac_f32 v130, v34, v164
  v_fmac_f32 v131, v35, v164
  v_fmac_f32 v132, v36, v164
  v_fmac_f32 v133, v37, v164
  v_fmac_f32 v134, v38, v164
  v_fmac_f32 v135, v39, v164
  v_cvt_pk_bf16_f32 v160, v128, v129
  v_cvt_pk_bf16_f32 v161, v130, v131
  v_cvt_pk_bf16_f32 v162, v132, v133
  v_cvt_pk_bf16_f32 v163, v134, v135
  buffer_store_dwordx4 v[160:163], v165, s[32:35], 0 offen sc1
L_end:
  s_endpgm
L_N_spin:
  s_waitcnt vmcnt(0) lgkmcnt(0)
  s_nop 15
  s_nop 3
  s_mov_b32 s61, 0
L_N_again:
  buffer_load_dword v109, off, s[36:39], 0 sc1
  s_waitcnt vmcnt(0) lgkmcnt(0)
  v_readfirstlane_b32 s59, v109
  s_nop 0
  s_cmp_lg_u32 s59, 0
  s_cbranch_scc1 L_N_done
  s_add_u32 s61, s61, 1
  s_cmp_lt_u32 s61, 262144
  s_cbranch_scc1 L_N_again
L_N_done:
  s_waitcnt vmcnt(0) lgkmcnt(0)
  s_nop 15
  s_nop 3
  s_branch L_N_ok
L_A_spin:
  s_waitcnt vmcnt(0) lgkmcnt(0)
  s_nop 15
  s_nop 3
  s_mov_b32 s61, 0
L_A_again:
  s_mov_b32 s99, 851968
  buffer_load_dword v76, v81, s[28:31], s99 offen sc1
  s_waitcnt vmcnt(0) lgkmcnt(0)
  v_cmp_ne_u32 vcc, s59, v76
  s_nop 0
  s_cmp_eq_u64 vcc, 0
  s_cbranch_scc1 L_A_done
  s_add_u32 s61, s61, 1
  s_cmp_lt_u32 s61, 262144
  s_cbranch_scc1 L_A_again
L_A_done:
  s_waitcnt vmcnt(0) lgkmcnt(0)
  s_nop 15
  s_nop 3
  s_branch L_A_ok
L_B_spin:
  s_waitcnt vmcnt(0) lgkmcnt(0)
  s_nop 15
  s_nop 3
  s_mov_b32 s61, 0
L_B_again:
  s_mov_b32 s99, 884736
  buffer_load_dword v25, v26, s[28:31], s99 offen sc1
  s_waitcnt vmcnt(0) lgkmcnt(0)
  v_cmp_ne_u32 vcc, s59, v25
  s_nop 0
  s_cmp_eq_u64 vcc, 0
  s_cbranch_scc1 L_B_done
  s_add_u32 s61, s61, 1
  s_cmp_lt_u32 s61, 262144
  s_cbranch_scc1 L_B_again
L_B_done:
  s_waitcnt vmcnt(0) lgkmcnt(0)
  s_nop 15
  s_nop 3
  s_branch L_B_ok
L_C_spin:
  s_waitcnt vmcnt(0) lgkmcnt(0)
  s_nop 15
  s_nop 3
  s_mov_b32 s61, 0
L_C_again:
  s_mov_b32 s99, 917504
  buffer_load_dword v21, v22, s[28:31], s99 offen sc1
  s_waitcnt vmcnt(0) lgkmcnt(0)
  v_cmp_ne_u32 vcc, s59, v21
  s_nop 0
  s_cmp_eq_u64 vcc, 0
  s_cbranch_scc1 L_C_done
  s_add_u32 s61, s61, 1
  s_cmp_lt_u32 s61, 262144
  s_cbranch_scc1 L_C_again
L_C_done:
  s_waitcnt vmcnt(0) lgkmcnt(0)
  s_nop 15
  s_nop 3
  s_branch L_C_ok
L_slow:
  s_waitcnt vmcnt(0) lgkmcnt(0)
  s_nop 15
  s_nop 3
  v_mov_b32 v24, 0xff800000
  v_mov_b32 v25, 0xff800000
  s_mov_b32 s61, 0
L_slow1:
  s_waitcnt vmcnt(0) lgkmcnt(0)
  s_nop 15
  s_nop 3
  s_lshr_b32 s78, s61, 3
  s_mul_i32 s78, s78, 20480
  s_add_u32 s78, s78, 1048576
  s_and_b32 s79, s61, 7
  s_lshl_b32 s80, s79, 10
  s_add_u32 s80, s80, s78
  buffer_load_dwordx4 a[180:183], v4, s[28:31], s80 offen sc1
  s_lshr_b32 s80, s79, 1
  s_lshl_b32 s80, s80, 9
  s_and_b32 s81, s79, 1
  s_lshl_b32 s81, s81, 3
  s_add_u32 s80, s80, s81
  s_add_u32 s80, s80, s78
  buffer_load_dwordx2 a[188:189], v9, s[28:31], s80 offen sc1
  s_mul_i32 s80, s79, 1280
  s_add_u32 s80, s80, s78
  s_waitcnt vmcnt(0)
  v_mfma_f32_32x32x4_2b_bf16 v[48:79], a[188:189], v[44:45], 0
  s_nop 15
  s_nop 1
  v_mfma_f32_32x32x16_bf16 v[48:63], a[180:183], v[36:39], v[48:63]
  v_mfma_f32_32x32x16_bf16 v[64:79], a[180:183], v[40:43], v[64:79]
  s_nop 10
  v_max3_f32 v24, v24, v48, v49
  v_max3_f32 v24, v24, v50, v51
  v_max3_f32 v24, v24, v52, v53
  v_max3_f32 v24, v24, v54, v55
  v_max3_f32 v24, v24, v56, v57
  v_max3_f32 v24, v24, v58, v59
  v_max3_f32 v24, v24, v60, v61
  v_max3_f32 v24, v24, v62, v63
  v_max3_f32 v25, v25, v64, v65
  v_max3_f32 v25, v25, v66, v67
  v_max3_f32 v25, v25, v68, v69
  v_max3_f32 v25, v25, v70, v71
  v_max3_f32 v25, v25, v72, v73
  v_max3_f32 v25, v25, v74, v75
  v_max3_f32 v25, v25, v76, v77
  v_max3_f32 v25, v25, v78, v79
  s_add_u32 s61, s61, 1
  s_cmp_lt_u32 s61, 64
  s_cbranch_scc1 L_slow1
  s_waitcnt vmcnt(0) lgkmcnt(0)
  s_nop 15
  s_nop 3
  v_mov_b32 v26, v24
  s_nop 1
  v_permlane32_swap_b32 v24, v26
  v_max_f32 v24, v24, v26
  v_mov_b32 v26, v25
  s_nop 1
  v_permlane32_swap_b32 v25, v26
  v_max_f32 v25, v25, v26
  v_mov_b32 v112, 0
  v_mov_b32 v113, 0
  v_mov_b32 v114, 0
  v_mov_b32 v115, 0
  v_mov_b32 v116, 0
  v_mov_b32 v117, 0
  v_mov_b32 v118, 0
  v_mov_b32 v119, 0
  v_mov_b32 v120, 0
  v_mov_b32 v121, 0
  v_mov_b32 v122, 0
  v_mov_b32 v123, 0
  v_mov_b32 v124, 0
  v_mov_b32 v125, 0
  v_mov_b32 v126, 0
  v_mov_b32 v127, 0
  v_mov_b32 v128, 0
  v_mov_b32 v129, 0
  v_mov_b32 v130, 0
  v_mov_b32 v131, 0
  v_mov_b32 v132, 0
  v_mov_b32 v133, 0
  v_mov_b32 v134, 0
  v_mov_b32 v135, 0
  v_mov_b32 v136, 0
  v_mov_b32 v137, 0
  v_mov_b32 v138, 0
  v_mov_b32 v139, 0
  v_mov_b32 v140, 0
  v_mov_b32 v141, 0
  v_mov_b32 v142, 0
  v_mov_b32 v143, 0
  s_mov_b32 s61, 0
L_slow2:
  s_waitcnt vmcnt(0) lgkmcnt(0)
  s_nop 15
  s_nop 3
  s_lshr_b32 s78, s61, 3
  s_mul_i32 s78, s78, 20480
  s_add_u32 s78, s78, 1048576
  s_and_b32 s79, s61, 7
  s_lshl_b32 s80, s79, 10
  s_add_u32 s80, s80, s78
  buffer_load_dwordx4 a[180:183], v4, s[28:31], s80 offen sc1
  s_lshr_b32 s80, s79, 1
  s_lshl_b32 s80, s80, 9
  s_and_b32 s81, s79, 1
  s_lshl_b32 s81, s81, 3
  s_add_u32 s80, s80, s81
  s_add_u32 s80, s80, s78
  buffer_load_dwordx2 a[188:189], v9, s[28:31], s80 offen sc1
  s_mul_i32 s80, s79, 1280
  s_add_u32 s80, s80, s78
  buffer_load_dwordx4 a[212:215], v11, s[28:31], s80 offen sc1
  buffer_load_dwordx4 a[216:219], v11, s[28:31], s80 offen offset:640 sc1
  s_waitcnt vmcnt(2)
  v_mfma_f32_32x32x4_2b_bf16 v[48:79], a[188:189], v[44:45], 0
  s_nop 15
  s_nop 1
  v_mfma_f32_32x32x16_bf16 v[48:63], a[180:183], v[36:39], v[48:63]
  v_mfma_f32_32x32x16_bf16 v[64:79], a[180:183], v[40:43], v[64:79]
  s_nop 10
  v_sub_f32 v48, v48, v24
  v_sub_f32 v49, v49, v24
  v_sub_f32 v50, v50, v24
  v_sub_f32 v51, v51, v24
  v_sub_f32 v52, v52, v24
  v_sub_f32 v53, v53, v24
  v_sub_f32 v54, v54, v24
  v_sub_f32 v55, v55, v24
  v_sub_f32 v56, v56, v24
  v_sub_f32 v57, v57, v24
  v_sub_f32 v58, v58, v24
  v_sub_f32 v59, v59, v24
  v_sub_f32 v60, v60, v24
  v_sub_f32 v61, v61, v24
  v_sub_f32 v62, v62, v24
  v_sub_f32 v63, v63, v24
  v_sub_f32 v64, v64, v25
  v_sub_f32 v65, v65, v25
  v_sub_f32 v66, v66, v25
  v_sub_f32 v67, v67, v25
  v_sub_f32 v68, v68, v25
  v_sub_f32 v69, v69, v25
  v_sub_f32 v70, v70, v25
  v_sub_f32 v71, v71, v25
  v_sub_f32 v72, v72, v25
  v_sub_f32 v73, v73, v25
  v_sub_f32 v74, v74, v25
  v_sub_f32 v75, v75, v25
  v_sub_f32 v76, v76, v25
  v_sub_f32 v77, v77, v25
  v_sub_f32 v78, v78, v25
  v_sub_f32 v79, v79, v25
  v_exp_f32 v48, v48
  v_exp_f32 v49, v49
  v_exp_f32 v50, v50
  v_exp_f32 v51, v51
  v_exp_f32 v52, v52
  v_exp_f32 v53, v53
  v_exp_f32 v54, v54
  v_exp_f32 v55, v55
  v_exp_f32 v56, v56
  v_exp_f32 v57, v57
  v_exp_f32 v58, v58
  v_exp_f32 v59, v59
  v_exp_f32 v60, v60
  v_exp_f32 v61, v61
  v_exp_f32 v62, v62
  v_exp_f32 v63, v63
  v_exp_f32 v64, v64
  v_exp_f32 v65, v65
  v_exp_f32 v66, v66
  v_exp_f32 v67, v67
  v_exp_f32 v68, v68
  v_exp_f32 v69, v69
  v_exp_f32 v70, v70
  v_exp_f32 v71, v71
  v_exp_f32 v72, v72
  v_exp_f32 v73, v73
  v_exp_f32 v74, v74
  v_exp_f32 v75, v75
  v_exp_f32 v76, v76
  v_exp_f32 v77, v77
  v_exp_f32 v78, v78
  v_exp_f32 v79, v79
  s_waitcnt vmcnt(1)
  v_smfmac_f32_32x32x32_bf16 v[112:127], a[212:215], v[48:55], v14
  s_waitcnt vmcnt(0)
  v_smfmac_f32_32x32x32_bf16 v[112:127], a[216:219], v[56:63], v14
  v_smfmac_f32_32x32x32_bf16 v[128:143], a[212:215], v[64:71], v14
  v_smfmac_f32_32x32x32_bf16 v[128:143], a[216:219], v[72:79], v14
  s_add_u32 s61, s61, 1
  s_cmp_lt_u32 s61, 64
  s_cbranch_scc1 L_slow2
  s_waitcnt vmcnt(0) lgkmcnt(0)
  s_nop 15
  s_nop 3
  v_mov_b32 v22, v122
  v_mov_b32 v23, v138
  s_nop 0
  v_permlane32_swap_b32 v22, v122
  v_permlane32_swap_b32 v23, v138
  v_mov_b32 v48, -1
  v_mov_b32 v64, -1
  s_add_u32 s78, s43, 36864
  v_mul_f32 v22, v22, v18
  v_rcp_f32 v22, v22
  s_nop 0
  v_mul_f32 v112, v112, v22
  v_mul_f32 v113, v113, v22
  v_mul_f32 v114, v114, v22
  v_mul_f32 v115, v115, v22
  v_mul_f32 v116, v116, v22
  v_mul_f32 v117, v117, v22
  v_mul_f32 v118, v118, v22
  v_mul_f32 v119, v119, v22
  v_mul_f32 v120, v120, v22
  v_mul_f32 v121, v121, v22
  v_cvt_pk_bf16_f32 v112, v112, v113
  v_cvt_pk_bf16_f32 v113, v114, v115
  v_cvt_pk_bf16_f32 v114, v116, v117
  v_cvt_pk_bf16_f32 v115, v118, v119
  v_cvt_pk_bf16_f32 v116, v120, v121
  s_waitcnt vmcnt(0) lgkmcnt(0)
  s_nop 15
  s_nop 3
  s_branch L_slow_back
L_O0_spin:
  s_waitcnt vmcnt(0) lgkmcnt(0)
  s_nop 1
  s_mov_b32 s61, 0
L_O0_again:
  buffer_load_dwordx4 v[48:51], v4, s[28:31], s51 offen offset:0 sc1
  buffer_load_dwordx4 v[52:55], v4, s[28:31], s51 offen offset:1024 sc1
  buffer_load_dwordx4 v[56:59], v4, s[28:31], s51 offen offset:2048 sc1
  buffer_load_dwordx4 v[60:63], v4, s[28:31], s51 offen offset:3072 sc1
  buffer_load_dword v80, v21, s[28:31], s50 offen offset:0 sc1
  buffer_load_dword v81, v21, s[28:31], s50 offen offset:128 sc1
  buffer_load_dword v82, v21, s[28:31], s50 offen offset:256 sc1
  buffer_load_dword v83, v21, s[28:31], s50 offen offset:384 sc1
  s_waitcnt vmcnt(0) lgkmcnt(0)
  v_max3_u32 v26, v48, v49, v50
  v_max3_u32 v27, v51, v52, v53
  v_max3_u32 v27, v27, v54, v55
  v_max3_u32 v26, v26, v56, v57
  v_max3_u32 v27, v27, v58, v59
  v_max3_u32 v26, v26, v60, v61
  v_max3_u32 v27, v27, v62, v63
  v_max_u32 v26, v26, v27
  v_cmp_eq_u32 vcc, -1, v26
  s_nop 0
  s_cmp_eq_u64 vcc, 0
  s_cbranch_scc1 L_O0_done
  s_add_u32 s61, s61, 1
  s_cmp_lt_u32 s61, 262144
  s_cbranch_scc1 L_O0_again
L_O0_done:
  s_waitcnt vmcnt(0) lgkmcnt(0)
  s_nop 1
  s_branch L_O0_ok
L_O3_spin:
  s_waitcnt vmcnt(0) lgkmcnt(0)
  s_nop 1
  s_mov_b32 s61, 0
L_O3_again:
  buffer_load_dwordx4 v[64:67], v4, s[28:31], s79 offen offset:0 sc1
  buffer_load_dwordx4 v[68:71], v4, s[28:31], s79 offen offset:1024 sc1
  buffer_load_dwordx4 v[72:75], v4, s[28:31], s79 offen offset:2048 sc1
  buffer_load_dwordx4 v[76:79], v4, s[28:31], s79 offen offset:3072 sc1
  buffer_load_dword v80, v21, s[28:31], s50 offen offset:0 sc1
  buffer_load_dword v81, v21, s[28:31], s50 offen offset:128 sc1
  buffer_load_dword v82, v21, s[28:31], s50 offen offset:256 sc1
  buffer_load_dword v83, v21, s[28:31], s50 offen offset:384 sc1
  s_waitcnt vmcnt(0) lgkmcnt(0)
  v_max3_u32 v26, v64, v65, v66
  v_max3_u32 v27, v67, v68, v69
  v_max3_u32 v27, v27, v70, v71
  v_max3_u32 v26, v26, v72, v73
  v_max3_u32 v27, v27, v74, v75
  v_max3_u32 v26, v26, v76, v77
  v_max3_u32 v27, v27, v78, v79
  v_max3_u32 v26, v26, v80, v81
  v_max3_u32 v27, v27, v82, v83
  v_max_u32 v26, v26, v27
  v_cmp_eq_u32 vcc, -1, v26
  s_nop 0
  s_cmp_eq_u64 vcc, 0
  s_cbranch_scc1 L_O3_done
  s_add_u32 s61, s61, 1
  s_cmp_lt_u32 s61, 262144
  s_cbranch_scc1 L_O3_again
L_O3_done:
  s_waitcnt vmcnt(0) lgkmcnt(0)
  s_nop 1
  s_branch L_O3_ok
L_codeend:
.section .rodata,"a"
.p2align 6
.amdhsa_kernel parallel_sum__grouped_kv_mqa__glu_gated_bilinear__prompt_kernel
  .amdhsa_next_free_vgpr 512
  .amdhsa_next_free_sgpr 102
  .amdhsa_accum_offset 256
  .amdhsa_group_segment_fixed_size 0
  .amdhsa_kernarg_size 96
  .amdhsa_user_sgpr_count 2
  .amdhsa_user_sgpr_kernarg_segment_ptr 1
  .amdhsa_system_sgpr_workgroup_id_x 1
  .amdhsa_float_denorm_mode_32 3
.end_amdhsa_kernel
```
